```python
import torch

def _softmax(x, axis=-1):
    return torch.softmax(x, dim=axis)
def _gelu(x):
    return torch.nn.functional.gelu(x, approximate="tanh")
def _silu(x):
    return torch.nn.functional.silu(x)
def _sigmoid(x):
    return torch.sigmoid(x)
def _layernorm(x, axis=-1, eps=1e-5):
    m = x.mean(dim=axis, keepdim=True)
    v = x.var(dim=axis, keepdim=True, unbiased=False)
    return (x - m) / torch.sqrt(v + eps)
def _scatter_add(tgt, idx, src, axis=0):
    return tgt.clone().index_add_(axis, idx, src)
def _segment_sum(src, seg, n):
    out = torch.zeros((n,) + src.shape[1:], dtype=src.dtype)
    return out.index_add_(0, seg, src)
def _pad(x, pw):
    flat = tuple(v for pair in reversed(pw) for v in pair)
    return torch.nn.functional.pad(x, flat)

kernel_name = 'recurrent_scan__gqa_block_cached__dense_activation_gelu__prompt'

def setup_inputs():

    _w = (lambda a: (lambda t: t.to(torch.bfloat16) if t.is_floating_point() else t)(torch.as_tensor(a)))
    def _A_setup():
        B, Sq, D = 1, 2048, 512
        Hq, Hkv, Sk, Dh = 32, 8, 2048, 128
        assert Hq % Hkv == 0, (Hq, Hkv)
        return {
            "x": _w((lambda *s: torch.randn(*s, dtype=torch.bfloat16) * 0.1)(B, Sq, D)),
            "k_cache": _w((lambda *s: torch.randn(*s, dtype=torch.bfloat16) * 0.8)(B, Hkv, Sk, Dh)),
            "v_cache": _w((lambda *s: torch.randn(*s, dtype=torch.bfloat16) * 3.2)(B, Hkv, Sk, Dh)),
            "wq": _w((lambda *s: torch.randn(*s, dtype=torch.bfloat16) * 0.8)(D, Hq * Dh) * (D ** -0.5)),
            "wo": _w((lambda *s: torch.randn(*s, dtype=torch.bfloat16) * 3.2)(Hq * Dh, D) * ((Hq * Dh) ** -0.5)),
        }
    _A_in = _A_setup()

    def _B_setup():
        B, S, D, F = 1, 2048, 512, 1792
        return {
            "x": _w((lambda *s: torch.randn(*s, dtype=torch.bfloat16) * 0.1)(B, S, D)),
            "w1": _w((lambda *s: torch.randn(*s, dtype=torch.bfloat16) * 3.2)(D, F) * (D ** -0.5)),
            "b1": _w((lambda *s: torch.randn(*s, dtype=torch.bfloat16) * 3.2)(F) * 0.01),
            "w2": _w((lambda *s: torch.randn(*s, dtype=torch.bfloat16) * 3.2)(F, D) * (F ** -0.5)),
            "b2": _w((lambda *s: torch.randn(*s, dtype=torch.bfloat16) * 3.2)(D) * 0.01),
        }
    _B_in = _B_setup()

    return {
        "A_x": _A_in["x"],
        "A_k_cache": _A_in["k_cache"],
        "A_v_cache": _A_in["v_cache"],
        "A_wq": _A_in["wq"],
        "A_wo": _A_in["wo"],
        "B_x": _B_in["x"],
        "B_w1": _B_in["w1"],
        "B_b1": _B_in["b1"],
        "B_w2": _B_in["w2"],
        "B_b2": _B_in["b2"],
    }

def reference(A_x, A_k_cache, A_v_cache, A_wq, A_wo, B_x, B_w1, B_b1, B_w2, B_b2):
    def _A_ref(x, k_cache, v_cache, wq, wo):
        B, Sq, D = x.shape
        Hq, Dh = 32, 128
        Hkv = k_cache.shape[1]
        rep = Hq // Hkv
        q = (lambda x, *d: x.permute(*d))((x @ wq).reshape(B, Sq, Hq, Dh), 0, 2, 1, 3)
        k = (lambda x, n, axis: torch.repeat_interleave(x, n, dim=axis))(k_cache, rep, axis=1)
        v = (lambda x, n, axis: torch.repeat_interleave(x, n, dim=axis))(v_cache, rep, axis=1)
        scores = torch.einsum("bhqd,bhkd->bhqk", q, k) * (Dh ** -0.5)
        p = _softmax(scores, axis=-1)
        o = torch.einsum("bhqk,bhkd->bhqd", p, v)
        return (lambda x, *d: x.permute(*d))(o, 0, 2, 1, 3).reshape(B, Sq, Hq * Dh) @ wo

    def _B_ref(x, w1, b1, w2, b2):
        h = torch.einsum("bsd,df->bsf", x, w1) + b1
        h = _gelu(h)
        return torch.einsum("bsf,fd->bsd", h, w2) + b2

    x = A_x
    xn = _layernorm(x, axis=-1)
    s = _A_ref(xn, A_k_cache, A_v_cache, A_wq, A_wo)
    g = _silu(_B_ref(xn, B_w1, B_b1, B_w2, B_b2))
    return x + s * g
```

```asm
; @launch grid=(256,1,1) block=(256,1,1) lds=163840
.amdgcn_target "amdgcn-amd-amdhsa--gfx950"
.text
.p2align 12
.globl recurrent_scan__gqa_block_cached__dense_activation_gelu__prompt_kernel
.p2align 8
.type recurrent_scan__gqa_block_cached__dense_activation_gelu__prompt_kernel,@function
recurrent_scan__gqa_block_cached__dense_activation_gelu__prompt_kernel:
L_codebeg:
  s_cmp_ge_u32 s2, 0x100
  s_cbranch_scc1 L_end
  s_load_dwordx2 s[32:33], s[0:1], 0x0
  s_load_dwordx2 s[48:49], s[0:1], 0x30
  s_lshr_b32 s31, s2, 3
  s_and_b32 s30, s2, 7
  s_getpc_b64 s[100:101]
  s_mul_i32 s68, s31, 3
  s_lshl_b32 s68, s68, 10
  s_min_u32 s68, s68, L_codeend-L_codebeg-3328
  v_mad_u32_u24 v236, v0, 12, s68
  global_load_dword a79, v236, s[100:101]
  v_lshrrev_b32 v237, 2, v0
  v_and_b32 v231, 3, v0
  v_lshlrev_b32 v235, 10, v237
  v_lshl_add_u32 v235, v231, 4, v235
  s_lshl_b32 s90, s31, 16
  s_mov_b32 s34, 0x200000
  s_mov_b32 s35, 0x20000
  s_mov_b32 s50, 0x1c0000
  s_mov_b32 s51, s35
  v_lshrrev_b32 v238, 4, v0
  v_mul_u32_u24 v238, 0xc00, v238
  v_lshl_add_u32 v238, v0, 5, v238
  s_lshl_b32 s70, s31, 7
  s_add_u32 s70, s70, s30
  s_mul_i32 s70, s70, 7
  s_and_b32 s75, s30, 1
  s_add_u32 s70, s70, s75
  s_lshl_b32 s70, s70, 6
  s_waitcnt lgkmcnt(0)
  buffer_load_dword a72, v238, s[48:51], s70 offen
  buffer_load_dwordx4 v[32:35], v235, s[32:35], s90 offen
  buffer_load_dwordx4 v[36:39], v235, s[32:35], s90 offen offset:64
  buffer_load_dwordx4 v[40:43], v235, s[32:35], s90 offen offset:128
  buffer_load_dwordx4 v[44:47], v235, s[32:35], s90 offen offset:192
  buffer_load_dwordx4 v[48:51], v235, s[32:35], s90 offen offset:256
  buffer_load_dwordx4 v[52:55], v235, s[32:35], s90 offen offset:320
  buffer_load_dwordx4 v[56:59], v235, s[32:35], s90 offen offset:384
  buffer_load_dwordx4 v[60:63], v235, s[32:35], s90 offen offset:448
  buffer_load_dwordx4 v[64:67], v235, s[32:35], s90 offen offset:512
  buffer_load_dwordx4 v[68:71], v235, s[32:35], s90 offen offset:576
  s_load_dwordx16 s[4:19], s[0:1], 0x0
  s_load_dwordx8 s[20:27], s[0:1], 0x40
  s_load_dwordx2 s[28:29], s[0:1], 0x60
  v_lshrrev_b32 v236, 6, v0
  v_and_b32 v232, 63, v0
  v_readfirstlane_b32 s3, v236
  v_and_b32 v233, 15, v232
  v_lshrrev_b32 v234, 4, v232
  v_lshlrev_b32 v1, 4, v232
  v_lshrrev_b32 v230, 2, v232
  s_mul_i32 s76, s30, 7
  s_add_u32 s76, s76, s75
  s_lshl_b32 s76, s76, 6
  v_lshrrev_b32 v228, 3, v232
  v_and_b32 v236, 7, v232
  v_lshlrev_b32 v237, 1, v234
  v_xor_b32 v229, v236, v237
  v_lshlrev_b32 v229, 4, v229
  v_xor_b32 v236, v237, v232
  v_lshlrev_b32 v247, 4, v236
  v_and_b32 v236, 4, v228
  v_add_u32 v225, v236, v228
  s_mul_i32 s72, s3, 0x6000
  s_add_u32 s72, s72, 0x10000
  v_lshlrev_b32 v226, 7, v230
  v_lshl_add_u32 v226, v231, 3, v226
  v_add_u32 v226, s72, v226
  v_and_b32 v227, 3, v228
  v_lshl_add_u32 v2, v227, 5, v226
  v_xor_b32 v3, 32, v2
  v_xor_b32 v4, 64, v2
  v_xor_b32 v5, 0x60, v2
  s_lshl_b32 s69, s30, 10
  s_lshl_b32 s70, s3, 8
  s_add_u32 s69, s69, s70
  v_lshlrev_b32 v236, 13, v225
  v_add3_u32 v10, v236, v229, s69
  v_add_u32 v11, 0x1fc00, v10
  v_add_u32 v12, 0x7800, v10
  v_add_u32 v13, 0x27400, v10
  v_lshlrev_b32 v236, 10, v228
  v_add3_u32 v28, v236, v229, s70
  v_add_u32 v29, 0x1c00, v28
  v_add_u32 v30, 0x3800, v28
  v_add_u32 v31, 0x5400, v28
  s_lshl_b32 s88, s76, 9
  s_lshl_b32 s89, s30, 19
  s_lshl_b32 s85, s3, 12
  s_add_u32 s68, s89, s85
  s_lshl_b32 s69, s3, 2
  v_add_u32 v236, s69, v234
  v_xor_b32 v236, v236, v233
  v_lshl_add_u32 v237, v234, 8, s68
  v_lshl_add_u32 v26, v236, 4, v237
  s_and_b32 s69, s69, 4
  v_add_lshl_u32 v236, s69, v234, 1
  v_xor_b32 v236, v236, v233
  v_lshl_add_u32 v27, v236, 4, v237
  v_lshrrev_b32 v236, 2, v233
  v_lshlrev_b32 v237, 12, v236
  v_lshl_add_u32 v237, v231, 8, v237
  v_lshrrev_b32 v239, 1, v234
  v_and_b32 v227, 1, v234
  v_lshl_add_u32 v239, v227, 1, v239
  v_xor_b32 v239, v239, v233
  v_lshl_add_u32 v14, v239, 4, v237
  v_xor_b32 v15, 64, v14
  v_xor_b32 v16, 0x80, v14
  v_xor_b32 v17, 0xc0, v14
  v_lshl_add_u32 v237, v234, 4, v236
  v_lshlrev_b32 v237, 8, v237
  v_lshl_add_u32 v237, v231, 3, v237
  v_lshl_add_u32 v239, v227, 2, v236
  v_and_b32 v238, 1, v231
  v_xor_b32 v239, v239, v238
  v_lshl_add_u32 v18, v239, 5, v237
  v_xor_b32 v19, 32, v18
  v_xor_b32 v20, 64, v18
  v_xor_b32 v21, 0x60, v18
  v_xor_b32 v22, 0x80, v18
  v_xor_b32 v23, 0xa0, v18
  v_xor_b32 v24, 0xc0, v18
  v_xor_b32 v25, 0xe0, v18
  v_lshlrev_b32 v236, 1, v231
  v_xor_b32 v236, v236, v230
  v_lshl_add_u32 v236, v231, 4, v236
  s_lshl_b32 s68, s3, 10
  v_lshl_add_u32 v246, v236, 4, s68
  s_waitcnt lgkmcnt(0)
  s_mov_b32 s44, s10
  s_mov_b32 s45, s11
  s_mov_b32 s46, 0x400000
  s_mov_b32 s47, 0x20000
  s_mov_b32 s64, s18
  s_mov_b32 s65, s19
  s_mov_b32 s66, 0xe00
  s_mov_b32 s67, 0x20000
  s_mov_b32 s36, s6
  s_mov_b32 s37, s7
  s_mov_b32 s38, 0x400000
  s_mov_b32 s39, 0x20000
  s_mov_b32 s40, s8
  s_mov_b32 s41, s9
  s_mov_b32 s42, 0x400000
  s_mov_b32 s43, 0x20000
  s_mov_b32 s52, s20
  s_mov_b32 s53, s21
  s_mov_b32 s54, 0x1c0000
  s_mov_b32 s55, 0x20000
  s_mov_b32 s56, s12
  s_mov_b32 s57, s13
  s_mov_b32 s58, 0x400000
  s_mov_b32 s59, 0x20000
  s_mov_b32 s60, s28
  s_mov_b32 s61, s29
  s_mov_b32 s62, 0x10000000
  s_mov_b32 s63, 0x20000
  s_mov_b32 s80, 0xc2469614
  s_mov_b32 s81, 0x3e0293ee
  s_mov_b32 s15, 0x3f8293ee
  s_lshl_b32 s68, s31, 17
  s_lshr_b32 s69, s31, 4
  s_lshl_b32 s69, s69, 16
  s_add_u32 s68, s68, s69
  s_lshl_b32 s69, s3, 14
  s_add_u32 s68, s68, s69
  s_xor_b32 s70, s30, 7
  s_lshl_b32 s69, s70, 22
  s_add_u32 s82, s68, s69
  s_lshl_b32 s69, s70, 10
  s_add_u32 s21, s68, s69
  s_lshl_b32 s94, s31, 14
  s_sub_u32 s94, s94, 0x4000
  s_mov_b32 s83, s94
  s_mov_b32 s84, s94
  s_mov_b32 s87, 0
  s_mov_b32 s92, 0x3f80
  s_mov_b32 s93, 0x3f800000
  s_mul_i32 s14, s31, 16
  s_lshr_b32 s14, s14, 5
  s_sub_u32 s69, 4, s75
  s_mul_i32 s69, s69, s3
  s_lshl_b32 s69, s69, 5
  s_add_u32 s76, s76, s69
  v_lshlrev_b32 v239, 3, v234
  buffer_load_dwordx2 a[64:65], v239, s[64:67], s76 offen
  buffer_load_dwordx2 a[66:67], v239, s[64:67], s76 offen offset:32
  buffer_load_dwordx2 a[68:69], v239, s[64:67], s76 offen offset:64
  buffer_load_dwordx2 a[70:71], v239, s[64:67], s76 offen offset:96
  s_lshl_b32 s68, s75, 2
  s_add_u32 s68, s68, s3
  s_mov_b32 s95, 1
  s_cmp_eq_u32 s68, 0
  s_cbranch_scc1 L_w0
  s_cmp_eq_u32 s68, 1
  s_cbranch_scc1 L_w1
  s_cmp_eq_u32 s68, 2
  s_cbranch_scc1 L_w2
  s_cmp_eq_u32 s68, 3
  s_cbranch_scc1 L_w3
  s_cmp_eq_u32 s68, 4
  s_cbranch_scc1 L_w4
  s_cmp_eq_u32 s68, 5
  s_cbranch_scc1 L_w5
  s_cmp_eq_u32 s68, 6
  s_cbranch_scc1 L_w6
  s_branch L_w7
L_wback:
  s_mov_b32 s95, 0
  buffer_load_dwordx4 v[72:75], v235, s[32:35], s90 offen offset:640
  buffer_load_dwordx4 v[76:79], v235, s[32:35], s90 offen offset:704
  buffer_load_dwordx4 v[80:83], v235, s[32:35], s90 offen offset:768
  buffer_load_dwordx4 v[84:87], v235, s[32:35], s90 offen offset:832
  buffer_load_dwordx4 v[88:91], v235, s[32:35], s90 offen offset:896
  buffer_load_dwordx4 v[92:95], v235, s[32:35], s90 offen offset:960
  s_cmp_eq_u32 s75, 0
  s_cbranch_scc1 L_wide
  s_branch L_narrow
.p2align 12
L_narrow:
L_w7:
L_p220:
  s_cmp_eq_u32 s95, 1
  s_cbranch_scc1 L_p2352
  v_add_u32 v236, 0, v232
  v_mul_u32_u24 v237, 0xab, v236
  v_lshrrev_b32 v237, 10, v237
  v_mul_u32_u24 v238, 6, v237
  v_sub_u32 v236, v236, v238
  v_and_b32 v238, 12, v237
  v_and_b32 v239, 15, v237
  v_add_u32 v238, v238, v239
  v_lshrrev_b32 v237, 4, v237
  v_lshl_add_u32 v238, v237, 2, v238
  v_mul_u32_u24 v238, 0xe00, v238
  v_lshl_add_u32 v236, v236, 4, s76
  v_add_u32 v6, v236, v238
  v_add_u32 v236, 64, v232
  v_mul_u32_u24 v237, 0xab, v236
  v_lshrrev_b32 v237, 10, v237
  v_mul_u32_u24 v238, 6, v237
  v_sub_u32 v236, v236, v238
  v_and_b32 v238, 12, v237
  v_and_b32 v239, 15, v237
  v_add_u32 v238, v238, v239
  v_lshrrev_b32 v237, 4, v237
  v_lshl_add_u32 v238, v237, 2, v238
  v_mul_u32_u24 v238, 0xe00, v238
  v_lshl_add_u32 v236, v236, 4, s76
  v_subrev_u32 v238, 0x400, v238
  v_add_u32 v7, v236, v238
  v_add_u32 v236, 0x80, v232
  v_mul_u32_u24 v237, 0xab, v236
  v_lshrrev_b32 v237, 10, v237
  v_mul_u32_u24 v238, 6, v237
  v_sub_u32 v236, v236, v238
  v_and_b32 v238, 12, v237
  v_and_b32 v239, 15, v237
  v_add_u32 v238, v238, v239
  v_lshrrev_b32 v237, 4, v237
  v_lshl_add_u32 v238, v237, 2, v238
  v_mul_u32_u24 v238, 0xe00, v238
  v_lshl_add_u32 v236, v236, 4, s76
  v_subrev_u32 v238, 0x800, v238
  v_add_u32 v8, v236, v238
  v_mul_u32_u24 v236, 0x60, v230
  v_lshl_add_u32 v236, v231, 3, v236
  v_add_u32 v240, s72, v236
  s_waitcnt vmcnt(19)
  v_lshlrev_b32 v245, 16, v32
  v_xor_b32 v245, 0x80000000, v245
  s_nop 1
  v_mov_b32_dpp v245, v245 quad_perm:[0,0,0,0] row_mask:0xf bank_mask:0xf
  v_dot2_f32_bf16 v96, v32, s92, v245
  v_dot2_f32_bf16 v97, v32, s93, v245
  v_dot2_f32_bf16 v98, v33, s92, v245
  v_dot2_f32_bf16 v99, v33, s93, v245
  v_dot2_f32_bf16 v100, v34, s92, v245
  v_dot2_f32_bf16 v101, v34, s93, v245
  v_dot2_f32_bf16 v102, v35, s92, v245
  v_dot2_f32_bf16 v103, v35, s93, v245
  v_pk_mul_f32 v[252:253], v[96:97], v[96:97]
  v_pk_mul_f32 v[254:255], v[98:99], v[98:99]
  v_pk_fma_f32 v[252:253], v[100:101], v[100:101], v[252:253]
  v_pk_fma_f32 v[254:255], v[102:103], v[102:103], v[254:255]
  v_pk_add_f32 v[248:249], v[100:101], v[96:97]
  v_pk_add_f32 v[250:251], v[102:103], v[98:99]
  s_waitcnt vmcnt(18)
  v_dot2_f32_bf16 v104, v36, s92, v245
  v_dot2_f32_bf16 v105, v36, s93, v245
  v_dot2_f32_bf16 v106, v37, s92, v245
  v_dot2_f32_bf16 v107, v37, s93, v245
  v_dot2_f32_bf16 v108, v38, s92, v245
  v_dot2_f32_bf16 v109, v38, s93, v245
  v_dot2_f32_bf16 v110, v39, s92, v245
  v_dot2_f32_bf16 v111, v39, s93, v245
  v_pk_fma_f32 v[252:253], v[104:105], v[104:105], v[252:253]
  v_pk_fma_f32 v[254:255], v[106:107], v[106:107], v[254:255]
  v_pk_fma_f32 v[252:253], v[108:109], v[108:109], v[252:253]
  v_pk_fma_f32 v[254:255], v[110:111], v[110:111], v[254:255]
  v_pk_add_f32 v[248:249], v[104:105], v[248:249]
  v_pk_add_f32 v[250:251], v[106:107], v[250:251]
  v_pk_add_f32 v[248:249], v[108:109], v[248:249]
  v_pk_add_f32 v[250:251], v[110:111], v[250:251]
  s_waitcnt vmcnt(17)
  v_dot2_f32_bf16 v112, v40, s92, v245
  v_dot2_f32_bf16 v113, v40, s93, v245
  v_dot2_f32_bf16 v114, v41, s92, v245
  v_dot2_f32_bf16 v115, v41, s93, v245
  v_dot2_f32_bf16 v116, v42, s92, v245
  v_dot2_f32_bf16 v117, v42, s93, v245
  v_dot2_f32_bf16 v118, v43, s92, v245
  v_dot2_f32_bf16 v119, v43, s93, v245
  v_pk_fma_f32 v[252:253], v[112:113], v[112:113], v[252:253]
  v_pk_fma_f32 v[254:255], v[114:115], v[114:115], v[254:255]
  v_pk_fma_f32 v[252:253], v[116:117], v[116:117], v[252:253]
  v_pk_fma_f32 v[254:255], v[118:119], v[118:119], v[254:255]
  v_pk_add_f32 v[248:249], v[112:113], v[248:249]
  v_pk_add_f32 v[250:251], v[114:115], v[250:251]
  v_pk_add_f32 v[248:249], v[116:117], v[248:249]
  v_pk_add_f32 v[250:251], v[118:119], v[250:251]
  s_waitcnt vmcnt(16)
  v_dot2_f32_bf16 v120, v44, s92, v245
  v_dot2_f32_bf16 v121, v44, s93, v245
  v_dot2_f32_bf16 v122, v45, s92, v245
  v_dot2_f32_bf16 v123, v45, s93, v245
  v_dot2_f32_bf16 v124, v46, s92, v245
  v_dot2_f32_bf16 v125, v46, s93, v245
  v_dot2_f32_bf16 v126, v47, s92, v245
  v_dot2_f32_bf16 v127, v47, s93, v245
  v_pk_fma_f32 v[252:253], v[120:121], v[120:121], v[252:253]
  v_pk_fma_f32 v[254:255], v[122:123], v[122:123], v[254:255]
  v_pk_fma_f32 v[252:253], v[124:125], v[124:125], v[252:253]
  v_pk_fma_f32 v[254:255], v[126:127], v[126:127], v[254:255]
  v_pk_add_f32 v[248:249], v[120:121], v[248:249]
  v_pk_add_f32 v[250:251], v[122:123], v[250:251]
  v_pk_add_f32 v[248:249], v[124:125], v[248:249]
  v_pk_add_f32 v[250:251], v[126:127], v[250:251]
  s_waitcnt vmcnt(15)
  v_dot2_f32_bf16 v128, v48, s92, v245
  v_dot2_f32_bf16 v129, v48, s93, v245
  v_dot2_f32_bf16 v130, v49, s92, v245
  v_dot2_f32_bf16 v131, v49, s93, v245
  v_dot2_f32_bf16 v132, v50, s92, v245
  v_dot2_f32_bf16 v133, v50, s93, v245
  v_dot2_f32_bf16 v134, v51, s92, v245
  v_dot2_f32_bf16 v135, v51, s93, v245
  v_pk_fma_f32 v[252:253], v[128:129], v[128:129], v[252:253]
  v_pk_fma_f32 v[254:255], v[130:131], v[130:131], v[254:255]
  v_pk_fma_f32 v[252:253], v[132:133], v[132:133], v[252:253]
  v_pk_fma_f32 v[254:255], v[134:135], v[134:135], v[254:255]
  v_pk_add_f32 v[248:249], v[128:129], v[248:249]
  v_pk_add_f32 v[250:251], v[130:131], v[250:251]
  v_pk_add_f32 v[248:249], v[132:133], v[248:249]
  v_pk_add_f32 v[250:251], v[134:135], v[250:251]
  s_waitcnt vmcnt(14)
  v_dot2_f32_bf16 v136, v52, s92, v245
  v_dot2_f32_bf16 v137, v52, s93, v245
  v_dot2_f32_bf16 v138, v53, s92, v245
  v_dot2_f32_bf16 v139, v53, s93, v245
  v_dot2_f32_bf16 v140, v54, s92, v245
  v_dot2_f32_bf16 v141, v54, s93, v245
  v_dot2_f32_bf16 v142, v55, s92, v245
  v_dot2_f32_bf16 v143, v55, s93, v245
  v_pk_fma_f32 v[252:253], v[136:137], v[136:137], v[252:253]
  v_pk_fma_f32 v[254:255], v[138:139], v[138:139], v[254:255]
  v_pk_fma_f32 v[252:253], v[140:141], v[140:141], v[252:253]
  v_pk_fma_f32 v[254:255], v[142:143], v[142:143], v[254:255]
  v_pk_add_f32 v[248:249], v[136:137], v[248:249]
  v_pk_add_f32 v[250:251], v[138:139], v[250:251]
  v_pk_add_f32 v[248:249], v[140:141], v[248:249]
  v_pk_add_f32 v[250:251], v[142:143], v[250:251]
  s_waitcnt vmcnt(13)
  v_dot2_f32_bf16 v144, v56, s92, v245
  v_dot2_f32_bf16 v145, v56, s93, v245
  v_dot2_f32_bf16 v146, v57, s92, v245
  v_dot2_f32_bf16 v147, v57, s93, v245
  v_dot2_f32_bf16 v148, v58, s92, v245
  v_dot2_f32_bf16 v149, v58, s93, v245
  v_dot2_f32_bf16 v150, v59, s92, v245
  v_dot2_f32_bf16 v151, v59, s93, v245
  v_pk_fma_f32 v[252:253], v[144:145], v[144:145], v[252:253]
  v_pk_fma_f32 v[254:255], v[146:147], v[146:147], v[254:255]
  v_pk_fma_f32 v[252:253], v[148:149], v[148:149], v[252:253]
  v_pk_fma_f32 v[254:255], v[150:151], v[150:151], v[254:255]
  v_pk_add_f32 v[248:249], v[144:145], v[248:249]
  v_pk_add_f32 v[250:251], v[146:147], v[250:251]
  v_pk_add_f32 v[248:249], v[148:149], v[248:249]
  v_pk_add_f32 v[250:251], v[150:151], v[250:251]
  s_mov_b32 s73, 0
  s_add_u32 m0, s72, 0
  s_nop 0
  buffer_load_dwordx4 v6, s[48:51], s73 offen lds
  s_waitcnt vmcnt(13)
  v_dot2_f32_bf16 v152, v60, s92, v245
  v_dot2_f32_bf16 v153, v60, s93, v245
  v_dot2_f32_bf16 v154, v61, s92, v245
  v_dot2_f32_bf16 v155, v61, s93, v245
  v_dot2_f32_bf16 v156, v62, s92, v245
  v_dot2_f32_bf16 v157, v62, s93, v245
  v_dot2_f32_bf16 v158, v63, s92, v245
  v_dot2_f32_bf16 v159, v63, s93, v245
  v_pk_fma_f32 v[252:253], v[152:153], v[152:153], v[252:253]
  v_pk_fma_f32 v[254:255], v[154:155], v[154:155], v[254:255]
  v_pk_fma_f32 v[252:253], v[156:157], v[156:157], v[252:253]
  v_pk_fma_f32 v[254:255], v[158:159], v[158:159], v[254:255]
  v_pk_add_f32 v[248:249], v[152:153], v[248:249]
  v_pk_add_f32 v[250:251], v[154:155], v[250:251]
  v_pk_add_f32 v[248:249], v[156:157], v[248:249]
  v_pk_add_f32 v[250:251], v[158:159], v[250:251]
  buffer_load_dwordx4 v7, s[48:51], s73 offen offset:1024 lds
  s_waitcnt vmcnt(13)
  v_dot2_f32_bf16 v160, v64, s92, v245
  v_dot2_f32_bf16 v161, v64, s93, v245
  v_dot2_f32_bf16 v162, v65, s92, v245
  v_dot2_f32_bf16 v163, v65, s93, v245
  v_dot2_f32_bf16 v164, v66, s92, v245
  v_dot2_f32_bf16 v165, v66, s93, v245
  v_dot2_f32_bf16 v166, v67, s92, v245
  v_dot2_f32_bf16 v167, v67, s93, v245
  v_pk_fma_f32 v[252:253], v[160:161], v[160:161], v[252:253]
  v_pk_fma_f32 v[254:255], v[162:163], v[162:163], v[254:255]
  v_pk_fma_f32 v[252:253], v[164:165], v[164:165], v[252:253]
  v_pk_fma_f32 v[254:255], v[166:167], v[166:167], v[254:255]
  v_pk_add_f32 v[248:249], v[160:161], v[248:249]
  v_pk_add_f32 v[250:251], v[162:163], v[250:251]
  v_pk_add_f32 v[248:249], v[164:165], v[248:249]
  v_pk_add_f32 v[250:251], v[166:167], v[250:251]
  buffer_load_dwordx4 v8, s[48:51], s73 offen offset:2048 lds
  s_waitcnt vmcnt(13)
  v_dot2_f32_bf16 v168, v68, s92, v245
  v_dot2_f32_bf16 v169, v68, s93, v245
  v_dot2_f32_bf16 v170, v69, s92, v245
  v_dot2_f32_bf16 v171, v69, s93, v245
  v_dot2_f32_bf16 v172, v70, s92, v245
  v_dot2_f32_bf16 v173, v70, s93, v245
  v_dot2_f32_bf16 v174, v71, s92, v245
  v_dot2_f32_bf16 v175, v71, s93, v245
  v_pk_fma_f32 v[252:253], v[168:169], v[168:169], v[252:253]
  v_pk_fma_f32 v[254:255], v[170:171], v[170:171], v[254:255]
  v_pk_fma_f32 v[252:253], v[172:173], v[172:173], v[252:253]
  v_pk_fma_f32 v[254:255], v[174:175], v[174:175], v[254:255]
  v_pk_add_f32 v[248:249], v[168:169], v[248:249]
  v_pk_add_f32 v[250:251], v[170:171], v[250:251]
  v_pk_add_f32 v[248:249], v[172:173], v[248:249]
  v_pk_add_f32 v[250:251], v[174:175], v[250:251]
  s_mov_b32 s74, 0x1c000
  s_add_u32 m0, s72, 0x1000
  s_nop 0
  buffer_load_dwordx4 v6, s[48:51], s74 offen lds
  s_waitcnt vmcnt(13)
  v_accvgpr_read_b32 v225, a64
  v_accvgpr_read_b32 v227, a65
  s_waitcnt vmcnt(12)
  v_accvgpr_read_b32 v229, a66
  v_accvgpr_read_b32 v231, a67
  s_waitcnt vmcnt(11)
  v_accvgpr_read_b32 v233, a68
  v_accvgpr_read_b32 v235, a69
  v_lshlrev_b32 v224, 16, v225
  v_and_b32 v225, 0xffff0000, v225
  v_lshlrev_b32 v226, 16, v227
  v_and_b32 v227, 0xffff0000, v227
  v_lshlrev_b32 v228, 16, v229
  v_and_b32 v229, 0xffff0000, v229
  v_lshlrev_b32 v230, 16, v231
  v_and_b32 v231, 0xffff0000, v231
  v_lshlrev_b32 v232, 16, v233
  v_and_b32 v233, 0xffff0000, v233
  v_lshlrev_b32 v234, 16, v235
  v_and_b32 v235, 0xffff0000, v235
  v_pk_mul_f32 v[224:225], v[224:225], s[80:81] op_sel:[0,1] op_sel_hi:[1,1]
  v_pk_mul_f32 v[226:227], v[226:227], s[80:81] op_sel:[0,1] op_sel_hi:[1,1]
  v_pk_mul_f32 v[228:229], v[228:229], s[80:81] op_sel:[0,1] op_sel_hi:[1,1]
  v_pk_mul_f32 v[230:231], v[230:231], s[80:81] op_sel:[0,1] op_sel_hi:[1,1]
  v_pk_mul_f32 v[232:233], v[232:233], s[80:81] op_sel:[0,1] op_sel_hi:[1,1]
  v_pk_mul_f32 v[234:235], v[234:235], s[80:81] op_sel:[0,1] op_sel_hi:[1,1]
  s_waitcnt vmcnt(9)
  v_dot2_f32_bf16 v176, v72, s92, v245
  v_dot2_f32_bf16 v177, v72, s93, v245
  v_dot2_f32_bf16 v178, v73, s92, v245
  v_dot2_f32_bf16 v179, v73, s93, v245
  v_dot2_f32_bf16 v180, v74, s92, v245
  v_dot2_f32_bf16 v181, v74, s93, v245
  v_dot2_f32_bf16 v182, v75, s92, v245
  v_dot2_f32_bf16 v183, v75, s93, v245
  v_pk_fma_f32 v[252:253], v[176:177], v[176:177], v[252:253]
  v_pk_fma_f32 v[254:255], v[178:179], v[178:179], v[254:255]
  v_pk_fma_f32 v[252:253], v[180:181], v[180:181], v[252:253]
  v_pk_fma_f32 v[254:255], v[182:183], v[182:183], v[254:255]
  v_pk_add_f32 v[248:249], v[176:177], v[248:249]
  v_pk_add_f32 v[250:251], v[178:179], v[250:251]
  v_pk_add_f32 v[248:249], v[180:181], v[248:249]
  v_pk_add_f32 v[250:251], v[182:183], v[250:251]
  buffer_load_dwordx4 v7, s[48:51], s74 offen offset:1024 lds
  s_waitcnt vmcnt(9)
  v_dot2_f32_bf16 v184, v76, s92, v245
  v_dot2_f32_bf16 v185, v76, s93, v245
  v_dot2_f32_bf16 v186, v77, s92, v245
  v_dot2_f32_bf16 v187, v77, s93, v245
  v_dot2_f32_bf16 v188, v78, s92, v245
  v_dot2_f32_bf16 v189, v78, s93, v245
  v_dot2_f32_bf16 v190, v79, s92, v245
  v_dot2_f32_bf16 v191, v79, s93, v245
  v_pk_fma_f32 v[252:253], v[184:185], v[184:185], v[252:253]
  v_pk_fma_f32 v[254:255], v[186:187], v[186:187], v[254:255]
  v_pk_fma_f32 v[252:253], v[188:189], v[188:189], v[252:253]
  v_pk_fma_f32 v[254:255], v[190:191], v[190:191], v[254:255]
  v_pk_add_f32 v[248:249], v[184:185], v[248:249]
  v_pk_add_f32 v[250:251], v[186:187], v[250:251]
  v_pk_add_f32 v[248:249], v[188:189], v[248:249]
  v_pk_add_f32 v[250:251], v[190:191], v[250:251]
  buffer_load_dwordx4 v8, s[48:51], s74 offen offset:2048 lds
  s_waitcnt vmcnt(9)
  v_dot2_f32_bf16 v192, v80, s92, v245
  v_dot2_f32_bf16 v193, v80, s93, v245
  v_dot2_f32_bf16 v194, v81, s92, v245
  v_dot2_f32_bf16 v195, v81, s93, v245
  v_dot2_f32_bf16 v196, v82, s92, v245
  v_dot2_f32_bf16 v197, v82, s93, v245
  v_dot2_f32_bf16 v198, v83, s92, v245
  v_dot2_f32_bf16 v199, v83, s93, v245
  v_pk_fma_f32 v[252:253], v[192:193], v[192:193], v[252:253]
  v_pk_fma_f32 v[254:255], v[194:195], v[194:195], v[254:255]
  v_pk_fma_f32 v[252:253], v[196:197], v[196:197], v[252:253]
  v_pk_fma_f32 v[254:255], v[198:199], v[198:199], v[254:255]
  v_pk_add_f32 v[248:249], v[192:193], v[248:249]
  v_pk_add_f32 v[250:251], v[194:195], v[250:251]
  v_pk_add_f32 v[248:249], v[196:197], v[248:249]
  v_pk_add_f32 v[250:251], v[198:199], v[250:251]
  s_mov_b32 s73, 0x38000
  s_add_u32 m0, s72, 0x2000
  s_nop 0
  buffer_load_dwordx4 v6, s[48:51], s73 offen lds
  s_waitcnt vmcnt(9)
  v_dot2_f32_bf16 v200, v84, s92, v245
  v_dot2_f32_bf16 v201, v84, s93, v245
  v_dot2_f32_bf16 v202, v85, s92, v245
  v_dot2_f32_bf16 v203, v85, s93, v245
  v_dot2_f32_bf16 v204, v86, s92, v245
  v_dot2_f32_bf16 v205, v86, s93, v245
  v_dot2_f32_bf16 v206, v87, s92, v245
  v_dot2_f32_bf16 v207, v87, s93, v245
  v_pk_fma_f32 v[252:253], v[200:201], v[200:201], v[252:253]
  v_pk_fma_f32 v[254:255], v[202:203], v[202:203], v[254:255]
  v_pk_fma_f32 v[252:253], v[204:205], v[204:205], v[252:253]
  v_pk_fma_f32 v[254:255], v[206:207], v[206:207], v[254:255]
  v_pk_add_f32 v[248:249], v[200:201], v[248:249]
  v_pk_add_f32 v[250:251], v[202:203], v[250:251]
  v_pk_add_f32 v[248:249], v[204:205], v[248:249]
  v_pk_add_f32 v[250:251], v[206:207], v[250:251]
  buffer_load_dwordx4 v7, s[48:51], s73 offen offset:1024 lds
  s_waitcnt vmcnt(9)
  v_dot2_f32_bf16 v208, v88, s92, v245
  v_dot2_f32_bf16 v209, v88, s93, v245
  v_dot2_f32_bf16 v210, v89, s92, v245
  v_dot2_f32_bf16 v211, v89, s93, v245
  v_dot2_f32_bf16 v212, v90, s92, v245
  v_dot2_f32_bf16 v213, v90, s93, v245
  v_dot2_f32_bf16 v214, v91, s92, v245
  v_dot2_f32_bf16 v215, v91, s93, v245
  v_pk_fma_f32 v[252:253], v[208:209], v[208:209], v[252:253]
  v_pk_fma_f32 v[254:255], v[210:211], v[210:211], v[254:255]
  v_pk_fma_f32 v[252:253], v[212:213], v[212:213], v[252:253]
  v_pk_fma_f32 v[254:255], v[214:215], v[214:215], v[254:255]
  v_pk_add_f32 v[248:249], v[208:209], v[248:249]
  v_pk_add_f32 v[250:251], v[210:211], v[250:251]
  v_pk_add_f32 v[248:249], v[212:213], v[248:249]
  v_pk_add_f32 v[250:251], v[214:215], v[250:251]
  buffer_load_dwordx4 v8, s[48:51], s73 offen offset:2048 lds
  s_waitcnt vmcnt(9)
  v_dot2_f32_bf16 v216, v92, s92, v245
  v_dot2_f32_bf16 v217, v92, s93, v245
  v_dot2_f32_bf16 v218, v93, s92, v245
  v_dot2_f32_bf16 v219, v93, s93, v245
  v_dot2_f32_bf16 v220, v94, s92, v245
  v_dot2_f32_bf16 v221, v94, s93, v245
  v_dot2_f32_bf16 v222, v95, s92, v245
  v_dot2_f32_bf16 v223, v95, s93, v245
  v_pk_fma_f32 v[252:253], v[216:217], v[216:217], v[252:253]
  v_pk_fma_f32 v[254:255], v[218:219], v[218:219], v[254:255]
  v_pk_fma_f32 v[252:253], v[220:221], v[220:221], v[252:253]
  v_pk_fma_f32 v[254:255], v[222:223], v[222:223], v[254:255]
  v_pk_add_f32 v[248:249], v[216:217], v[248:249]
  v_pk_add_f32 v[250:251], v[218:219], v[250:251]
  v_pk_add_f32 v[248:249], v[220:221], v[248:249]
  v_pk_add_f32 v[250:251], v[222:223], v[250:251]
  s_mov_b32 s74, 0x54000
  s_add_u32 m0, s72, 0x3000
  s_nop 0
  buffer_load_dwordx4 v6, s[48:51], s74 offen lds
  v_pk_add_f32 v[248:249], v[248:249], v[250:251]
  v_pk_add_f32 v[252:253], v[252:253], v[254:255]
  v_add_f32 v248, v248, v249
  v_add_f32 v252, v252, v253
  v_mov_b32 v250, 0x3727c5ac
  v_add_f32_dpp v248, v248, v248 quad_perm:[1,0,3,2] row_mask:0xf bank_mask:0xf
  v_add_f32_dpp v252, v252, v252 quad_perm:[1,0,3,2] row_mask:0xf bank_mask:0xf
  s_nop 0
  v_add_f32_dpp v248, v248, v248 quad_perm:[2,3,0,1] row_mask:0xf bank_mask:0xf
  v_add_f32_dpp v252, v252, v252 quad_perm:[2,3,0,1] row_mask:0xf bank_mask:0xf
  v_mul_f32 v248, 0x3b000000, v248
  v_fmac_f32 v250, 0x3b000000, v252
  v_fma_f32 v250, -v248, v248, v250
  v_max_f32 v250, 0x3727c5ac, v250
  v_rsq_f32 v250, v250
  s_nop 0
  v_mul_f32 v250, s81, v250
  v_mul_f32 v254, -v248, v250
  v_pk_fma_f32 v[96:97], v[96:97], v[250:251], v[254:255] op_sel_hi:[1,0,0]
  v_pk_fma_f32 v[98:99], v[98:99], v[250:251], v[254:255] op_sel_hi:[1,0,0]
  v_pk_fma_f32 v[100:101], v[100:101], v[250:251], v[254:255] op_sel_hi:[1,0,0]
  v_pk_fma_f32 v[102:103], v[102:103], v[250:251], v[254:255] op_sel_hi:[1,0,0]
  v_cvt_pk_bf16_f32 v32, v96, v97
  v_cvt_pk_bf16_f32 v33, v98, v99
  v_cvt_pk_bf16_f32 v34, v100, v101
  v_cvt_pk_bf16_f32 v35, v102, v103
  ds_write_b128 v246, v[32:35]
  buffer_load_dwordx4 v7, s[48:51], s74 offen offset:1024 lds
  v_pk_fma_f32 v[104:105], v[104:105], v[250:251], v[254:255] op_sel_hi:[1,0,0]
  v_pk_fma_f32 v[106:107], v[106:107], v[250:251], v[254:255] op_sel_hi:[1,0,0]
  v_pk_fma_f32 v[108:109], v[108:109], v[250:251], v[254:255] op_sel_hi:[1,0,0]
  v_pk_fma_f32 v[110:111], v[110:111], v[250:251], v[254:255] op_sel_hi:[1,0,0]
  v_cvt_pk_bf16_f32 v36, v104, v105
  v_cvt_pk_bf16_f32 v37, v106, v107
  v_cvt_pk_bf16_f32 v38, v108, v109
  v_cvt_pk_bf16_f32 v39, v110, v111
  ds_write_b128 v246, v[36:39] offset:4096
  buffer_load_dwordx4 v8, s[48:51], s74 offen offset:2048 lds
  v_pk_fma_f32 v[112:113], v[112:113], v[250:251], v[254:255] op_sel_hi:[1,0,0]
  v_pk_fma_f32 v[114:115], v[114:115], v[250:251], v[254:255] op_sel_hi:[1,0,0]
  v_pk_fma_f32 v[116:117], v[116:117], v[250:251], v[254:255] op_sel_hi:[1,0,0]
  v_pk_fma_f32 v[118:119], v[118:119], v[250:251], v[254:255] op_sel_hi:[1,0,0]
  v_cvt_pk_bf16_f32 v40, v112, v113
  v_cvt_pk_bf16_f32 v41, v114, v115
  v_cvt_pk_bf16_f32 v42, v116, v117
  v_cvt_pk_bf16_f32 v43, v118, v119
  ds_write_b128 v246, v[40:43] offset:8192
  s_mov_b32 s73, 0x70000
  s_add_u32 m0, s72, 0x4000
  s_nop 0
  buffer_load_dwordx4 v6, s[48:51], s73 offen lds
  v_pk_fma_f32 v[120:121], v[120:121], v[250:251], v[254:255] op_sel_hi:[1,0,0]
  v_pk_fma_f32 v[122:123], v[122:123], v[250:251], v[254:255] op_sel_hi:[1,0,0]
  v_pk_fma_f32 v[124:125], v[124:125], v[250:251], v[254:255] op_sel_hi:[1,0,0]
  v_pk_fma_f32 v[126:127], v[126:127], v[250:251], v[254:255] op_sel_hi:[1,0,0]
  v_cvt_pk_bf16_f32 v44, v120, v121
  v_cvt_pk_bf16_f32 v45, v122, v123
  v_cvt_pk_bf16_f32 v46, v124, v125
  v_cvt_pk_bf16_f32 v47, v126, v127
  ds_write_b128 v246, v[44:47] offset:12288
  buffer_load_dwordx4 v7, s[48:51], s73 offen offset:1024 lds
  v_pk_fma_f32 v[128:129], v[128:129], v[250:251], v[254:255] op_sel_hi:[1,0,0]
  v_pk_fma_f32 v[130:131], v[130:131], v[250:251], v[254:255] op_sel_hi:[1,0,0]
  v_pk_fma_f32 v[132:133], v[132:133], v[250:251], v[254:255] op_sel_hi:[1,0,0]
  v_pk_fma_f32 v[134:135], v[134:135], v[250:251], v[254:255] op_sel_hi:[1,0,0]
  v_cvt_pk_bf16_f32 v48, v128, v129
  v_cvt_pk_bf16_f32 v49, v130, v131
  v_cvt_pk_bf16_f32 v50, v132, v133
  v_cvt_pk_bf16_f32 v51, v134, v135
  ds_write_b128 v246, v[48:51] offset:16384
  buffer_load_dwordx4 v8, s[48:51], s73 offen offset:2048 lds
  v_pk_fma_f32 v[136:137], v[136:137], v[250:251], v[254:255] op_sel_hi:[1,0,0]
  v_pk_fma_f32 v[138:139], v[138:139], v[250:251], v[254:255] op_sel_hi:[1,0,0]
  v_pk_fma_f32 v[140:141], v[140:141], v[250:251], v[254:255] op_sel_hi:[1,0,0]
  v_pk_fma_f32 v[142:143], v[142:143], v[250:251], v[254:255] op_sel_hi:[1,0,0]
  v_cvt_pk_bf16_f32 v52, v136, v137
  v_cvt_pk_bf16_f32 v53, v138, v139
  v_cvt_pk_bf16_f32 v54, v140, v141
  v_cvt_pk_bf16_f32 v55, v142, v143
  ds_write_b128 v246, v[52:55] offset:20480
  s_mov_b32 s74, 0x8c000
  s_add_u32 m0, s72, 0x5000
  s_nop 0
  buffer_load_dwordx4 v6, s[48:51], s74 offen lds
  v_pk_fma_f32 v[144:145], v[144:145], v[250:251], v[254:255] op_sel_hi:[1,0,0]
  v_pk_fma_f32 v[146:147], v[146:147], v[250:251], v[254:255] op_sel_hi:[1,0,0]
  v_pk_fma_f32 v[148:149], v[148:149], v[250:251], v[254:255] op_sel_hi:[1,0,0]
  v_pk_fma_f32 v[150:151], v[150:151], v[250:251], v[254:255] op_sel_hi:[1,0,0]
  v_cvt_pk_bf16_f32 v56, v144, v145
  v_cvt_pk_bf16_f32 v57, v146, v147
  v_cvt_pk_bf16_f32 v58, v148, v149
  v_cvt_pk_bf16_f32 v59, v150, v151
  ds_write_b128 v246, v[56:59] offset:24576
  buffer_load_dwordx4 v7, s[48:51], s74 offen offset:1024 lds
  v_pk_fma_f32 v[152:153], v[152:153], v[250:251], v[254:255] op_sel_hi:[1,0,0]
  v_pk_fma_f32 v[154:155], v[154:155], v[250:251], v[254:255] op_sel_hi:[1,0,0]
  v_pk_fma_f32 v[156:157], v[156:157], v[250:251], v[254:255] op_sel_hi:[1,0,0]
  v_pk_fma_f32 v[158:159], v[158:159], v[250:251], v[254:255] op_sel_hi:[1,0,0]
  v_cvt_pk_bf16_f32 v60, v152, v153
  v_cvt_pk_bf16_f32 v61, v154, v155
  v_cvt_pk_bf16_f32 v62, v156, v157
  v_cvt_pk_bf16_f32 v63, v158, v159
  ds_write_b128 v246, v[60:63] offset:28672
  buffer_load_dwordx4 v8, s[48:51], s74 offen offset:2048 lds
  v_pk_fma_f32 v[160:161], v[160:161], v[250:251], v[254:255] op_sel_hi:[1,0,0]
  v_pk_fma_f32 v[162:163], v[162:163], v[250:251], v[254:255] op_sel_hi:[1,0,0]
  v_pk_fma_f32 v[164:165], v[164:165], v[250:251], v[254:255] op_sel_hi:[1,0,0]
  v_pk_fma_f32 v[166:167], v[166:167], v[250:251], v[254:255] op_sel_hi:[1,0,0]
  v_cvt_pk_bf16_f32 v64, v160, v161
  v_cvt_pk_bf16_f32 v65, v162, v163
  v_cvt_pk_bf16_f32 v66, v164, v165
  v_cvt_pk_bf16_f32 v67, v166, v167
  ds_write_b128 v246, v[64:67] offset:32768
  v_pk_fma_f32 v[168:169], v[168:169], v[250:251], v[254:255] op_sel_hi:[1,0,0]
  v_pk_fma_f32 v[170:171], v[170:171], v[250:251], v[254:255] op_sel_hi:[1,0,0]
  v_pk_fma_f32 v[172:173], v[172:173], v[250:251], v[254:255] op_sel_hi:[1,0,0]
  v_pk_fma_f32 v[174:175], v[174:175], v[250:251], v[254:255] op_sel_hi:[1,0,0]
  v_cvt_pk_bf16_f32 v68, v168, v169
  v_cvt_pk_bf16_f32 v69, v170, v171
  v_cvt_pk_bf16_f32 v70, v172, v173
  v_cvt_pk_bf16_f32 v71, v174, v175
  ds_write_b128 v246, v[68:71] offset:36864
  v_pk_fma_f32 v[176:177], v[176:177], v[250:251], v[254:255] op_sel_hi:[1,0,0]
  v_pk_fma_f32 v[178:179], v[178:179], v[250:251], v[254:255] op_sel_hi:[1,0,0]
  v_pk_fma_f32 v[180:181], v[180:181], v[250:251], v[254:255] op_sel_hi:[1,0,0]
  v_pk_fma_f32 v[182:183], v[182:183], v[250:251], v[254:255] op_sel_hi:[1,0,0]
  v_cvt_pk_bf16_f32 v72, v176, v177
  v_cvt_pk_bf16_f32 v73, v178, v179
  v_cvt_pk_bf16_f32 v74, v180, v181
  v_cvt_pk_bf16_f32 v75, v182, v183
  ds_write_b128 v246, v[72:75] offset:40960
  v_pk_fma_f32 v[184:185], v[184:185], v[250:251], v[254:255] op_sel_hi:[1,0,0]
  v_pk_fma_f32 v[186:187], v[186:187], v[250:251], v[254:255] op_sel_hi:[1,0,0]
  v_pk_fma_f32 v[188:189], v[188:189], v[250:251], v[254:255] op_sel_hi:[1,0,0]
  v_pk_fma_f32 v[190:191], v[190:191], v[250:251], v[254:255] op_sel_hi:[1,0,0]
  v_cvt_pk_bf16_f32 v76, v184, v185
  v_cvt_pk_bf16_f32 v77, v186, v187
  v_cvt_pk_bf16_f32 v78, v188, v189
  v_cvt_pk_bf16_f32 v79, v190, v191
  ds_write_b128 v246, v[76:79] offset:45056
  v_pk_fma_f32 v[192:193], v[192:193], v[250:251], v[254:255] op_sel_hi:[1,0,0]
  v_pk_fma_f32 v[194:195], v[194:195], v[250:251], v[254:255] op_sel_hi:[1,0,0]
  v_pk_fma_f32 v[196:197], v[196:197], v[250:251], v[254:255] op_sel_hi:[1,0,0]
  v_pk_fma_f32 v[198:199], v[198:199], v[250:251], v[254:255] op_sel_hi:[1,0,0]
  v_cvt_pk_bf16_f32 v80, v192, v193
  v_cvt_pk_bf16_f32 v81, v194, v195
  v_cvt_pk_bf16_f32 v82, v196, v197
  v_cvt_pk_bf16_f32 v83, v198, v199
  ds_write_b128 v246, v[80:83] offset:49152
  s_waitcnt vmcnt(16)
  ds_read_b64_tr_b16 a[192:193], v240
  ds_read_b64_tr_b16 a[200:201], v240 offset:32
  ds_read_b64_tr_b16 a[208:209], v240 offset:64
  s_waitcnt vmcnt(15)
  ds_read_b64_tr_b16 a[194:195], v240 offset:1536
  v_pk_fma_f32 v[200:201], v[200:201], v[250:251], v[254:255] op_sel_hi:[1,0,0]
  v_pk_fma_f32 v[202:203], v[202:203], v[250:251], v[254:255] op_sel_hi:[1,0,0]
  v_pk_fma_f32 v[204:205], v[204:205], v[250:251], v[254:255] op_sel_hi:[1,0,0]
  v_pk_fma_f32 v[206:207], v[206:207], v[250:251], v[254:255] op_sel_hi:[1,0,0]
  v_cvt_pk_bf16_f32 v84, v200, v201
  v_cvt_pk_bf16_f32 v85, v202, v203
  v_cvt_pk_bf16_f32 v86, v204, v205
  v_cvt_pk_bf16_f32 v87, v206, v207
  ds_write_b128 v246, v[84:87] offset:53248
  ds_read_b64_tr_b16 a[202:203], v240 offset:1568
  ds_read_b64_tr_b16 a[210:211], v240 offset:1600
  s_waitcnt vmcnt(13)
  ds_read_b64_tr_b16 a[196:197], v240 offset:4096
  ds_read_b64_tr_b16 a[204:205], v240 offset:4128
  v_pk_fma_f32 v[208:209], v[208:209], v[250:251], v[254:255] op_sel_hi:[1,0,0]
  v_pk_fma_f32 v[210:211], v[210:211], v[250:251], v[254:255] op_sel_hi:[1,0,0]
  v_pk_fma_f32 v[212:213], v[212:213], v[250:251], v[254:255] op_sel_hi:[1,0,0]
  v_pk_fma_f32 v[214:215], v[214:215], v[250:251], v[254:255] op_sel_hi:[1,0,0]
  v_cvt_pk_bf16_f32 v88, v208, v209
  v_cvt_pk_bf16_f32 v89, v210, v211
  v_cvt_pk_bf16_f32 v90, v212, v213
  v_cvt_pk_bf16_f32 v91, v214, v215
  ds_write_b128 v246, v[88:91] offset:57344
  ds_read_b64_tr_b16 a[212:213], v240 offset:4160
  s_waitcnt vmcnt(12)
  ds_read_b64_tr_b16 a[198:199], v240 offset:5632
L_w6:
L_p736:
  s_cmp_eq_u32 s95, 1
  s_cbranch_scc1 L_p2857
  ds_read_b64_tr_b16 a[206:207], v240 offset:5664
  ds_read_b64_tr_b16 a[214:215], v240 offset:5696
  v_pk_fma_f32 v[216:217], v[216:217], v[250:251], v[254:255] op_sel_hi:[1,0,0]
  v_pk_fma_f32 v[218:219], v[218:219], v[250:251], v[254:255] op_sel_hi:[1,0,0]
  v_pk_fma_f32 v[220:221], v[220:221], v[250:251], v[254:255] op_sel_hi:[1,0,0]
  v_pk_fma_f32 v[222:223], v[222:223], v[250:251], v[254:255] op_sel_hi:[1,0,0]
  v_cvt_pk_bf16_f32 v92, v216, v217
  v_cvt_pk_bf16_f32 v93, v218, v219
  v_cvt_pk_bf16_f32 v94, v220, v221
  v_cvt_pk_bf16_f32 v95, v222, v223
  ds_write_b128 v246, v[92:95] offset:61440
  v_mov_b32 v248, 0xc1906ebb
  s_waitcnt lgkmcnt(0)
  s_barrier
  ds_read_b128 a[0:3], v247
  ds_read_b128 a[16:19], v247 offset:4096
  ds_read_b128 a[4:7], v247 offset:1024
  ds_read_b128 a[20:23], v247 offset:5120
  ds_read_b128 a[8:11], v247 offset:2048
  ds_read_b128 a[24:27], v247 offset:6144
  ds_read_b128 a[12:15], v247 offset:3072
  ds_read_b128 a[28:31], v247 offset:7168
  s_waitcnt lgkmcnt(7)
  v_mfma_f32_16x16x32_bf16 v[96:99], a[192:195], a[0:3], v[224:227]
  s_mov_b32 s73, 0xa8000
  s_waitcnt vmcnt(10) lgkmcnt(6)
  ds_read_b64_tr_b16 a[224:225], v240 offset:8192
  ds_read_b64_tr_b16 a[232:233], v240 offset:8224
  ds_read_b64_tr_b16 a[240:241], v240 offset:8256
  v_mfma_f32_16x16x32_bf16 v[96:99], a[196:199], a[16:19], v[96:99]
  s_add_u32 m0, s72, 0
  s_waitcnt lgkmcnt(7)
  ds_read_b128 a[32:35], v247 offset:8192
  ds_read_b128 a[48:51], v247 offset:12288
  v_mfma_f32_16x16x32_bf16 v[100:103], a[196:199], a[20:23], v[224:227]
  buffer_load_dwordx4 v6, s[48:51], s73 offen lds
  v_mfma_f32_16x16x32_bf16 v[100:103], a[192:195], a[4:7], v[100:103]
  s_waitcnt vmcnt(10) lgkmcnt(7)
  ds_read_b64_tr_b16 a[226:227], v240 offset:9728
  ds_read_b64_tr_b16 a[234:235], v240 offset:9760
  v_mfma_f32_16x16x32_bf16 v[104:107], a[192:195], a[8:11], v[224:227]
  buffer_load_dwordx4 v7, s[48:51], s73 offen offset:1024 lds
  v_mfma_f32_16x16x32_bf16 v[104:107], a[196:199], a[24:27], v[104:107]
  s_waitcnt lgkmcnt(7)
  ds_read_b64_tr_b16 a[242:243], v240 offset:9792
  ds_read_b128 a[36:39], v247 offset:9216
  v_mfma_f32_16x16x32_bf16 v[108:111], a[196:199], a[28:31], v[224:227]
  ds_read_b128 a[52:55], v247 offset:13312
  s_cmp_eq_u32 s14, 0
  s_cbranch_scc1 L_t30
L_r30:
  v_mfma_f32_16x16x32_bf16 v[108:111], a[192:195], a[12:15], v[108:111]
  buffer_load_dwordx4 v8, s[48:51], s73 offen offset:2048 lds
  v_mfma_f32_16x16x32_bf16 v[124:127], a[200:203], a[12:15], v[228:231]
  s_waitcnt vmcnt(10)
  ds_read_b64_tr_b16 a[228:229], v240 offset:12288
  v_mfma_f32_16x16x32_bf16 v[124:127], a[204:207], a[28:31], v[124:127]
  s_mov_b32 s74, 0xc4000
  ds_read_b64_tr_b16 a[236:237], v240 offset:12320
  v_mfma_f32_16x16x32_bf16 v[120:123], a[204:207], a[24:27], v[228:231]
  s_add_u32 m0, s72, 0x1000
  ds_read_b64_tr_b16 a[244:245], v240 offset:12352
  v_mfma_f32_16x16x32_bf16 v[120:123], a[200:203], a[8:11], v[120:123]
  buffer_load_dwordx4 v6, s[48:51], s74 offen lds
  v_mfma_f32_16x16x32_bf16 v[116:119], a[200:203], a[4:7], v[228:231]
  ds_read_b128 a[40:43], v247 offset:10240
  v_mfma_f32_16x16x32_bf16 v[116:119], a[204:207], a[20:23], v[116:119]
  ds_read_b128 a[56:59], v247 offset:14336
  v_mfma_f32_16x16x32_bf16 v[112:115], a[204:207], a[16:19], v[228:231]
  s_waitcnt vmcnt(10)
  ds_read_b64_tr_b16 a[230:231], v240 offset:13824
  ds_read_b64_tr_b16 a[238:239], v240 offset:13856
  v_mfma_f32_16x16x32_bf16 v[112:115], a[200:203], a[0:3], v[112:115]
  buffer_load_dwordx4 v7, s[48:51], s74 offen offset:1024 lds
  v_mfma_f32_16x16x32_bf16 v[128:131], a[208:211], a[0:3], v[232:235]
  ds_read_b64_tr_b16 a[246:247], v240 offset:13888
  v_mfma_f32_16x16x32_bf16 v[128:131], a[212:215], a[16:19], v[128:131]
  ds_read_b128 a[44:47], v247 offset:11264
  v_mfma_f32_16x16x32_bf16 v[132:135], a[212:215], a[20:23], v[232:235]
  ds_read_b128 a[60:63], v247 offset:15360
  v_mfma_f32_16x16x32_bf16 v[132:135], a[208:211], a[4:7], v[132:135]
  buffer_load_dwordx4 v8, s[48:51], s74 offen offset:2048 lds
  v_mfma_f32_16x16x32_bf16 v[136:139], a[208:211], a[8:11], v[232:235]
  s_waitcnt vmcnt(10)
  ds_read_b64_tr_b16 a[192:193], v240 offset:16384
  v_mfma_f32_16x16x32_bf16 v[136:139], a[212:215], a[24:27], v[136:139]
  s_mov_b32 s73, 0xe0000
  ds_read_b64_tr_b16 a[200:201], v240 offset:16416
  v_mfma_f32_16x16x32_bf16 v[140:143], a[212:215], a[28:31], v[232:235]
  s_add_u32 m0, s72, 0x2000
  s_waitcnt lgkmcnt(9)
  v_mfma_f32_16x16x32_bf16 v[140:143], a[208:211], a[12:15], v[140:143]
  buffer_load_dwordx4 v6, s[48:51], s73 offen lds
  v_mfma_f32_16x16x32_bf16 v[96:99], a[224:227], a[32:35], v[96:99]
  s_waitcnt lgkmcnt(6)
  ds_read_b64_tr_b16 a[208:209], v240 offset:16448
  ds_read_b128 a[64:67], v247 offset:16384
  v_mfma_f32_16x16x32_bf16 v[96:99], a[228:231], a[48:51], v[96:99]
  ds_read_b128 a[80:83], v247 offset:20480
  s_cmp_eq_u32 s14, 1
  s_cbranch_scc1 L_t31
L_r31:
  v_mfma_f32_16x16x32_bf16 v[100:103], a[228:231], a[52:55], v[100:103]
  s_waitcnt vmcnt(10)
  ds_read_b64_tr_b16 a[194:195], v240 offset:17920
  ds_read_b64_tr_b16 a[202:203], v240 offset:17952
  v_mfma_f32_16x16x32_bf16 v[100:103], a[224:227], a[36:39], v[100:103]
  buffer_load_dwordx4 v7, s[48:51], s73 offen offset:1024 lds
  v_mfma_f32_16x16x32_bf16 v[104:107], a[224:227], a[40:43], v[104:107]
  ds_read_b64_tr_b16 a[210:211], v240 offset:17984
  v_mfma_f32_16x16x32_bf16 v[104:107], a[228:231], a[56:59], v[104:107]
  s_waitcnt lgkmcnt(8)
  ds_read_b128 a[68:71], v247 offset:17408
  v_mfma_f32_16x16x32_bf16 v[108:111], a[228:231], a[60:63], v[108:111]
  ds_read_b128 a[84:87], v247 offset:21504
  v_mfma_f32_16x16x32_bf16 v[108:111], a[224:227], a[44:47], v[108:111]
  buffer_load_dwordx4 v8, s[48:51], s73 offen offset:2048 lds
  v_mfma_f32_16x16x32_bf16 v[124:127], a[232:235], a[44:47], v[124:127]
  s_waitcnt vmcnt(10)
  ds_read_b64_tr_b16 a[196:197], v240 offset:20480
  v_mfma_f32_16x16x32_bf16 v[124:127], a[236:239], a[60:63], v[124:127]
  s_mov_b32 s74, 0xfc000
  ds_read_b64_tr_b16 a[204:205], v240 offset:20512
  v_mfma_f32_16x16x32_bf16 v[120:123], a[236:239], a[56:59], v[120:123]
  s_add_u32 m0, s72, 0x3000
  ds_read_b64_tr_b16 a[212:213], v240 offset:20544
  v_mfma_f32_16x16x32_bf16 v[120:123], a[232:235], a[40:43], v[120:123]
  buffer_load_dwordx4 v6, s[48:51], s74 offen lds
  v_mfma_f32_16x16x32_bf16 v[116:119], a[232:235], a[36:39], v[116:119]
  ds_read_b128 a[72:75], v247 offset:18432
  v_mfma_f32_16x16x32_bf16 v[116:119], a[236:239], a[52:55], v[116:119]
  ds_read_b128 a[88:91], v247 offset:22528
  v_mfma_f32_16x16x32_bf16 v[112:115], a[236:239], a[48:51], v[112:115]
  s_waitcnt vmcnt(10)
  ds_read_b64_tr_b16 a[198:199], v240 offset:22016
  ds_read_b64_tr_b16 a[206:207], v240 offset:22048
  v_mfma_f32_16x16x32_bf16 v[112:115], a[232:235], a[32:35], v[112:115]
  buffer_load_dwordx4 v7, s[48:51], s74 offen offset:1024 lds
  v_mfma_f32_16x16x32_bf16 v[128:131], a[240:243], a[32:35], v[128:131]
  ds_read_b64_tr_b16 a[214:215], v240 offset:22080
  v_mfma_f32_16x16x32_bf16 v[128:131], a[244:247], a[48:51], v[128:131]
  ds_read_b128 a[76:79], v247 offset:19456
  v_mfma_f32_16x16x32_bf16 v[132:135], a[244:247], a[52:55], v[132:135]
  ds_read_b128 a[92:95], v247 offset:23552
  v_mfma_f32_16x16x32_bf16 v[132:135], a[240:243], a[36:39], v[132:135]
  buffer_load_dwordx4 v8, s[48:51], s74 offen offset:2048 lds
  v_mfma_f32_16x16x32_bf16 v[136:139], a[240:243], a[40:43], v[136:139]
  s_waitcnt vmcnt(10)
  ds_read_b64_tr_b16 a[224:225], v240
  v_mfma_f32_16x16x32_bf16 v[136:139], a[244:247], a[56:59], v[136:139]
  s_mov_b32 s73, 0x118000
  ds_read_b64_tr_b16 a[232:233], v240 offset:32
  v_mfma_f32_16x16x32_bf16 v[140:143], a[244:247], a[60:63], v[140:143]
  s_add_u32 m0, s72, 0x4000
  s_waitcnt lgkmcnt(9)
  v_mfma_f32_16x16x32_bf16 v[140:143], a[240:243], a[44:47], v[140:143]
  buffer_load_dwordx4 v6, s[48:51], s73 offen lds
  v_mfma_f32_16x16x32_bf16 v[96:99], a[192:195], a[64:67], v[96:99]
  s_waitcnt lgkmcnt(6)
  ds_read_b64_tr_b16 a[240:241], v240 offset:64
  ds_read_b128 a[96:99], v247 offset:24576
  v_mfma_f32_16x16x32_bf16 v[96:99], a[196:199], a[80:83], v[96:99]
  ds_read_b128 a[112:115], v247 offset:28672
  s_cmp_eq_u32 s14, 2
  s_cbranch_scc1 L_t32
L_r32:
  v_mfma_f32_16x16x32_bf16 v[100:103], a[196:199], a[84:87], v[100:103]
  s_waitcnt vmcnt(10)
  ds_read_b64_tr_b16 a[226:227], v240 offset:1536
  ds_read_b64_tr_b16 a[234:235], v240 offset:1568
  v_mfma_f32_16x16x32_bf16 v[100:103], a[192:195], a[68:71], v[100:103]
  buffer_load_dwordx4 v7, s[48:51], s73 offen offset:1024 lds
  v_mfma_f32_16x16x32_bf16 v[104:107], a[192:195], a[72:75], v[104:107]
  ds_read_b64_tr_b16 a[242:243], v240 offset:1600
  v_mfma_f32_16x16x32_bf16 v[104:107], a[196:199], a[88:91], v[104:107]
  s_waitcnt lgkmcnt(8)
  ds_read_b128 a[100:103], v247 offset:25600
  v_mfma_f32_16x16x32_bf16 v[108:111], a[196:199], a[92:95], v[108:111]
  ds_read_b128 a[116:119], v247 offset:29696
  v_mfma_f32_16x16x32_bf16 v[108:111], a[192:195], a[76:79], v[108:111]
  buffer_load_dwordx4 v8, s[48:51], s73 offen offset:2048 lds
  v_mfma_f32_16x16x32_bf16 v[124:127], a[200:203], a[76:79], v[124:127]
  s_waitcnt vmcnt(10)
  ds_read_b64_tr_b16 a[228:229], v240 offset:4096
  v_mfma_f32_16x16x32_bf16 v[124:127], a[204:207], a[92:95], v[124:127]
  s_mov_b32 s74, 0x134000
  ds_read_b64_tr_b16 a[236:237], v240 offset:4128
  v_mfma_f32_16x16x32_bf16 v[120:123], a[204:207], a[88:91], v[120:123]
  s_add_u32 m0, s72, 0x5000
  ds_read_b64_tr_b16 a[244:245], v240 offset:4160
  v_mfma_f32_16x16x32_bf16 v[120:123], a[200:203], a[72:75], v[120:123]
  buffer_load_dwordx4 v6, s[48:51], s74 offen lds
  v_mfma_f32_16x16x32_bf16 v[116:119], a[200:203], a[68:71], v[116:119]
  ds_read_b128 a[104:107], v247 offset:26624
  v_mfma_f32_16x16x32_bf16 v[116:119], a[204:207], a[84:87], v[116:119]
  ds_read_b128 a[120:123], v247 offset:30720
  v_mfma_f32_16x16x32_bf16 v[112:115], a[204:207], a[80:83], v[112:115]
  s_waitcnt vmcnt(10)
  ds_read_b64_tr_b16 a[230:231], v240 offset:5632
  ds_read_b64_tr_b16 a[238:239], v240 offset:5664
  v_mfma_f32_16x16x32_bf16 v[112:115], a[200:203], a[64:67], v[112:115]
  buffer_load_dwordx4 v7, s[48:51], s74 offen offset:1024 lds
  v_mfma_f32_16x16x32_bf16 v[128:131], a[208:211], a[64:67], v[128:131]
  ds_read_b64_tr_b16 a[246:247], v240 offset:5696
  v_mfma_f32_16x16x32_bf16 v[128:131], a[212:215], a[80:83], v[128:131]
  ds_read_b128 a[108:111], v247 offset:27648
  v_mfma_f32_16x16x32_bf16 v[132:135], a[212:215], a[84:87], v[132:135]
  ds_read_b128 a[124:127], v247 offset:31744
  v_mfma_f32_16x16x32_bf16 v[132:135], a[208:211], a[68:71], v[132:135]
  buffer_load_dwordx4 v8, s[48:51], s74 offen offset:2048 lds
  v_mfma_f32_16x16x32_bf16 v[136:139], a[208:211], a[72:75], v[136:139]
  s_waitcnt vmcnt(10)
  ds_read_b64_tr_b16 a[192:193], v240 offset:8192
  v_mfma_f32_16x16x32_bf16 v[136:139], a[212:215], a[88:91], v[136:139]
  s_mov_b32 s73, 0x150000
  ds_read_b64_tr_b16 a[200:201], v240 offset:8224
  v_mfma_f32_16x16x32_bf16 v[140:143], a[212:215], a[92:95], v[140:143]
  s_add_u32 m0, s72, 0
  s_waitcnt lgkmcnt(9)
  v_mfma_f32_16x16x32_bf16 v[140:143], a[208:211], a[76:79], v[140:143]
  buffer_load_dwordx4 v6, s[48:51], s73 offen lds
  v_mfma_f32_16x16x32_bf16 v[96:99], a[224:227], a[96:99], v[96:99]
  s_waitcnt lgkmcnt(6)
  ds_read_b64_tr_b16 a[208:209], v240 offset:8256
  ds_read_b128 a[128:131], v247 offset:32768
  v_mfma_f32_16x16x32_bf16 v[96:99], a[228:231], a[112:115], v[96:99]
  ds_read_b128 a[144:147], v247 offset:36864
  s_cmp_eq_u32 s14, 3
  s_cbranch_scc1 L_t33
L_r33:
  v_mfma_f32_16x16x32_bf16 v[100:103], a[228:231], a[116:119], v[100:103]
  s_waitcnt vmcnt(10)
  ds_read_b64_tr_b16 a[194:195], v240 offset:9728
  ds_read_b64_tr_b16 a[202:203], v240 offset:9760
  v_mfma_f32_16x16x32_bf16 v[100:103], a[224:227], a[100:103], v[100:103]
  buffer_load_dwordx4 v7, s[48:51], s73 offen offset:1024 lds
  v_mfma_f32_16x16x32_bf16 v[104:107], a[224:227], a[104:107], v[104:107]
  ds_read_b64_tr_b16 a[210:211], v240 offset:9792
  v_mfma_f32_16x16x32_bf16 v[104:107], a[228:231], a[120:123], v[104:107]
  s_waitcnt lgkmcnt(8)
  ds_read_b128 a[132:135], v247 offset:33792
  v_mfma_f32_16x16x32_bf16 v[108:111], a[228:231], a[124:127], v[108:111]
  ds_read_b128 a[148:151], v247 offset:37888
  v_mfma_f32_16x16x32_bf16 v[108:111], a[224:227], a[108:111], v[108:111]
  buffer_load_dwordx4 v8, s[48:51], s73 offen offset:2048 lds
  v_mfma_f32_16x16x32_bf16 v[124:127], a[232:235], a[108:111], v[124:127]
  s_waitcnt vmcnt(10)
  ds_read_b64_tr_b16 a[196:197], v240 offset:12288
  v_mfma_f32_16x16x32_bf16 v[124:127], a[236:239], a[124:127], v[124:127]
  s_mov_b32 s74, 0x16c000
  ds_read_b64_tr_b16 a[204:205], v240 offset:12320
  v_mfma_f32_16x16x32_bf16 v[120:123], a[236:239], a[120:123], v[120:123]
  s_add_u32 m0, s72, 0x1000
  ds_read_b64_tr_b16 a[212:213], v240 offset:12352
  v_mfma_f32_16x16x32_bf16 v[120:123], a[232:235], a[104:107], v[120:123]
  buffer_load_dwordx4 v6, s[48:51], s74 offen lds
  v_mfma_f32_16x16x32_bf16 v[116:119], a[232:235], a[100:103], v[116:119]
  ds_read_b128 a[136:139], v247 offset:34816
  v_mfma_f32_16x16x32_bf16 v[116:119], a[236:239], a[116:119], v[116:119]
  ds_read_b128 a[152:155], v247 offset:38912
  v_mfma_f32_16x16x32_bf16 v[112:115], a[236:239], a[112:115], v[112:115]
  s_waitcnt vmcnt(10)
  ds_read_b64_tr_b16 a[198:199], v240 offset:13824
  ds_read_b64_tr_b16 a[206:207], v240 offset:13856
  v_mfma_f32_16x16x32_bf16 v[112:115], a[232:235], a[96:99], v[112:115]
  buffer_load_dwordx4 v7, s[48:51], s74 offen offset:1024 lds
  v_mfma_f32_16x16x32_bf16 v[128:131], a[240:243], a[96:99], v[128:131]
  ds_read_b64_tr_b16 a[214:215], v240 offset:13888
  v_mfma_f32_16x16x32_bf16 v[128:131], a[244:247], a[112:115], v[128:131]
  ds_read_b128 a[140:143], v247 offset:35840
  v_mfma_f32_16x16x32_bf16 v[132:135], a[244:247], a[116:119], v[132:135]
  ds_read_b128 a[156:159], v247 offset:39936
  v_mfma_f32_16x16x32_bf16 v[132:135], a[240:243], a[100:103], v[132:135]
  buffer_load_dwordx4 v8, s[48:51], s74 offen offset:2048 lds
  v_mfma_f32_16x16x32_bf16 v[136:139], a[240:243], a[104:107], v[136:139]
  s_waitcnt vmcnt(10)
  ds_read_b64_tr_b16 a[224:225], v240 offset:16384
  v_mfma_f32_16x16x32_bf16 v[136:139], a[244:247], a[120:123], v[136:139]
  s_mov_b32 s73, 0x188000
  ds_read_b64_tr_b16 a[232:233], v240 offset:16416
  v_mfma_f32_16x16x32_bf16 v[140:143], a[244:247], a[124:127], v[140:143]
  s_add_u32 m0, s72, 0x2000
  s_waitcnt lgkmcnt(9)
  v_mfma_f32_16x16x32_bf16 v[140:143], a[240:243], a[108:111], v[140:143]
  buffer_load_dwordx4 v6, s[48:51], s73 offen lds
  v_mfma_f32_16x16x32_bf16 v[96:99], a[192:195], a[128:131], v[96:99]
  s_waitcnt lgkmcnt(6)
  ds_read_b64_tr_b16 a[240:241], v240 offset:16448
  ds_read_b128 a[160:163], v247 offset:40960
  v_mfma_f32_16x16x32_bf16 v[96:99], a[196:199], a[144:147], v[96:99]
  ds_read_b128 a[176:179], v247 offset:45056
  s_cmp_eq_u32 s14, 4
  s_cbranch_scc1 L_t34
L_r34:
  v_mfma_f32_16x16x32_bf16 v[100:103], a[196:199], a[148:151], v[100:103]
  s_waitcnt vmcnt(10)
  ds_read_b64_tr_b16 a[226:227], v240 offset:17920
  ds_read_b64_tr_b16 a[234:235], v240 offset:17952
  v_mfma_f32_16x16x32_bf16 v[100:103], a[192:195], a[132:135], v[100:103]
  buffer_load_dwordx4 v7, s[48:51], s73 offen offset:1024 lds
  v_mfma_f32_16x16x32_bf16 v[104:107], a[192:195], a[136:139], v[104:107]
  ds_read_b64_tr_b16 a[242:243], v240 offset:17984
  v_mfma_f32_16x16x32_bf16 v[104:107], a[196:199], a[152:155], v[104:107]
  s_waitcnt lgkmcnt(8)
  ds_read_b128 a[164:167], v247 offset:41984
  v_mfma_f32_16x16x32_bf16 v[108:111], a[196:199], a[156:159], v[108:111]
  ds_read_b128 a[180:183], v247 offset:46080
  v_mfma_f32_16x16x32_bf16 v[108:111], a[192:195], a[140:143], v[108:111]
  buffer_load_dwordx4 v8, s[48:51], s73 offen offset:2048 lds
  v_mfma_f32_16x16x32_bf16 v[124:127], a[200:203], a[140:143], v[124:127]
  s_waitcnt vmcnt(10)
  ds_read_b64_tr_b16 a[228:229], v240 offset:20480
  v_mfma_f32_16x16x32_bf16 v[124:127], a[204:207], a[156:159], v[124:127]
  s_mov_b32 s74, 0x1a4000
  ds_read_b64_tr_b16 a[236:237], v240 offset:20512
  v_mfma_f32_16x16x32_bf16 v[120:123], a[204:207], a[152:155], v[120:123]
  s_add_u32 m0, s72, 0x3000
  ds_read_b64_tr_b16 a[244:245], v240 offset:20544
  v_mfma_f32_16x16x32_bf16 v[120:123], a[200:203], a[136:139], v[120:123]
  buffer_load_dwordx4 v6, s[48:51], s74 offen lds
  v_mfma_f32_16x16x32_bf16 v[116:119], a[200:203], a[132:135], v[116:119]
  ds_read_b128 a[168:171], v247 offset:43008
  v_mfma_f32_16x16x32_bf16 v[116:119], a[204:207], a[148:151], v[116:119]
  ds_read_b128 a[184:187], v247 offset:47104
  v_mfma_f32_16x16x32_bf16 v[112:115], a[204:207], a[144:147], v[112:115]
  s_waitcnt vmcnt(10)
  ds_read_b64_tr_b16 a[230:231], v240 offset:22016
  ds_read_b64_tr_b16 a[238:239], v240 offset:22048
  v_mfma_f32_16x16x32_bf16 v[112:115], a[200:203], a[128:131], v[112:115]
  buffer_load_dwordx4 v7, s[48:51], s74 offen offset:1024 lds
  v_mfma_f32_16x16x32_bf16 v[128:131], a[208:211], a[128:131], v[128:131]
  ds_read_b64_tr_b16 a[246:247], v240 offset:22080
  v_mfma_f32_16x16x32_bf16 v[128:131], a[212:215], a[144:147], v[128:131]
  ds_read_b128 a[172:175], v247 offset:44032
  v_mfma_f32_16x16x32_bf16 v[132:135], a[212:215], a[148:151], v[132:135]
  ds_read_b128 a[188:191], v247 offset:48128
  v_mfma_f32_16x16x32_bf16 v[132:135], a[208:211], a[132:135], v[132:135]
  buffer_load_dwordx4 v8, s[48:51], s74 offen offset:2048 lds
  v_mfma_f32_16x16x32_bf16 v[136:139], a[208:211], a[136:139], v[136:139]
  s_waitcnt vmcnt(10)
  ds_read_b64_tr_b16 a[192:193], v240
  v_mfma_f32_16x16x32_bf16 v[136:139], a[212:215], a[152:155], v[136:139]
  s_mov_b32 s73, 0x380000
  ds_read_b64_tr_b16 a[200:201], v240 offset:32
  v_mfma_f32_16x16x32_bf16 v[140:143], a[212:215], a[156:159], v[140:143]
  s_add_u32 m0, s72, 0x4000
  s_waitcnt lgkmcnt(9)
  v_mfma_f32_16x16x32_bf16 v[140:143], a[208:211], a[140:143], v[140:143]
  buffer_load_dwordx4 v10, s[44:47], s73 offen lds
  v_mfma_f32_16x16x32_bf16 v[96:99], a[224:227], a[160:163], v[96:99]
  s_waitcnt lgkmcnt(6)
  ds_read_b64_tr_b16 a[208:209], v240 offset:64
  ds_read_b128 a[0:3], v247 offset:49152
  v_mfma_f32_16x16x32_bf16 v[96:99], a[228:231], a[176:179], v[96:99]
  ds_read_b128 a[16:19], v247 offset:53248
  s_cmp_eq_u32 s14, 5
  s_cbranch_scc1 L_t35
L_r35:
  v_mfma_f32_16x16x32_bf16 v[100:103], a[228:231], a[180:183], v[100:103]
  buffer_load_dwordx4 v11, s[44:47], s73 offen offset:1024 lds
  v_mfma_f32_16x16x32_bf16 v[100:103], a[224:227], a[164:167], v[100:103]
  s_waitcnt vmcnt(11)
  ds_read_b64_tr_b16 a[194:195], v240 offset:1536
  ds_read_b64_tr_b16 a[202:203], v240 offset:1568
  v_mfma_f32_16x16x32_bf16 v[104:107], a[224:227], a[168:171], v[104:107]
  s_waitcnt lgkmcnt(7)
  ds_read_b64_tr_b16 a[210:211], v240 offset:1600
  v_mfma_f32_16x16x32_bf16 v[104:107], a[228:231], a[184:187], v[104:107]
  buffer_load_dwordx4 v12, s[44:47], s73 offen offset:2048 lds
  v_mfma_f32_16x16x32_bf16 v[108:111], a[228:231], a[188:191], v[108:111]
  ds_read_b128 a[4:7], v247 offset:50176
  v_mfma_f32_16x16x32_bf16 v[108:111], a[224:227], a[172:175], v[108:111]
  ds_read_b128 a[20:23], v247 offset:54272
  v_mfma_f32_16x16x32_bf16 v[124:127], a[232:235], a[172:175], v[124:127]
  buffer_load_dwordx4 v13, s[44:47], s73 offen offset:3072 lds
  v_mfma_f32_16x16x32_bf16 v[124:127], a[236:239], a[188:191], v[124:127]
  s_mov_b32 s74, 0x3c0000
  s_waitcnt vmcnt(11)
  ds_read_b64_tr_b16 a[196:197], v240 offset:4096
  ds_read_b64_tr_b16 a[204:205], v240 offset:4128
  v_mfma_f32_16x16x32_bf16 v[120:123], a[236:239], a[184:187], v[120:123]
  s_add_u32 m0, s72, 0x5000
  ds_read_b64_tr_b16 a[212:213], v240 offset:4160
  v_mfma_f32_16x16x32_bf16 v[120:123], a[232:235], a[168:171], v[120:123]
  buffer_load_dwordx4 v10, s[44:47], s74 offen lds
  v_mfma_f32_16x16x32_bf16 v[116:119], a[232:235], a[164:167], v[116:119]
  ds_read_b128 a[8:11], v247 offset:51200
  v_mfma_f32_16x16x32_bf16 v[116:119], a[236:239], a[180:183], v[116:119]
  ds_read_b128 a[24:27], v247 offset:55296
  v_mfma_f32_16x16x32_bf16 v[112:115], a[236:239], a[176:179], v[112:115]
  buffer_load_dwordx4 v11, s[44:47], s74 offen offset:1024 lds
  v_mfma_f32_16x16x32_bf16 v[112:115], a[232:235], a[160:163], v[112:115]
  s_waitcnt vmcnt(12)
  ds_read_b64_tr_b16 a[198:199], v240 offset:5632
  ds_read_b64_tr_b16 a[206:207], v240 offset:5664
  v_mfma_f32_16x16x32_bf16 v[128:131], a[240:243], a[160:163], v[128:131]
  ds_read_b64_tr_b16 a[214:215], v240 offset:5696
  v_mfma_f32_16x16x32_bf16 v[128:131], a[244:247], a[176:179], v[128:131]
  buffer_load_dwordx4 v12, s[44:47], s74 offen offset:2048 lds
  v_mfma_f32_16x16x32_bf16 v[132:135], a[244:247], a[180:183], v[132:135]
  ds_read_b128 a[12:15], v247 offset:52224
  v_mfma_f32_16x16x32_bf16 v[132:135], a[240:243], a[164:167], v[132:135]
  ds_read_b128 a[28:31], v247 offset:56320
  v_mfma_f32_16x16x32_bf16 v[136:139], a[240:243], a[168:171], v[136:139]
  buffer_load_dwordx4 v13, s[44:47], s74 offen offset:3072 lds
  v_mfma_f32_16x16x32_bf16 v[136:139], a[244:247], a[184:187], v[136:139]
  s_mov_b32 s73, 0x380080
  s_waitcnt vmcnt(12)
  ds_read_b64_tr_b16 a[224:225], v240 offset:8192
  ds_read_b64_tr_b16 a[232:233], v240 offset:8224
  v_mfma_f32_16x16x32_bf16 v[140:143], a[244:247], a[188:191], v[140:143]
  s_add_u32 m0, s72, 0
  s_waitcnt lgkmcnt(9)
  v_mfma_f32_16x16x32_bf16 v[140:143], a[240:243], a[172:175], v[140:143]
  buffer_load_dwordx4 v10, s[44:47], s73 offen lds
  v_mfma_f32_16x16x32_bf16 v[96:99], a[192:195], a[0:3], v[96:99]
  s_waitcnt lgkmcnt(6)
  ds_read_b64_tr_b16 a[240:241], v240 offset:8256
  ds_read_b128 a[32:35], v247 offset:57344
  v_mfma_f32_16x16x32_bf16 v[96:99], a[196:199], a[16:19], v[96:99]
  ds_read_b128 a[48:51], v247 offset:61440
  s_cmp_eq_u32 s14, 6
  s_cbranch_scc1 L_t36
L_r36:
  v_mfma_f32_16x16x32_bf16 v[100:103], a[196:199], a[20:23], v[100:103]
  buffer_load_dwordx4 v11, s[44:47], s73 offen offset:1024 lds
  v_mfma_f32_16x16x32_bf16 v[100:103], a[192:195], a[4:7], v[100:103]
  s_waitcnt vmcnt(13)
  ds_read_b64_tr_b16 a[226:227], v240 offset:9728
  ds_read_b64_tr_b16 a[234:235], v240 offset:9760
  v_mfma_f32_16x16x32_bf16 v[104:107], a[192:195], a[8:11], v[104:107]
  s_waitcnt lgkmcnt(7)
  ds_read_b64_tr_b16 a[242:243], v240 offset:9792
  v_mfma_f32_16x16x32_bf16 v[104:107], a[196:199], a[24:27], v[104:107]
  buffer_load_dwordx4 v12, s[44:47], s73 offen offset:2048 lds
  v_mfma_f32_16x16x32_bf16 v[108:111], a[196:199], a[28:31], v[108:111]
  ds_read_b128 a[36:39], v247 offset:58368
  v_mfma_f32_16x16x32_bf16 v[108:111], a[192:195], a[12:15], v[108:111]
  ds_read_b128 a[52:55], v247 offset:62464
  v_mfma_f32_16x16x32_bf16 v[124:127], a[200:203], a[12:15], v[124:127]
  buffer_load_dwordx4 v13, s[44:47], s73 offen offset:3072 lds
  v_mfma_f32_16x16x32_bf16 v[124:127], a[204:207], a[28:31], v[124:127]
  s_mov_b32 s74, 0x3c0080
  s_waitcnt vmcnt(13)
  ds_read_b64_tr_b16 a[228:229], v240 offset:12288
  ds_read_b64_tr_b16 a[236:237], v240 offset:12320
  v_mfma_f32_16x16x32_bf16 v[120:123], a[204:207], a[24:27], v[120:123]
  s_add_u32 m0, s72, 0x1000
  ds_read_b64_tr_b16 a[244:245], v240 offset:12352
  v_mfma_f32_16x16x32_bf16 v[120:123], a[200:203], a[8:11], v[120:123]
  buffer_load_dwordx4 v10, s[44:47], s74 offen lds
  v_mfma_f32_16x16x32_bf16 v[116:119], a[200:203], a[4:7], v[116:119]
  ds_read_b128 a[40:43], v247 offset:59392
  v_mfma_f32_16x16x32_bf16 v[116:119], a[204:207], a[20:23], v[116:119]
  ds_read_b128 a[56:59], v247 offset:63488
  v_mfma_f32_16x16x32_bf16 v[112:115], a[204:207], a[16:19], v[112:115]
  buffer_load_dwordx4 v11, s[44:47], s74 offen offset:1024 lds
  v_mfma_f32_16x16x32_bf16 v[112:115], a[200:203], a[0:3], v[112:115]
  s_waitcnt vmcnt(14)
  ds_read_b64_tr_b16 a[230:231], v240 offset:13824
  ds_read_b64_tr_b16 a[238:239], v240 offset:13856
  v_mfma_f32_16x16x32_bf16 v[128:131], a[208:211], a[0:3], v[128:131]
  ds_read_b64_tr_b16 a[246:247], v240 offset:13888
  v_mfma_f32_16x16x32_bf16 v[128:131], a[212:215], a[16:19], v[128:131]
  buffer_load_dwordx4 v12, s[44:47], s74 offen offset:2048 lds
  v_mfma_f32_16x16x32_bf16 v[132:135], a[212:215], a[20:23], v[132:135]
  ds_read_b128 a[44:47], v247 offset:60416
  v_mfma_f32_16x16x32_bf16 v[132:135], a[208:211], a[4:7], v[132:135]
  ds_read_b128 a[60:63], v247 offset:64512
  v_mfma_f32_16x16x32_bf16 v[136:139], a[208:211], a[8:11], v[136:139]
  buffer_load_dwordx4 v13, s[44:47], s74 offen offset:3072 lds
  v_mfma_f32_16x16x32_bf16 v[136:139], a[212:215], a[24:27], v[136:139]
  s_mov_b32 s73, 0x300000
  s_waitcnt vmcnt(14)
  ds_read_b64_tr_b16 a[192:193], v2 offset:16384
  v_mfma_f32_16x16x32_bf16 v[140:143], a[212:215], a[28:31], v[140:143]
  s_add_u32 m0, s72, 0x2000
  s_waitcnt lgkmcnt(8)
  ds_read_b64_tr_b16 a[200:201], v3 offset:16384
  v_mfma_f32_16x16x32_bf16 v[140:143], a[208:211], a[12:15], v[140:143]
  buffer_load_dwordx4 v10, s[44:47], s73 offen lds
  v_mfma_f32_16x16x32_bf16 v[96:99], a[224:227], a[32:35], v[96:99]
  s_waitcnt lgkmcnt(6)
  ds_read_b64_tr_b16 a[208:209], v4 offset:16384
  v_mfma_f32_16x16x32_bf16 v[96:99], a[228:231], a[48:51], v[96:99]
  ds_read_b64_tr_b16 a[216:217], v5 offset:16384
  s_cmp_eq_u32 s14, 7
  s_cbranch_scc1 L_t37
L_r37:
  v_mfma_f32_16x16x32_bf16 v[100:103], a[228:231], a[52:55], v[100:103]
  buffer_load_dwordx4 v11, s[44:47], s73 offen offset:1024 lds
  v_mfma_f32_16x16x32_bf16 v[100:103], a[224:227], a[36:39], v[100:103]
  s_waitcnt vmcnt(14)
  ds_read_b64_tr_b16 a[194:195], v2 offset:18432
  v_mfma_f32_16x16x32_bf16 v[104:107], a[224:227], a[40:43], v[104:107]
  s_waitcnt lgkmcnt(5)
  ds_read_b64_tr_b16 a[202:203], v3 offset:18432
  v_mfma_f32_16x16x32_bf16 v[104:107], a[228:231], a[56:59], v[104:107]
  buffer_load_dwordx4 v12, s[44:47], s73 offen offset:2048 lds
  v_mfma_f32_16x16x32_bf16 v[108:111], a[228:231], a[60:63], v[108:111]
  ds_read_b64_tr_b16 a[210:211], v4 offset:18432
  v_mfma_f32_16x16x32_bf16 v[108:111], a[224:227], a[44:47], v[108:111]
  ds_read_b64_tr_b16 a[218:219], v5 offset:18432
  v_mfma_f32_16x16x32_bf16 v[124:127], a[232:235], a[44:47], v[124:127]
  buffer_load_dwordx4 v13, s[44:47], s73 offen offset:3072 lds
  v_mfma_f32_16x16x32_bf16 v[124:127], a[236:239], a[60:63], v[124:127]
  s_mov_b32 s74, 0x340000
  s_waitcnt vmcnt(14)
  ds_read_b64_tr_b16 a[196:197], v2 offset:20480
  v_mfma_f32_16x16x32_bf16 v[120:123], a[236:239], a[56:59], v[120:123]
  s_add_u32 m0, s72, 0x3000
  ds_read_b64_tr_b16 a[204:205], v3 offset:20480
  v_mfma_f32_16x16x32_bf16 v[120:123], a[232:235], a[40:43], v[120:123]
  buffer_load_dwordx4 v10, s[44:47], s74 offen lds
  v_mfma_f32_16x16x32_bf16 v[116:119], a[232:235], a[36:39], v[116:119]
  ds_read_b64_tr_b16 a[212:213], v4 offset:20480
  v_mul_f32 v249, v96, v96
  v_mfma_f32_16x16x32_bf16 v[116:119], a[236:239], a[52:55], v[116:119]
  ds_read_b64_tr_b16 a[220:221], v5 offset:20480
  v_fma_f32 v249, v249, s80, v248
  v_mfma_f32_16x16x32_bf16 v[112:115], a[236:239], a[48:51], v[112:115]
  buffer_load_dwordx4 v11, s[44:47], s74 offen offset:1024 lds
  v_mfma_f32_16x16x32_bf16 v[112:115], a[232:235], a[32:35], v[112:115]
  s_waitcnt vmcnt(14)
  ds_read_b64_tr_b16 a[198:199], v2 offset:22528
  v_mul_f32 v249, v249, v96
  v_mfma_f32_16x16x32_bf16 v[128:131], a[240:243], a[32:35], v[128:131]
  ds_read_b64_tr_b16 a[206:207], v3 offset:22528
  v_exp_f32 v249, v249
  v_mfma_f32_16x16x32_bf16 v[128:131], a[244:247], a[48:51], v[128:131]
  buffer_load_dwordx4 v12, s[44:47], s74 offen offset:2048 lds
  v_mfma_f32_16x16x32_bf16 v[132:135], a[244:247], a[52:55], v[132:135]
  ds_read_b64_tr_b16 a[214:215], v4 offset:22528
  v_fma_f32 v249, v249, s15, s15
  v_mfma_f32_16x16x32_bf16 v[132:135], a[240:243], a[36:39], v[132:135]
  ds_read_b64_tr_b16 a[222:223], v5 offset:22528
  v_rcp_f32 v249, v249
  v_mfma_f32_16x16x32_bf16 v[136:139], a[240:243], a[40:43], v[136:139]
  buffer_load_dwordx4 v13, s[44:47], s74 offen offset:3072 lds
  v_mfma_f32_16x16x32_bf16 v[136:139], a[244:247], a[56:59], v[136:139]
  s_mov_b32 s73, 0x300080
  s_waitcnt vmcnt(14)
  ds_read_b64_tr_b16 a[224:225], v2
  v_mul_f32 v96, v96, v249
  v_mfma_f32_16x16x32_bf16 v[140:143], a[244:247], a[60:63], v[140:143]
  s_add_u32 m0, s72, 0x4000
  s_waitcnt lgkmcnt(5)
  ds_read_b64_tr_b16 a[232:233], v3
  v_mul_f32 v250, v97, v97
  v_mfma_f32_16x16x32_bf16 v[140:143], a[240:243], a[44:47], v[140:143]
  buffer_load_dwordx4 v10, s[44:47], s73 offen lds
  v_mfma_f32_16x16x32_bf16 v[32:35], a[192:195], a[32:35], 0
  s_waitcnt lgkmcnt(5)
  ds_read_b64_tr_b16 a[240:241], v4
  v_fma_f32 v250, v250, s80, v248
  v_mfma_f32_16x16x32_bf16 v[32:35], a[196:199], a[48:51], v[32:35]
  ds_read_b64_tr_b16 a[248:249], v5
  v_mul_f32 v250, v250, v97
  v_mfma_f32_16x16x32_bf16 v[48:51], a[196:199], a[52:55], 0
  s_cmp_eq_u32 s14, 8
  s_cbranch_scc1 L_t38
L_r38:
  v_mfma_f32_16x16x32_bf16 v[48:51], a[192:195], a[36:39], v[48:51]
  buffer_load_dwordx4 v11, s[44:47], s73 offen offset:1024 lds
  v_mfma_f32_16x16x32_bf16 v[64:67], a[192:195], a[40:43], 0
  s_waitcnt vmcnt(14)
  ds_read_b64_tr_b16 a[226:227], v2 offset:2048
  v_mfma_f32_16x16x32_bf16 v[64:67], a[196:199], a[56:59], v[64:67]
L_w5:
L_p1243:
  s_cmp_eq_u32 s95, 1
  s_cbranch_scc1 L_p4003
  ds_read_b64_tr_b16 a[234:235], v3 offset:2048
  v_mfma_f32_16x16x32_bf16 v[80:83], a[196:199], a[60:63], 0
  v_exp_f32 v250, v250
  v_mfma_f32_16x16x32_bf16 v[80:83], a[192:195], a[44:47], v[80:83]
  buffer_load_dwordx4 v12, s[44:47], s73 offen offset:2048 lds
  v_mfma_f32_16x16x32_bf16 v[208:211], a[200:203], a[44:47], 0
  s_waitcnt lgkmcnt(4)
  ds_read_b64_tr_b16 a[242:243], v4 offset:2048
  v_fma_f32 v250, v250, s15, s15
  v_mfma_f32_16x16x32_bf16 v[208:211], a[204:207], a[60:63], v[208:211]
  ds_read_b64_tr_b16 a[250:251], v5 offset:2048
  v_mul_f32 v251, v98, v98
  v_mfma_f32_16x16x32_bf16 v[192:195], a[204:207], a[56:59], 0
  v_rcp_f32 v250, v250
  v_mfma_f32_16x16x32_bf16 v[192:195], a[200:203], a[40:43], v[192:195]
  buffer_load_dwordx4 v13, s[44:47], s73 offen offset:3072 lds
  v_mfma_f32_16x16x32_bf16 v[176:179], a[200:203], a[36:39], 0
  s_waitcnt vmcnt(14)
  ds_read_b64_tr_b16 a[228:229], v2 offset:4096
  v_mul_f32 v97, v97, v250
  v_mfma_f32_16x16x32_bf16 v[176:179], a[204:207], a[52:55], v[176:179]
  s_mov_b32 s74, 0x340080
  ds_read_b64_tr_b16 a[236:237], v3 offset:4096
  v_fma_f32 v251, v251, s80, v248
  v_mfma_f32_16x16x32_bf16 v[160:163], a[204:207], a[48:51], 0
  s_add_u32 m0, s72, 0x5000
  v_mul_f32 v251, v251, v98
  v_cvt_pk_bf16_f32 v96, v96, v97
  v_mfma_f32_16x16x32_bf16 v[160:163], a[200:203], a[32:35], v[160:163]
  buffer_load_dwordx4 v10, s[44:47], s74 offen lds
  v_mfma_f32_16x16x32_bf16 v[36:39], a[208:211], a[32:35], 0
  ds_read_b64_tr_b16 a[244:245], v4 offset:4096
  v_mul_f32 v252, v99, v99
  v_mfma_f32_16x16x32_bf16 v[36:39], a[212:215], a[48:51], v[36:39]
  ds_read_b64_tr_b16 a[252:253], v5 offset:4096
  v_fma_f32 v252, v252, s80, v248
  v_mfma_f32_16x16x32_bf16 v[52:55], a[212:215], a[52:55], 0
  v_exp_f32 v251, v251
  v_mfma_f32_16x16x32_bf16 v[52:55], a[208:211], a[36:39], v[52:55]
  buffer_load_dwordx4 v11, s[44:47], s74 offen offset:1024 lds
  v_mfma_f32_16x16x32_bf16 v[68:71], a[208:211], a[40:43], 0
  s_waitcnt vmcnt(14)
  ds_read_b64_tr_b16 a[230:231], v2 offset:6144
  v_fma_f32 v251, v251, s15, s15
  v_mfma_f32_16x16x32_bf16 v[68:71], a[212:215], a[56:59], v[68:71]
  ds_read_b64_tr_b16 a[238:239], v3 offset:6144
  v_mul_f32 v252, v252, v99
  v_mfma_f32_16x16x32_bf16 v[84:87], a[212:215], a[60:63], 0
  v_rcp_f32 v251, v251
  v_mfma_f32_16x16x32_bf16 v[84:87], a[208:211], a[44:47], v[84:87]
  buffer_load_dwordx4 v12, s[44:47], s74 offen offset:2048 lds
  v_mfma_f32_16x16x32_bf16 v[212:215], a[216:219], a[44:47], 0
  ds_read_b64_tr_b16 a[246:247], v4 offset:6144
  v_mul_f32 v98, v98, v251
  v_mfma_f32_16x16x32_bf16 v[212:215], a[220:223], a[60:63], v[212:215]
  ds_read_b64_tr_b16 a[254:255], v5 offset:6144
  v_mul_f32 v253, v100, v100
  v_mfma_f32_16x16x32_bf16 v[196:199], a[220:223], a[56:59], 0
  s_mul_i32 s77, s3, 0x1800
  v_exp_f32 v252, v252
  v_mfma_f32_16x16x32_bf16 v[196:199], a[216:219], a[40:43], v[196:199]
  buffer_load_dwordx4 v13, s[44:47], s74 offen offset:3072 lds
  v_mfma_f32_16x16x32_bf16 v[180:183], a[216:219], a[36:39], 0
  s_waitcnt vmcnt(14)
  ds_read_b64_tr_b16 a[192:193], v2 offset:8192
  v_fma_f32 v252, v252, s15, s15
  v_mfma_f32_16x16x32_bf16 v[180:183], a[220:223], a[52:55], v[180:183]
  s_mov_b32 s73, 0x280000
  ds_read_b64_tr_b16 a[200:201], v3 offset:8192
  v_fma_f32 v253, v253, s80, v248
  v_mfma_f32_16x16x32_bf16 v[164:167], a[220:223], a[48:51], 0
  s_add_u32 m0, s72, 0
  s_waitcnt lgkmcnt(5)
  v_rcp_f32 v252, v252
  v_mfma_f32_16x16x32_bf16 v[164:167], a[216:219], a[32:35], v[164:167]
  buffer_load_dwordx4 v10, s[44:47], s73 offen lds
  v_mfma_f32_16x16x32_bf16 v[40:43], a[224:227], a[32:35], 0
  ds_read_b64_tr_b16 a[208:209], v4 offset:8192
  v_mul_f32 v99, v99, v252
  v_mfma_f32_16x16x32_bf16 v[40:43], a[228:231], a[48:51], v[40:43]
  ds_read_b64_tr_b16 a[216:217], v5 offset:8192
  v_cvt_pk_bf16_f32 v97, v98, v99
  v_mfma_f32_16x16x32_bf16 v[56:59], a[228:231], a[52:55], 0
  v_mul_f32 v253, v253, v100
  s_cmp_eq_u32 s14, 9
  s_cbranch_scc1 L_t39
L_r39:
  v_mfma_f32_16x16x32_bf16 v[56:59], a[224:227], a[36:39], v[56:59]
  buffer_load_dwordx4 v11, s[44:47], s73 offen offset:1024 lds
  v_mfma_f32_16x16x32_bf16 v[72:75], a[224:227], a[40:43], 0
  s_waitcnt vmcnt(14)
  ds_read_b64_tr_b16 a[194:195], v2 offset:10240
  v_mul_f32 v254, v101, v101
  v_mfma_f32_16x16x32_bf16 v[72:75], a[228:231], a[56:59], v[72:75]
  ds_read_b64_tr_b16 a[202:203], v3 offset:10240
  v_fma_f32 v254, v254, s80, v248
  v_mfma_f32_16x16x32_bf16 v[88:91], a[228:231], a[60:63], 0
  v_exp_f32 v253, v253
  v_mfma_f32_16x16x32_bf16 v[88:91], a[224:227], a[44:47], v[88:91]
  buffer_load_dwordx4 v12, s[44:47], s73 offen offset:2048 lds
  v_mfma_f32_16x16x32_bf16 v[216:219], a[232:235], a[44:47], 0
  s_waitcnt lgkmcnt(4)
  ds_read_b64_tr_b16 a[210:211], v4 offset:10240
  v_fma_f32 v253, v253, s15, s15
  v_mfma_f32_16x16x32_bf16 v[216:219], a[236:239], a[60:63], v[216:219]
  ds_read_b64_tr_b16 a[218:219], v5 offset:10240
  v_mul_f32 v254, v254, v101
  v_mfma_f32_16x16x32_bf16 v[200:203], a[236:239], a[56:59], 0
  v_rcp_f32 v253, v253
  v_mfma_f32_16x16x32_bf16 v[200:203], a[232:235], a[40:43], v[200:203]
  buffer_load_dwordx4 v13, s[44:47], s73 offen offset:3072 lds
  v_mfma_f32_16x16x32_bf16 v[184:187], a[232:235], a[36:39], 0
  s_waitcnt vmcnt(14)
  ds_read_b64_tr_b16 a[196:197], v2 offset:12288
  v_mul_f32 v100, v100, v253
  v_mfma_f32_16x16x32_bf16 v[184:187], a[236:239], a[52:55], v[184:187]
  s_mov_b32 s74, 0x2c0000
  ds_read_b64_tr_b16 a[204:205], v3 offset:12288
  v_mul_f32 v255, v102, v102
  v_mfma_f32_16x16x32_bf16 v[168:171], a[236:239], a[48:51], 0
  s_add_u32 m0, s72, 0x1000
  v_exp_f32 v254, v254
  v_mfma_f32_16x16x32_bf16 v[168:171], a[232:235], a[32:35], v[168:171]
  buffer_load_dwordx4 v10, s[44:47], s74 offen lds
  v_mfma_f32_16x16x32_bf16 v[44:47], a[240:243], a[32:35], 0
  ds_read_b64_tr_b16 a[212:213], v4 offset:12288
  v_fma_f32 v254, v254, s15, s15
  v_mfma_f32_16x16x32_bf16 v[44:47], a[244:247], a[48:51], v[44:47]
  ds_read_b64_tr_b16 a[220:221], v5 offset:12288
  v_fma_f32 v255, v255, s80, v248
  v_mfma_f32_16x16x32_bf16 v[60:63], a[244:247], a[52:55], 0
  v_rcp_f32 v254, v254
  v_mfma_f32_16x16x32_bf16 v[60:63], a[240:243], a[36:39], v[60:63]
  buffer_load_dwordx4 v11, s[44:47], s74 offen offset:1024 lds
  v_mul_f32 v249, v103, v103
  v_mfma_f32_16x16x32_bf16 v[76:79], a[240:243], a[40:43], 0
  s_waitcnt vmcnt(14)
  ds_read_b64_tr_b16 a[198:199], v2 offset:14336
  v_mul_f32 v101, v101, v254
  v_mfma_f32_16x16x32_bf16 v[76:79], a[244:247], a[56:59], v[76:79]
  ds_read_b64_tr_b16 a[206:207], v3 offset:14336
  v_mul_f32 v255, v255, v102
  v_cvt_pk_bf16_f32 v98, v100, v101
  v_mfma_f32_16x16x32_bf16 v[92:95], a[244:247], a[60:63], 0
  v_exp_f32 v255, v255
  v_mfma_f32_16x16x32_bf16 v[92:95], a[240:243], a[44:47], v[92:95]
  buffer_load_dwordx4 v12, s[44:47], s74 offen offset:2048 lds
  v_mfma_f32_16x16x32_bf16 v[220:223], a[248:251], a[44:47], 0
  ds_read_b64_tr_b16 a[214:215], v4 offset:14336
  v_fma_f32 v255, v255, s15, s15
  v_mfma_f32_16x16x32_bf16 v[220:223], a[252:255], a[60:63], v[220:223]
  ds_read_b64_tr_b16 a[222:223], v5 offset:14336
  v_fma_f32 v249, v249, s80, v248
  v_mfma_f32_16x16x32_bf16 v[204:207], a[252:255], a[56:59], 0
  v_rcp_f32 v255, v255
  v_mfma_f32_16x16x32_bf16 v[204:207], a[248:251], a[40:43], v[204:207]
  buffer_load_dwordx4 v13, s[44:47], s74 offen offset:3072 lds
  v_mfma_f32_16x16x32_bf16 v[188:191], a[248:251], a[36:39], 0
  s_waitcnt vmcnt(14)
  ds_read_b64_tr_b16 a[224:225], v2 offset:16384
  v_mul_f32 v102, v102, v255
  v_mfma_f32_16x16x32_bf16 v[188:191], a[252:255], a[52:55], v[188:191]
  s_mov_b32 s73, 0x280080
  ds_read_b64_tr_b16 a[232:233], v3 offset:16384
  v_mul_f32 v249, v249, v103
  v_mfma_f32_16x16x32_bf16 v[172:175], a[252:255], a[48:51], 0
  s_add_u32 m0, s72, 0x2000
  s_waitcnt lgkmcnt(4)
  v_exp_f32 v249, v249
  v_mfma_f32_16x16x32_bf16 v[172:175], a[248:251], a[32:35], v[172:175]
  buffer_load_dwordx4 v10, s[44:47], s73 offen lds
  v_mfma_f32_16x16x32_bf16 v[32:35], a[192:195], a[0:3], v[32:35]
  ds_read_b64_tr_b16 a[240:241], v4 offset:16384
  v_fma_f32 v249, v249, s15, s15
  v_mfma_f32_16x16x32_bf16 v[32:35], a[196:199], a[16:19], v[32:35]
  ds_read_b64_tr_b16 a[248:249], v5 offset:16384
  v_mul_f32 v250, v104, v104
  v_mfma_f32_16x16x32_bf16 v[48:51], a[196:199], a[20:23], v[48:51]
  s_cmp_eq_u32 s14, 10
  s_cbranch_scc1 L_t310
L_r310:
  v_mfma_f32_16x16x32_bf16 v[48:51], a[192:195], a[4:7], v[48:51]
  buffer_load_dwordx4 v11, s[44:47], s73 offen offset:1024 lds
  v_mfma_f32_16x16x32_bf16 v[64:67], a[192:195], a[8:11], v[64:67]
  s_waitcnt vmcnt(14)
  ds_read_b64_tr_b16 a[226:227], v2 offset:18432
  v_fma_f32 v250, v250, s80, v248
  v_mfma_f32_16x16x32_bf16 v[64:67], a[196:199], a[24:27], v[64:67]
  ds_read_b64_tr_b16 a[234:235], v3 offset:18432
  v_mul_f32 v250, v250, v104
  v_mfma_f32_16x16x32_bf16 v[80:83], a[196:199], a[28:31], v[80:83]
  v_rcp_f32 v249, v249
  v_mul_f32 v251, v105, v105
  v_mfma_f32_16x16x32_bf16 v[80:83], a[192:195], a[12:15], v[80:83]
  buffer_load_dwordx4 v12, s[44:47], s73 offen offset:2048 lds
  v_fma_f32 v251, v251, s80, v248
  v_mfma_f32_16x16x32_bf16 v[208:211], a[200:203], a[12:15], v[208:211]
  ds_read_b64_tr_b16 a[242:243], v4 offset:18432
  v_mul_f32 v103, v103, v249
  v_mfma_f32_16x16x32_bf16 v[208:211], a[204:207], a[28:31], v[208:211]
  ds_read_b64_tr_b16 a[250:251], v5 offset:18432
  v_cvt_pk_bf16_f32 v99, v102, v103
  v_mfma_f32_16x16x32_bf16 v[192:195], a[204:207], a[24:27], v[192:195]
  v_exp_f32 v250, v250
  v_mfma_f32_16x16x32_bf16 v[192:195], a[200:203], a[8:11], v[192:195]
  buffer_load_dwordx4 v13, s[44:47], s73 offen offset:3072 lds
  v_mfma_f32_16x16x32_bf16 v[176:179], a[200:203], a[4:7], v[176:179]
  s_waitcnt vmcnt(14)
  ds_read_b64_tr_b16 a[228:229], v2 offset:20480
  v_fma_f32 v250, v250, s15, s15
  v_mfma_f32_16x16x32_bf16 v[176:179], a[204:207], a[20:23], v[176:179]
  s_mov_b32 s74, 0x2c0080
  ds_read_b64_tr_b16 a[236:237], v3 offset:20480
  v_mul_f32 v251, v251, v105
  v_mfma_f32_16x16x32_bf16 v[160:163], a[204:207], a[16:19], v[160:163]
  s_add_u32 m0, s72, 0x3000
  v_rcp_f32 v250, v250
  v_mfma_f32_16x16x32_bf16 v[160:163], a[200:203], a[0:3], v[160:163]
  buffer_load_dwordx4 v10, s[44:47], s74 offen lds
  v_mfma_f32_16x16x32_bf16 v[36:39], a[208:211], a[0:3], v[36:39]
  s_waitcnt lgkmcnt(4)
  ds_read_b64_tr_b16 a[244:245], v4 offset:20480
  v_mul_f32 v104, v104, v250
  v_mfma_f32_16x16x32_bf16 v[36:39], a[212:215], a[16:19], v[36:39]
  ds_read_b64_tr_b16 a[252:253], v5 offset:20480
  v_mul_f32 v252, v106, v106
  v_mfma_f32_16x16x32_bf16 v[52:55], a[212:215], a[20:23], v[52:55]
  v_exp_f32 v251, v251
  v_mfma_f32_16x16x32_bf16 v[52:55], a[208:211], a[4:7], v[52:55]
  buffer_load_dwordx4 v11, s[44:47], s74 offen offset:1024 lds
  v_mfma_f32_16x16x32_bf16 v[68:71], a[208:211], a[8:11], v[68:71]
  s_waitcnt vmcnt(14)
  ds_read_b64_tr_b16 a[230:231], v2 offset:22528
  v_fma_f32 v251, v251, s15, s15
  v_mfma_f32_16x16x32_bf16 v[68:71], a[212:215], a[24:27], v[68:71]
  ds_read_b64_tr_b16 a[238:239], v3 offset:22528
  v_fma_f32 v252, v252, s80, v248
  v_mfma_f32_16x16x32_bf16 v[84:87], a[212:215], a[28:31], v[84:87]
  v_rcp_f32 v251, v251
  v_mfma_f32_16x16x32_bf16 v[84:87], a[208:211], a[12:15], v[84:87]
  buffer_load_dwordx4 v12, s[44:47], s74 offen offset:2048 lds
  v_mfma_f32_16x16x32_bf16 v[212:215], a[216:219], a[12:15], v[212:215]
  ds_read_b64_tr_b16 a[246:247], v4 offset:22528
  v_mul_f32 v105, v105, v251
  v_mfma_f32_16x16x32_bf16 v[212:215], a[220:223], a[28:31], v[212:215]
  ds_read_b64_tr_b16 a[254:255], v5 offset:22528
  v_mul_f32 v252, v252, v106
  v_cvt_pk_bf16_f32 v104, v104, v105
  v_mfma_f32_16x16x32_bf16 v[196:199], a[220:223], a[24:27], v[196:199]
  v_exp_f32 v252, v252
  v_mfma_f32_16x16x32_bf16 v[196:199], a[216:219], a[8:11], v[196:199]
  buffer_load_dwordx4 v13, s[44:47], s74 offen offset:3072 lds
  v_mfma_f32_16x16x32_bf16 v[180:183], a[216:219], a[4:7], v[180:183]
  s_waitcnt vmcnt(14)
  ds_read_b64_tr_b16 a[192:193], v2
  v_fma_f32 v252, v252, s15, s15
  v_mfma_f32_16x16x32_bf16 v[180:183], a[220:223], a[20:23], v[180:183]
  s_mov_b32 s73, 0x200000
  ds_read_b64_tr_b16 a[200:201], v3
  v_mul_f32 v253, v107, v107
  v_mfma_f32_16x16x32_bf16 v[164:167], a[220:223], a[16:19], v[164:167]
  s_add_u32 m0, s72, 0x4000
  v_rcp_f32 v252, v252
  v_mfma_f32_16x16x32_bf16 v[164:167], a[216:219], a[0:3], v[164:167]
  buffer_load_dwordx4 v10, s[44:47], s73 offen lds
  v_mfma_f32_16x16x32_bf16 v[40:43], a[224:227], a[0:3], v[40:43]
  s_waitcnt lgkmcnt(4)
  ds_read_b64_tr_b16 a[208:209], v4
  v_mul_f32 v106, v106, v252
  v_mfma_f32_16x16x32_bf16 v[40:43], a[228:231], a[16:19], v[40:43]
  ds_read_b64_tr_b16 a[216:217], v5
  v_fma_f32 v253, v253, s80, v248
  v_mfma_f32_16x16x32_bf16 v[56:59], a[228:231], a[20:23], v[56:59]
  s_cmp_eq_u32 s14, 11
  s_cbranch_scc1 L_t311
L_r311:
  v_mfma_f32_16x16x32_bf16 v[56:59], a[224:227], a[4:7], v[56:59]
  buffer_load_dwordx4 v11, s[44:47], s73 offen offset:1024 lds
  v_mfma_f32_16x16x32_bf16 v[72:75], a[224:227], a[8:11], v[72:75]
  s_waitcnt vmcnt(14)
  ds_read_b64_tr_b16 a[194:195], v2 offset:2048
  v_mul_f32 v253, v253, v107
  v_mfma_f32_16x16x32_bf16 v[72:75], a[228:231], a[24:27], v[72:75]
  ds_read_b64_tr_b16 a[202:203], v3 offset:2048
  v_mul_f32 v254, v108, v108
  v_mfma_f32_16x16x32_bf16 v[88:91], a[228:231], a[28:31], v[88:91]
  v_exp_f32 v253, v253
  v_mfma_f32_16x16x32_bf16 v[88:91], a[224:227], a[12:15], v[88:91]
  buffer_load_dwordx4 v12, s[44:47], s73 offen offset:2048 lds
  v_mfma_f32_16x16x32_bf16 v[216:219], a[232:235], a[12:15], v[216:219]
  ds_read_b64_tr_b16 a[210:211], v4 offset:2048
  v_fma_f32 v253, v253, s15, s15
  v_mfma_f32_16x16x32_bf16 v[216:219], a[236:239], a[28:31], v[216:219]
  ds_read_b64_tr_b16 a[218:219], v5 offset:2048
  v_fma_f32 v254, v254, s80, v248
  v_mfma_f32_16x16x32_bf16 v[200:203], a[236:239], a[24:27], v[200:203]
  v_rcp_f32 v253, v253
  v_mfma_f32_16x16x32_bf16 v[200:203], a[232:235], a[8:11], v[200:203]
  buffer_load_dwordx4 v13, s[44:47], s73 offen offset:3072 lds
  v_mfma_f32_16x16x32_bf16 v[184:187], a[232:235], a[4:7], v[184:187]
  s_waitcnt vmcnt(14)
  ds_read_b64_tr_b16 a[196:197], v2 offset:4096
  v_mul_f32 v107, v107, v253
  v_mfma_f32_16x16x32_bf16 v[184:187], a[236:239], a[20:23], v[184:187]
  s_mov_b32 s74, 0x240000
  ds_read_b64_tr_b16 a[204:205], v3 offset:4096
  v_cvt_pk_bf16_f32 v105, v106, v107
  v_mfma_f32_16x16x32_bf16 v[168:171], a[236:239], a[16:19], v[168:171]
  s_add_u32 m0, s72, 0x5000
  v_mul_f32 v254, v254, v108
  v_mul_f32 v255, v109, v109
  v_mfma_f32_16x16x32_bf16 v[168:171], a[232:235], a[0:3], v[168:171]
  buffer_load_dwordx4 v10, s[44:47], s74 offen lds
  v_mfma_f32_16x16x32_bf16 v[44:47], a[240:243], a[0:3], v[44:47]
  s_waitcnt lgkmcnt(4)
  ds_read_b64_tr_b16 a[212:213], v4 offset:4096
  v_fma_f32 v255, v255, s80, v248
  v_mfma_f32_16x16x32_bf16 v[44:47], a[244:247], a[16:19], v[44:47]
  ds_read_b64_tr_b16 a[220:221], v5 offset:4096
  v_mul_f32 v255, v255, v109
  v_mfma_f32_16x16x32_bf16 v[60:63], a[244:247], a[20:23], v[60:63]
  v_exp_f32 v254, v254
  v_mfma_f32_16x16x32_bf16 v[60:63], a[240:243], a[4:7], v[60:63]
  buffer_load_dwordx4 v11, s[44:47], s74 offen offset:1024 lds
  v_mul_f32 v249, v110, v110
  v_mfma_f32_16x16x32_bf16 v[76:79], a[240:243], a[8:11], v[76:79]
  s_waitcnt vmcnt(14)
  ds_read_b64_tr_b16 a[198:199], v2 offset:6144
  v_fma_f32 v254, v254, s15, s15
  v_fma_f32 v249, v249, s80, v248
  v_mfma_f32_16x16x32_bf16 v[76:79], a[244:247], a[24:27], v[76:79]
  ds_read_b64_tr_b16 a[206:207], v3 offset:6144
  v_exp_f32 v255, v255
  v_mul_f32 v249, v249, v110
  v_mfma_f32_16x16x32_bf16 v[92:95], a[244:247], a[28:31], v[92:95]
  v_rcp_f32 v254, v254
  v_exp_f32 v249, v249
  v_mfma_f32_16x16x32_bf16 v[92:95], a[240:243], a[12:15], v[92:95]
  buffer_load_dwordx4 v12, s[44:47], s74 offen offset:2048 lds
  v_fma_f32 v249, v249, s15, s15
  v_mfma_f32_16x16x32_bf16 v[220:223], a[248:251], a[12:15], v[220:223]
  ds_read_b64_tr_b16 a[214:215], v4 offset:6144
  v_mul_f32 v108, v108, v254
  v_mfma_f32_16x16x32_bf16 v[220:223], a[252:255], a[28:31], v[220:223]
  ds_read_b64_tr_b16 a[222:223], v5 offset:6144
  v_fma_f32 v255, v255, s15, s15
  v_mfma_f32_16x16x32_bf16 v[204:207], a[252:255], a[24:27], v[204:207]
  v_rcp_f32 v255, v255
  v_mfma_f32_16x16x32_bf16 v[204:207], a[248:251], a[8:11], v[204:207]
  buffer_load_dwordx4 v13, s[44:47], s74 offen offset:3072 lds
  v_mfma_f32_16x16x32_bf16 v[188:191], a[248:251], a[4:7], v[188:191]
  s_waitcnt vmcnt(14)
  ds_read_b64_tr_b16 a[224:225], v2 offset:8192
  v_mul_f32 v109, v109, v255
  v_mfma_f32_16x16x32_bf16 v[188:191], a[252:255], a[20:23], v[188:191]
  s_mov_b32 s73, 0x200080
  ds_read_b64_tr_b16 a[232:233], v3 offset:8192
  v_rcp_f32 v249, v249
  v_cvt_pk_bf16_f32 v106, v108, v109
  v_mfma_f32_16x16x32_bf16 v[172:175], a[252:255], a[16:19], v[172:175]
  s_add_u32 m0, s72, 0
  v_mul_f32 v110, v110, v249
  v_mul_f32 v250, v111, v111
  v_mfma_f32_16x16x32_bf16 v[172:175], a[248:251], a[0:3], v[172:175]
  buffer_load_dwordx4 v10, s[44:47], s73 offen lds
  v_mfma_f32_16x16x32_bf16 v[32:35], a[192:195], a[160:163], v[32:35]
  s_waitcnt lgkmcnt(4)
  ds_read_b64_tr_b16 a[240:241], v4 offset:8192
  v_fma_f32 v250, v250, s80, v248
  v_mfma_f32_16x16x32_bf16 v[32:35], a[196:199], a[176:179], v[32:35]
  ds_read_b64_tr_b16 a[248:249], v5 offset:8192
  v_mul_f32 v250, v250, v111
  v_mfma_f32_16x16x32_bf16 v[48:51], a[196:199], a[180:183], v[48:51]
  v_exp_f32 v250, v250
  s_cmp_eq_u32 s14, 12
  s_cbranch_scc1 L_t312
L_r312:
  v_mfma_f32_16x16x32_bf16 v[48:51], a[192:195], a[164:167], v[48:51]
  buffer_load_dwordx4 v11, s[44:47], s73 offen offset:1024 lds
  v_mfma_f32_16x16x32_bf16 v[64:67], a[192:195], a[168:171], v[64:67]
  s_waitcnt vmcnt(14)
  ds_read_b64_tr_b16 a[226:227], v2 offset:10240
  v_fma_f32 v250, v250, s15, s15
  v_mfma_f32_16x16x32_bf16 v[64:67], a[196:199], a[184:187], v[64:67]
  ds_read_b64_tr_b16 a[234:235], v3 offset:10240
  v_add_u32 v241, 8, v1
  v_mfma_f32_16x16x32_bf16 v[80:83], a[196:199], a[188:191], v[80:83]
  ds_read_b64_tr_b16 a[242:243], v4 offset:10240
  v_mul_f32 v251, v112, v112
  v_mfma_f32_16x16x32_bf16 v[80:83], a[192:195], a[172:175], v[80:83]
  buffer_load_dwordx4 v12, s[44:47], s73 offen offset:2048 lds
  v_mfma_f32_16x16x32_bf16 v[208:211], a[200:203], a[172:175], v[208:211]
  ds_read_b64_tr_b16 a[250:251], v5 offset:10240
  v_fma_f32 v251, v251, s80, v248
  v_mfma_f32_16x16x32_bf16 v[208:211], a[204:207], a[188:191], v[208:211]
  ds_read_b128 a[32:35], v247 offset:8192
  v_mul_f32 v251, v251, v112
  v_mfma_f32_16x16x32_bf16 v[192:195], a[204:207], a[184:187], v[192:195]
  v_rcp_f32 v250, v250
  v_mfma_f32_16x16x32_bf16 v[192:195], a[200:203], a[168:171], v[192:195]
  buffer_load_dwordx4 v13, s[44:47], s73 offen offset:3072 lds
  v_mfma_f32_16x16x32_bf16 v[176:179], a[200:203], a[164:167], v[176:179]
  s_waitcnt vmcnt(14)
  ds_read_b64_tr_b16 a[228:229], v2 offset:12288
  v_mul_f32 v111, v111, v250
  v_mfma_f32_16x16x32_bf16 v[176:179], a[204:207], a[180:183], v[176:179]
  s_mov_b32 s74, 0x240080
  ds_read_b64_tr_b16 a[236:237], v3 offset:12288
  v_cvt_pk_bf16_f32 v107, v110, v111
  v_mfma_f32_16x16x32_bf16 v[160:163], a[204:207], a[176:179], v[160:163]
  s_add_u32 m0, s72, 0x1000
  v_exp_f32 v251, v251
  v_mfma_f32_16x16x32_bf16 v[160:163], a[200:203], a[160:163], v[160:163]
  buffer_load_dwordx4 v10, s[44:47], s74 offen lds
  v_mfma_f32_16x16x32_bf16 v[36:39], a[208:211], a[160:163], v[36:39]
  s_waitcnt lgkmcnt(4)
  ds_read_b64_tr_b16 a[244:245], v4 offset:12288
  v_fma_f32 v251, v251, s15, s15
  v_mfma_f32_16x16x32_bf16 v[36:39], a[212:215], a[176:179], v[36:39]
  ds_read_b64_tr_b16 a[252:253], v5 offset:12288
  v_mul_f32 v252, v113, v113
  v_mfma_f32_16x16x32_bf16 v[52:55], a[212:215], a[180:183], v[52:55]
  v_rcp_f32 v251, v251
  v_mfma_f32_16x16x32_bf16 v[52:55], a[208:211], a[164:167], v[52:55]
  buffer_load_dwordx4 v11, s[44:47], s74 offen offset:1024 lds
  v_mfma_f32_16x16x32_bf16 v[68:71], a[208:211], a[168:171], v[68:71]
  s_waitcnt vmcnt(14)
  ds_read_b64_tr_b16 a[230:231], v2 offset:14336
  v_mul_f32 v112, v112, v251
  v_mfma_f32_16x16x32_bf16 v[68:71], a[212:215], a[184:187], v[68:71]
  ds_read_b64_tr_b16 a[238:239], v3 offset:14336
  v_fma_f32 v252, v252, s80, v248
  v_mfma_f32_16x16x32_bf16 v[84:87], a[212:215], a[188:191], v[84:87]
  ds_read_b64_tr_b16 a[246:247], v4 offset:14336
  v_mul_f32 v252, v252, v113
  v_mfma_f32_16x16x32_bf16 v[84:87], a[208:211], a[172:175], v[84:87]
  buffer_load_dwordx4 v12, s[44:47], s74 offen offset:2048 lds
  v_mfma_f32_16x16x32_bf16 v[212:215], a[216:219], a[172:175], v[212:215]
  ds_read_b64_tr_b16 a[254:255], v5 offset:14336
  v_mul_f32 v253, v114, v114
  v_mfma_f32_16x16x32_bf16 v[212:215], a[220:223], a[188:191], v[212:215]
  ds_read_b128 a[48:51], v247 offset:12288
  v_fma_f32 v253, v253, s80, v248
  v_mfma_f32_16x16x32_bf16 v[196:199], a[220:223], a[184:187], v[196:199]
  v_exp_f32 v252, v252
  v_mfma_f32_16x16x32_bf16 v[196:199], a[216:219], a[168:171], v[196:199]
  buffer_load_dwordx4 v13, s[44:47], s74 offen offset:3072 lds
  v_mfma_f32_16x16x32_bf16 v[180:183], a[216:219], a[164:167], v[180:183]
  s_waitcnt vmcnt(14)
  ds_read_b64_tr_b16 a[192:193], v2 offset:16384
  v_fma_f32 v252, v252, s15, s15
  v_mfma_f32_16x16x32_bf16 v[180:183], a[220:223], a[180:183], v[180:183]
  s_mov_b32 s73, 0x180000
  ds_read_b64_tr_b16 a[200:201], v3 offset:16384
  v_mul_f32 v253, v253, v114
  v_mfma_f32_16x16x32_bf16 v[164:167], a[220:223], a[176:179], v[164:167]
  s_add_u32 m0, s72, 0x2000
  v_rcp_f32 v252, v252
  v_mfma_f32_16x16x32_bf16 v[164:167], a[216:219], a[160:163], v[164:167]
  buffer_load_dwordx4 v10, s[44:47], s73 offen lds
  v_mfma_f32_16x16x32_bf16 v[40:43], a[224:227], a[160:163], v[40:43]
  s_waitcnt lgkmcnt(4)
  ds_read_b64_tr_b16 a[208:209], v4 offset:16384
  v_mul_f32 v113, v113, v252
  v_mfma_f32_16x16x32_bf16 v[40:43], a[228:231], a[176:179], v[40:43]
  ds_read_b64_tr_b16 a[216:217], v5 offset:16384
  v_exp_f32 v253, v253
  v_mfma_f32_16x16x32_bf16 v[56:59], a[228:231], a[180:183], v[56:59]
  v_cvt_pk_bf16_f32 v112, v112, v113
  s_cmp_eq_u32 s14, 13
  s_cbranch_scc1 L_t313
L_r313:
  v_mfma_f32_16x16x32_bf16 v[56:59], a[224:227], a[164:167], v[56:59]
  buffer_load_dwordx4 v11, s[44:47], s73 offen offset:1024 lds
  v_mfma_f32_16x16x32_bf16 v[72:75], a[224:227], a[168:171], v[72:75]
  s_waitcnt vmcnt(14)
  ds_read_b64_tr_b16 a[194:195], v2 offset:18432
  v_fma_f32 v253, v253, s15, s15
  v_mfma_f32_16x16x32_bf16 v[72:75], a[228:231], a[184:187], v[72:75]
  ds_read_b64_tr_b16 a[202:203], v3 offset:18432
  v_mul_f32 v254, v115, v115
  v_mfma_f32_16x16x32_bf16 v[88:91], a[228:231], a[188:191], v[88:91]
  ds_read_b64_tr_b16 a[210:211], v4 offset:18432
  v_fma_f32 v254, v254, s80, v248
  v_mfma_f32_16x16x32_bf16 v[88:91], a[224:227], a[172:175], v[88:91]
  buffer_load_dwordx4 v12, s[44:47], s73 offen offset:2048 lds
  v_mfma_f32_16x16x32_bf16 v[216:219], a[232:235], a[172:175], v[216:219]
  ds_read_b64_tr_b16 a[218:219], v5 offset:18432
  v_mul_f32 v254, v254, v115
  v_mfma_f32_16x16x32_bf16 v[216:219], a[236:239], a[188:191], v[216:219]
  ds_read_b128 a[36:39], v247 offset:9216
  v_add_u32 v246, s77, v1
  v_mfma_f32_16x16x32_bf16 v[200:203], a[236:239], a[184:187], v[200:203]
  v_rcp_f32 v253, v253
  v_mfma_f32_16x16x32_bf16 v[200:203], a[232:235], a[168:171], v[200:203]
  buffer_load_dwordx4 v13, s[44:47], s73 offen offset:3072 lds
  v_mfma_f32_16x16x32_bf16 v[184:187], a[232:235], a[164:167], v[184:187]
  s_waitcnt vmcnt(14)
  ds_read_b64_tr_b16 a[196:197], v2 offset:20480
  v_mul_f32 v114, v114, v253
  v_mfma_f32_16x16x32_bf16 v[184:187], a[236:239], a[180:183], v[184:187]
  s_mov_b32 s74, 0x1c0000
  ds_read_b64_tr_b16 a[204:205], v3 offset:20480
  v_mul_f32 v255, v116, v116
  v_mfma_f32_16x16x32_bf16 v[168:171], a[236:239], a[176:179], v[168:171]
  s_add_u32 m0, s72, 0x3000
  v_exp_f32 v254, v254
  v_mfma_f32_16x16x32_bf16 v[168:171], a[232:235], a[160:163], v[168:171]
  buffer_load_dwordx4 v10, s[44:47], s74 offen lds
  v_mfma_f32_16x16x32_bf16 v[44:47], a[240:243], a[160:163], v[44:47]
  ds_read_b64_tr_b16 a[212:213], v4 offset:20480
  v_fma_f32 v254, v254, s15, s15
  v_mfma_f32_16x16x32_bf16 v[44:47], a[244:247], a[176:179], v[44:47]
  ds_read_b64_tr_b16 a[220:221], v5 offset:20480
  v_fma_f32 v255, v255, s80, v248
  v_mfma_f32_16x16x32_bf16 v[60:63], a[244:247], a[180:183], v[60:63]
  v_rcp_f32 v254, v254
  v_mfma_f32_16x16x32_bf16 v[60:63], a[240:243], a[164:167], v[60:63]
  buffer_load_dwordx4 v11, s[44:47], s74 offen offset:1024 lds
  v_mfma_f32_16x16x32_bf16 v[76:79], a[240:243], a[168:171], v[76:79]
  s_waitcnt vmcnt(14)
  ds_read_b64_tr_b16 a[198:199], v2 offset:22528
  v_mul_f32 v115, v115, v254
  v_mfma_f32_16x16x32_bf16 v[76:79], a[244:247], a[184:187], v[76:79]
  ds_read_b64_tr_b16 a[206:207], v3 offset:22528
  v_cvt_pk_bf16_f32 v113, v114, v115
  v_mfma_f32_16x16x32_bf16 v[92:95], a[244:247], a[188:191], v[92:95]
  s_waitcnt lgkmcnt(4)
  ds_read_b64_tr_b16 a[214:215], v4 offset:22528
  v_mul_f32 v255, v255, v116
  v_mfma_f32_16x16x32_bf16 v[92:95], a[240:243], a[172:175], v[92:95]
  buffer_load_dwordx4 v12, s[44:47], s74 offen offset:2048 lds
  v_mfma_f32_16x16x32_bf16 v[220:223], a[248:251], a[172:175], v[220:223]
  ds_read_b64_tr_b16 a[222:223], v5 offset:22528
  v_mul_f32 v249, v117, v117
  v_mfma_f32_16x16x32_bf16 v[220:223], a[252:255], a[188:191], v[220:223]
  ds_read_b128 a[52:55], v247 offset:13312
  v_fma_f32 v249, v249, s80, v248
  v_mfma_f32_16x16x32_bf16 v[204:207], a[252:255], a[184:187], v[204:207]
  v_exp_f32 v255, v255
  v_mfma_f32_16x16x32_bf16 v[204:207], a[248:251], a[168:171], v[204:207]
  buffer_load_dwordx4 v13, s[44:47], s74 offen offset:3072 lds
  v_mfma_f32_16x16x32_bf16 v[188:191], a[248:251], a[164:167], v[188:191]
  s_waitcnt vmcnt(14)
  ds_read_b64_tr_b16 a[224:225], v2
  v_fma_f32 v255, v255, s15, s15
  v_mul_f32 v250, v118, v118
  v_mfma_f32_16x16x32_bf16 v[188:191], a[252:255], a[180:183], v[188:191]
  s_mov_b32 s73, 0x180080
  ds_read_b64_tr_b16 a[232:233], v3
  v_mul_f32 v249, v249, v117
  v_mfma_f32_16x16x32_bf16 v[172:175], a[252:255], a[176:179], v[172:175]
  s_add_u32 m0, s72, 0x4000
  v_rcp_f32 v255, v255
  v_mfma_f32_16x16x32_bf16 v[172:175], a[248:251], a[160:163], v[172:175]
  buffer_load_dwordx4 v10, s[44:47], s73 offen lds
  v_mfma_f32_16x16x32_bf16 v[32:35], a[192:195], a[128:131], v[32:35]
  s_waitcnt lgkmcnt(4)
  ds_read_b64_tr_b16 a[240:241], v4
  v_mul_f32 v116, v116, v255
  v_mfma_f32_16x16x32_bf16 v[32:35], a[196:199], a[144:147], v[32:35]
  ds_read_b64_tr_b16 a[248:249], v5
  v_exp_f32 v249, v249
  v_mfma_f32_16x16x32_bf16 v[48:51], a[196:199], a[148:151], v[48:51]
  v_fma_f32 v250, v250, s80, v248
  s_cmp_eq_u32 s14, 14
  s_cbranch_scc1 L_t314
L_r314:
  v_mfma_f32_16x16x32_bf16 v[48:51], a[192:195], a[132:135], v[48:51]
  buffer_load_dwordx4 v11, s[44:47], s73 offen offset:1024 lds
  v_mfma_f32_16x16x32_bf16 v[64:67], a[192:195], a[136:139], v[64:67]
  s_waitcnt vmcnt(14)
  ds_read_b64_tr_b16 a[226:227], v2 offset:2048
  v_fma_f32 v249, v249, s15, s15
  v_mfma_f32_16x16x32_bf16 v[64:67], a[196:199], a[152:155], v[64:67]
  ds_read_b64_tr_b16 a[234:235], v3 offset:2048
  v_mul_f32 v250, v250, v118
  v_mfma_f32_16x16x32_bf16 v[80:83], a[196:199], a[156:159], v[80:83]
  ds_read_b64_tr_b16 a[242:243], v4 offset:2048
  v_exp_f32 v250, v250
  v_mfma_f32_16x16x32_bf16 v[80:83], a[192:195], a[140:143], v[80:83]
  buffer_load_dwordx4 v12, s[44:47], s73 offen offset:2048 lds
  v_mfma_f32_16x16x32_bf16 v[208:211], a[200:203], a[140:143], v[208:211]
  ds_read_b64_tr_b16 a[250:251], v5 offset:2048
  v_fma_f32 v250, v250, s15, s15
  v_mfma_f32_16x16x32_bf16 v[208:211], a[204:207], a[156:159], v[208:211]
  ds_read_b128 a[40:43], v247 offset:10240
  v_mul_f32 v251, v119, v119
  v_mfma_f32_16x16x32_bf16 v[192:195], a[204:207], a[152:155], v[192:195]
  v_rcp_f32 v249, v249
  v_mfma_f32_16x16x32_bf16 v[192:195], a[200:203], a[136:139], v[192:195]
  buffer_load_dwordx4 v13, s[44:47], s73 offen offset:3072 lds
L_w4:
L_p1799:
  s_cmp_eq_u32 s95, 1
  s_cbranch_scc1 L_p3427
  v_mfma_f32_16x16x32_bf16 v[176:179], a[200:203], a[132:135], v[176:179]
  s_waitcnt vmcnt(14)
  ds_read_b64_tr_b16 a[228:229], v2 offset:4096
  v_mul_f32 v117, v117, v249
  v_mfma_f32_16x16x32_bf16 v[176:179], a[204:207], a[148:151], v[176:179]
  s_mov_b32 s74, 0x1c0080
  ds_read_b64_tr_b16 a[236:237], v3 offset:4096
  v_fma_f32 v251, v251, s80, v248
  v_cvt_pk_bf16_f32 v114, v116, v117
  v_mfma_f32_16x16x32_bf16 v[160:163], a[204:207], a[144:147], v[160:163]
  s_add_u32 m0, s72, 0x5000
  v_rcp_f32 v250, v250
  v_mfma_f32_16x16x32_bf16 v[160:163], a[200:203], a[128:131], v[160:163]
  buffer_load_dwordx4 v10, s[44:47], s74 offen lds
  v_mul_f32 v252, v120, v120
  v_mfma_f32_16x16x32_bf16 v[36:39], a[208:211], a[128:131], v[36:39]
  ds_read_b64_tr_b16 a[244:245], v4 offset:4096
  v_mul_f32 v118, v118, v250
  v_mfma_f32_16x16x32_bf16 v[36:39], a[212:215], a[144:147], v[36:39]
  ds_read_b64_tr_b16 a[252:253], v5 offset:4096
  v_mul_f32 v251, v251, v119
  v_mfma_f32_16x16x32_bf16 v[52:55], a[212:215], a[148:151], v[52:55]
  v_exp_f32 v251, v251
  v_mfma_f32_16x16x32_bf16 v[52:55], a[208:211], a[132:135], v[52:55]
  buffer_load_dwordx4 v11, s[44:47], s74 offen offset:1024 lds
  v_mfma_f32_16x16x32_bf16 v[68:71], a[208:211], a[136:139], v[68:71]
  s_waitcnt vmcnt(14)
  ds_read_b64_tr_b16 a[230:231], v2 offset:6144
  v_fma_f32 v251, v251, s15, s15
  v_mfma_f32_16x16x32_bf16 v[68:71], a[212:215], a[152:155], v[68:71]
  ds_read_b64_tr_b16 a[238:239], v3 offset:6144
  v_fma_f32 v252, v252, s80, v248
  v_mfma_f32_16x16x32_bf16 v[84:87], a[212:215], a[156:159], v[84:87]
  s_waitcnt lgkmcnt(4)
  ds_read_b64_tr_b16 a[246:247], v4 offset:6144
  v_mul_f32 v252, v252, v120
  v_mfma_f32_16x16x32_bf16 v[84:87], a[208:211], a[140:143], v[84:87]
  buffer_load_dwordx4 v12, s[44:47], s74 offen offset:2048 lds
  v_mfma_f32_16x16x32_bf16 v[212:215], a[216:219], a[140:143], v[212:215]
  ds_read_b64_tr_b16 a[254:255], v5 offset:6144
  v_exp_f32 v252, v252
  v_mul_f32 v253, v121, v121
  v_mfma_f32_16x16x32_bf16 v[212:215], a[220:223], a[156:159], v[212:215]
  ds_read_b128 a[56:59], v247 offset:14336
  v_fma_f32 v252, v252, s15, s15
  v_fma_f32 v253, v253, s80, v248
  v_mfma_f32_16x16x32_bf16 v[196:199], a[220:223], a[152:155], v[196:199]
  v_rcp_f32 v251, v251
  v_mul_f32 v253, v253, v121
  v_mfma_f32_16x16x32_bf16 v[196:199], a[216:219], a[136:139], v[196:199]
  buffer_load_dwordx4 v13, s[44:47], s74 offen offset:3072 lds
  v_exp_f32 v253, v253
  v_mfma_f32_16x16x32_bf16 v[180:183], a[216:219], a[132:135], v[180:183]
  s_waitcnt vmcnt(14)
  ds_read_b64_tr_b16 a[192:193], v2 offset:8192
  v_mul_f32 v119, v119, v251
  v_mfma_f32_16x16x32_bf16 v[180:183], a[220:223], a[148:151], v[180:183]
  s_mov_b32 s73, 0x100000
  ds_read_b64_tr_b16 a[200:201], v3 offset:8192
  v_cvt_pk_bf16_f32 v115, v118, v119
  v_mfma_f32_16x16x32_bf16 v[164:167], a[220:223], a[144:147], v[164:167]
  s_add_u32 m0, s72, 0
  v_rcp_f32 v252, v252
  v_mfma_f32_16x16x32_bf16 v[164:167], a[216:219], a[128:131], v[164:167]
  buffer_load_dwordx4 v10, s[44:47], s73 offen lds
  v_mfma_f32_16x16x32_bf16 v[40:43], a[224:227], a[128:131], v[40:43]
  s_waitcnt lgkmcnt(3)
  ds_read_b64_tr_b16 a[208:209], v4 offset:8192
  v_mul_f32 v120, v120, v252
  v_mfma_f32_16x16x32_bf16 v[40:43], a[228:231], a[144:147], v[40:43]
  ds_read_b64_tr_b16 a[216:217], v5 offset:8192
  v_fma_f32 v253, v253, s15, s15
  v_mfma_f32_16x16x32_bf16 v[56:59], a[228:231], a[148:151], v[56:59]
  v_rcp_f32 v253, v253
  s_cmp_eq_u32 s14, 15
  s_cbranch_scc1 L_t315
L_r315:
  v_mfma_f32_16x16x32_bf16 v[56:59], a[224:227], a[132:135], v[56:59]
  buffer_load_dwordx4 v11, s[44:47], s73 offen offset:1024 lds
  v_mfma_f32_16x16x32_bf16 v[72:75], a[224:227], a[136:139], v[72:75]
  s_waitcnt vmcnt(14)
  ds_read_b64_tr_b16 a[194:195], v2 offset:10240
  v_mul_f32 v121, v121, v253
  v_mfma_f32_16x16x32_bf16 v[72:75], a[228:231], a[152:155], v[72:75]
  ds_read_b64_tr_b16 a[202:203], v3 offset:10240
  v_mul_f32 v254, v122, v122
  v_mfma_f32_16x16x32_bf16 v[88:91], a[228:231], a[156:159], v[88:91]
  ds_read_b64_tr_b16 a[210:211], v4 offset:10240
  v_fma_f32 v254, v254, s80, v248
  v_mfma_f32_16x16x32_bf16 v[88:91], a[224:227], a[140:143], v[88:91]
  buffer_load_dwordx4 v12, s[44:47], s73 offen offset:2048 lds
  v_mfma_f32_16x16x32_bf16 v[216:219], a[232:235], a[140:143], v[216:219]
  ds_read_b64_tr_b16 a[218:219], v5 offset:10240
  v_mul_f32 v254, v254, v122
  v_mfma_f32_16x16x32_bf16 v[216:219], a[236:239], a[156:159], v[216:219]
  ds_read_b128 a[44:47], v247 offset:11264
  v_cvt_pk_bf16_f32 v120, v120, v121
  v_mfma_f32_16x16x32_bf16 v[200:203], a[236:239], a[152:155], v[200:203]
  v_exp_f32 v254, v254
  v_mfma_f32_16x16x32_bf16 v[200:203], a[232:235], a[136:139], v[200:203]
  buffer_load_dwordx4 v13, s[44:47], s73 offen offset:3072 lds
  v_mfma_f32_16x16x32_bf16 v[184:187], a[232:235], a[132:135], v[184:187]
  s_waitcnt vmcnt(14)
  ds_read_b64_tr_b16 a[196:197], v2 offset:12288
  v_fma_f32 v254, v254, s15, s15
  v_mfma_f32_16x16x32_bf16 v[184:187], a[236:239], a[148:151], v[184:187]
  s_mov_b32 s74, 0x140000
  ds_read_b64_tr_b16 a[204:205], v3 offset:12288
  v_mul_f32 v255, v123, v123
  v_mfma_f32_16x16x32_bf16 v[168:171], a[236:239], a[144:147], v[168:171]
  s_add_u32 m0, s72, 0x1000
  v_rcp_f32 v254, v254
  v_mfma_f32_16x16x32_bf16 v[168:171], a[232:235], a[128:131], v[168:171]
  buffer_load_dwordx4 v10, s[44:47], s74 offen lds
  v_mfma_f32_16x16x32_bf16 v[44:47], a[240:243], a[128:131], v[44:47]
  ds_read_b64_tr_b16 a[212:213], v4 offset:12288
  v_mul_f32 v122, v122, v254
  v_mfma_f32_16x16x32_bf16 v[44:47], a[244:247], a[144:147], v[44:47]
  ds_read_b64_tr_b16 a[220:221], v5 offset:12288
  v_fma_f32 v255, v255, s80, v248
  v_mfma_f32_16x16x32_bf16 v[60:63], a[244:247], a[148:151], v[60:63]
  v_mul_f32 v255, v255, v123
  v_mfma_f32_16x16x32_bf16 v[60:63], a[240:243], a[132:135], v[60:63]
  buffer_load_dwordx4 v11, s[44:47], s74 offen offset:1024 lds
  v_mfma_f32_16x16x32_bf16 v[76:79], a[240:243], a[136:139], v[76:79]
  s_waitcnt vmcnt(14)
  ds_read_b64_tr_b16 a[198:199], v2 offset:14336
  v_exp_f32 v255, v255
  v_mfma_f32_16x16x32_bf16 v[76:79], a[244:247], a[152:155], v[76:79]
  ds_read_b64_tr_b16 a[206:207], v3 offset:14336
  v_fma_f32 v255, v255, s15, s15
  v_mfma_f32_16x16x32_bf16 v[92:95], a[244:247], a[156:159], v[92:95]
  ds_read_b64_tr_b16 a[214:215], v4 offset:14336
  v_mul_f32 v249, v124, v124
  v_mfma_f32_16x16x32_bf16 v[92:95], a[240:243], a[140:143], v[92:95]
  buffer_load_dwordx4 v12, s[44:47], s74 offen offset:2048 lds
  v_mfma_f32_16x16x32_bf16 v[220:223], a[248:251], a[140:143], v[220:223]
  ds_read_b64_tr_b16 a[222:223], v5 offset:14336
  v_fma_f32 v249, v249, s80, v248
  v_mfma_f32_16x16x32_bf16 v[220:223], a[252:255], a[156:159], v[220:223]
  ds_read_b128 a[60:63], v247 offset:15360
  v_mul_f32 v249, v249, v124
  v_mfma_f32_16x16x32_bf16 v[204:207], a[252:255], a[152:155], v[204:207]
  v_rcp_f32 v255, v255
  v_mfma_f32_16x16x32_bf16 v[204:207], a[248:251], a[136:139], v[204:207]
  buffer_load_dwordx4 v13, s[44:47], s74 offen offset:3072 lds
  v_mfma_f32_16x16x32_bf16 v[188:191], a[248:251], a[132:135], v[188:191]
  s_waitcnt vmcnt(14)
  ds_read_b64_tr_b16 a[224:225], v2 offset:16384
  v_mul_f32 v123, v123, v255
  v_mfma_f32_16x16x32_bf16 v[188:191], a[252:255], a[148:151], v[188:191]
  s_mov_b32 s73, 0x100080
  ds_read_b64_tr_b16 a[232:233], v3 offset:16384
  v_cvt_pk_bf16_f32 v121, v122, v123
  v_mfma_f32_16x16x32_bf16 v[172:175], a[252:255], a[144:147], v[172:175]
  s_add_u32 m0, s72, 0x2000
  s_waitcnt lgkmcnt(5)
  v_exp_f32 v249, v249
  v_mfma_f32_16x16x32_bf16 v[172:175], a[248:251], a[128:131], v[172:175]
  buffer_load_dwordx4 v10, s[44:47], s73 offen lds
  v_mfma_f32_16x16x32_bf16 v[32:35], a[192:195], a[96:99], v[32:35]
  ds_read_b64_tr_b16 a[240:241], v4 offset:16384
  v_fma_f32 v249, v249, s15, s15
  v_mfma_f32_16x16x32_bf16 v[32:35], a[196:199], a[112:115], v[32:35]
  ds_read_b64_tr_b16 a[248:249], v5 offset:16384
  v_mul_f32 v250, v125, v125
  v_mfma_f32_16x16x32_bf16 v[48:51], a[196:199], a[116:119], v[48:51]
  v_rcp_f32 v249, v249
  v_mfma_f32_16x16x32_bf16 v[48:51], a[192:195], a[100:103], v[48:51]
  buffer_load_dwordx4 v11, s[44:47], s73 offen offset:1024 lds
  v_mfma_f32_16x16x32_bf16 v[64:67], a[192:195], a[104:107], v[64:67]
  s_waitcnt vmcnt(14)
  ds_read_b64_tr_b16 a[226:227], v2 offset:18432
  v_mul_f32 v124, v124, v249
  v_mfma_f32_16x16x32_bf16 v[64:67], a[196:199], a[120:123], v[64:67]
  ds_read_b64_tr_b16 a[234:235], v3 offset:18432
  v_fma_f32 v250, v250, s80, v248
  v_mfma_f32_16x16x32_bf16 v[80:83], a[196:199], a[124:127], v[80:83]
  ds_read_b64_tr_b16 a[242:243], v4 offset:18432
  v_mul_f32 v250, v250, v125
  v_mfma_f32_16x16x32_bf16 v[80:83], a[192:195], a[108:111], v[80:83]
  buffer_load_dwordx4 v12, s[44:47], s73 offen offset:2048 lds
  v_mfma_f32_16x16x32_bf16 v[208:211], a[200:203], a[108:111], v[208:211]
  ds_read_b64_tr_b16 a[250:251], v5 offset:18432
  v_mul_f32 v251, v126, v126
  v_mfma_f32_16x16x32_bf16 v[208:211], a[204:207], a[124:127], v[208:211]
  ds_read_b128 a[0:3], v247
  v_fma_f32 v251, v251, s80, v248
  v_mfma_f32_16x16x32_bf16 v[192:195], a[204:207], a[120:123], v[192:195]
  v_exp_f32 v250, v250
  v_mfma_f32_16x16x32_bf16 v[192:195], a[200:203], a[104:107], v[192:195]
  buffer_load_dwordx4 v13, s[44:47], s73 offen offset:3072 lds
  v_mfma_f32_16x16x32_bf16 v[176:179], a[200:203], a[100:103], v[176:179]
  s_waitcnt vmcnt(14)
  ds_read_b64_tr_b16 a[228:229], v2 offset:20480
  v_fma_f32 v250, v250, s15, s15
  v_mfma_f32_16x16x32_bf16 v[176:179], a[204:207], a[116:119], v[176:179]
  s_mov_b32 s74, 0x140080
  ds_read_b64_tr_b16 a[236:237], v3 offset:20480
  v_mul_f32 v251, v251, v126
  v_mfma_f32_16x16x32_bf16 v[160:163], a[204:207], a[112:115], v[160:163]
  s_add_u32 m0, s72, 0x3000
  v_rcp_f32 v250, v250
  v_mfma_f32_16x16x32_bf16 v[160:163], a[200:203], a[96:99], v[160:163]
  buffer_load_dwordx4 v10, s[44:47], s74 offen lds
  v_mfma_f32_16x16x32_bf16 v[36:39], a[208:211], a[96:99], v[36:39]
  s_waitcnt lgkmcnt(4)
  ds_read_b64_tr_b16 a[244:245], v4 offset:20480
  v_mul_f32 v125, v125, v250
  v_mfma_f32_16x16x32_bf16 v[36:39], a[212:215], a[112:115], v[36:39]
  ds_read_b64_tr_b16 a[252:253], v5 offset:20480
  v_mul_f32 v252, v127, v127
  v_cvt_pk_bf16_f32 v122, v124, v125
  v_mfma_f32_16x16x32_bf16 v[52:55], a[212:215], a[116:119], v[52:55]
  v_exp_f32 v251, v251
  v_mfma_f32_16x16x32_bf16 v[52:55], a[208:211], a[100:103], v[52:55]
  buffer_load_dwordx4 v11, s[44:47], s74 offen offset:1024 lds
  v_mfma_f32_16x16x32_bf16 v[68:71], a[208:211], a[104:107], v[68:71]
  s_waitcnt vmcnt(14)
  ds_read_b64_tr_b16 a[230:231], v2 offset:22528
  v_fma_f32 v251, v251, s15, s15
  v_mfma_f32_16x16x32_bf16 v[68:71], a[212:215], a[120:123], v[68:71]
  ds_read_b64_tr_b16 a[238:239], v3 offset:22528
  v_fma_f32 v252, v252, s80, v248
  v_mfma_f32_16x16x32_bf16 v[84:87], a[212:215], a[124:127], v[84:87]
  ds_read_b64_tr_b16 a[246:247], v4 offset:22528
  v_mul_f32 v252, v252, v127
  v_mfma_f32_16x16x32_bf16 v[84:87], a[208:211], a[108:111], v[84:87]
  buffer_load_dwordx4 v12, s[44:47], s74 offen offset:2048 lds
  v_mfma_f32_16x16x32_bf16 v[212:215], a[216:219], a[108:111], v[212:215]
  ds_read_b64_tr_b16 a[254:255], v5 offset:22528
  v_exp_f32 v252, v252
  v_mfma_f32_16x16x32_bf16 v[212:215], a[220:223], a[124:127], v[212:215]
  ds_read_b128 a[16:19], v247 offset:4096
  v_fma_f32 v252, v252, s15, s15
  v_mfma_f32_16x16x32_bf16 v[196:199], a[220:223], a[120:123], v[196:199]
  v_rcp_f32 v251, v251
  v_mfma_f32_16x16x32_bf16 v[196:199], a[216:219], a[104:107], v[196:199]
  buffer_load_dwordx4 v13, s[44:47], s74 offen offset:3072 lds
  v_mfma_f32_16x16x32_bf16 v[180:183], a[216:219], a[100:103], v[180:183]
  s_waitcnt vmcnt(14)
  ds_read_b64_tr_b16 a[192:193], v2
  v_mul_f32 v126, v126, v251
  v_mfma_f32_16x16x32_bf16 v[180:183], a[220:223], a[116:119], v[180:183]
  s_mov_b32 s73, 0x80000
  ds_read_b64_tr_b16 a[200:201], v3
  v_mul_f32 v253, v128, v128
  v_mfma_f32_16x16x32_bf16 v[164:167], a[220:223], a[112:115], v[164:167]
  s_add_u32 m0, s72, 0x4000
  v_rcp_f32 v252, v252
  v_mfma_f32_16x16x32_bf16 v[164:167], a[216:219], a[96:99], v[164:167]
  buffer_load_dwordx4 v10, s[44:47], s73 offen lds
  v_mfma_f32_16x16x32_bf16 v[40:43], a[224:227], a[96:99], v[40:43]
  s_waitcnt lgkmcnt(4)
  ds_read_b64_tr_b16 a[208:209], v4
  v_mul_f32 v127, v127, v252
  v_mfma_f32_16x16x32_bf16 v[40:43], a[228:231], a[112:115], v[40:43]
  ds_read_b64_tr_b16 a[216:217], v5
  v_cvt_pk_bf16_f32 v123, v126, v127
  v_mfma_f32_16x16x32_bf16 v[56:59], a[228:231], a[116:119], v[56:59]
  v_fma_f32 v253, v253, s80, v248
  v_mul_f32 v254, v129, v129
  v_mfma_f32_16x16x32_bf16 v[56:59], a[224:227], a[100:103], v[56:59]
  buffer_load_dwordx4 v11, s[44:47], s73 offen offset:1024 lds
  v_mfma_f32_16x16x32_bf16 v[72:75], a[224:227], a[104:107], v[72:75]
  s_waitcnt vmcnt(14)
  ds_read_b64_tr_b16 a[194:195], v2 offset:2048
  v_mul_f32 v253, v253, v128
  v_mfma_f32_16x16x32_bf16 v[72:75], a[228:231], a[120:123], v[72:75]
  ds_read_b64_tr_b16 a[202:203], v3 offset:2048
  v_fma_f32 v254, v254, s80, v248
  v_mfma_f32_16x16x32_bf16 v[88:91], a[228:231], a[124:127], v[88:91]
  ds_read_b64_tr_b16 a[210:211], v4 offset:2048
  v_mul_f32 v254, v254, v129
  v_mfma_f32_16x16x32_bf16 v[88:91], a[224:227], a[108:111], v[88:91]
  buffer_load_dwordx4 v12, s[44:47], s73 offen offset:2048 lds
  v_mfma_f32_16x16x32_bf16 v[216:219], a[232:235], a[108:111], v[216:219]
  ds_read_b64_tr_b16 a[218:219], v5 offset:2048
  v_exp_f32 v254, v254
  v_mfma_f32_16x16x32_bf16 v[216:219], a[236:239], a[124:127], v[216:219]
  ds_read_b128 a[4:7], v247 offset:1024
  v_fma_f32 v254, v254, s15, s15
  v_mfma_f32_16x16x32_bf16 v[200:203], a[236:239], a[120:123], v[200:203]
  v_exp_f32 v253, v253
  v_mul_f32 v255, v130, v130
  v_mfma_f32_16x16x32_bf16 v[200:203], a[232:235], a[104:107], v[200:203]
  buffer_load_dwordx4 v13, s[44:47], s73 offen offset:3072 lds
  v_fma_f32 v255, v255, s80, v248
  v_mfma_f32_16x16x32_bf16 v[184:187], a[232:235], a[100:103], v[184:187]
  s_waitcnt vmcnt(14)
  ds_read_b64_tr_b16 a[196:197], v2 offset:4096
  v_fma_f32 v253, v253, s15, s15
  v_mul_f32 v255, v255, v130
  v_mfma_f32_16x16x32_bf16 v[184:187], a[236:239], a[116:119], v[184:187]
  s_mov_b32 s74, 0xc0000
  ds_read_b64_tr_b16 a[204:205], v3 offset:4096
  v_rcp_f32 v254, v254
  v_mfma_f32_16x16x32_bf16 v[168:171], a[236:239], a[112:115], v[168:171]
  s_add_u32 m0, s72, 0x5000
  v_rcp_f32 v253, v253
  v_mfma_f32_16x16x32_bf16 v[168:171], a[232:235], a[96:99], v[168:171]
  buffer_load_dwordx4 v10, s[44:47], s74 offen lds
  v_mfma_f32_16x16x32_bf16 v[44:47], a[240:243], a[96:99], v[44:47]
  ds_read_b64_tr_b16 a[212:213], v4 offset:4096
  v_mul_f32 v128, v128, v253
  v_mfma_f32_16x16x32_bf16 v[44:47], a[244:247], a[112:115], v[44:47]
  ds_read_b64_tr_b16 a[220:221], v5 offset:4096
  v_mul_f32 v129, v129, v254
  v_mfma_f32_16x16x32_bf16 v[60:63], a[244:247], a[116:119], v[60:63]
  v_exp_f32 v255, v255
  v_cvt_pk_bf16_f32 v128, v128, v129
  v_mfma_f32_16x16x32_bf16 v[60:63], a[240:243], a[100:103], v[60:63]
  buffer_load_dwordx4 v11, s[44:47], s74 offen offset:1024 lds
  v_mfma_f32_16x16x32_bf16 v[76:79], a[240:243], a[104:107], v[76:79]
  s_waitcnt vmcnt(14)
  ds_read_b64_tr_b16 a[198:199], v2 offset:6144
  v_fma_f32 v255, v255, s15, s15
  v_mfma_f32_16x16x32_bf16 v[76:79], a[244:247], a[120:123], v[76:79]
  ds_read_b64_tr_b16 a[206:207], v3 offset:6144
  v_mul_f32 v249, v131, v131
  v_mfma_f32_16x16x32_bf16 v[92:95], a[244:247], a[124:127], v[92:95]
  s_waitcnt lgkmcnt(4)
  ds_read_b64_tr_b16 a[214:215], v4 offset:6144
  v_fma_f32 v249, v249, s80, v248
  v_mfma_f32_16x16x32_bf16 v[92:95], a[240:243], a[108:111], v[92:95]
  buffer_load_dwordx4 v12, s[44:47], s74 offen offset:2048 lds
  v_mfma_f32_16x16x32_bf16 v[220:223], a[248:251], a[108:111], v[220:223]
  ds_read_b64_tr_b16 a[222:223], v5 offset:6144
  v_mul_f32 v249, v249, v131
  v_mfma_f32_16x16x32_bf16 v[220:223], a[252:255], a[124:127], v[220:223]
  ds_read_b128 a[20:23], v247 offset:5120
  v_mfma_f32_16x16x32_bf16 v[204:207], a[252:255], a[120:123], v[204:207]
  v_rcp_f32 v255, v255
  v_mfma_f32_16x16x32_bf16 v[204:207], a[248:251], a[104:107], v[204:207]
  buffer_load_dwordx4 v13, s[44:47], s74 offen offset:3072 lds
  v_mfma_f32_16x16x32_bf16 v[188:191], a[248:251], a[100:103], v[188:191]
  s_waitcnt vmcnt(14)
  ds_read_b64_tr_b16 a[224:225], v2 offset:8192
  v_mul_f32 v130, v130, v255
  v_mfma_f32_16x16x32_bf16 v[188:191], a[252:255], a[116:119], v[188:191]
  s_mov_b32 s73, 0x80080
  ds_read_b64_tr_b16 a[232:233], v3 offset:8192
  v_mul_f32 v250, v132, v132
  v_mfma_f32_16x16x32_bf16 v[172:175], a[252:255], a[112:115], v[172:175]
  s_add_u32 m0, s72, 0
  v_exp_f32 v249, v249
  v_mfma_f32_16x16x32_bf16 v[172:175], a[248:251], a[96:99], v[172:175]
  buffer_load_dwordx4 v10, s[44:47], s73 offen lds
  v_mfma_f32_16x16x32_bf16 v[32:35], a[192:195], a[64:67], v[32:35]
  s_waitcnt lgkmcnt(4)
  ds_read_b64_tr_b16 a[240:241], v4 offset:8192
  v_fma_f32 v249, v249, s15, s15
  v_mfma_f32_16x16x32_bf16 v[32:35], a[196:199], a[80:83], v[32:35]
  ds_read_b64_tr_b16 a[248:249], v5 offset:8192
  v_fma_f32 v250, v250, s80, v248
  v_mfma_f32_16x16x32_bf16 v[48:51], a[196:199], a[84:87], v[48:51]
  v_rcp_f32 v249, v249
  v_mfma_f32_16x16x32_bf16 v[48:51], a[192:195], a[68:71], v[48:51]
  buffer_load_dwordx4 v11, s[44:47], s73 offen offset:1024 lds
  v_mfma_f32_16x16x32_bf16 v[64:67], a[192:195], a[72:75], v[64:67]
  s_waitcnt vmcnt(14)
  ds_read_b64_tr_b16 a[226:227], v2 offset:10240
  v_mul_f32 v131, v131, v249
  v_mfma_f32_16x16x32_bf16 v[64:67], a[196:199], a[88:91], v[64:67]
  ds_read_b64_tr_b16 a[234:235], v3 offset:10240
  v_cvt_pk_bf16_f32 v129, v130, v131
  v_mfma_f32_16x16x32_bf16 v[80:83], a[196:199], a[92:95], v[80:83]
  ds_read_b64_tr_b16 a[242:243], v4 offset:10240
  v_mul_f32 v250, v250, v132
  v_mfma_f32_16x16x32_bf16 v[80:83], a[192:195], a[76:79], v[80:83]
  buffer_load_dwordx4 v12, s[44:47], s73 offen offset:2048 lds
  v_mfma_f32_16x16x32_bf16 v[208:211], a[200:203], a[76:79], v[208:211]
  ds_read_b64_tr_b16 a[250:251], v5 offset:10240
  v_mul_f32 v251, v133, v133
  v_mfma_f32_16x16x32_bf16 v[208:211], a[204:207], a[92:95], v[208:211]
  ds_read_b128 a[8:11], v247 offset:2048
  v_fma_f32 v251, v251, s80, v248
  v_mfma_f32_16x16x32_bf16 v[192:195], a[204:207], a[88:91], v[192:195]
  v_exp_f32 v250, v250
  v_mfma_f32_16x16x32_bf16 v[192:195], a[200:203], a[72:75], v[192:195]
  buffer_load_dwordx4 v13, s[44:47], s73 offen offset:3072 lds
  v_mfma_f32_16x16x32_bf16 v[176:179], a[200:203], a[68:71], v[176:179]
  s_waitcnt vmcnt(14)
  ds_read_b64_tr_b16 a[228:229], v2 offset:12288
  v_fma_f32 v250, v250, s15, s15
  v_mfma_f32_16x16x32_bf16 v[176:179], a[204:207], a[84:87], v[176:179]
  s_mov_b32 s74, 0xc0080
  ds_read_b64_tr_b16 a[236:237], v3 offset:12288
  v_mul_f32 v251, v251, v133
  v_mfma_f32_16x16x32_bf16 v[160:163], a[204:207], a[80:83], v[160:163]
  s_add_u32 m0, s72, 0x1000
  v_rcp_f32 v250, v250
  v_mfma_f32_16x16x32_bf16 v[160:163], a[200:203], a[64:67], v[160:163]
  buffer_load_dwordx4 v10, s[44:47], s74 offen lds
  v_mfma_f32_16x16x32_bf16 v[36:39], a[208:211], a[64:67], v[36:39]
  ds_read_b64_tr_b16 a[244:245], v4 offset:12288
  v_mul_f32 v132, v132, v250
  v_mfma_f32_16x16x32_bf16 v[36:39], a[212:215], a[80:83], v[36:39]
  ds_read_b64_tr_b16 a[252:253], v5 offset:12288
  v_mul_f32 v252, v134, v134
  v_mfma_f32_16x16x32_bf16 v[52:55], a[212:215], a[84:87], v[52:55]
  v_exp_f32 v251, v251
  v_mfma_f32_16x16x32_bf16 v[52:55], a[208:211], a[68:71], v[52:55]
  buffer_load_dwordx4 v11, s[44:47], s74 offen offset:1024 lds
  v_mfma_f32_16x16x32_bf16 v[68:71], a[208:211], a[72:75], v[68:71]
  s_waitcnt vmcnt(14)
  ds_read_b64_tr_b16 a[230:231], v2 offset:14336
  v_fma_f32 v251, v251, s15, s15
  v_mfma_f32_16x16x32_bf16 v[68:71], a[212:215], a[88:91], v[68:71]
  ds_read_b64_tr_b16 a[238:239], v3 offset:14336
  v_fma_f32 v252, v252, s80, v248
  v_mfma_f32_16x16x32_bf16 v[84:87], a[212:215], a[92:95], v[84:87]
  s_waitcnt lgkmcnt(4)
  ds_read_b64_tr_b16 a[246:247], v4 offset:14336
  v_mul_f32 v252, v252, v134
  v_mfma_f32_16x16x32_bf16 v[84:87], a[208:211], a[76:79], v[84:87]
  buffer_load_dwordx4 v12, s[44:47], s74 offen offset:2048 lds
  v_mul_f32 v253, v135, v135
  v_mfma_f32_16x16x32_bf16 v[212:215], a[216:219], a[76:79], v[212:215]
  ds_read_b64_tr_b16 a[254:255], v5 offset:14336
  v_exp_f32 v252, v252
  v_mfma_f32_16x16x32_bf16 v[212:215], a[220:223], a[92:95], v[212:215]
  ds_read_b128 a[24:27], v247 offset:6144
  v_fma_f32 v252, v252, s15, s15
  v_mfma_f32_16x16x32_bf16 v[196:199], a[220:223], a[88:91], v[196:199]
  v_rcp_f32 v251, v251
  v_mfma_f32_16x16x32_bf16 v[196:199], a[216:219], a[72:75], v[196:199]
  buffer_load_dwordx4 v13, s[44:47], s74 offen offset:3072 lds
  v_mfma_f32_16x16x32_bf16 v[180:183], a[216:219], a[68:71], v[180:183]
  s_waitcnt vmcnt(14)
  ds_read_b64_tr_b16 a[192:193], v2 offset:16384
  v_mul_f32 v133, v133, v251
  v_mfma_f32_16x16x32_bf16 v[180:183], a[220:223], a[84:87], v[180:183]
  s_mov_b32 s73, 0
  ds_read_b64_tr_b16 a[200:201], v3 offset:16384
  v_fma_f32 v253, v253, s80, v248
  v_cvt_pk_bf16_f32 v130, v132, v133
  v_mfma_f32_16x16x32_bf16 v[164:167], a[220:223], a[80:83], v[164:167]
  s_add_u32 m0, s72, 0x2000
  v_rcp_f32 v252, v252
  v_mfma_f32_16x16x32_bf16 v[164:167], a[216:219], a[64:67], v[164:167]
  buffer_load_dwordx4 v10, s[44:47], s73 offen lds
  v_mfma_f32_16x16x32_bf16 v[40:43], a[224:227], a[64:67], v[40:43]
  s_waitcnt lgkmcnt(4)
  ds_read_b64_tr_b16 a[208:209], v4 offset:16384
  v_mul_f32 v134, v134, v252
  v_mfma_f32_16x16x32_bf16 v[40:43], a[228:231], a[80:83], v[40:43]
  ds_read_b64_tr_b16 a[216:217], v5 offset:16384
  v_mul_f32 v253, v253, v135
  v_mfma_f32_16x16x32_bf16 v[56:59], a[228:231], a[84:87], v[56:59]
  v_exp_f32 v253, v253
  v_mfma_f32_16x16x32_bf16 v[56:59], a[224:227], a[68:71], v[56:59]
  buffer_load_dwordx4 v11, s[44:47], s73 offen offset:1024 lds
  v_mfma_f32_16x16x32_bf16 v[72:75], a[224:227], a[72:75], v[72:75]
  s_waitcnt vmcnt(14)
  ds_read_b64_tr_b16 a[194:195], v2 offset:18432
  v_fma_f32 v253, v253, s15, s15
  v_mfma_f32_16x16x32_bf16 v[72:75], a[228:231], a[88:91], v[72:75]
  ds_read_b64_tr_b16 a[202:203], v3 offset:18432
  v_mul_f32 v254, v136, v136
  v_mfma_f32_16x16x32_bf16 v[88:91], a[228:231], a[92:95], v[88:91]
  ds_read_b64_tr_b16 a[210:211], v4 offset:18432
  v_fma_f32 v254, v254, s80, v248
  v_mfma_f32_16x16x32_bf16 v[88:91], a[224:227], a[76:79], v[88:91]
  buffer_load_dwordx4 v12, s[44:47], s73 offen offset:2048 lds
  v_mfma_f32_16x16x32_bf16 v[216:219], a[232:235], a[76:79], v[216:219]
  ds_read_b64_tr_b16 a[218:219], v5 offset:18432
  v_mul_f32 v254, v254, v136
  v_mfma_f32_16x16x32_bf16 v[216:219], a[236:239], a[92:95], v[216:219]
  ds_read_b128 a[12:15], v247 offset:3072
  v_mfma_f32_16x16x32_bf16 v[200:203], a[236:239], a[88:91], v[200:203]
  v_rcp_f32 v253, v253
  v_mul_f32 v255, v137, v137
  v_mfma_f32_16x16x32_bf16 v[200:203], a[232:235], a[72:75], v[200:203]
  buffer_load_dwordx4 v13, s[44:47], s73 offen offset:3072 lds
  v_fma_f32 v255, v255, s80, v248
  v_mfma_f32_16x16x32_bf16 v[184:187], a[232:235], a[68:71], v[184:187]
  s_waitcnt vmcnt(14)
  ds_read_b64_tr_b16 a[196:197], v2 offset:20480
  v_mul_f32 v135, v135, v253
  v_mfma_f32_16x16x32_bf16 v[184:187], a[236:239], a[84:87], v[184:187]
  s_mov_b32 s74, 0x40000
  ds_read_b64_tr_b16 a[204:205], v3 offset:20480
  v_cvt_pk_bf16_f32 v131, v134, v135
  v_mfma_f32_16x16x32_bf16 v[168:171], a[236:239], a[80:83], v[168:171]
  s_add_u32 m0, s72, 0x3000
  v_exp_f32 v254, v254
  v_mfma_f32_16x16x32_bf16 v[168:171], a[232:235], a[64:67], v[168:171]
  buffer_load_dwordx4 v10, s[44:47], s74 offen lds
  v_mfma_f32_16x16x32_bf16 v[44:47], a[240:243], a[64:67], v[44:47]
  ds_read_b64_tr_b16 a[212:213], v4 offset:20480
  v_fma_f32 v254, v254, s15, s15
  v_mfma_f32_16x16x32_bf16 v[44:47], a[244:247], a[80:83], v[44:47]
  ds_read_b64_tr_b16 a[220:221], v5 offset:20480
  v_mul_f32 v255, v255, v137
  v_mfma_f32_16x16x32_bf16 v[60:63], a[244:247], a[84:87], v[60:63]
  v_rcp_f32 v254, v254
  v_mfma_f32_16x16x32_bf16 v[60:63], a[240:243], a[68:71], v[60:63]
  buffer_load_dwordx4 v11, s[44:47], s74 offen offset:1024 lds
  v_mfma_f32_16x16x32_bf16 v[76:79], a[240:243], a[72:75], v[76:79]
  s_waitcnt vmcnt(14)
  ds_read_b64_tr_b16 a[198:199], v2 offset:22528
  v_mul_f32 v136, v136, v254
  v_mfma_f32_16x16x32_bf16 v[76:79], a[244:247], a[88:91], v[76:79]
  ds_read_b64_tr_b16 a[206:207], v3 offset:22528
  v_exp_f32 v255, v255
  v_mfma_f32_16x16x32_bf16 v[92:95], a[244:247], a[92:95], v[92:95]
  s_waitcnt lgkmcnt(4)
  ds_read_b64_tr_b16 a[214:215], v4 offset:22528
  v_fma_f32 v255, v255, s15, s15
  v_mfma_f32_16x16x32_bf16 v[92:95], a[240:243], a[76:79], v[92:95]
  buffer_load_dwordx4 v12, s[44:47], s74 offen offset:2048 lds
  v_mfma_f32_16x16x32_bf16 v[220:223], a[248:251], a[76:79], v[220:223]
  ds_read_b64_tr_b16 a[222:223], v5 offset:22528
  v_mul_f32 v249, v138, v138
  v_mfma_f32_16x16x32_bf16 v[220:223], a[252:255], a[92:95], v[220:223]
  ds_read_b128 a[28:31], v247 offset:7168
  v_fma_f32 v249, v249, s80, v248
  v_mfma_f32_16x16x32_bf16 v[204:207], a[252:255], a[88:91], v[204:207]
  v_rcp_f32 v255, v255
  v_mfma_f32_16x16x32_bf16 v[204:207], a[248:251], a[72:75], v[204:207]
  buffer_load_dwordx4 v13, s[44:47], s74 offen offset:3072 lds
  v_mfma_f32_16x16x32_bf16 v[188:191], a[248:251], a[68:71], v[188:191]
  s_waitcnt vmcnt(14)
  ds_read_b64_tr_b16 a[224:225], v2
  v_mul_f32 v137, v137, v255
  v_mfma_f32_16x16x32_bf16 v[188:191], a[252:255], a[84:87], v[188:191]
  s_mov_b32 s73, 0x80
  ds_read_b64_tr_b16 a[232:233], v3
  v_mul_f32 v249, v249, v138
  v_cvt_pk_bf16_f32 v136, v136, v137
  v_mfma_f32_16x16x32_bf16 v[172:175], a[252:255], a[80:83], v[172:175]
  s_add_u32 m0, s72, 0x4000
  v_exp_f32 v249, v249
  v_mfma_f32_16x16x32_bf16 v[172:175], a[248:251], a[64:67], v[172:175]
  buffer_load_dwordx4 v10, s[44:47], s73 offen lds
  v_mfma_f32_16x16x32_bf16 v[32:35], a[192:195], a[32:35], v[32:35]
  s_waitcnt lgkmcnt(4)
  ds_read_b64_tr_b16 a[240:241], v4
  v_fma_f32 v249, v249, s15, s15
  v_mfma_f32_16x16x32_bf16 v[32:35], a[196:199], a[48:51], v[32:35]
  ds_read_b64_tr_b16 a[248:249], v5
  v_mul_f32 v250, v139, v139
  v_mfma_f32_16x16x32_bf16 v[48:51], a[196:199], a[52:55], v[48:51]
  v_rcp_f32 v249, v249
  v_mfma_f32_16x16x32_bf16 v[48:51], a[192:195], a[36:39], v[48:51]
  buffer_load_dwordx4 v11, s[44:47], s73 offen offset:1024 lds
  v_mfma_f32_16x16x32_bf16 v[64:67], a[192:195], a[40:43], v[64:67]
  s_waitcnt vmcnt(14)
  ds_read_b64_tr_b16 a[226:227], v2 offset:2048
  v_mul_f32 v138, v138, v249
  v_mfma_f32_16x16x32_bf16 v[64:67], a[196:199], a[56:59], v[64:67]
  ds_read_b64_tr_b16 a[234:235], v3 offset:2048
  v_fma_f32 v250, v250, s80, v248
  v_mfma_f32_16x16x32_bf16 v[80:83], a[196:199], a[60:63], v[80:83]
  v_mul_f32 v250, v250, v139
  v_mul_f32 v251, v140, v140
  v_mfma_f32_16x16x32_bf16 v[80:83], a[192:195], a[44:47], v[80:83]
  buffer_load_dwordx4 v12, s[44:47], s73 offen offset:2048 lds
  v_mfma_f32_16x16x32_bf16 v[208:211], a[200:203], a[44:47], v[208:211]
  ds_read_b64_tr_b16 a[242:243], v4 offset:2048
  v_fma_f32 v251, v251, s80, v248
  v_mfma_f32_16x16x32_bf16 v[208:211], a[204:207], a[60:63], v[208:211]
  ds_read_b64_tr_b16 a[250:251], v5 offset:2048
  v_mul_f32 v251, v251, v140
  v_mfma_f32_16x16x32_bf16 v[192:195], a[204:207], a[56:59], v[192:195]
  v_exp_f32 v250, v250
  v_mfma_f32_16x16x32_bf16 v[192:195], a[200:203], a[40:43], v[192:195]
  buffer_load_dwordx4 v13, s[44:47], s73 offen offset:3072 lds
  v_mfma_f32_16x16x32_bf16 v[176:179], a[200:203], a[36:39], v[176:179]
  s_waitcnt vmcnt(14)
  ds_read_b64_tr_b16 a[228:229], v2 offset:4096
  v_fma_f32 v250, v250, s15, s15
  v_mfma_f32_16x16x32_bf16 v[176:179], a[204:207], a[52:55], v[176:179]
  s_mov_b32 s74, 0x40080
  ds_read_b64_tr_b16 a[236:237], v3 offset:4096
  v_exp_f32 v251, v251
  v_mfma_f32_16x16x32_bf16 v[160:163], a[204:207], a[48:51], v[160:163]
  s_add_u32 m0, s72, 0x5000
  v_rcp_f32 v250, v250
  v_mfma_f32_16x16x32_bf16 v[160:163], a[200:203], a[32:35], v[160:163]
  buffer_load_dwordx4 v10, s[44:47], s74 offen lds
  v_mfma_f32_16x16x32_bf16 v[36:39], a[208:211], a[32:35], v[36:39]
  ds_read_b64_tr_b16 a[244:245], v4 offset:4096
  v_mul_f32 v139, v139, v250
  v_mfma_f32_16x16x32_bf16 v[36:39], a[212:215], a[48:51], v[36:39]
  ds_read_b64_tr_b16 a[252:253], v5 offset:4096
  v_cvt_pk_bf16_f32 v137, v138, v139
  v_mfma_f32_16x16x32_bf16 v[52:55], a[212:215], a[52:55], v[52:55]
L_p2352:
  s_cmp_eq_u32 s95, 1
  s_cbranch_scc1 L_p5141
  v_fma_f32 v251, v251, s15, s15
  v_mul_f32 v252, v141, v141
  v_mfma_f32_16x16x32_bf16 v[52:55], a[208:211], a[36:39], v[52:55]
  buffer_load_dwordx4 v11, s[44:47], s74 offen offset:1024 lds
  v_mfma_f32_16x16x32_bf16 v[68:71], a[208:211], a[40:43], v[68:71]
  s_waitcnt vmcnt(14)
  ds_read_b64_tr_b16 a[230:231], v2 offset:6144
  v_fma_f32 v252, v252, s80, v248
  v_mfma_f32_16x16x32_bf16 v[68:71], a[212:215], a[56:59], v[68:71]
  ds_read_b64_tr_b16 a[238:239], v3 offset:6144
  v_mul_f32 v252, v252, v141
  v_mfma_f32_16x16x32_bf16 v[84:87], a[212:215], a[60:63], v[84:87]
  s_waitcnt lgkmcnt(4)
  v_rcp_f32 v251, v251
  v_mfma_f32_16x16x32_bf16 v[84:87], a[208:211], a[44:47], v[84:87]
  buffer_load_dwordx4 v12, s[44:47], s74 offen offset:2048 lds
  v_mfma_f32_16x16x32_bf16 v[212:215], a[216:219], a[44:47], v[212:215]
  ds_read_b64_tr_b16 a[246:247], v4 offset:6144
  v_mul_f32 v140, v140, v251
  v_mfma_f32_16x16x32_bf16 v[212:215], a[220:223], a[60:63], v[212:215]
  ds_read_b64_tr_b16 a[254:255], v5 offset:6144
  v_mul_f32 v253, v142, v142
  v_mfma_f32_16x16x32_bf16 v[196:199], a[220:223], a[56:59], v[196:199]
  v_exp_f32 v252, v252
  v_mfma_f32_16x16x32_bf16 v[196:199], a[216:219], a[40:43], v[196:199]
  buffer_load_dwordx4 v13, s[44:47], s74 offen offset:3072 lds
  v_mfma_f32_16x16x32_bf16 v[180:183], a[216:219], a[36:39], v[180:183]
  s_waitcnt vmcnt(14)
  ds_read_b64_tr_b16 a[192:193], v2 offset:8192
  v_fma_f32 v252, v252, s15, s15
  v_mfma_f32_16x16x32_bf16 v[180:183], a[220:223], a[52:55], v[180:183]
  s_add_u32 s73, s88, 0
  ds_read_b64_tr_b16 a[200:201], v3 offset:8192
  v_fma_f32 v253, v253, s80, v248
  v_mfma_f32_16x16x32_bf16 v[164:167], a[220:223], a[48:51], v[164:167]
  s_add_u32 m0, s72, 0
  v_rcp_f32 v252, v252
  v_mfma_f32_16x16x32_bf16 v[164:167], a[216:219], a[32:35], v[164:167]
  buffer_load_dwordx4 v28, s[52:55], s73 offen lds
  v_mfma_f32_16x16x32_bf16 v[40:43], a[224:227], a[32:35], v[40:43]
  s_waitcnt lgkmcnt(4)
  ds_read_b64_tr_b16 a[208:209], v4 offset:8192
  v_mul_f32 v141, v141, v252
  v_mfma_f32_16x16x32_bf16 v[40:43], a[228:231], a[48:51], v[40:43]
  ds_read_b64_tr_b16 a[216:217], v5 offset:8192
  v_mul_f32 v253, v253, v142
  v_cvt_pk_bf16_f32 v138, v140, v141
  v_mfma_f32_16x16x32_bf16 v[56:59], a[228:231], a[52:55], v[56:59]
  v_exp_f32 v253, v253
  v_mfma_f32_16x16x32_bf16 v[56:59], a[224:227], a[36:39], v[56:59]
  buffer_load_dwordx4 v29, s[52:55], s73 offen offset:1024 lds
  v_mfma_f32_16x16x32_bf16 v[72:75], a[224:227], a[40:43], v[72:75]
  s_waitcnt vmcnt(14)
  ds_read_b64_tr_b16 a[194:195], v2 offset:10240
  v_fma_f32 v253, v253, s15, s15
  v_mfma_f32_16x16x32_bf16 v[72:75], a[228:231], a[56:59], v[72:75]
  ds_read_b64_tr_b16 a[202:203], v3 offset:10240
  v_mul_f32 v254, v143, v143
  v_mfma_f32_16x16x32_bf16 v[88:91], a[228:231], a[60:63], v[88:91]
  v_rcp_f32 v253, v253
  v_mfma_f32_16x16x32_bf16 v[88:91], a[224:227], a[44:47], v[88:91]
  buffer_load_dwordx4 v30, s[52:55], s73 offen offset:2048 lds
  v_mfma_f32_16x16x32_bf16 v[216:219], a[232:235], a[44:47], v[216:219]
  ds_read_b64_tr_b16 a[210:211], v4 offset:10240
  v_mul_f32 v142, v142, v253
  v_mfma_f32_16x16x32_bf16 v[216:219], a[236:239], a[60:63], v[216:219]
  ds_read_b64_tr_b16 a[218:219], v5 offset:10240
  v_fma_f32 v254, v254, s80, v248
  v_mfma_f32_16x16x32_bf16 v[200:203], a[236:239], a[56:59], v[200:203]
  v_mul_f32 v254, v254, v143
  v_mfma_f32_16x16x32_bf16 v[200:203], a[232:235], a[40:43], v[200:203]
  buffer_load_dwordx4 v31, s[52:55], s73 offen offset:3072 lds
  v_mfma_f32_16x16x32_bf16 v[184:187], a[232:235], a[36:39], v[184:187]
  s_waitcnt vmcnt(14)
  ds_read_b64_tr_b16 a[196:197], v2 offset:12288
  v_mfma_f32_16x16x32_bf16 v[184:187], a[236:239], a[52:55], v[184:187]
  s_add_u32 s74, s88, 0x8000
  ds_read_b64_tr_b16 a[204:205], v3 offset:12288
  v_mfma_f32_16x16x32_bf16 v[168:171], a[236:239], a[48:51], v[168:171]
  s_add_u32 m0, s72, 0x1000
  v_exp_f32 v254, v254
  v_mfma_f32_16x16x32_bf16 v[168:171], a[232:235], a[32:35], v[168:171]
  buffer_load_dwordx4 v28, s[52:55], s74 offen lds
  v_mfma_f32_16x16x32_bf16 v[44:47], a[240:243], a[32:35], v[44:47]
  s_waitcnt lgkmcnt(4)
  ds_read_b64_tr_b16 a[212:213], v4 offset:12288
  v_fma_f32 v254, v254, s15, s15
  v_mfma_f32_16x16x32_bf16 v[44:47], a[244:247], a[48:51], v[44:47]
  ds_read_b64_tr_b16 a[220:221], v5 offset:12288
  v_mfma_f32_16x16x32_bf16 v[60:63], a[244:247], a[52:55], v[60:63]
  v_rcp_f32 v254, v254
  v_mfma_f32_16x16x32_bf16 v[60:63], a[240:243], a[36:39], v[60:63]
  buffer_load_dwordx4 v29, s[52:55], s74 offen offset:1024 lds
  v_mfma_f32_16x16x32_bf16 v[76:79], a[240:243], a[40:43], v[76:79]
  s_waitcnt vmcnt(14)
  ds_read_b64_tr_b16 a[198:199], v2 offset:14336
  v_mul_f32 v143, v143, v254
  v_mfma_f32_16x16x32_bf16 v[76:79], a[244:247], a[56:59], v[76:79]
  ds_read_b64_tr_b16 a[206:207], v3 offset:14336
  v_cvt_pk_bf16_f32 v139, v142, v143
  v_mfma_f32_16x16x32_bf16 v[92:95], a[244:247], a[60:63], v[92:95]
  v_mfma_f32_16x16x32_bf16 v[92:95], a[240:243], a[44:47], v[92:95]
  buffer_load_dwordx4 v30, s[52:55], s74 offen offset:2048 lds
  v_mfma_f32_16x16x32_bf16 v[220:223], a[248:251], a[44:47], v[220:223]
  ds_read_b64_tr_b16 a[214:215], v4 offset:14336
  v_mfma_f32_16x16x32_bf16 v[220:223], a[252:255], a[60:63], v[220:223]
  ds_read_b64_tr_b16 a[222:223], v5 offset:14336
  v_mfma_f32_16x16x32_bf16 v[204:207], a[252:255], a[56:59], v[204:207]
  v_mfma_f32_16x16x32_bf16 v[204:207], a[248:251], a[40:43], v[204:207]
  buffer_load_dwordx4 v31, s[52:55], s74 offen offset:3072 lds
  v_mfma_f32_16x16x32_bf16 v[188:191], a[248:251], a[36:39], v[188:191]
  s_waitcnt vmcnt(14)
  ds_read_b64_tr_b16 a[224:225], v2 offset:16384
  v_mfma_f32_16x16x32_bf16 v[188:191], a[252:255], a[52:55], v[188:191]
  s_add_u32 s73, s88, 0x10000
  ds_read_b64_tr_b16 a[232:233], v3 offset:16384
  v_mfma_f32_16x16x32_bf16 v[172:175], a[252:255], a[48:51], v[172:175]
  s_add_u32 m0, s72, 0x2000
  v_mfma_f32_16x16x32_bf16 v[172:175], a[248:251], a[32:35], v[172:175]
  buffer_load_dwordx4 v28, s[52:55], s73 offen lds
  v_mfma_f32_16x16x32_bf16 v[32:35], a[192:195], a[0:3], v[32:35]
  s_waitcnt lgkmcnt(5)
  ds_read_b64_tr_b16 a[240:241], v4 offset:16384
  v_mfma_f32_16x16x32_bf16 v[32:35], a[196:199], a[16:19], v[32:35]
  ds_read_b64_tr_b16 a[248:249], v5 offset:16384
  v_mfma_f32_16x16x32_bf16 v[48:51], a[196:199], a[20:23], v[48:51]
  v_mfma_f32_16x16x32_bf16 v[48:51], a[192:195], a[4:7], v[48:51]
  buffer_load_dwordx4 v29, s[52:55], s73 offen offset:1024 lds
  v_mfma_f32_16x16x32_bf16 v[64:67], a[192:195], a[8:11], v[64:67]
  s_waitcnt vmcnt(14)
  ds_read_b64_tr_b16 a[226:227], v2 offset:18432
  v_mfma_f32_16x16x32_bf16 v[64:67], a[196:199], a[24:27], v[64:67]
  ds_read_b64_tr_b16 a[234:235], v3 offset:18432
  v_mfma_f32_16x16x32_bf16 v[80:83], a[196:199], a[28:31], v[80:83]
  s_barrier
  v_mfma_f32_16x16x32_bf16 v[80:83], a[192:195], a[12:15], v[80:83]
  buffer_load_dwordx4 v30, s[52:55], s73 offen offset:2048 lds
  v_mfma_f32_16x16x32_bf16 v[208:211], a[200:203], a[12:15], v[208:211]
  s_waitcnt lgkmcnt(6)
  ds_read_b64_tr_b16 a[242:243], v4 offset:18432
  v_mfma_f32_16x16x32_bf16 v[208:211], a[204:207], a[28:31], v[208:211]
  ds_read_b64_tr_b16 a[250:251], v5 offset:18432
  v_mfma_f32_16x16x32_bf16 v[192:195], a[204:207], a[24:27], v[192:195]
  v_mfma_f32_16x16x32_bf16 v[192:195], a[200:203], a[8:11], v[192:195]
  buffer_load_dwordx4 v31, s[52:55], s73 offen offset:3072 lds
  v_mfma_f32_16x16x32_bf16 v[176:179], a[200:203], a[4:7], v[176:179]
  s_add_u32 s83, s83, 0x4000
  s_waitcnt vmcnt(14)
  ds_read_b64_tr_b16 a[228:229], v2 offset:20480
  v_mfma_f32_16x16x32_bf16 v[176:179], a[204:207], a[20:23], v[176:179]
  s_and_b32 s83, s83, 0x7ffff
  ds_read_b64_tr_b16 a[236:237], v3 offset:20480
  v_mfma_f32_16x16x32_bf16 v[160:163], a[204:207], a[16:19], v[160:163]
  s_add_u32 m0, s85, 0x8000
  ds_read_b64_tr_b16 a[244:245], v4 offset:20480
  v_mfma_f32_16x16x32_bf16 v[160:163], a[200:203], a[0:3], v[160:163]
  buffer_load_dwordx4 v26, s[36:39], s83 offen lds
  v_mfma_f32_16x16x32_bf16 v[36:39], a[208:211], a[0:3], v[36:39]
  ds_read_b64_tr_b16 a[252:253], v5 offset:20480
  v_mfma_f32_16x16x32_bf16 v[36:39], a[212:215], a[16:19], v[36:39]
  buffer_load_dwordx4 v26, s[36:39], s83 offen offset:1024 lds
  v_mfma_f32_16x16x32_bf16 v[52:55], a[212:215], a[20:23], v[52:55]
  v_mfma_f32_16x16x32_bf16 v[52:55], a[208:211], a[4:7], v[52:55]
  buffer_load_dwordx4 v26, s[36:39], s83 offen offset:2048 lds
  v_mfma_f32_16x16x32_bf16 v[68:71], a[208:211], a[8:11], v[68:71]
  s_waitcnt vmcnt(15)
  ds_read_b64_tr_b16 a[230:231], v2 offset:22528
  v_cvt_pk_bf16_f32 v32, v32, v33
  v_mfma_f32_16x16x32_bf16 v[68:71], a[212:215], a[24:27], v[68:71]
  buffer_load_dwordx4 v26, s[36:39], s83 offen offset:3072 lds
  v_mfma_f32_16x16x32_bf16 v[84:87], a[212:215], a[28:31], v[84:87]
  s_add_u32 s84, s84, 0x4000
  ds_read_b64_tr_b16 a[238:239], v3 offset:22528
  v_cvt_pk_bf16_f32 v33, v34, v35
  v_mfma_f32_16x16x32_bf16 v[84:87], a[208:211], a[12:15], v[84:87]
  s_and_b32 s84, s84, 0x7ffff
  ds_read_b64_tr_b16 a[246:247], v4 offset:22528
  v_cvt_pk_bf16_f32 v34, v160, v161
  v_mfma_f32_16x16x32_bf16 v[212:215], a[216:219], a[12:15], v[212:215]
  s_add_u32 m0, s85, 0xc000
  ds_read_b64_tr_b16 a[254:255], v5 offset:22528
  v_cvt_pk_bf16_f32 v35, v162, v163
  v_mfma_f32_16x16x32_bf16 v[212:215], a[220:223], a[28:31], v[212:215]
  buffer_load_dwordx4 v27, s[40:43], s84 offen lds
  v_mfma_f32_16x16x32_bf16 v[196:199], a[220:223], a[24:27], v[196:199]
  ds_write_b128 v246, v[96:99]
  v_mfma_f32_16x16x32_bf16 v[196:199], a[216:219], a[8:11], v[196:199]
  buffer_load_dwordx4 v27, s[40:43], s84 offen offset:1024 lds
  v_mfma_f32_16x16x32_bf16 v[180:183], a[216:219], a[4:7], v[180:183]
  s_waitcnt vmcnt(16)
  ds_write_b128 v246, v[104:107] offset:1024
  ds_read_b64_tr_b16 a[192:193], v2
  v_mfma_f32_16x16x32_bf16 v[180:183], a[220:223], a[20:23], v[180:183]
  buffer_load_dwordx4 v27, s[40:43], s84 offen offset:2048 lds
  v_mfma_f32_16x16x32_bf16 v[164:167], a[220:223], a[16:19], v[164:167]
  s_waitcnt lgkmcnt(6)
  ds_write_b128 v246, v[112:115] offset:2048
  ds_read_b64_tr_b16 a[200:201], v3
  v_mfma_f32_16x16x32_bf16 v[164:167], a[216:219], a[0:3], v[164:167]
  buffer_load_dwordx4 v27, s[40:43], s84 offen offset:3072 lds
  v_mfma_f32_16x16x32_bf16 v[40:43], a[224:227], a[0:3], v[40:43]
  s_add_u32 s74, s88, 0x18000
  ds_write_b128 v246, v[120:123] offset:3072
  ds_read_b64_tr_b16 a[208:209], v4
  v_mfma_f32_16x16x32_bf16 v[40:43], a[228:231], a[16:19], v[40:43]
  s_add_u32 m0, s72, 0x3000
  ds_write_b128 v246, v[128:131] offset:4096
  ds_read_b64_tr_b16 a[216:217], v5
  v_mfma_f32_16x16x32_bf16 v[56:59], a[228:231], a[20:23], v[56:59]
  buffer_load_dwordx4 v28, s[52:55], s74 offen lds
  v_mfma_f32_16x16x32_bf16 v[56:59], a[224:227], a[4:7], v[56:59]
  ds_write_b128 v246, v[136:139] offset:5120
  v_mfma_f32_16x16x32_bf16 v[72:75], a[224:227], a[8:11], v[72:75]
  buffer_load_dwordx4 v29, s[52:55], s74 offen offset:1024 lds
  v_mfma_f32_16x16x32_bf16 v[72:75], a[228:231], a[24:27], v[72:75]
  s_waitcnt vmcnt(18)
  ds_read_b64_tr_b16 a[194:195], v2 offset:2048
  ds_read_b64_tr_b16 a[202:203], v3 offset:2048
  v_mfma_f32_16x16x32_bf16 v[88:91], a[228:231], a[28:31], v[88:91]
  buffer_load_dwordx4 v30, s[52:55], s74 offen offset:2048 lds
  v_mfma_f32_16x16x32_bf16 v[88:91], a[224:227], a[12:15], v[88:91]
  s_waitcnt lgkmcnt(8)
  ds_read_b64_tr_b16 a[210:211], v4 offset:2048
  ds_read_b64_tr_b16 a[218:219], v5 offset:2048
  v_mfma_f32_16x16x32_bf16 v[216:219], a[232:235], a[12:15], v[216:219]
  buffer_load_dwordx4 v31, s[52:55], s74 offen offset:3072 lds
  v_mfma_f32_16x16x32_bf16 v[216:219], a[236:239], a[28:31], v[216:219]
  s_add_u32 s73, s88, 0x20000
  v_cvt_pk_bf16_f32 v48, v48, v49
  v_cvt_pk_bf16_f32 v49, v50, v51
  v_mfma_f32_16x16x32_bf16 v[200:203], a[236:239], a[24:27], v[200:203]
  s_add_u32 m0, s72, 0x4000
  s_waitcnt lgkmcnt(4)
  s_barrier
  v_mfma_f32_16x16x32_bf16 v[200:203], a[232:235], a[8:11], v[200:203]
  buffer_load_dwordx4 v28, s[52:55], s73 offen lds
  ds_read2st64_b64 a[32:35], v1 offset0:0 offset1:4
  ds_read2st64_b64 a[48:51], v1 offset0:8 offset1:12
  v_mfma_f32_16x16x32_bf16 v[184:187], a[232:235], a[4:7], v[184:187]
  s_waitcnt vmcnt(19)
  ds_read_b64_tr_b16 a[196:197], v2 offset:4096
  ds_read_b64_tr_b16 a[204:205], v3 offset:4096
  v_mfma_f32_16x16x32_bf16 v[184:187], a[236:239], a[20:23], v[184:187]
  buffer_load_dwordx4 v29, s[52:55], s73 offen offset:1024 lds
  v_mfma_f32_16x16x32_bf16 v[168:171], a[236:239], a[16:19], v[168:171]
  ds_read_b64_tr_b16 a[212:213], v4 offset:4096
  v_cvt_pk_bf16_f32 v50, v176, v177
  v_mfma_f32_16x16x32_bf16 v[168:171], a[232:235], a[0:3], v[168:171]
  buffer_load_dwordx4 v30, s[52:55], s73 offen offset:2048 lds
  v_mfma_f32_16x16x32_bf16 v[44:47], a[240:243], a[0:3], v[44:47]
  ds_read_b64_tr_b16 a[220:221], v5 offset:4096
  ds_read2st64_b64 a[36:39], v241 offset0:0 offset1:4
  v_mfma_f32_16x16x32_bf16 v[44:47], a[244:247], a[16:19], v[44:47]
  buffer_load_dwordx4 v31, s[52:55], s73 offen offset:3072 lds
  v_mfma_f32_16x16x32_bf16 v[60:63], a[244:247], a[20:23], v[60:63]
  s_add_u32 s74, s88, 0x28000
  ds_read2st64_b64 a[52:55], v241 offset0:8 offset1:12
  v_cvt_pk_bf16_f32 v51, v178, v179
  v_mfma_f32_16x16x32_bf16 v[60:63], a[240:243], a[4:7], v[60:63]
  s_add_u32 m0, s72, 0x5000
  ds_read2st64_b64 a[40:43], v1 offset0:2 offset1:6
  v_cvt_pk_bf16_f32 v64, v64, v65
  v_mfma_f32_16x16x32_bf16 v[76:79], a[240:243], a[8:11], v[76:79]
  buffer_load_dwordx4 v28, s[52:55], s74 offen lds
  v_mfma_f32_16x16x32_bf16 v[76:79], a[244:247], a[24:27], v[76:79]
  s_waitcnt vmcnt(21)
  ds_read_b64_tr_b16 a[198:199], v2 offset:6144
  ds_read_b64_tr_b16 a[206:207], v3 offset:6144
  v_mfma_f32_16x16x32_bf16 v[92:95], a[244:247], a[28:31], v[92:95]
  buffer_load_dwordx4 v29, s[52:55], s74 offen offset:1024 lds
  v_mfma_f32_16x16x32_bf16 v[92:95], a[240:243], a[12:15], v[92:95]
  ds_read_b64_tr_b16 a[214:215], v4 offset:6144
  ds_read_b64_tr_b16 a[222:223], v5 offset:6144
  v_mfma_f32_16x16x32_bf16 v[220:223], a[248:251], a[12:15], v[220:223]
  buffer_load_dwordx4 v30, s[52:55], s74 offen offset:2048 lds
  v_mfma_f32_16x16x32_bf16 v[220:223], a[252:255], a[28:31], v[220:223]
  ds_read2st64_b64 a[56:59], v1 offset0:10 offset1:14
  ds_read2st64_b64 a[44:47], v241 offset0:2 offset1:6
  v_mfma_f32_16x16x32_bf16 v[204:207], a[252:255], a[24:27], v[204:207]
  ds_read2st64_b64 a[60:63], v241 offset0:10 offset1:14
  v_cvt_pk_bf16_f32 v65, v66, v67
  v_mfma_f32_16x16x32_bf16 v[204:207], a[248:251], a[8:11], v[204:207]
  buffer_load_dwordx4 v31, s[52:55], s74 offen offset:3072 lds
  v_mfma_f32_16x16x32_bf16 v[188:191], a[248:251], a[4:7], v[188:191]
  s_waitcnt vmcnt(22)
  ds_read_b64_tr_b16 a[224:225], v2 offset:8192
  v_cvt_pk_bf16_f32 v66, v192, v193
  v_mfma_f32_16x16x32_bf16 v[188:191], a[252:255], a[20:23], v[188:191]
  s_add_u32 s73, s88, 0x80
  ds_read_b64_tr_b16 a[232:233], v3 offset:8192
  v_cvt_pk_bf16_f32 v67, v194, v195
  v_mfma_f32_16x16x32_bf16 v[172:175], a[252:255], a[16:19], v[172:175]
  s_add_u32 m0, s72, 0
  s_waitcnt lgkmcnt(7)
  ds_read_b64_tr_b16 a[240:241], v4 offset:8192
  v_cvt_pk_bf16_f32 v80, v80, v81
  v_mfma_f32_16x16x32_bf16 v[172:175], a[248:251], a[0:3], v[172:175]
  buffer_load_dwordx4 v28, s[52:55], s73 offen lds
  v_mfma_f32_16x16x32_bf16 v[128:131], a[192:195], a[32:35], 0
  ds_read_b64_tr_b16 a[248:249], v5 offset:8192
  v_cvt_pk_bf16_f32 v81, v82, v83
  v_mfma_f32_16x16x32_bf16 v[128:131], a[196:199], a[48:51], v[128:131]
  ds_read2st64_b64 a[64:67], v1 offset0:16 offset1:20
  v_cvt_pk_bf16_f32 v82, v208, v209
  v_mfma_f32_16x16x32_bf16 v[132:135], a[196:199], a[52:55], 0
  ds_read2st64_b64 a[80:83], v1 offset0:24 offset1:28
  v_cvt_pk_bf16_f32 v83, v210, v211
  v_mfma_f32_16x16x32_bf16 v[132:135], a[192:195], a[36:39], v[132:135]
  buffer_load_dwordx4 v29, s[52:55], s73 offen offset:1024 lds
  v_mfma_f32_16x16x32_bf16 v[136:139], a[192:195], a[40:43], 0
  s_waitcnt vmcnt(22) lgkmcnt(6)
  ds_read_b64_tr_b16 a[226:227], v2 offset:10240
  v_cvt_pk_bf16_f32 v36, v36, v37
  v_mfma_f32_16x16x32_bf16 v[136:139], a[196:199], a[56:59], v[136:139]
  ds_read_b64_tr_b16 a[234:235], v3 offset:10240
  v_cvt_pk_bf16_f32 v37, v38, v39
  v_mfma_f32_16x16x32_bf16 v[140:143], a[196:199], a[60:63], 0
  ds_read_b64_tr_b16 a[242:243], v4 offset:10240
  v_cvt_pk_bf16_f32 v38, v164, v165
  v_mfma_f32_16x16x32_bf16 v[140:143], a[192:195], a[44:47], v[140:143]
  buffer_load_dwordx4 v30, s[52:55], s73 offen offset:2048 lds
  v_mfma_f32_16x16x32_bf16 v[108:111], a[200:203], a[44:47], 0
  ds_read_b64_tr_b16 a[250:251], v5 offset:10240
  v_cvt_pk_bf16_f32 v39, v166, v167
  v_mfma_f32_16x16x32_bf16 v[108:111], a[204:207], a[60:63], v[108:111]
  ds_read2st64_b64 a[68:71], v241 offset0:16 offset1:20
  v_cvt_pk_bf16_f32 v52, v52, v53
  v_mfma_f32_16x16x32_bf16 v[104:107], a[204:207], a[56:59], 0
  ds_read2st64_b64 a[84:87], v241 offset0:24 offset1:28
  v_cvt_pk_bf16_f32 v53, v54, v55
  v_mfma_f32_16x16x32_bf16 v[104:107], a[200:203], a[40:43], v[104:107]
  buffer_load_dwordx4 v31, s[52:55], s73 offen offset:3072 lds
  v_mfma_f32_16x16x32_bf16 v[100:103], a[200:203], a[36:39], 0
  s_waitcnt vmcnt(14)
  ds_read_b64_tr_b16 a[228:229], v2 offset:12288
  v_cvt_pk_bf16_f32 v54, v180, v181
  v_mfma_f32_16x16x32_bf16 v[100:103], a[204:207], a[52:55], v[100:103]
  s_add_u32 s74, s88, 0x8080
  ds_read_b64_tr_b16 a[236:237], v3 offset:12288
  v_cvt_pk_bf16_f32 v55, v182, v183
  v_mfma_f32_16x16x32_bf16 v[96:99], a[204:207], a[48:51], 0
  s_add_u32 m0, s72, 0x1000
  ds_read_b64_tr_b16 a[244:245], v4 offset:12288
  v_cvt_pk_bf16_f32 v68, v68, v69
  v_mfma_f32_16x16x32_bf16 v[96:99], a[200:203], a[32:35], v[96:99]
  buffer_load_dwordx4 v28, s[52:55], s74 offen lds
  v_mfma_f32_16x16x32_bf16 v[144:147], a[208:211], a[32:35], 0
  ds_read_b64_tr_b16 a[252:253], v5 offset:12288
  v_cvt_pk_bf16_f32 v69, v70, v71
  v_mfma_f32_16x16x32_bf16 v[144:147], a[212:215], a[48:51], v[144:147]
  ds_read2st64_b64 a[72:75], v1 offset0:18 offset1:22
  v_cvt_pk_bf16_f32 v70, v196, v197
  v_mfma_f32_16x16x32_bf16 v[148:151], a[212:215], a[52:55], 0
  ds_read2st64_b64 a[88:91], v1 offset0:26 offset1:30
  v_cvt_pk_bf16_f32 v71, v198, v199
  v_mfma_f32_16x16x32_bf16 v[148:151], a[208:211], a[36:39], v[148:151]
  buffer_load_dwordx4 v29, s[52:55], s74 offen offset:1024 lds
  v_mfma_f32_16x16x32_bf16 v[152:155], a[208:211], a[40:43], 0
  s_waitcnt vmcnt(14)
  ds_read_b64_tr_b16 a[230:231], v2 offset:14336
  v_cvt_pk_bf16_f32 v84, v84, v85
  v_mfma_f32_16x16x32_bf16 v[152:155], a[212:215], a[56:59], v[152:155]
  ds_read_b64_tr_b16 a[238:239], v3 offset:14336
  v_cvt_pk_bf16_f32 v85, v86, v87
  v_mfma_f32_16x16x32_bf16 v[156:159], a[212:215], a[60:63], 0
  ds_read_b64_tr_b16 a[246:247], v4 offset:14336
  v_cvt_pk_bf16_f32 v86, v212, v213
  v_mfma_f32_16x16x32_bf16 v[156:159], a[208:211], a[44:47], v[156:159]
  buffer_load_dwordx4 v30, s[52:55], s74 offen offset:2048 lds
  v_mfma_f32_16x16x32_bf16 v[124:127], a[216:219], a[44:47], 0
  ds_read_b64_tr_b16 a[254:255], v5 offset:14336
  v_cvt_pk_bf16_f32 v87, v214, v215
  v_mfma_f32_16x16x32_bf16 v[124:127], a[220:223], a[60:63], v[124:127]
  ds_read2st64_b64 a[76:79], v241 offset0:18 offset1:22
  v_cvt_pk_bf16_f32 v40, v40, v41
  v_mfma_f32_16x16x32_bf16 v[120:123], a[220:223], a[56:59], 0
  ds_read2st64_b64 a[92:95], v241 offset0:26 offset1:30
  v_cvt_pk_bf16_f32 v41, v42, v43
  v_mfma_f32_16x16x32_bf16 v[120:123], a[216:219], a[40:43], v[120:123]
  buffer_load_dwordx4 v31, s[52:55], s74 offen offset:3072 lds
  v_mfma_f32_16x16x32_bf16 v[116:119], a[216:219], a[36:39], 0
  s_waitcnt vmcnt(14)
  ds_read_b64_tr_b16 a[192:193], v2 offset:16384
  v_cvt_pk_bf16_f32 v42, v168, v169
  v_mfma_f32_16x16x32_bf16 v[116:119], a[220:223], a[52:55], v[116:119]
  s_add_u32 s73, s88, 0x10080
  ds_read_b64_tr_b16 a[200:201], v3 offset:16384
  v_cvt_pk_bf16_f32 v43, v170, v171
  v_mfma_f32_16x16x32_bf16 v[112:115], a[220:223], a[48:51], 0
  s_add_u32 m0, s72, 0x2000
  s_waitcnt lgkmcnt(6)
  ds_read_b64_tr_b16 a[208:209], v4 offset:16384
  v_cvt_pk_bf16_f32 v56, v56, v57
  v_mfma_f32_16x16x32_bf16 v[112:115], a[216:219], a[32:35], v[112:115]
  buffer_load_dwordx4 v28, s[52:55], s73 offen lds
  v_mfma_f32_16x16x32_bf16 v[128:131], a[224:227], a[64:67], v[128:131]
  ds_read_b64_tr_b16 a[216:217], v5 offset:16384
  v_cvt_pk_bf16_f32 v57, v58, v59
  v_mfma_f32_16x16x32_bf16 v[128:131], a[228:231], a[80:83], v[128:131]
  ds_read2st64_b64 a[96:99], v1 offset0:32 offset1:36
  v_cvt_pk_bf16_f32 v58, v184, v185
  v_mfma_f32_16x16x32_bf16 v[132:135], a[228:231], a[84:87], v[132:135]
  ds_read2st64_b64 a[112:115], v1 offset0:40 offset1:44
  v_cvt_pk_bf16_f32 v59, v186, v187
  v_mfma_f32_16x16x32_bf16 v[132:135], a[224:227], a[68:71], v[132:135]
  buffer_load_dwordx4 v29, s[52:55], s73 offen offset:1024 lds
  v_mfma_f32_16x16x32_bf16 v[136:139], a[224:227], a[72:75], v[136:139]
  s_waitcnt vmcnt(14)
  ds_read_b64_tr_b16 a[194:195], v2 offset:18432
  v_cvt_pk_bf16_f32 v72, v72, v73
  v_mfma_f32_16x16x32_bf16 v[136:139], a[228:231], a[88:91], v[136:139]
  s_waitcnt lgkmcnt(6)
  ds_read_b64_tr_b16 a[202:203], v3 offset:18432
  v_cvt_pk_bf16_f32 v73, v74, v75
  v_mfma_f32_16x16x32_bf16 v[140:143], a[228:231], a[92:95], v[140:143]
  ds_read_b64_tr_b16 a[210:211], v4 offset:18432
  v_cvt_pk_bf16_f32 v74, v200, v201
  v_mfma_f32_16x16x32_bf16 v[140:143], a[224:227], a[76:79], v[140:143]
  buffer_load_dwordx4 v30, s[52:55], s73 offen offset:2048 lds
  v_mfma_f32_16x16x32_bf16 v[108:111], a[232:235], a[76:79], v[108:111]
  ds_read_b64_tr_b16 a[218:219], v5 offset:18432
  v_cvt_pk_bf16_f32 v75, v202, v203
  v_mfma_f32_16x16x32_bf16 v[108:111], a[236:239], a[92:95], v[108:111]
  ds_read2st64_b64 a[100:103], v241 offset0:32 offset1:36
  v_cvt_pk_bf16_f32 v88, v88, v89
  v_mfma_f32_16x16x32_bf16 v[104:107], a[236:239], a[88:91], v[104:107]
  ds_read2st64_b64 a[116:119], v241 offset0:40 offset1:44
  v_cvt_pk_bf16_f32 v89, v90, v91
  v_mfma_f32_16x16x32_bf16 v[104:107], a[232:235], a[72:75], v[104:107]
  buffer_load_dwordx4 v31, s[52:55], s73 offen offset:3072 lds
  v_mfma_f32_16x16x32_bf16 v[100:103], a[232:235], a[68:71], v[100:103]
  s_waitcnt vmcnt(14)
  ds_read_b64_tr_b16 a[196:197], v2 offset:20480
  v_cvt_pk_bf16_f32 v90, v216, v217
  v_mfma_f32_16x16x32_bf16 v[100:103], a[236:239], a[84:87], v[100:103]
  s_add_u32 s74, s88, 0x18080
  ds_read_b64_tr_b16 a[204:205], v3 offset:20480
  v_cvt_pk_bf16_f32 v91, v218, v219
  v_mfma_f32_16x16x32_bf16 v[96:99], a[236:239], a[80:83], v[96:99]
  s_add_u32 m0, s72, 0x3000
  ds_read_b64_tr_b16 a[212:213], v4 offset:20480
  v_cvt_pk_bf16_f32 v44, v44, v45
  v_mfma_f32_16x16x32_bf16 v[96:99], a[232:235], a[64:67], v[96:99]
  buffer_load_dwordx4 v28, s[52:55], s74 offen lds
  v_mfma_f32_16x16x32_bf16 v[144:147], a[240:243], a[64:67], v[144:147]
  ds_read_b64_tr_b16 a[220:221], v5 offset:20480
  v_cvt_pk_bf16_f32 v45, v46, v47
  v_mfma_f32_16x16x32_bf16 v[144:147], a[244:247], a[80:83], v[144:147]
  ds_read2st64_b64 a[104:107], v1 offset0:34 offset1:38
  v_cvt_pk_bf16_f32 v46, v172, v173
  v_mfma_f32_16x16x32_bf16 v[148:151], a[244:247], a[84:87], v[148:151]
  ds_read2st64_b64 a[120:123], v1 offset0:42 offset1:46
  v_cvt_pk_bf16_f32 v47, v174, v175
  v_mfma_f32_16x16x32_bf16 v[148:151], a[240:243], a[68:71], v[148:151]
  buffer_load_dwordx4 v29, s[52:55], s74 offen offset:1024 lds
  v_mfma_f32_16x16x32_bf16 v[152:155], a[240:243], a[72:75], v[152:155]
  s_waitcnt vmcnt(14)
  ds_read_b64_tr_b16 a[198:199], v2 offset:22528
  v_cvt_pk_bf16_f32 v60, v60, v61
  v_mfma_f32_16x16x32_bf16 v[152:155], a[244:247], a[88:91], v[152:155]
  ds_read_b64_tr_b16 a[206:207], v3 offset:22528
  v_cvt_pk_bf16_f32 v61, v62, v63
  v_mfma_f32_16x16x32_bf16 v[156:159], a[244:247], a[92:95], v[156:159]
  ds_read_b64_tr_b16 a[214:215], v4 offset:22528
  v_cvt_pk_bf16_f32 v62, v188, v189
  v_mfma_f32_16x16x32_bf16 v[156:159], a[240:243], a[76:79], v[156:159]
  buffer_load_dwordx4 v30, s[52:55], s74 offen offset:2048 lds
  v_mfma_f32_16x16x32_bf16 v[124:127], a[248:251], a[76:79], v[124:127]
  ds_read_b64_tr_b16 a[222:223], v5 offset:22528
  v_cvt_pk_bf16_f32 v63, v190, v191
  v_mfma_f32_16x16x32_bf16 v[124:127], a[252:255], a[92:95], v[124:127]
  ds_read2st64_b64 a[108:111], v241 offset0:34 offset1:38
  v_cvt_pk_bf16_f32 v76, v76, v77
  v_mfma_f32_16x16x32_bf16 v[120:123], a[252:255], a[88:91], v[120:123]
  ds_read2st64_b64 a[124:127], v241 offset0:42 offset1:46
  v_cvt_pk_bf16_f32 v77, v78, v79
  v_mfma_f32_16x16x32_bf16 v[120:123], a[248:251], a[72:75], v[120:123]
  buffer_load_dwordx4 v31, s[52:55], s74 offen offset:3072 lds
  v_mfma_f32_16x16x32_bf16 v[116:119], a[248:251], a[68:71], v[116:119]
  s_waitcnt vmcnt(14)
  ds_read_b64_tr_b16 a[224:225], v2
  v_cvt_pk_bf16_f32 v78, v204, v205
  v_mfma_f32_16x16x32_bf16 v[116:119], a[252:255], a[84:87], v[116:119]
  s_add_u32 s73, s88, 0x20080
  ds_read_b64_tr_b16 a[232:233], v3
  v_cvt_pk_bf16_f32 v79, v206, v207
  v_mfma_f32_16x16x32_bf16 v[112:115], a[252:255], a[80:83], v[112:115]
  s_add_u32 m0, s72, 0x4000
  s_waitcnt lgkmcnt(6)
  v_cvt_pk_bf16_f32 v92, v92, v93
  v_cvt_pk_bf16_f32 v93, v94, v95
  v_mfma_f32_16x16x32_bf16 v[112:115], a[248:251], a[64:67], v[112:115]
  buffer_load_dwordx4 v28, s[52:55], s73 offen lds
  v_mfma_f32_16x16x32_bf16 v[128:131], a[192:195], a[96:99], v[128:131]
  ds_read_b64_tr_b16 a[240:241], v4
  v_cvt_pk_bf16_f32 v94, v220, v221
  v_mfma_f32_16x16x32_bf16 v[128:131], a[196:199], a[112:115], v[128:131]
  ds_read_b64_tr_b16 a[248:249], v5
  v_cvt_pk_bf16_f32 v95, v222, v223
  v_mfma_f32_16x16x32_bf16 v[132:135], a[196:199], a[116:119], v[132:135]
  v_permlane16_swap_b32 v32, v34
  v_mfma_f32_16x16x32_bf16 v[132:135], a[192:195], a[100:103], v[132:135]
  buffer_load_dwordx4 v29, s[52:55], s73 offen offset:1024 lds
  v_mfma_f32_16x16x32_bf16 v[136:139], a[192:195], a[104:107], v[136:139]
  s_waitcnt lgkmcnt(4)
  s_barrier
  v_mfma_f32_16x16x32_bf16 v[136:139], a[196:199], a[120:123], v[136:139]
  s_waitcnt vmcnt(14)
  ds_read_b64_tr_b16 a[226:227], v2 offset:2048
  v_cvt_pk_bf16_f32 v128, v128, v129
  v_mfma_f32_16x16x32_bf16 v[140:143], a[196:199], a[124:127], v[140:143]
  ds_read_b64_tr_b16 a[234:235], v3 offset:2048
  v_cvt_pk_bf16_f32 v129, v130, v131
  v_mfma_f32_16x16x32_bf16 v[140:143], a[192:195], a[108:111], v[140:143]
  buffer_load_dwordx4 v30, s[52:55], s73 offen offset:2048 lds
  v_mfma_f32_16x16x32_bf16 v[108:111], a[200:203], a[108:111], v[108:111]
  ds_read_b64_tr_b16 a[242:243], v4 offset:2048
  v_mov_b32 v224, 0x40c00000
  v_mfma_f32_16x16x32_bf16 v[108:111], a[204:207], a[124:127], v[108:111]
  ds_read_b64_tr_b16 a[250:251], v5 offset:2048
  v_mov_b32 v225, 0x40c00000
  v_mfma_f32_16x16x32_bf16 v[104:107], a[204:207], a[120:123], v[104:107]
  v_permlane16_swap_b32 v33, v35
  v_mfma_f32_16x16x32_bf16 v[104:107], a[200:203], a[104:107], v[104:107]
  buffer_load_dwordx4 v31, s[52:55], s73 offen offset:3072 lds
  v_mfma_f32_16x16x32_bf16 v[100:103], a[200:203], a[100:103], v[100:103]
  s_waitcnt vmcnt(14)
  ds_read_b64_tr_b16 a[228:229], v2 offset:4096
  v_mov_b32 v226, 0x40c00000
  v_mfma_f32_16x16x32_bf16 v[100:103], a[204:207], a[116:119], v[100:103]
  s_add_u32 s74, s88, 0x28080
  ds_read_b64_tr_b16 a[236:237], v3 offset:4096
  v_mov_b32 v227, 0x40c00000
  v_mfma_f32_16x16x32_bf16 v[96:99], a[204:207], a[112:115], v[96:99]
  s_add_u32 m0, s72, 0x5000
  v_permlane16_swap_b32 v48, v50
  v_mfma_f32_16x16x32_bf16 v[96:99], a[200:203], a[96:99], v[96:99]
  buffer_load_dwordx4 v28, s[52:55], s74 offen lds
  v_mfma_f32_16x16x32_bf16 v[144:147], a[208:211], a[96:99], v[144:147]
  ds_read_b64_tr_b16 a[244:245], v4 offset:4096
  v_mov_b32 v228, 0x40c00000
  v_mfma_f32_16x16x32_bf16 v[144:147], a[212:215], a[112:115], v[144:147]
L_p2857:
  s_cmp_eq_u32 s95, 1
  s_cbranch_scc1 L_p4590
  ds_read_b64_tr_b16 a[252:253], v5 offset:4096
  v_mov_b32 v229, 0x40c00000
  v_mfma_f32_16x16x32_bf16 v[148:151], a[212:215], a[116:119], v[148:151]
  v_permlane16_swap_b32 v49, v51
  v_mfma_f32_16x16x32_bf16 v[148:151], a[208:211], a[100:103], v[148:151]
  buffer_load_dwordx4 v29, s[52:55], s74 offen offset:1024 lds
  v_mfma_f32_16x16x32_bf16 v[152:155], a[208:211], a[104:107], v[152:155]
  s_waitcnt vmcnt(14)
  ds_read_b64_tr_b16 a[230:231], v2 offset:6144
  v_cvt_pk_bf16_f32 v130, v96, v97
  v_mfma_f32_16x16x32_bf16 v[152:155], a[212:215], a[120:123], v[152:155]
  ds_read_b64_tr_b16 a[238:239], v3 offset:6144
  v_cvt_pk_bf16_f32 v131, v98, v99
  v_mfma_f32_16x16x32_bf16 v[156:159], a[212:215], a[124:127], v[156:159]
  v_permlane16_swap_b32 v64, v66
  v_mfma_f32_16x16x32_bf16 v[156:159], a[208:211], a[108:111], v[156:159]
  buffer_load_dwordx4 v30, s[52:55], s74 offen offset:2048 lds
  v_mfma_f32_16x16x32_bf16 v[124:127], a[216:219], a[108:111], v[124:127]
  ds_read_b64_tr_b16 a[246:247], v4 offset:6144
  v_cvt_pk_bf16_f32 v132, v132, v133
  v_mfma_f32_16x16x32_bf16 v[124:127], a[220:223], a[124:127], v[124:127]
  ds_read_b64_tr_b16 a[254:255], v5 offset:6144
  v_cvt_pk_bf16_f32 v133, v134, v135
  v_mfma_f32_16x16x32_bf16 v[120:123], a[220:223], a[120:123], v[120:123]
  v_permlane16_swap_b32 v65, v67
  v_mfma_f32_16x16x32_bf16 v[120:123], a[216:219], a[104:107], v[120:123]
  buffer_load_dwordx4 v31, s[52:55], s74 offen offset:3072 lds
  v_mfma_f32_16x16x32_bf16 v[116:119], a[216:219], a[100:103], v[116:119]
  s_add_u32 s83, s83, 0x4000
  s_waitcnt vmcnt(14)
  ds_read_b64_tr_b16 a[192:193], v2 offset:8192
  v_cvt_pk_bf16_f32 v134, v100, v101
  v_mfma_f32_16x16x32_bf16 v[116:119], a[220:223], a[116:119], v[116:119]
  s_and_b32 s83, s83, 0x7ffff
  ds_read_b64_tr_b16 a[200:201], v3 offset:8192
  v_cvt_pk_bf16_f32 v135, v102, v103
  v_mfma_f32_16x16x32_bf16 v[112:115], a[220:223], a[112:115], v[112:115]
  s_add_u32 m0, s85, 0
  s_waitcnt lgkmcnt(4)
  ds_read_b64_tr_b16 a[208:209], v4 offset:8192
  v_cvt_pk_bf16_f32 v136, v136, v137
  v_mfma_f32_16x16x32_bf16 v[112:115], a[216:219], a[96:99], v[112:115]
  buffer_load_dwordx4 v26, s[36:39], s83 offen lds
  v_mfma_f32_16x16x32_bf16 v[192:195], a[224:227], a[32:35], 0
  ds_read_b64_tr_b16 a[216:217], v5 offset:8192
  v_cvt_pk_bf16_f32 v137, v138, v139
  v_mfma_f32_16x16x32_bf16 v[192:195], a[228:231], a[48:51], v[192:195]
  buffer_load_dwordx4 v26, s[36:39], s83 offen offset:1024 lds
  v_mfma_f32_16x16x32_bf16 v[196:199], a[228:231], a[52:55], 0
  v_permlane16_swap_b32 v80, v82
  v_mfma_f32_16x16x32_bf16 v[196:199], a[224:227], a[36:39], v[196:199]
  buffer_load_dwordx4 v26, s[36:39], s83 offen offset:2048 lds
  v_mfma_f32_16x16x32_bf16 v[200:203], a[224:227], a[40:43], 0
  s_waitcnt vmcnt(15)
  ds_read_b64_tr_b16 a[194:195], v2 offset:10240
  v_cvt_pk_bf16_f32 v138, v104, v105
  v_mfma_f32_16x16x32_bf16 v[200:203], a[228:231], a[56:59], v[200:203]
  buffer_load_dwordx4 v26, s[36:39], s83 offen offset:3072 lds
  v_mfma_f32_16x16x32_bf16 v[204:207], a[228:231], a[60:63], 0
  s_xor_b32 s90, s21, 0x10000
  ds_read_b64_tr_b16 a[202:203], v3 offset:10240
  v_cvt_pk_bf16_f32 v139, v106, v107
  v_mfma_f32_16x16x32_bf16 v[204:207], a[224:227], a[44:47], v[204:207]
  buffer_store_dwordx4 v[128:131], v1, s[60:63], s90 offen sc1
  v_permlane16_swap_b32 v81, v83
  v_mfma_f32_16x16x32_bf16 v[172:175], a[232:235], a[44:47], 0
  ds_read_b64_tr_b16 a[210:211], v4 offset:10240
  v_cvt_pk_bf16_f32 v140, v140, v141
  v_mfma_f32_16x16x32_bf16 v[172:175], a[236:239], a[60:63], v[172:175]
  v_permlane16_swap_b32 v36, v38
  v_mfma_f32_16x16x32_bf16 v[168:171], a[236:239], a[56:59], 0
  ds_read_b64_tr_b16 a[218:219], v5 offset:10240
  v_cvt_pk_bf16_f32 v141, v142, v143
  v_mfma_f32_16x16x32_bf16 v[168:171], a[232:235], a[40:43], v[168:171]
  v_permlane16_swap_b32 v37, v39
  v_mfma_f32_16x16x32_bf16 v[164:167], a[232:235], a[36:39], 0
  s_waitcnt vmcnt(15)
  ds_read_b64_tr_b16 a[196:197], v2 offset:12288
  v_cvt_pk_bf16_f32 v142, v108, v109
  v_mfma_f32_16x16x32_bf16 v[164:167], a[236:239], a[52:55], v[164:167]
  v_permlane16_swap_b32 v52, v54
  v_mfma_f32_16x16x32_bf16 v[160:163], a[236:239], a[48:51], 0
  ds_read_b64_tr_b16 a[204:205], v3 offset:12288
  v_cvt_pk_bf16_f32 v143, v110, v111
  v_mfma_f32_16x16x32_bf16 v[160:163], a[232:235], a[32:35], v[160:163]
  v_permlane16_swap_b32 v53, v55
  v_mfma_f32_16x16x32_bf16 v[208:211], a[240:243], a[32:35], 0
  s_waitcnt lgkmcnt(4)
  ds_read_b64_tr_b16 a[212:213], v4 offset:12288
  v_cvt_pk_bf16_f32 v144, v144, v145
  v_mfma_f32_16x16x32_bf16 v[208:211], a[244:247], a[48:51], v[208:211]
  v_permlane16_swap_b32 v68, v70
  v_mfma_f32_16x16x32_bf16 v[212:215], a[244:247], a[52:55], 0
  ds_read_b64_tr_b16 a[220:221], v5 offset:12288
  v_cvt_pk_bf16_f32 v145, v146, v147
  v_mfma_f32_16x16x32_bf16 v[212:215], a[240:243], a[36:39], v[212:215]
  v_permlane16_swap_b32 v69, v71
  v_mfma_f32_16x16x32_bf16 v[216:219], a[240:243], a[40:43], 0
  s_waitcnt vmcnt(13)
  ds_read_b64_tr_b16 a[198:199], v2 offset:14336
  v_cvt_pk_bf16_f32 v146, v112, v113
  v_mfma_f32_16x16x32_bf16 v[216:219], a[244:247], a[56:59], v[216:219]
  v_permlane16_swap_b32 v84, v86
  v_mfma_f32_16x16x32_bf16 v[220:223], a[244:247], a[60:63], 0
  s_xor_b32 s91, s21, 0x410400
  ds_read_b64_tr_b16 a[206:207], v3 offset:14336
  v_cvt_pk_bf16_f32 v147, v114, v115
  v_mfma_f32_16x16x32_bf16 v[220:223], a[240:243], a[44:47], v[220:223]
  buffer_store_dwordx4 v[132:135], v1, s[60:63], s91 offen sc1
  v_permlane16_swap_b32 v85, v87
  v_mfma_f32_16x16x32_bf16 v[188:191], a[248:251], a[44:47], 0
  ds_read_b64_tr_b16 a[214:215], v4 offset:14336
  v_cvt_pk_bf16_f32 v148, v148, v149
  v_mfma_f32_16x16x32_bf16 v[188:191], a[252:255], a[60:63], v[188:191]
  v_permlane16_swap_b32 v40, v42
  v_mfma_f32_16x16x32_bf16 v[184:187], a[252:255], a[56:59], 0
  ds_read_b64_tr_b16 a[222:223], v5 offset:14336
  v_cvt_pk_bf16_f32 v149, v150, v151
  v_mfma_f32_16x16x32_bf16 v[184:187], a[248:251], a[40:43], v[184:187]
  v_permlane16_swap_b32 v41, v43
  v_mfma_f32_16x16x32_bf16 v[180:183], a[248:251], a[36:39], 0
  s_waitcnt vmcnt(12)
  ds_read_b64_tr_b16 a[224:225], v2 offset:16384
  v_cvt_pk_bf16_f32 v150, v116, v117
  v_mfma_f32_16x16x32_bf16 v[180:183], a[252:255], a[52:55], v[180:183]
  ds_read_b64_tr_b16 a[232:233], v3 offset:16384
  v_cvt_pk_bf16_f32 v151, v118, v119
  v_mfma_f32_16x16x32_bf16 v[176:179], a[252:255], a[48:51], 0
  v_permlane16_swap_b32 v56, v58
  v_mfma_f32_16x16x32_bf16 v[176:179], a[248:251], a[32:35], v[176:179]
  ds_read_b64_tr_b16 a[240:241], v4 offset:16384
  v_cvt_pk_bf16_f32 v152, v152, v153
  v_mfma_f32_16x16x32_bf16 v[192:195], a[192:195], a[64:67], v[192:195]
  s_waitcnt lgkmcnt(5)
  ds_read_b64_tr_b16 a[248:249], v5 offset:16384
  v_cvt_pk_bf16_f32 v153, v154, v155
  v_mfma_f32_16x16x32_bf16 v[192:195], a[196:199], a[80:83], v[192:195]
  v_permlane16_swap_b32 v57, v59
  v_mfma_f32_16x16x32_bf16 v[196:199], a[196:199], a[84:87], v[196:199]
  ds_read_b128 a[128:131], v14 offset:32768
  v_cvt_pk_bf16_f32 v154, v120, v121
  v_mfma_f32_16x16x32_bf16 v[196:199], a[192:195], a[68:71], v[196:199]
  v_permlane16_swap_b32 v72, v74
  v_mfma_f32_16x16x32_bf16 v[200:203], a[192:195], a[72:75], v[200:203]
  s_waitcnt vmcnt(10)
  ds_read_b64_tr_b16 a[226:227], v2 offset:18432
  v_cvt_pk_bf16_f32 v155, v122, v123
  v_mfma_f32_16x16x32_bf16 v[200:203], a[196:199], a[88:91], v[200:203]
  s_mov_b32 s48, s26
  ds_read_b64_tr_b16 a[234:235], v3 offset:18432
  v_cvt_pk_bf16_f32 v156, v156, v157
  v_mfma_f32_16x16x32_bf16 v[204:207], a[196:199], a[92:95], v[204:207]
  s_mov_b32 s49, s27
  v_permlane16_swap_b32 v73, v75
  v_mfma_f32_16x16x32_bf16 v[204:207], a[192:195], a[76:79], v[204:207]
  s_mov_b32 s50, 0x100
  ds_read_b64_tr_b16 a[242:243], v4 offset:18432
  v_cvt_pk_bf16_f32 v157, v158, v159
  v_mfma_f32_16x16x32_bf16 v[172:175], a[200:203], a[76:79], v[172:175]
  s_xor_b32 s90, s21, 0x810800
  ds_read_b64_tr_b16 a[250:251], v5 offset:18432
  v_cvt_pk_bf16_f32 v158, v124, v125
  v_mfma_f32_16x16x32_bf16 v[172:175], a[204:207], a[92:95], v[172:175]
  buffer_store_dwordx4 v[136:139], v1, s[60:63], s90 offen sc1
  v_permlane16_swap_b32 v88, v90
  v_mfma_f32_16x16x32_bf16 v[168:171], a[204:207], a[88:91], v[168:171]
  s_mov_b32 s51, 0x20000
  ds_read_b128 a[132:135], v15 offset:32768
  v_cvt_pk_bf16_f32 v159, v126, v127
  v_mfma_f32_16x16x32_bf16 v[168:171], a[200:203], a[72:75], v[168:171]
  s_mov_b32 s44, s24
  v_permlane16_swap_b32 v89, v91
  v_mfma_f32_16x16x32_bf16 v[164:167], a[200:203], a[68:71], v[164:167]
  s_waitcnt vmcnt(9)
  ds_read_b64_tr_b16 a[228:229], v2 offset:20480
  v_mov_b32 v230, 0x40c00000
  v_mfma_f32_16x16x32_bf16 v[164:167], a[204:207], a[84:87], v[164:167]
  s_mov_b32 s45, s25
  ds_read_b64_tr_b16 a[236:237], v3 offset:20480
  v_mov_b32 v231, 0x40c00000
  v_mfma_f32_16x16x32_bf16 v[160:163], a[204:207], a[80:83], v[160:163]
  s_mov_b32 s46, 0x200000
  v_permlane16_swap_b32 v44, v46
  v_mfma_f32_16x16x32_bf16 v[160:163], a[200:203], a[64:67], v[160:163]
  s_mov_b32 s47, 0x20000
  ds_read_b64_tr_b16 a[244:245], v4 offset:20480
  v_mov_b32 v232, 0x40c00000
  v_mfma_f32_16x16x32_bf16 v[208:211], a[208:211], a[64:67], v[208:211]
  s_waitcnt lgkmcnt(5)
  ds_read_b64_tr_b16 a[252:253], v5 offset:20480
  v_mov_b32 v233, 0x40c00000
  v_mfma_f32_16x16x32_bf16 v[208:211], a[212:215], a[80:83], v[208:211]
  s_mov_b32 s64, s22
  v_permlane16_swap_b32 v45, v47
  v_mfma_f32_16x16x32_bf16 v[212:215], a[212:215], a[84:87], v[212:215]
  s_mov_b32 s65, s23
  ds_read_b128 a[136:139], v16 offset:32768
  v_mov_b32 v234, 0x40c00000
  v_mfma_f32_16x16x32_bf16 v[212:215], a[208:211], a[68:71], v[212:215]
  s_mov_b32 s66, 0x400
  v_permlane16_swap_b32 v60, v62
  v_mfma_f32_16x16x32_bf16 v[216:219], a[208:211], a[72:75], v[216:219]
  s_waitcnt vmcnt(7)
  ds_read_b64_tr_b16 a[230:231], v2 offset:22528
  v_mov_b32 v235, 0x40c00000
  v_mfma_f32_16x16x32_bf16 v[216:219], a[212:215], a[88:91], v[216:219]
  s_mov_b32 s67, 0x20000
  ds_read_b64_tr_b16 a[238:239], v3 offset:22528
  v_mov_b32 v236, 0x40c00000
  v_mfma_f32_16x16x32_bf16 v[220:223], a[212:215], a[92:95], v[220:223]
  s_lshl_b32 s11, s31, 2
  v_permlane16_swap_b32 v61, v63
  v_mfma_f32_16x16x32_bf16 v[220:223], a[208:211], a[76:79], v[220:223]
  s_add_u32 s11, s11, 0x80
  ds_read_b64_tr_b16 a[246:247], v4 offset:22528
  v_mov_b32 v237, 0x40c00000
  v_mfma_f32_16x16x32_bf16 v[188:191], a[216:219], a[76:79], v[188:191]
  s_lshl_b32 s68, s31, 13
  ds_read_b64_tr_b16 a[254:255], v5 offset:22528
  v_mov_b32 v238, 0x40c00000
  v_mfma_f32_16x16x32_bf16 v[188:191], a[220:223], a[92:95], v[188:191]
  s_add_u32 s68, s68, 0x2000000
  v_permlane16_swap_b32 v76, v78
  v_mfma_f32_16x16x32_bf16 v[184:187], a[220:223], a[88:91], v[184:187]
  s_lshl_b32 s69, s3, 8
  ds_read_b128 a[140:143], v17 offset:32768
  v_mov_b32 v239, 0x40c00000
  v_mfma_f32_16x16x32_bf16 v[184:187], a[216:219], a[72:75], v[184:187]
  s_add_u32 s8, s68, s69
  v_permlane16_swap_b32 v77, v79
  v_mfma_f32_16x16x32_bf16 v[180:183], a[216:219], a[68:71], v[180:183]
  s_lshl_b32 s68, s30, 10
  v_permlane16_swap_b32 v92, v94
  v_mfma_f32_16x16x32_bf16 v[180:183], a[220:223], a[84:87], v[180:183]
  s_xor_b32 s91, s21, 0xc10c00
  v_permlane16_swap_b32 v93, v95
  v_mfma_f32_16x16x32_bf16 v[176:179], a[220:223], a[80:83], v[176:179]
  buffer_store_dwordx4 v[140:143], v1, s[60:63], s91 offen sc1
  v_mfma_f32_16x16x32_bf16 v[176:179], a[216:219], a[64:67], v[176:179]
  s_add_u32 s7, s8, s68
  ds_read_b128 a[144:147], v14 offset:33792
  v_bfe_i32 v252, v1, 5, 1
  v_mfma_f32_16x16x32_bf16 v[192:195], a[224:227], a[96:99], v[192:195]
  s_waitcnt lgkmcnt(4)
  ds_read_b128 a[148:151], v15 offset:33792
  v_not_b32 v252, v252
  v_mfma_f32_16x16x32_bf16 v[192:195], a[228:231], a[112:115], v[192:195]
  s_xor_b32 s9, s82, 0x1c00000
  ds_read_b128 a[152:155], v16 offset:33792
  v_and_b32 v248, 0x3f803f80, v252
  v_mfma_f32_16x16x32_bf16 v[196:199], a[228:231], a[116:119], v[196:199]
  s_lshr_b32 s68, s30, 2
  v_bfe_i32 v252, v1, 6, 1
  v_lshrrev_b32 v6, 2, v1
  v_mfma_f32_16x16x32_bf16 v[196:199], a[224:227], a[100:103], v[196:199]
  s_lshl_b32 s68, s68, 7
  v_and_b32 v252, v252, v248
  v_mov_b32 v7, 0
  v_mfma_f32_16x16x32_bf16 v[200:203], a[224:227], a[104:107], v[200:203]
  s_add_u32 s28, s68, s69
  ds_read_b128 a[156:159], v17 offset:33792
  v_xor_b32 v248, v248, v252
  v_mov_b32 v8, 1
  v_mfma_f32_16x16x32_bf16 v[200:203], a[228:231], a[120:123], v[200:203]
  s_and_b32 s68, s30, 3
  v_mov_b32 v249, v248
  v_lshl_add_u32 v9, v1, 4, s85
  v_mfma_f32_16x16x32_bf16 v[204:207], a[228:231], a[124:127], v[204:207]
  s_lshl_b32 s68, s68, 14
  ds_read_b128 a[160:163], v14 offset:34816
  v_mov_b32 v250, v248
  v_bfe_u32 v13, v1, 9, 1
  v_mfma_f32_16x16x32_bf16 v[204:207], a[224:227], a[108:111], v[204:207]
  s_add_u32 s10, s68, s28
  v_mov_b32 v251, v248
  v_bfe_u32 v12, v1, 8, 1
  v_mfma_f32_16x16x32_bf16 v[172:175], a[232:235], a[108:111], v[172:175]
  s_lshl_b32 s68, s31, 16
  v_mov_b32 v253, v252
  v_lshl_add_u32 v13, v12, 1, v13
  v_mfma_f32_16x16x32_bf16 v[172:175], a[236:239], a[124:127], v[172:175]
  s_add_u32 s10, s10, s68
  ds_read_b128 a[164:167], v15 offset:34816
  v_mov_b32 v254, v252
  v_lshlrev_b32 v13, 4, v13
  v_mfma_f32_16x16x32_bf16 v[168:171], a[236:239], a[120:123], v[168:171]
  s_mul_i32 s5, s31, 0x4000
  v_mov_b32 v255, v252
  v_and_b32 v12, 0xf0, v1
  v_mfma_f32_16x16x32_bf16 v[168:171], a[232:235], a[104:107], v[168:171]
  s_mov_b32 s80, 0x7060302
  v_bfe_i32 v11, v1, 4, 1
  v_lshl_add_u32 v12, v12, 6, v13
  v_mfma_f32_16x16x32_bf16 v[164:167], a[232:235], a[100:103], v[164:167]
  buffer_store_dword v7, v6, s[60:63], s7 offen sc1
  ds_read_b128 a[168:171], v16 offset:34816
  v_and_b32 v11, 0xaaaaaaaa, v11
  v_mfma_f32_16x16x32_bf16 v[164:167], a[236:239], a[116:119], v[164:167]
  v_or_b32 v11, 0x44444444, v11
  v_mov_b32 v240, 0
  v_mfma_f32_16x16x32_bf16 v[160:163], a[236:239], a[112:115], v[160:163]
  s_xor_b32 s90, s21, 0x12000
  ds_read_b128 a[172:175], v17 offset:34816
  v_mov_b32 v241, 0
  v_mfma_f32_16x16x32_bf16 v[160:163], a[232:235], a[96:99], v[160:163]
  buffer_store_dwordx4 v[144:147], v1, s[60:63], s90 offen sc1
  v_mfma_f32_16x16x32_bf16 v[208:211], a[240:243], a[96:99], v[208:211]
  s_waitcnt lgkmcnt(3)
  v_mov_b32 v242, 0
  v_mov_b32 v243, 0
  v_mfma_f32_16x16x32_bf16 v[208:211], a[244:247], a[112:115], v[208:211]
  ds_read_b128 a[176:179], v14 offset:35840
  v_mov_b32 v244, 0
  v_mfma_f32_16x16x32_bf16 v[212:215], a[244:247], a[116:119], v[212:215]
  v_mov_b32 v245, 0
  v_mov_b32 v246, 0
  v_mfma_f32_16x16x32_bf16 v[212:215], a[240:243], a[100:103], v[212:215]
  v_mov_b32 v247, 0
  v_cvt_pk_bf16_f32 v192, v192, v193
  v_mfma_f32_16x16x32_bf16 v[216:219], a[240:243], a[104:107], v[216:219]
  ds_read_b128 a[180:183], v15 offset:35840
  v_cvt_pk_bf16_f32 v193, v194, v195
  v_mfma_f32_16x16x32_bf16 v[216:219], a[244:247], a[120:123], v[216:219]
  v_cvt_pk_bf16_f32 v194, v160, v161
  v_cvt_pk_bf16_f32 v195, v162, v163
  v_mfma_f32_16x16x32_bf16 v[220:223], a[244:247], a[124:127], v[220:223]
  ds_read_b128 a[184:187], v16 offset:35840
  v_cvt_pk_bf16_f32 v196, v196, v197
  v_mfma_f32_16x16x32_bf16 v[220:223], a[240:243], a[108:111], v[220:223]
  v_cvt_pk_bf16_f32 v197, v198, v199
  v_cvt_pk_bf16_f32 v198, v164, v165
  v_mfma_f32_16x16x32_bf16 v[188:191], a[248:251], a[108:111], v[188:191]
  v_cvt_pk_bf16_f32 v199, v166, v167
  v_cvt_pk_bf16_f32 v200, v200, v201
  v_mfma_f32_16x16x32_bf16 v[188:191], a[252:255], a[124:127], v[188:191]
  ds_read_b128 a[188:191], v17 offset:35840
  v_cvt_pk_bf16_f32 v201, v202, v203
  v_mfma_f32_16x16x32_bf16 v[184:187], a[252:255], a[120:123], v[184:187]
  v_cvt_pk_bf16_f32 v202, v168, v169
  v_cvt_pk_bf16_f32 v203, v170, v171
  v_mfma_f32_16x16x32_bf16 v[184:187], a[248:251], a[104:107], v[184:187]
  v_cvt_pk_bf16_f32 v204, v204, v205
  v_cvt_pk_bf16_f32 v205, v206, v207
  v_mfma_f32_16x16x32_bf16 v[180:183], a[248:251], a[100:103], v[180:183]
  s_andn2_b32 s68, 4, s30
  v_cvt_pk_bf16_f32 v206, v172, v173
  v_cvt_pk_bf16_f32 v207, v174, v175
  v_mfma_f32_16x16x32_bf16 v[180:183], a[252:255], a[116:119], v[180:183]
  s_lshl_b32 s68, s68, 5
  v_cvt_pk_bf16_f32 v208, v208, v209
  v_cvt_pk_bf16_f32 v209, v210, v211
  v_mfma_f32_16x16x32_bf16 v[176:179], a[252:255], a[112:115], v[176:179]
  s_xor_b32 s91, s21, 0x412400
  s_or_b32 s89, s89, s68
  v_mfma_f32_16x16x32_bf16 v[176:179], a[248:251], a[96:99], v[176:179]
  buffer_store_dwordx4 v[148:151], v1, s[60:63], s91 offen sc1
  v_mfma_f32_16x16x32_bf16 v[96:99], a[128:131], v[32:35], v[224:227]
  v_mfma_f32_16x16x32_bf16 v[96:99], a[132:135], v[36:39], v[96:99]
  v_mfma_f32_16x16x32_bf16 v[96:99], a[136:139], v[40:43], v[96:99]
  v_mfma_f32_16x16x32_bf16 v[96:99], a[140:143], v[44:47], v[96:99]
  s_nop 2
  v_cvt_pk_bf16_f32 v210, v176, v177
  v_cvt_pk_bf16_f32 v211, v178, v179
  v_mfma_f32_16x16x32_bf16 v[100:103], a[140:143], v[60:63], v[228:231]
  v_cvt_pk_bf16_f32 v212, v212, v213
  v_cvt_pk_bf16_f32 v213, v214, v215
  v_mfma_f32_16x16x32_bf16 v[100:103], a[136:139], v[56:59], v[100:103]
  v_cvt_pk_bf16_f32 v214, v180, v181
  v_cvt_pk_bf16_f32 v215, v182, v183
  v_mfma_f32_16x16x32_bf16 v[100:103], a[132:135], v[52:55], v[100:103]
  v_cvt_pk_bf16_f32 v216, v216, v217
  v_cvt_pk_bf16_f32 v217, v218, v219
  v_mfma_f32_16x16x32_bf16 v[100:103], a[128:131], v[48:51], v[100:103]
  v_cvt_pk_bf16_f32 v218, v184, v185
  v_cvt_pk_bf16_f32 v219, v186, v187
  v_mfma_f32_16x16x32_bf16 v[104:107], a[128:131], v[64:67], v[232:235]
  v_cvt_pk_bf16_f32 v220, v220, v221
  v_cvt_pk_bf16_f32 v221, v222, v223
  v_mfma_f32_16x16x32_bf16 v[104:107], a[132:135], v[68:71], v[104:107]
  v_cvt_pk_bf16_f32 v222, v188, v189
  v_cvt_pk_bf16_f32 v223, v190, v191
  v_mfma_f32_16x16x32_bf16 v[104:107], a[136:139], v[72:75], v[104:107]
  v_exp_f32 v96, v96
  v_mfma_f32_16x16x32_bf16 v[104:107], a[140:143], v[76:79], v[104:107]
  v_exp_f32 v97, v97
  v_mfma_f32_16x16x32_bf16 v[108:111], a[140:143], v[92:95], v[236:239]
  v_exp_f32 v98, v98
  v_mfma_f32_16x16x32_bf16 v[108:111], a[136:139], v[88:91], v[108:111]
  v_exp_f32 v99, v99
  v_mfma_f32_16x16x32_bf16 v[108:111], a[132:135], v[84:87], v[108:111]
  s_xor_b32 s90, s21, 0x812800
  v_exp_f32 v100, v100
  v_mfma_f32_16x16x32_bf16 v[108:111], a[128:131], v[80:83], v[108:111]
  buffer_store_dwordx4 v[152:155], v1, s[60:63], s90 offen sc1
  v_mfma_f32_16x16x32_bf16 v[124:127], a[144:147], v[80:83], v[236:239]
  v_exp_f32 v101, v101
  v_mfma_f32_16x16x32_bf16 v[124:127], a[148:151], v[84:87], v[124:127]
  v_exp_f32 v102, v102
  v_mfma_f32_16x16x32_bf16 v[124:127], a[152:155], v[88:91], v[124:127]
  v_exp_f32 v103, v103
  v_mfma_f32_16x16x32_bf16 v[124:127], a[156:159], v[92:95], v[124:127]
  v_exp_f32 v104, v104
  v_mfma_f32_16x16x32_bf16 v[120:123], a[156:159], v[76:79], v[232:235]
  v_exp_f32 v105, v105
  v_mfma_f32_16x16x32_bf16 v[120:123], a[152:155], v[72:75], v[120:123]
  v_exp_f32 v106, v106
  v_mfma_f32_16x16x32_bf16 v[120:123], a[148:151], v[68:71], v[120:123]
  v_exp_f32 v107, v107
  v_mfma_f32_16x16x32_bf16 v[120:123], a[144:147], v[64:67], v[120:123]
  v_exp_f32 v108, v108
  v_mfma_f32_16x16x32_bf16 v[116:119], a[144:147], v[48:51], v[228:231]
  v_exp_f32 v109, v109
  v_mfma_f32_16x16x32_bf16 v[116:119], a[148:151], v[52:55], v[116:119]
  v_exp_f32 v110, v110
  v_mfma_f32_16x16x32_bf16 v[116:119], a[152:155], v[56:59], v[116:119]
  v_exp_f32 v111, v111
  v_mfma_f32_16x16x32_bf16 v[116:119], a[156:159], v[60:63], v[116:119]
  v_exp_f32 v124, v124
  v_mfma_f32_16x16x32_bf16 v[112:115], a[156:159], v[44:47], v[224:227]
  v_exp_f32 v125, v125
  v_mfma_f32_16x16x32_bf16 v[112:115], a[152:155], v[40:43], v[112:115]
  v_exp_f32 v126, v126
  v_mfma_f32_16x16x32_bf16 v[112:115], a[148:151], v[36:39], v[112:115]
  s_xor_b32 s91, s21, 0xc12c00
  v_exp_f32 v127, v127
  v_mfma_f32_16x16x32_bf16 v[112:115], a[144:147], v[32:35], v[112:115]
  buffer_store_dwordx4 v[156:159], v1, s[60:63], s91 offen sc1
  v_mfma_f32_16x16x32_bf16 v[128:131], a[160:163], v[32:35], v[224:227]
  s_waitcnt lgkmcnt(0)
  v_exp_f32 v120, v120
  v_mfma_f32_16x16x32_bf16 v[128:131], a[164:167], v[36:39], v[128:131]
  v_exp_f32 v121, v121
  v_mfma_f32_16x16x32_bf16 v[128:131], a[168:171], v[40:43], v[128:131]
  v_exp_f32 v122, v122
  v_mfma_f32_16x16x32_bf16 v[128:131], a[172:175], v[44:47], v[128:131]
  v_exp_f32 v123, v123
  v_mfma_f32_16x16x32_bf16 v[132:135], a[172:175], v[60:63], v[228:231]
  v_exp_f32 v116, v116
  v_mfma_f32_16x16x32_bf16 v[132:135], a[168:171], v[56:59], v[132:135]
  s_waitcnt vmcnt(9)
  s_barrier
  v_mfma_f32_16x16x32_bf16 v[132:135], a[164:167], v[52:55], v[132:135]
  v_exp_f32 v117, v117
  v_mfma_f32_16x16x32_bf16 v[132:135], a[160:163], v[48:51], v[132:135]
  ds_read_b128 a[128:131], v14
  v_cvt_pk_bf16_f32 v160, v96, v97
  v_cvt_pk_bf16_f32 v170, v116, v117
  v_mfma_f32_16x16x32_bf16 v[136:139], a[160:163], v[64:67], v[232:235]
  v_exp_f32 v118, v118
  v_mfma_f32_16x16x32_bf16 v[136:139], a[164:167], v[68:71], v[136:139]
  ds_read_b128 a[132:135], v15
  v_cvt_pk_bf16_f32 v161, v98, v99
  v_mfma_f32_16x16x32_bf16 v[136:139], a[168:171], v[72:75], v[136:139]
  v_exp_f32 v119, v119
  v_mfma_f32_16x16x32_bf16 v[136:139], a[172:175], v[76:79], v[136:139]
  ds_read_b128 a[136:139], v16
  v_cvt_pk_bf16_f32 v168, v100, v101
  v_cvt_pk_bf16_f32 v171, v118, v119
  v_mfma_f32_16x16x32_bf16 v[140:143], a[172:175], v[92:95], v[236:239]
  v_exp_f32 v112, v112
  v_mfma_f32_16x16x32_bf16 v[140:143], a[168:171], v[88:91], v[140:143]
  ds_read_b128 a[140:143], v17
  v_cvt_pk_bf16_f32 v169, v102, v103
  v_mfma_f32_16x16x32_bf16 v[140:143], a[164:167], v[84:87], v[140:143]
  s_xor_b32 s90, s21, 0x1011000
  v_exp_f32 v113, v113
  v_mfma_f32_16x16x32_bf16 v[140:143], a[160:163], v[80:83], v[140:143]
  buffer_store_dwordx4 v[192:195], v1, s[60:63], s90 offen sc1
  v_cvt_pk_bf16_f32 v162, v112, v113
  v_mfma_f32_16x16x32_bf16 v[156:159], a[176:179], v[80:83], v[236:239]
  ds_read_b128 a[144:147], v14 offset:1024
  v_cvt_pk_bf16_f32 v176, v104, v105
  v_mfma_f32_16x16x32_bf16 v[156:159], a[180:183], v[84:87], v[156:159]
  ds_read_b128 a[148:151], v15 offset:1024
  v_cvt_pk_bf16_f32 v177, v106, v107
  v_mfma_f32_16x16x32_bf16 v[156:159], a[184:187], v[88:91], v[156:159]
  v_exp_f32 v114, v114
  v_mfma_f32_16x16x32_bf16 v[156:159], a[188:191], v[92:95], v[156:159]
  ds_read_b128 a[152:155], v16 offset:1024
  v_cvt_pk_bf16_f32 v184, v108, v109
  v_mfma_f32_16x16x32_bf16 v[152:155], a[188:191], v[76:79], v[232:235]
  s_add_u32 s83, s83, 0x4000
  v_exp_f32 v115, v115
  v_mfma_f32_16x16x32_bf16 v[152:155], a[184:187], v[72:75], v[152:155]
  s_and_b32 s83, s83, 0x7ffff
  ds_read_b128 a[156:159], v17 offset:1024
  v_cvt_pk_bf16_f32 v185, v110, v111
  v_cvt_pk_bf16_f32 v163, v114, v115
  v_mfma_f32_16x16x32_bf16 v[152:155], a[180:183], v[68:71], v[152:155]
  s_add_u32 m0, s85, 0x8000
  v_exp_f32 v128, v128
  v_mfma_f32_16x16x32_bf16 v[152:155], a[176:179], v[64:67], v[152:155]
  buffer_load_dwordx4 v26, s[36:39], s83 offen lds
  v_mfma_f32_16x16x32_bf16 v[148:151], a[176:179], v[48:51], v[228:231]
  v_exp_f32 v129, v129
  v_mfma_f32_16x16x32_bf16 v[148:151], a[180:183], v[52:55], v[148:151]
  ds_read_b128 a[160:163], v14 offset:2048
  v_cvt_pk_bf16_f32 v186, v124, v125
  v_cvt_pk_bf16_f32 v164, v128, v129
  v_mfma_f32_16x16x32_bf16 v[148:151], a[184:187], v[56:59], v[148:151]
  v_exp_f32 v130, v130
  v_mfma_f32_16x16x32_bf16 v[148:151], a[188:191], v[60:63], v[148:151]
  ds_read_b128 a[164:167], v15 offset:2048
  v_cvt_pk_bf16_f32 v187, v126, v127
  v_mfma_f32_16x16x32_bf16 v[144:147], a[188:191], v[44:47], v[224:227]
  v_exp_f32 v131, v131
  v_mfma_f32_16x16x32_bf16 v[144:147], a[184:187], v[40:43], v[144:147]
  buffer_load_dwordx4 v26, s[36:39], s83 offen offset:1024 lds
  v_cvt_pk_bf16_f32 v165, v130, v131
  v_mfma_f32_16x16x32_bf16 v[144:147], a[180:183], v[36:39], v[144:147]
  v_exp_f32 v132, v132
  v_exp_f32 v133, v133
  v_exp_f32 v134, v134
  v_exp_f32 v135, v135
  v_exp_f32 v136, v136
  v_exp_f32 v137, v137
  v_exp_f32 v138, v138
  v_exp_f32 v139, v139
  v_exp_f32 v140, v140
  v_exp_f32 v141, v141
  v_mfma_f32_16x16x32_bf16 v[144:147], a[176:179], v[32:35], v[144:147]
  v_cvt_pk_bf16_f32 v178, v120, v121
  v_cvt_pk_bf16_f32 v179, v122, v123
  v_cvt_pk_bf16_f32 v172, v132, v133
  v_cvt_pk_bf16_f32 v173, v134, v135
  v_cvt_pk_bf16_f32 v180, v136, v137
  v_cvt_pk_bf16_f32 v181, v138, v139
L_it0:
  s_waitcnt lgkmcnt(0)
  v_mfma_f32_16x16x32_bf16 v[96:99], a[128:131], v[32:35], v[224:227]
  ds_read_b128 a[168:171], v16 offset:2048
  v_cvt_pk_bf16_f32 v188, v140, v141
  v_mfma_f32_16x16x32_bf16 v[96:99], a[132:135], v[36:39], v[96:99]
  s_xor_b32 s91, s21, 0x1811800
  v_exp_f32 v142, v142
  v_mfma_f32_16x16x32_bf16 v[96:99], a[136:139], v[40:43], v[96:99]
  buffer_store_dwordx4 v[200:203], v1, s[60:63], s91 offen sc1
  ds_read_b128 a[172:175], v17 offset:2048
  v_mfma_f32_16x16x32_bf16 v[96:99], a[140:143], v[44:47], v[96:99]
  v_exp_f32 v143, v143
  v_mfma_f32_16x16x32_bf16 v[100:103], a[140:143], v[60:63], v[228:231]
  buffer_load_dwordx4 v26, s[36:39], s83 offen offset:2048 lds
  v_mfma_f32_16x16x32_bf16 v[100:103], a[136:139], v[56:59], v[100:103]
  v_exp_f32 v156, v156
  v_mfma_f32_16x16x32_bf16 v[100:103], a[132:135], v[52:55], v[100:103]
  ds_read_b128 a[176:179], v14 offset:3072
  v_cvt_pk_bf16_f32 v189, v142, v143
  v_mfma_f32_16x16x32_bf16 v[100:103], a[128:131], v[48:51], v[100:103]
  v_exp_f32 v157, v157
  v_mfma_f32_16x16x32_bf16 v[104:107], a[128:131], v[64:67], v[232:235]
  ds_read_b128 a[180:183], v15 offset:3072
  v_cvt_pk_bf16_f32 v190, v156, v157
  v_mfma_f32_16x16x32_bf16 v[104:107], a[132:135], v[68:71], v[104:107]
  v_exp_f32 v158, v158
  v_mfma_f32_16x16x32_bf16 v[104:107], a[136:139], v[72:75], v[104:107]
  buffer_load_dwordx4 v26, s[36:39], s83 offen offset:3072 lds
  v_mfma_f32_16x16x32_bf16 v[104:107], a[140:143], v[76:79], v[104:107]
  v_exp_f32 v159, v159
  v_mfma_f32_16x16x32_bf16 v[108:111], a[140:143], v[92:95], v[236:239]
  ds_read_b128 a[184:187], v16 offset:3072
  v_cvt_pk_bf16_f32 v191, v158, v159
  v_mfma_f32_16x16x32_bf16 v[108:111], a[136:139], v[88:91], v[108:111]
  s_add_u32 s84, s84, 0x4000
  v_exp_f32 v152, v152
  v_mfma_f32_16x16x32_bf16 v[108:111], a[132:135], v[84:87], v[108:111]
  s_and_b32 s84, s84, 0x7ffff
  ds_read_b128 a[188:191], v17 offset:3072
  v_mfma_f32_16x16x32_bf16 v[108:111], a[128:131], v[80:83], v[108:111]
  s_add_u32 m0, s85, 0x4000
  v_exp_f32 v153, v153
  v_mfma_f32_16x16x32_bf16 v[124:127], a[144:147], v[80:83], v[236:239]
  buffer_load_dwordx4 v27, s[40:43], s84 offen lds
  v_mfma_f32_16x16x32_bf16 v[124:127], a[148:151], v[84:87], v[124:127]
  v_exp_f32 v154, v154
  v_mfma_f32_16x16x32_bf16 v[124:127], a[152:155], v[88:91], v[124:127]
  s_xor_b32 s90, s21, 0x1013000
  ds_read_b64_tr_b16 a[192:193], v18 offset:49152
  v_cvt_pk_bf16_f32 v182, v152, v153
  v_mfma_f32_16x16x32_bf16 v[124:127], a[156:159], v[92:95], v[124:127]
  buffer_store_dwordx4 v[208:211], v1, s[60:63], s90 offen sc1
  v_exp_f32 v155, v155
  v_mfma_f32_16x16x32_bf16 v[120:123], a[156:159], v[76:79], v[232:235]
  ds_read_b64_tr_b16 a[194:195], v18 offset:50176
  v_cvt_pk_bf16_f32 v183, v154, v155
  v_mfma_f32_16x16x32_bf16 v[120:123], a[152:155], v[72:75], v[120:123]
  v_exp_f32 v148, v148
  v_mfma_f32_16x16x32_bf16 v[120:123], a[148:151], v[68:71], v[120:123]
  buffer_load_dwordx4 v27, s[40:43], s84 offen offset:1024 lds
  v_mfma_f32_16x16x32_bf16 v[120:123], a[144:147], v[64:67], v[120:123]
L_p3427:
  s_cmp_eq_u32 s95, 1
  s_cbranch_scc1 L_p5654
  v_exp_f32 v149, v149
  v_mfma_f32_16x16x32_bf16 v[116:119], a[144:147], v[48:51], v[228:231]
  ds_read_b64_tr_b16 a[196:197], v18 offset:51200
  v_cvt_pk_bf16_f32 v174, v148, v149
  v_mfma_f32_16x16x32_bf16 v[116:119], a[148:151], v[52:55], v[116:119]
  v_exp_f32 v150, v150
  v_mfma_f32_16x16x32_bf16 v[116:119], a[152:155], v[56:59], v[116:119]
  ds_read_b64_tr_b16 a[198:199], v18 offset:52224
  v_mfma_f32_16x16x32_bf16 v[116:119], a[156:159], v[60:63], v[116:119]
  s_mov_b32 s86, 0
  v_exp_f32 v151, v151
  v_mfma_f32_16x16x32_bf16 v[112:115], a[156:159], v[44:47], v[224:227]
  buffer_load_dwordx4 v27, s[40:43], s84 offen offset:2048 lds
  v_mfma_f32_16x16x32_bf16 v[112:115], a[152:155], v[40:43], v[112:115]
  s_waitcnt lgkmcnt(3)
  v_exp_f32 v144, v144
  v_accvgpr_read_b32 v246, a192
  v_mfma_f32_16x16x32_bf16 v[112:115], a[148:151], v[36:39], v[112:115]
  s_mov_b32 s4, 0
  ds_read_b64_tr_b16 a[200:201], v19 offset:49152
  v_cvt_pk_bf16_f32 v175, v150, v151
  v_accvgpr_read_b32 v243, a193
  v_mfma_f32_16x16x32_bf16 v[112:115], a[144:147], v[32:35], v[112:115]
  s_waitcnt lgkmcnt(3)
  v_exp_f32 v145, v145
  v_accvgpr_read_b32 v242, a194
  v_mfma_f32_16x16x32_bf16 v[128:131], a[160:163], v[32:35], v[224:227]
  ds_read_b64_tr_b16 a[202:203], v19 offset:50176
  v_cvt_pk_bf16_f32 v166, v144, v145
  v_max3_f32 v246, |v246|, |v243|, |v242|
  v_mfma_f32_16x16x32_bf16 v[128:131], a[164:167], v[36:39], v[128:131]
  s_xor_b32 s91, s21, 0x1813800
  v_exp_f32 v146, v146
  v_accvgpr_read_b32 v243, a195
  v_mfma_f32_16x16x32_bf16 v[128:131], a[168:171], v[40:43], v[128:131]
  buffer_load_dwordx4 v27, s[40:43], s84 offen offset:3072 lds
  v_max_f32 v246, v246, |v243|
  v_mfma_f32_16x16x32_bf16 v[128:131], a[172:175], v[44:47], v[128:131]
  buffer_store_dwordx4 v[216:219], v1, s[60:63], s91 offen sc1
  v_exp_f32 v147, v147
  v_readfirstlane_b32 s71, v246
  v_mfma_f32_16x16x32_bf16 v[132:135], a[172:175], v[60:63], v[228:231]
  ds_read_b64_tr_b16 a[204:205], v19 offset:51200
  v_cvt_pk_bf16_f32 v167, v146, v147
  s_nop 0
  v_mov_b32 v246, s71
  v_mfma_f32_16x16x32_bf16 v[132:135], a[168:171], v[56:59], v[132:135]
  v_exp_f32 v96, v96
  v_and_b32 v246, 0x7f800000, v246
  v_mfma_f32_16x16x32_bf16 v[132:135], a[164:167], v[52:55], v[132:135]
  v_exp_f32 v97, v97
  v_mfma_f32_16x16x32_bf16 v[132:135], a[160:163], v[48:51], v[132:135]
  ds_read_b64_tr_b16 a[206:207], v19 offset:52224
  v_cvt_pk_bf16_f32 v192, v96, v97
  v_mfma_f32_16x16x32_bf16 v[136:139], a[160:163], v[64:67], v[232:235]
  v_exp_f32 v98, v98
  v_mfma_f32_16x16x32_bf16 v[136:139], a[164:167], v[68:71], v[136:139]
  v_min_u32 v246, 0x64000000, v246
  v_mfma_f32_16x16x32_bf16 v[136:139], a[168:171], v[72:75], v[136:139]
  v_exp_f32 v99, v99
  v_mfma_f32_16x16x32_bf16 v[136:139], a[172:175], v[76:79], v[136:139]
  ds_read_b64_tr_b16 a[208:209], v20 offset:49152
  v_cvt_pk_bf16_f32 v193, v98, v99
  v_mfma_f32_16x16x32_bf16 v[140:143], a[172:175], v[92:95], v[236:239]
  v_exp_f32 v100, v100
  v_mfma_f32_16x16x32_bf16 v[140:143], a[168:171], v[88:91], v[140:143]
  ds_read_b64_tr_b16 a[210:211], v20 offset:50176
  v_add_u32 v246, 0x8400000, v246
  v_mfma_f32_16x16x32_bf16 v[140:143], a[164:167], v[84:87], v[140:143]
  v_exp_f32 v101, v101
  v_mfma_f32_16x16x32_bf16 v[140:143], a[160:163], v[80:83], v[140:143]
  ds_read_b64_tr_b16 a[212:213], v20 offset:51200
  v_cvt_pk_bf16_f32 v200, v100, v101
  v_mfma_f32_16x16x32_bf16 v[156:159], a[176:179], v[80:83], v[236:239]
  v_exp_f32 v102, v102
  v_mfma_f32_16x16x32_bf16 v[156:159], a[180:183], v[84:87], v[156:159]
  ds_read_b64_tr_b16 a[214:215], v20 offset:52224
  v_bfi_b32 v246, s87, 0, v246
  v_mfma_f32_16x16x32_bf16 v[156:159], a[184:187], v[88:91], v[156:159]
  v_exp_f32 v103, v103
  v_mfma_f32_16x16x32_bf16 v[156:159], a[188:191], v[92:95], v[156:159]
  s_xor_b32 s90, s21, 0x1411400
  ds_read_b64_tr_b16 a[216:217], v21 offset:49152
  v_cvt_pk_bf16_f32 v201, v102, v103
  v_mfma_f32_16x16x32_bf16 v[152:155], a[188:191], v[76:79], v[232:235]
  buffer_store_dwordx4 v[196:199], v1, s[60:63], s90 offen sc1
  v_exp_f32 v104, v104
  v_mfma_f32_16x16x32_bf16 v[152:155], a[184:187], v[72:75], v[152:155]
  ds_read_b64_tr_b16 a[218:219], v21 offset:50176
  v_lshlrev_b32 v7, 3, v1
  v_mfma_f32_16x16x32_bf16 v[152:155], a[180:183], v[68:71], v[152:155]
  v_exp_f32 v105, v105
  v_mfma_f32_16x16x32_bf16 v[152:155], a[176:179], v[64:67], v[152:155]
  ds_read_b64_tr_b16 a[220:221], v21 offset:51200
  v_cvt_pk_bf16_f32 v208, v104, v105
  v_mfma_f32_16x16x32_bf16 v[148:151], a[176:179], v[48:51], v[228:231]
  v_exp_f32 v106, v106
  v_mfma_f32_16x16x32_bf16 v[148:151], a[180:183], v[52:55], v[148:151]
  ds_read_b64_tr_b16 a[222:223], v21 offset:52224
  v_mfma_f32_16x16x32_bf16 v[148:151], a[184:187], v[56:59], v[148:151]
  v_exp_f32 v107, v107
  v_mfma_f32_16x16x32_bf16 v[148:151], a[188:191], v[60:63], v[148:151]
  ds_read_b64_tr_b16 a[224:225], v22 offset:49152
  v_cvt_pk_bf16_f32 v209, v106, v107
  v_mfma_f32_16x16x32_bf16 v[144:147], a[188:191], v[44:47], v[224:227]
  v_exp_f32 v108, v108
  v_mfma_f32_16x16x32_bf16 v[144:147], a[184:187], v[40:43], v[144:147]
  ds_read_b64_tr_b16 a[226:227], v22 offset:50176
  v_mfma_f32_16x16x32_bf16 v[144:147], a[180:183], v[36:39], v[144:147]
  v_exp_f32 v109, v109
  v_mfma_f32_16x16x32_bf16 v[144:147], a[176:179], v[32:35], v[144:147]
  ds_read_b64_tr_b16 a[228:229], v22 offset:51200
  v_cvt_pk_bf16_f32 v216, v108, v109
  v_smfmac_f32_16x16x64_bf16 v[240:243], v[248:251], v[160:167], v11
  v_accvgpr_write_b32 a188, v246
  v_accvgpr_write_b32 a189, v246
  v_smfmac_f32_16x16x64_bf16 v[240:243], v[252:255], v[168:175], v11
  v_accvgpr_write_b32 a190, v246
  v_accvgpr_write_b32 a191, v246
  v_smfmac_f32_16x16x64_bf16 v[244:247], v[248:251], v[176:183], v11
  v_smfmac_f32_16x16x64_bf16 v[244:247], v[252:255], v[184:191], v11
  s_xor_b32 s91, s21, 0x1c11c00
  s_waitcnt lgkmcnt(3)
  v_mfma_f32_16x16x32_bf16 a[0:3], v[160:163], a[192:195], a[188:191]
  buffer_store_dwordx4 v[204:207], v1, s[60:63], s91 offen sc1
  v_exp_f32 v110, v110
  v_mfma_f32_16x16x32_bf16 a[0:3], v[164:167], a[196:199], a[0:3]
  ds_read_b64_tr_b16 a[230:231], v22 offset:52224
  v_mfma_f32_16x16x32_bf16 a[4:7], v[172:175], a[196:199], a[188:191]
  v_exp_f32 v111, v111
  v_mfma_f32_16x16x32_bf16 a[4:7], v[168:171], a[192:195], a[4:7]
  ds_read_b64_tr_b16 a[232:233], v23 offset:49152
  v_cvt_pk_bf16_f32 v217, v110, v111
  v_mfma_f32_16x16x32_bf16 a[8:11], v[176:179], a[192:195], a[188:191]
  v_exp_f32 v124, v124
  v_mfma_f32_16x16x32_bf16 a[8:11], v[180:183], a[196:199], a[8:11]
  ds_read_b64_tr_b16 a[234:235], v23 offset:50176
  v_mfma_f32_16x16x32_bf16 a[12:15], v[188:191], a[196:199], a[188:191]
  v_exp_f32 v125, v125
  v_mfma_f32_16x16x32_bf16 a[12:15], v[184:187], a[192:195], a[12:15]
  ds_read_b64_tr_b16 a[236:237], v23 offset:51200
  v_cvt_pk_bf16_f32 v218, v124, v125
  v_mfma_f32_16x16x32_bf16 a[28:31], v[184:187], a[200:203], a[188:191]
  v_exp_f32 v126, v126
  v_mfma_f32_16x16x32_bf16 a[28:31], v[188:191], a[204:207], a[28:31]
  ds_read_b64_tr_b16 a[238:239], v23 offset:52224
  v_mfma_f32_16x16x32_bf16 a[24:27], v[180:183], a[204:207], a[188:191]
  v_exp_f32 v127, v127
  v_mfma_f32_16x16x32_bf16 a[24:27], v[176:179], a[200:203], a[24:27]
  ds_read_b64_tr_b16 a[240:241], v24 offset:49152
  v_cvt_pk_bf16_f32 v219, v126, v127
  v_mfma_f32_16x16x32_bf16 a[20:23], v[168:171], a[200:203], a[188:191]
  v_exp_f32 v120, v120
  v_mfma_f32_16x16x32_bf16 a[20:23], v[172:175], a[204:207], a[20:23]
  ds_read_b64_tr_b16 a[242:243], v24 offset:50176
  v_mfma_f32_16x16x32_bf16 a[16:19], v[164:167], a[204:207], a[188:191]
  v_exp_f32 v121, v121
  v_mfma_f32_16x16x32_bf16 a[16:19], v[160:163], a[200:203], a[16:19]
  s_xor_b32 s90, s21, 0x1413400
  ds_read_b64_tr_b16 a[244:245], v24 offset:51200
  v_cvt_pk_bf16_f32 v210, v120, v121
  v_mfma_f32_16x16x32_bf16 a[32:35], v[160:163], a[208:211], a[188:191]
  buffer_store_dwordx4 v[212:215], v1, s[60:63], s90 offen sc1
  v_exp_f32 v122, v122
  v_mfma_f32_16x16x32_bf16 a[32:35], v[164:167], a[212:215], a[32:35]
  ds_read_b64_tr_b16 a[246:247], v24 offset:52224
  v_mfma_f32_16x16x32_bf16 a[36:39], v[172:175], a[212:215], a[188:191]
  v_exp_f32 v123, v123
  v_mfma_f32_16x16x32_bf16 a[36:39], v[168:171], a[208:211], a[36:39]
  ds_read_b64_tr_b16 a[248:249], v25 offset:49152
  v_cvt_pk_bf16_f32 v211, v122, v123
  v_mfma_f32_16x16x32_bf16 a[40:43], v[176:179], a[208:211], a[188:191]
  v_exp_f32 v116, v116
  v_mfma_f32_16x16x32_bf16 a[40:43], v[180:183], a[212:215], a[40:43]
  ds_read_b64_tr_b16 a[250:251], v25 offset:50176
  v_mfma_f32_16x16x32_bf16 a[44:47], v[188:191], a[212:215], a[188:191]
  v_exp_f32 v117, v117
  v_mfma_f32_16x16x32_bf16 a[44:47], v[184:187], a[208:211], a[44:47]
  ds_read_b64_tr_b16 a[252:253], v25 offset:51200
  v_cvt_pk_bf16_f32 v202, v116, v117
  v_mfma_f32_16x16x32_bf16 a[60:63], v[184:187], a[216:219], a[188:191]
  v_exp_f32 v118, v118
  v_mfma_f32_16x16x32_bf16 a[60:63], v[188:191], a[220:223], a[60:63]
  ds_read_b64_tr_b16 a[254:255], v25 offset:52224
  v_mfma_f32_16x16x32_bf16 a[56:59], v[180:183], a[220:223], a[188:191]
  v_exp_f32 v119, v119
  v_mfma_f32_16x16x32_bf16 a[56:59], v[176:179], a[216:219], a[56:59]
  v_cvt_pk_bf16_f32 v203, v118, v119
  v_mfma_f32_16x16x32_bf16 a[52:55], v[168:171], a[216:219], a[188:191]
  v_exp_f32 v112, v112
  v_mfma_f32_16x16x32_bf16 a[52:55], v[172:175], a[220:223], a[52:55]
  s_xor_b32 s17, s9, 0x10000
  v_mfma_f32_16x16x32_bf16 a[48:51], v[164:167], a[220:223], a[188:191]
  s_and_b32 s18, s31, 3
  v_exp_f32 v113, v113
  v_mfma_f32_16x16x32_bf16 a[48:51], v[160:163], a[216:219], a[48:51]
  s_add_u32 s18, s18, 5
  s_waitcnt lgkmcnt(3)
  v_cvt_pk_bf16_f32 v194, v112, v113
  v_mfma_f32_16x16x32_bf16 a[64:67], v[160:163], a[224:227], a[188:191]
  s_xor_b32 s91, s21, 0x1c13c00
  v_exp_f32 v114, v114
  v_mfma_f32_16x16x32_bf16 a[64:67], v[164:167], a[228:231], a[64:67]
  buffer_store_dwordx4 v[220:223], v1, s[60:63], s91 offen sc1
  v_mfma_f32_16x16x32_bf16 a[68:71], v[172:175], a[228:231], a[188:191]
  v_exp_f32 v115, v115
  v_mfma_f32_16x16x32_bf16 a[68:71], v[168:171], a[224:227], a[68:71]
  v_cvt_pk_bf16_f32 v195, v114, v115
  v_mfma_f32_16x16x32_bf16 a[72:75], v[176:179], a[224:227], a[188:191]
  v_exp_f32 v128, v128
  v_mfma_f32_16x16x32_bf16 a[72:75], v[180:183], a[228:231], a[72:75]
  s_waitcnt vmcnt(5) lgkmcnt(0)
  s_barrier
  v_mfma_f32_16x16x32_bf16 a[76:79], v[188:191], a[228:231], a[188:191]
  v_exp_f32 v129, v129
  v_mfma_f32_16x16x32_bf16 a[76:79], v[184:187], a[224:227], a[76:79]
  ds_read_b128 a[128:131], v14 offset:32768
  v_cvt_pk_bf16_f32 v196, v128, v129
  v_mfma_f32_16x16x32_bf16 a[92:95], v[184:187], a[232:235], a[188:191]
  v_exp_f32 v130, v130
  v_mfma_f32_16x16x32_bf16 a[92:95], v[188:191], a[236:239], a[92:95]
  ds_read_b128 a[132:135], v15 offset:32768
  v_mfma_f32_16x16x32_bf16 a[88:91], v[180:183], a[236:239], a[188:191]
  v_exp_f32 v131, v131
  v_mfma_f32_16x16x32_bf16 a[88:91], v[176:179], a[232:235], a[88:91]
  ds_read_b128 a[136:139], v16 offset:32768
  v_cvt_pk_bf16_f32 v197, v130, v131
  v_mfma_f32_16x16x32_bf16 a[84:87], v[168:171], a[232:235], a[188:191]
  v_exp_f32 v132, v132
  v_mfma_f32_16x16x32_bf16 a[84:87], v[172:175], a[236:239], a[84:87]
  ds_read_b128 a[140:143], v17 offset:32768
  v_mfma_f32_16x16x32_bf16 a[80:83], v[164:167], a[236:239], a[188:191]
  v_exp_f32 v133, v133
  v_mfma_f32_16x16x32_bf16 a[80:83], v[160:163], a[232:235], a[80:83]
  ds_read_b128 a[144:147], v14 offset:33792
  v_cvt_pk_bf16_f32 v204, v132, v133
  v_mfma_f32_16x16x32_bf16 a[96:99], v[160:163], a[240:243], a[188:191]
  v_exp_f32 v134, v134
  v_mfma_f32_16x16x32_bf16 a[96:99], v[164:167], a[244:247], a[96:99]
  ds_read_b128 a[148:151], v15 offset:33792
  v_mfma_f32_16x16x32_bf16 a[100:103], v[172:175], a[244:247], a[188:191]
  v_exp_f32 v135, v135
  v_mfma_f32_16x16x32_bf16 a[100:103], v[168:171], a[240:243], a[100:103]
  ds_read_b128 a[152:155], v16 offset:33792
  v_cvt_pk_bf16_f32 v205, v134, v135
  v_mfma_f32_16x16x32_bf16 a[104:107], v[176:179], a[240:243], a[188:191]
  s_add_u32 s83, s83, 0x4000
  v_exp_f32 v136, v136
  v_mfma_f32_16x16x32_bf16 a[104:107], v[180:183], a[244:247], a[104:107]
  s_and_b32 s83, s83, 0x7ffff
  ds_read_b128 a[156:159], v17 offset:33792
  v_mfma_f32_16x16x32_bf16 a[108:111], v[188:191], a[244:247], a[188:191]
  s_add_u32 m0, s85, 0
  v_exp_f32 v137, v137
  v_mfma_f32_16x16x32_bf16 a[108:111], v[184:187], a[240:243], a[108:111]
  buffer_load_dwordx4 v26, s[36:39], s83 offen lds
  v_mfma_f32_16x16x32_bf16 a[124:127], v[184:187], a[248:251], a[188:191]
  v_exp_f32 v138, v138
  v_mfma_f32_16x16x32_bf16 a[124:127], v[188:191], a[252:255], a[124:127]
  ds_read_b128 a[160:163], v14 offset:34816
  v_cvt_pk_bf16_f32 v212, v136, v137
  v_mfma_f32_16x16x32_bf16 a[120:123], v[180:183], a[252:255], a[188:191]
  v_exp_f32 v139, v139
  v_mfma_f32_16x16x32_bf16 a[120:123], v[176:179], a[248:251], a[120:123]
  ds_read_b128 a[164:167], v15 offset:34816
  v_cvt_pk_bf16_f32 v213, v138, v139
  v_mfma_f32_16x16x32_bf16 a[116:119], v[168:171], a[248:251], a[188:191]
  v_exp_f32 v140, v140
  v_mfma_f32_16x16x32_bf16 a[116:119], v[172:175], a[252:255], a[116:119]
  buffer_load_dwordx4 v26, s[36:39], s83 offen offset:1024 lds
  v_mfma_f32_16x16x32_bf16 a[112:115], v[164:167], a[252:255], a[188:191]
  v_exp_f32 v141, v141
  v_mfma_f32_16x16x32_bf16 a[112:115], v[160:163], a[248:251], a[112:115]
.p2align 5
L_loop:
  s_waitcnt lgkmcnt(3)
  v_mfma_f32_16x16x32_bf16 v[96:99], a[128:131], v[32:35], v[224:227]
  ds_read_b128 a[168:171], v16 offset:34816
  v_cvt_pk_bf16_f32 v220, v140, v141
  v_mfma_f32_16x16x32_bf16 v[96:99], a[132:135], v[36:39], v[96:99]
  v_exp_f32 v142, v142
  v_mfma_f32_16x16x32_bf16 v[96:99], a[136:139], v[40:43], v[96:99]
  ds_read_b128 a[172:175], v17 offset:34816
  v_mfma_f32_16x16x32_bf16 v[96:99], a[140:143], v[44:47], v[96:99]
  v_exp_f32 v143, v143
  v_mfma_f32_16x16x32_bf16 v[100:103], a[140:143], v[60:63], v[228:231]
  buffer_load_dwordx4 v26, s[36:39], s83 offen offset:2048 lds
  v_mfma_f32_16x16x32_bf16 v[100:103], a[136:139], v[56:59], v[100:103]
  v_exp_f32 v156, v156
  v_mfma_f32_16x16x32_bf16 v[100:103], a[132:135], v[52:55], v[100:103]
  ds_read_b128 a[176:179], v14 offset:35840
  v_cvt_pk_bf16_f32 v221, v142, v143
  v_mfma_f32_16x16x32_bf16 v[100:103], a[128:131], v[48:51], v[100:103]
  v_exp_f32 v157, v157
  v_mfma_f32_16x16x32_bf16 v[104:107], a[128:131], v[64:67], v[232:235]
  ds_read_b128 a[180:183], v15 offset:35840
  v_cvt_pk_bf16_f32 v222, v156, v157
  v_mfma_f32_16x16x32_bf16 v[104:107], a[132:135], v[68:71], v[104:107]
  v_exp_f32 v158, v158
  v_mfma_f32_16x16x32_bf16 v[104:107], a[136:139], v[72:75], v[104:107]
  buffer_load_dwordx4 v26, s[36:39], s83 offen offset:3072 lds
  v_mfma_f32_16x16x32_bf16 v[104:107], a[140:143], v[76:79], v[104:107]
  v_exp_f32 v159, v159
  v_mfma_f32_16x16x32_bf16 v[108:111], a[140:143], v[92:95], v[236:239]
  ds_read_b128 a[184:187], v16 offset:35840
  v_cvt_pk_bf16_f32 v223, v158, v159
  v_mfma_f32_16x16x32_bf16 v[108:111], a[136:139], v[88:91], v[108:111]
  s_add_u32 s84, s84, 0x4000
  v_exp_f32 v152, v152
  v_mfma_f32_16x16x32_bf16 v[108:111], a[132:135], v[84:87], v[108:111]
  s_and_b32 s84, s84, 0x7ffff
  ds_read_b128 a[188:191], v17 offset:35840
  v_mfma_f32_16x16x32_bf16 v[108:111], a[128:131], v[80:83], v[108:111]
  s_add_u32 m0, s85, 0xc000
  v_exp_f32 v153, v153
  v_mfma_f32_16x16x32_bf16 v[124:127], a[144:147], v[80:83], v[236:239]
  buffer_load_dwordx4 v27, s[40:43], s84 offen lds
  v_mfma_f32_16x16x32_bf16 v[124:127], a[148:151], v[84:87], v[124:127]
  v_exp_f32 v154, v154
  v_mfma_f32_16x16x32_bf16 v[124:127], a[152:155], v[88:91], v[124:127]
  s_waitcnt lgkmcnt(2)
  ds_read_b64_tr_b16 a[192:193], v18 offset:16384
  v_cvt_pk_bf16_f32 v214, v152, v153
  v_mfma_f32_16x16x32_bf16 v[124:127], a[156:159], v[92:95], v[124:127]
  v_exp_f32 v155, v155
  v_mfma_f32_16x16x32_bf16 v[120:123], a[156:159], v[76:79], v[232:235]
  ds_read_b64_tr_b16 a[194:195], v18 offset:17408
  v_cvt_pk_bf16_f32 v215, v154, v155
  v_mfma_f32_16x16x32_bf16 v[120:123], a[152:155], v[72:75], v[120:123]
  v_exp_f32 v148, v148
  v_mfma_f32_16x16x32_bf16 v[120:123], a[148:151], v[68:71], v[120:123]
  buffer_load_dwordx4 v27, s[40:43], s84 offen offset:1024 lds
  v_mfma_f32_16x16x32_bf16 v[120:123], a[144:147], v[64:67], v[120:123]
  v_exp_f32 v149, v149
  v_mfma_f32_16x16x32_bf16 v[116:119], a[144:147], v[48:51], v[228:231]
  s_and_b32 s68, s4, 1
  ds_read_b64_tr_b16 a[196:197], v18 offset:18432
  v_cvt_pk_bf16_f32 v206, v148, v149
  v_mfma_f32_16x16x32_bf16 v[116:119], a[148:151], v[52:55], v[116:119]
  s_lshl_b32 s68, s68, 7
  v_exp_f32 v150, v150
  v_mfma_f32_16x16x32_bf16 v[116:119], a[152:155], v[56:59], v[116:119]
  s_lshr_b32 s69, s4, 1
  ds_read_b64_tr_b16 a[198:199], v18 offset:19456
  v_mfma_f32_16x16x32_bf16 v[116:119], a[156:159], v[60:63], v[116:119]
  s_lshl_b32 s69, s69, 13
  v_exp_f32 v151, v151
  v_mfma_f32_16x16x32_bf16 v[112:115], a[156:159], v[44:47], v[224:227]
  buffer_load_dwordx4 v27, s[40:43], s84 offen offset:2048 lds
  v_mfma_f32_16x16x32_bf16 v[112:115], a[152:155], v[40:43], v[112:115]
  s_add_u32 s68, s68, s69
  v_exp_f32 v144, v144
  v_mfma_f32_16x16x32_bf16 v[112:115], a[148:151], v[36:39], v[112:115]
  s_add_u32 s68, s68, s5
  ds_read_b64_tr_b16 a[200:201], v19 offset:16384
  v_cvt_pk_bf16_f32 v207, v150, v151
  v_mfma_f32_16x16x32_bf16 v[112:115], a[144:147], v[32:35], v[112:115]
  s_sub_u32 s69, s4, 4
  v_exp_f32 v145, v145
  v_mfma_f32_16x16x32_bf16 v[128:131], a[160:163], v[32:35], v[224:227]
  s_max_i32 s69, s69, 0
  ds_read_b64_tr_b16 a[202:203], v19 offset:17408
  v_cvt_pk_bf16_f32 v198, v144, v145
  v_mfma_f32_16x16x32_bf16 v[128:131], a[164:167], v[36:39], v[128:131]
  s_lshl_b32 s70, s69, 13
  v_exp_f32 v146, v146
  v_mfma_f32_16x16x32_bf16 v[128:131], a[168:171], v[40:43], v[128:131]
  buffer_load_dwordx4 v27, s[40:43], s84 offen offset:3072 lds
  v_mfma_f32_16x16x32_bf16 v[128:131], a[172:175], v[44:47], v[128:131]
  s_cmp_lt_u32 s4, 4
  v_exp_f32 v147, v147
  v_mfma_f32_16x16x32_bf16 v[132:135], a[172:175], v[60:63], v[228:231]
  s_cselect_b32 s68, s68, s70
  ds_read_b64_tr_b16 a[204:205], v19 offset:18432
  v_cvt_pk_bf16_f32 v199, v146, v147
  v_mfma_f32_16x16x32_bf16 v[132:135], a[168:171], v[56:59], v[132:135]
  s_xor_b32 s6, s68, s89
  v_exp_f32 v96, v96
  v_mfma_f32_16x16x32_bf16 v[132:135], a[164:167], v[52:55], v[132:135]
  s_lshl_b32 s69, s69, 10
  v_exp_f32 v97, v97
  v_mfma_f32_16x16x32_bf16 v[132:135], a[160:163], v[48:51], v[132:135]
  s_add_u32 s4, s4, 1
  ds_read_b64_tr_b16 a[206:207], v19 offset:19456
  v_cvt_pk_bf16_f32 v160, v96, v97
  v_mfma_f32_16x16x32_bf16 v[136:139], a[160:163], v[64:67], v[232:235]
  s_add_u32 m0, s72, s69
  v_exp_f32 v98, v98
  v_mfma_f32_16x16x32_bf16 v[136:139], a[164:167], v[68:71], v[136:139]
  buffer_load_dwordx4 v28, s[56:59], s6 offen lds
  v_mfma_f32_16x16x32_bf16 v[136:139], a[168:171], v[72:75], v[136:139]
  v_exp_f32 v99, v99
  v_mfma_f32_16x16x32_bf16 v[136:139], a[172:175], v[76:79], v[136:139]
  ds_read_b64_tr_b16 a[208:209], v20 offset:16384
  v_cvt_pk_bf16_f32 v161, v98, v99
  v_mfma_f32_16x16x32_bf16 v[140:143], a[172:175], v[92:95], v[236:239]
  v_exp_f32 v100, v100
  v_mfma_f32_16x16x32_bf16 v[140:143], a[168:171], v[88:91], v[140:143]
  ds_read_b64_tr_b16 a[210:211], v20 offset:17408
  v_mfma_f32_16x16x32_bf16 v[140:143], a[164:167], v[84:87], v[140:143]
  v_exp_f32 v101, v101
  v_mfma_f32_16x16x32_bf16 v[140:143], a[160:163], v[80:83], v[140:143]
  ds_read_b64_tr_b16 a[212:213], v20 offset:18432
  v_cvt_pk_bf16_f32 v168, v100, v101
  v_mfma_f32_16x16x32_bf16 v[156:159], a[176:179], v[80:83], v[236:239]
  v_exp_f32 v102, v102
  v_mfma_f32_16x16x32_bf16 v[156:159], a[180:183], v[84:87], v[156:159]
  s_waitcnt lgkmcnt(4)
  ds_read_b64_tr_b16 a[214:215], v20 offset:19456
  v_mfma_f32_16x16x32_bf16 v[156:159], a[184:187], v[88:91], v[156:159]
  v_exp_f32 v103, v103
  v_mfma_f32_16x16x32_bf16 v[156:159], a[188:191], v[92:95], v[156:159]
  ds_read_b64_tr_b16 a[216:217], v21 offset:16384
  v_cvt_pk_bf16_f32 v169, v102, v103
  v_mfma_f32_16x16x32_bf16 v[152:155], a[188:191], v[76:79], v[232:235]
  v_exp_f32 v104, v104
  v_mfma_f32_16x16x32_bf16 v[152:155], a[184:187], v[72:75], v[152:155]
  ds_read_b64_tr_b16 a[218:219], v21 offset:17408
  v_mfma_f32_16x16x32_bf16 v[152:155], a[180:183], v[68:71], v[152:155]
  v_exp_f32 v105, v105
  v_mfma_f32_16x16x32_bf16 v[152:155], a[176:179], v[64:67], v[152:155]
  ds_read_b64_tr_b16 a[220:221], v21 offset:18432
  v_cvt_pk_bf16_f32 v176, v104, v105
  v_mfma_f32_16x16x32_bf16 v[148:151], a[176:179], v[48:51], v[228:231]
  v_exp_f32 v106, v106
  v_mfma_f32_16x16x32_bf16 v[148:151], a[180:183], v[52:55], v[148:151]
  ds_read_b64_tr_b16 a[222:223], v21 offset:19456
  v_mfma_f32_16x16x32_bf16 v[148:151], a[184:187], v[56:59], v[148:151]
  v_exp_f32 v107, v107
  v_mfma_f32_16x16x32_bf16 v[148:151], a[188:191], v[60:63], v[148:151]
  s_sub_u32 s68, s86, s18
  ds_read_b64_tr_b16 a[224:225], v22 offset:16384
  v_cvt_pk_bf16_f32 v177, v106, v107
  v_mfma_f32_16x16x32_bf16 v[144:147], a[188:191], v[44:47], v[224:227]
  s_lshl_b32 s69, s68, 11
  v_exp_f32 v108, v108
  v_mfma_f32_16x16x32_bf16 v[144:147], a[184:187], v[40:43], v[144:147]
  s_add_u32 s20, s69, s17
  ds_read_b64_tr_b16 a[226:227], v22 offset:17408
  v_mfma_f32_16x16x32_bf16 v[144:147], a[180:183], v[36:39], v[144:147]
  s_andn2_b32 s68, s68, 4
  v_exp_f32 v109, v109
  v_mfma_f32_16x16x32_bf16 v[144:147], a[176:179], v[32:35], v[144:147]
  s_cselect_b32 s69, 0x1000, s11
  ds_read_b64_tr_b16 a[228:229], v22 offset:18432
  v_cvt_pk_bf16_f32 v184, v108, v109
  v_smfmac_f32_16x16x64_bf16 v[240:243], v[248:251], v[192:199], v11
  buffer_load_dword v10, v7, s[48:51], s69 offen sc1
  v_smfmac_f32_16x16x64_bf16 v[240:243], v[252:255], v[200:207], v11
  v_smfmac_f32_16x16x64_bf16 v[244:247], v[248:251], v[208:215], v11
  v_smfmac_f32_16x16x64_bf16 v[244:247], v[252:255], v[216:223], v11
  v_mfma_f32_16x16x32_bf16 a[0:3], v[192:195], a[192:195], a[0:3]
  v_exp_f32 v110, v110
  v_mfma_f32_16x16x32_bf16 a[0:3], v[196:199], a[196:199], a[0:3]
  ds_read_b64_tr_b16 a[230:231], v22 offset:19456
  v_mfma_f32_16x16x32_bf16 a[4:7], v[204:207], a[196:199], a[4:7]
  v_exp_f32 v111, v111
  v_mfma_f32_16x16x32_bf16 a[4:7], v[200:203], a[192:195], a[4:7]
  ds_read_b64_tr_b16 a[232:233], v23 offset:16384
  v_cvt_pk_bf16_f32 v185, v110, v111
  v_mfma_f32_16x16x32_bf16 a[8:11], v[208:211], a[192:195], a[8:11]
  v_exp_f32 v124, v124
  v_mfma_f32_16x16x32_bf16 a[8:11], v[212:215], a[196:199], a[8:11]
  ds_read_b64_tr_b16 a[234:235], v23 offset:17408
  v_mfma_f32_16x16x32_bf16 a[12:15], v[220:223], a[196:199], a[12:15]
  v_exp_f32 v125, v125
  v_mfma_f32_16x16x32_bf16 a[12:15], v[216:219], a[192:195], a[12:15]
  ds_read_b64_tr_b16 a[236:237], v23 offset:18432
  v_cvt_pk_bf16_f32 v186, v124, v125
  v_mfma_f32_16x16x32_bf16 a[28:31], v[216:219], a[200:203], a[28:31]
  s_waitcnt lgkmcnt(4)
  v_exp_f32 v126, v126
  v_mfma_f32_16x16x32_bf16 a[28:31], v[220:223], a[204:207], a[28:31]
  ds_read_b64_tr_b16 a[238:239], v23 offset:19456
  v_mfma_f32_16x16x32_bf16 a[24:27], v[212:215], a[204:207], a[24:27]
  v_exp_f32 v127, v127
  v_mfma_f32_16x16x32_bf16 a[24:27], v[208:211], a[200:203], a[24:27]
  ds_read_b64_tr_b16 a[240:241], v24 offset:16384
  v_cvt_pk_bf16_f32 v187, v126, v127
  v_mfma_f32_16x16x32_bf16 a[20:23], v[200:203], a[200:203], a[20:23]
  v_exp_f32 v120, v120
  v_mfma_f32_16x16x32_bf16 a[20:23], v[204:207], a[204:207], a[20:23]
  ds_read_b64_tr_b16 a[242:243], v24 offset:17408
  v_mfma_f32_16x16x32_bf16 a[16:19], v[196:199], a[204:207], a[16:19]
  v_exp_f32 v121, v121
  v_mfma_f32_16x16x32_bf16 a[16:19], v[192:195], a[200:203], a[16:19]
  ds_read_b64_tr_b16 a[244:245], v24 offset:18432
  v_cvt_pk_bf16_f32 v178, v120, v121
  v_mfma_f32_16x16x32_bf16 a[32:35], v[192:195], a[208:211], a[32:35]
  v_exp_f32 v122, v122
  v_mfma_f32_16x16x32_bf16 a[32:35], v[196:199], a[212:215], a[32:35]
  ds_read_b64_tr_b16 a[246:247], v24 offset:19456
  v_mfma_f32_16x16x32_bf16 a[36:39], v[204:207], a[212:215], a[36:39]
  v_exp_f32 v123, v123
  v_mfma_f32_16x16x32_bf16 a[36:39], v[200:203], a[208:211], a[36:39]
  ds_read_b64_tr_b16 a[248:249], v25 offset:16384
  v_cvt_pk_bf16_f32 v179, v122, v123
  v_mfma_f32_16x16x32_bf16 a[40:43], v[208:211], a[208:211], a[40:43]
  v_exp_f32 v116, v116
  v_mfma_f32_16x16x32_bf16 a[40:43], v[212:215], a[212:215], a[40:43]
  ds_read_b64_tr_b16 a[250:251], v25 offset:17408
  v_mfma_f32_16x16x32_bf16 a[44:47], v[220:223], a[212:215], a[44:47]
  v_exp_f32 v117, v117
  v_mfma_f32_16x16x32_bf16 a[44:47], v[216:219], a[208:211], a[44:47]
  ds_read_b64_tr_b16 a[252:253], v25 offset:18432
  v_cvt_pk_bf16_f32 v170, v116, v117
  v_mfma_f32_16x16x32_bf16 a[60:63], v[216:219], a[216:219], a[60:63]
  v_exp_f32 v118, v118
  v_mfma_f32_16x16x32_bf16 a[60:63], v[220:223], a[220:223], a[60:63]
  ds_read_b64_tr_b16 a[254:255], v25 offset:19456
  v_mfma_f32_16x16x32_bf16 a[56:59], v[212:215], a[220:223], a[56:59]
  v_exp_f32 v119, v119
  v_mfma_f32_16x16x32_bf16 a[56:59], v[208:211], a[216:219], a[56:59]
  v_cvt_pk_bf16_f32 v171, v118, v119
  v_mfma_f32_16x16x32_bf16 a[52:55], v[200:203], a[216:219], a[52:55]
  v_exp_f32 v112, v112
  v_mfma_f32_16x16x32_bf16 a[52:55], v[204:207], a[220:223], a[52:55]
  v_mfma_f32_16x16x32_bf16 a[48:51], v[196:199], a[220:223], a[48:51]
  v_exp_f32 v113, v113
  v_mfma_f32_16x16x32_bf16 a[48:51], v[192:195], a[216:219], a[48:51]
  v_cvt_pk_bf16_f32 v162, v112, v113
  v_mfma_f32_16x16x32_bf16 a[64:67], v[192:195], a[224:227], a[64:67]
  s_waitcnt lgkmcnt(3)
  v_exp_f32 v114, v114
  v_mfma_f32_16x16x32_bf16 a[64:67], v[196:199], a[228:231], a[64:67]
  v_mfma_f32_16x16x32_bf16 a[68:71], v[204:207], a[228:231], a[68:71]
  v_exp_f32 v115, v115
  v_mfma_f32_16x16x32_bf16 a[68:71], v[200:203], a[224:227], a[68:71]
  v_cvt_pk_bf16_f32 v163, v114, v115
  v_mfma_f32_16x16x32_bf16 a[72:75], v[208:211], a[224:227], a[72:75]
  v_exp_f32 v128, v128
  v_mfma_f32_16x16x32_bf16 a[72:75], v[212:215], a[228:231], a[72:75]
  s_waitcnt vmcnt(2) lgkmcnt(0)
  s_barrier
  v_mfma_f32_16x16x32_bf16 a[76:79], v[220:223], a[228:231], a[76:79]
  v_exp_f32 v129, v129
  v_mfma_f32_16x16x32_bf16 a[76:79], v[216:219], a[224:227], a[76:79]
  ds_read_b128 a[128:131], v14
  v_cvt_pk_bf16_f32 v164, v128, v129
  v_mfma_f32_16x16x32_bf16 a[92:95], v[216:219], a[232:235], a[92:95]
  v_exp_f32 v130, v130
  v_mfma_f32_16x16x32_bf16 a[92:95], v[220:223], a[236:239], a[92:95]
  ds_read_b128 a[132:135], v15
  v_mfma_f32_16x16x32_bf16 a[88:91], v[212:215], a[236:239], a[88:91]
  v_exp_f32 v131, v131
  v_mfma_f32_16x16x32_bf16 a[88:91], v[208:211], a[232:235], a[88:91]
  ds_read_b128 a[136:139], v16
  v_cvt_pk_bf16_f32 v165, v130, v131
  v_mfma_f32_16x16x32_bf16 a[84:87], v[200:203], a[232:235], a[84:87]
  v_exp_f32 v132, v132
  v_mfma_f32_16x16x32_bf16 a[84:87], v[204:207], a[236:239], a[84:87]
  ds_read_b128 a[140:143], v17
  v_mfma_f32_16x16x32_bf16 a[80:83], v[196:199], a[236:239], a[80:83]
  v_exp_f32 v133, v133
  v_mfma_f32_16x16x32_bf16 a[80:83], v[192:195], a[232:235], a[80:83]
  ds_read_b128 a[144:147], v14 offset:1024
  v_cvt_pk_bf16_f32 v172, v132, v133
  v_mfma_f32_16x16x32_bf16 a[96:99], v[192:195], a[240:243], a[96:99]
  v_exp_f32 v134, v134
  v_mfma_f32_16x16x32_bf16 a[96:99], v[196:199], a[244:247], a[96:99]
  ds_read_b128 a[148:151], v15 offset:1024
  v_mfma_f32_16x16x32_bf16 a[100:103], v[204:207], a[244:247], a[100:103]
  v_exp_f32 v135, v135
  v_mfma_f32_16x16x32_bf16 a[100:103], v[200:203], a[240:243], a[100:103]
  ds_read_b128 a[152:155], v16 offset:1024
  v_cvt_pk_bf16_f32 v173, v134, v135
  v_mfma_f32_16x16x32_bf16 a[104:107], v[208:211], a[240:243], a[104:107]
  s_add_u32 s83, s83, 0x4000
  v_exp_f32 v136, v136
  v_mfma_f32_16x16x32_bf16 a[104:107], v[212:215], a[244:247], a[104:107]
  s_and_b32 s83, s83, 0x7ffff
  ds_read_b128 a[156:159], v17 offset:1024
  v_mfma_f32_16x16x32_bf16 a[108:111], v[220:223], a[244:247], a[108:111]
  s_add_u32 m0, s85, 0x8000
  v_exp_f32 v137, v137
  v_mfma_f32_16x16x32_bf16 a[108:111], v[216:219], a[240:243], a[108:111]
  buffer_load_dwordx4 v26, s[36:39], s83 offen lds
  v_mfma_f32_16x16x32_bf16 a[124:127], v[216:219], a[248:251], a[124:127]
  v_exp_f32 v138, v138
  v_mfma_f32_16x16x32_bf16 a[124:127], v[220:223], a[252:255], a[124:127]
  ds_read_b128 a[160:163], v14 offset:2048
  v_cvt_pk_bf16_f32 v180, v136, v137
  v_mfma_f32_16x16x32_bf16 a[120:123], v[212:215], a[252:255], a[120:123]
  v_exp_f32 v139, v139
  v_mfma_f32_16x16x32_bf16 a[120:123], v[208:211], a[248:251], a[120:123]
  ds_read_b128 a[164:167], v15 offset:2048
  v_cvt_pk_bf16_f32 v181, v138, v139
  v_mfma_f32_16x16x32_bf16 a[116:119], v[200:203], a[248:251], a[116:119]
L_p4003:
  s_cmp_eq_u32 s95, 1
  s_cbranch_scc1 L_p6137
  v_exp_f32 v140, v140
  v_mfma_f32_16x16x32_bf16 a[116:119], v[204:207], a[252:255], a[116:119]
  buffer_load_dwordx4 v26, s[36:39], s83 offen offset:1024 lds
  v_mfma_f32_16x16x32_bf16 a[112:115], v[196:199], a[252:255], a[112:115]
  s_waitcnt lgkmcnt(3)
  v_exp_f32 v141, v141
  v_mfma_f32_16x16x32_bf16 a[112:115], v[192:195], a[248:251], a[112:115]
  buffer_atomic_add v8, v9, s[48:51], s11 offen sc1
  v_mfma_f32_16x16x32_bf16 v[96:99], a[128:131], v[32:35], v[224:227]
  ds_read_b128 a[168:171], v16 offset:2048
  v_cvt_pk_bf16_f32 v188, v140, v141
  v_mfma_f32_16x16x32_bf16 v[96:99], a[132:135], v[36:39], v[96:99]
  v_exp_f32 v142, v142
  v_mfma_f32_16x16x32_bf16 v[96:99], a[136:139], v[40:43], v[96:99]
  ds_read_b128 a[172:175], v17 offset:2048
  v_mov_b32 v9, 0x1000
  v_mfma_f32_16x16x32_bf16 v[96:99], a[140:143], v[44:47], v[96:99]
  v_exp_f32 v143, v143
  v_mfma_f32_16x16x32_bf16 v[100:103], a[140:143], v[60:63], v[228:231]
  buffer_load_dwordx4 v26, s[36:39], s83 offen offset:2048 lds
  v_mfma_f32_16x16x32_bf16 v[100:103], a[136:139], v[56:59], v[100:103]
  v_exp_f32 v156, v156
  v_mfma_f32_16x16x32_bf16 v[100:103], a[132:135], v[52:55], v[100:103]
  ds_read_b128 a[176:179], v14 offset:3072
  v_cvt_pk_bf16_f32 v189, v142, v143
  v_mfma_f32_16x16x32_bf16 v[100:103], a[128:131], v[48:51], v[100:103]
  v_exp_f32 v157, v157
  v_mfma_f32_16x16x32_bf16 v[104:107], a[128:131], v[64:67], v[232:235]
  ds_read_b128 a[180:183], v15 offset:3072
  v_cvt_pk_bf16_f32 v190, v156, v157
  v_mfma_f32_16x16x32_bf16 v[104:107], a[132:135], v[68:71], v[104:107]
  v_exp_f32 v158, v158
  v_mfma_f32_16x16x32_bf16 v[104:107], a[136:139], v[72:75], v[104:107]
  buffer_load_dwordx4 v26, s[36:39], s83 offen offset:3072 lds
  v_mfma_f32_16x16x32_bf16 v[104:107], a[140:143], v[76:79], v[104:107]
  v_exp_f32 v159, v159
  v_mfma_f32_16x16x32_bf16 v[108:111], a[140:143], v[92:95], v[236:239]
  ds_read_b128 a[184:187], v16 offset:3072
  v_cvt_pk_bf16_f32 v191, v158, v159
  v_mfma_f32_16x16x32_bf16 v[108:111], a[136:139], v[88:91], v[108:111]
  s_add_u32 s84, s84, 0x4000
  v_exp_f32 v152, v152
  v_mfma_f32_16x16x32_bf16 v[108:111], a[132:135], v[84:87], v[108:111]
  s_and_b32 s84, s84, 0x7ffff
  ds_read_b128 a[188:191], v17 offset:3072
  v_mfma_f32_16x16x32_bf16 v[108:111], a[128:131], v[80:83], v[108:111]
  s_add_u32 m0, s85, 0x4000
  v_exp_f32 v153, v153
  v_mfma_f32_16x16x32_bf16 v[124:127], a[144:147], v[80:83], v[236:239]
  buffer_load_dwordx4 v27, s[40:43], s84 offen lds
  v_mfma_f32_16x16x32_bf16 v[124:127], a[148:151], v[84:87], v[124:127]
  v_exp_f32 v154, v154
  v_mfma_f32_16x16x32_bf16 v[124:127], a[152:155], v[88:91], v[124:127]
  s_waitcnt lgkmcnt(2)
  ds_read_b64_tr_b16 a[192:193], v18 offset:49152
  v_cvt_pk_bf16_f32 v182, v152, v153
  v_mfma_f32_16x16x32_bf16 v[124:127], a[156:159], v[92:95], v[124:127]
  v_exp_f32 v155, v155
  v_mfma_f32_16x16x32_bf16 v[120:123], a[156:159], v[76:79], v[232:235]
  ds_read_b64_tr_b16 a[194:195], v18 offset:50176
  v_cvt_pk_bf16_f32 v183, v154, v155
  v_mfma_f32_16x16x32_bf16 v[120:123], a[152:155], v[72:75], v[120:123]
  v_exp_f32 v148, v148
  v_mfma_f32_16x16x32_bf16 v[120:123], a[148:151], v[68:71], v[120:123]
  buffer_load_dwordx4 v27, s[40:43], s84 offen offset:1024 lds
  v_mfma_f32_16x16x32_bf16 v[120:123], a[144:147], v[64:67], v[120:123]
  v_exp_f32 v149, v149
  v_mfma_f32_16x16x32_bf16 v[116:119], a[144:147], v[48:51], v[228:231]
  s_and_b32 s68, s4, 1
  ds_read_b64_tr_b16 a[196:197], v18 offset:51200
  v_cvt_pk_bf16_f32 v174, v148, v149
  v_mfma_f32_16x16x32_bf16 v[116:119], a[148:151], v[52:55], v[116:119]
  s_lshl_b32 s68, s68, 7
  v_exp_f32 v150, v150
  v_mfma_f32_16x16x32_bf16 v[116:119], a[152:155], v[56:59], v[116:119]
  s_lshr_b32 s69, s4, 1
  ds_read_b64_tr_b16 a[198:199], v18 offset:52224
  v_mfma_f32_16x16x32_bf16 v[116:119], a[156:159], v[60:63], v[116:119]
  s_lshl_b32 s69, s69, 13
  v_exp_f32 v151, v151
  v_mfma_f32_16x16x32_bf16 v[112:115], a[156:159], v[44:47], v[224:227]
  buffer_load_dwordx4 v27, s[40:43], s84 offen offset:2048 lds
  v_mfma_f32_16x16x32_bf16 v[112:115], a[152:155], v[40:43], v[112:115]
  s_add_u32 s68, s68, s69
  v_exp_f32 v144, v144
  v_mfma_f32_16x16x32_bf16 v[112:115], a[148:151], v[36:39], v[112:115]
  s_add_u32 s68, s68, s5
  ds_read_b64_tr_b16 a[200:201], v19 offset:49152
  v_cvt_pk_bf16_f32 v175, v150, v151
  v_mfma_f32_16x16x32_bf16 v[112:115], a[144:147], v[32:35], v[112:115]
  s_sub_u32 s69, s4, 4
  v_exp_f32 v145, v145
  v_mfma_f32_16x16x32_bf16 v[128:131], a[160:163], v[32:35], v[224:227]
  s_max_i32 s69, s69, 0
  ds_read_b64_tr_b16 a[202:203], v19 offset:50176
  v_cvt_pk_bf16_f32 v166, v144, v145
  v_mfma_f32_16x16x32_bf16 v[128:131], a[164:167], v[36:39], v[128:131]
  s_lshl_b32 s70, s69, 13
  v_exp_f32 v146, v146
  v_mfma_f32_16x16x32_bf16 v[128:131], a[168:171], v[40:43], v[128:131]
  buffer_load_dwordx4 v27, s[40:43], s84 offen offset:3072 lds
  v_mfma_f32_16x16x32_bf16 v[128:131], a[172:175], v[44:47], v[128:131]
  s_cmp_lt_u32 s4, 4
  v_exp_f32 v147, v147
  v_mfma_f32_16x16x32_bf16 v[132:135], a[172:175], v[60:63], v[228:231]
  s_cselect_b32 s68, s68, s70
  ds_read_b64_tr_b16 a[204:205], v19 offset:51200
  v_cvt_pk_bf16_f32 v167, v146, v147
  v_mfma_f32_16x16x32_bf16 v[132:135], a[168:171], v[56:59], v[132:135]
  s_xor_b32 s6, s68, s89
  v_exp_f32 v96, v96
  v_mfma_f32_16x16x32_bf16 v[132:135], a[164:167], v[52:55], v[132:135]
  s_lshl_b32 s69, s69, 10
  v_exp_f32 v97, v97
  v_mfma_f32_16x16x32_bf16 v[132:135], a[160:163], v[48:51], v[132:135]
  s_add_u32 s4, s4, 1
  ds_read_b64_tr_b16 a[206:207], v19 offset:52224
  v_cvt_pk_bf16_f32 v192, v96, v97
  v_mfma_f32_16x16x32_bf16 v[136:139], a[160:163], v[64:67], v[232:235]
  s_add_u32 m0, s72, s69
  v_exp_f32 v98, v98
  v_mfma_f32_16x16x32_bf16 v[136:139], a[164:167], v[68:71], v[136:139]
  buffer_load_dwordx4 v28, s[56:59], s6 offen lds
  v_mfma_f32_16x16x32_bf16 v[136:139], a[168:171], v[72:75], v[136:139]
  v_exp_f32 v99, v99
  v_mfma_f32_16x16x32_bf16 v[136:139], a[172:175], v[76:79], v[136:139]
  ds_read_b64_tr_b16 a[208:209], v20 offset:49152
  v_cvt_pk_bf16_f32 v193, v98, v99
  v_mfma_f32_16x16x32_bf16 v[140:143], a[172:175], v[92:95], v[236:239]
  v_exp_f32 v100, v100
  v_mfma_f32_16x16x32_bf16 v[140:143], a[168:171], v[88:91], v[140:143]
  s_waitcnt vmcnt(10)
  ds_read_b64_tr_b16 a[210:211], v20 offset:50176
  v_readfirstlane_b32 s19, v10
  v_mfma_f32_16x16x32_bf16 v[140:143], a[164:167], v[84:87], v[140:143]
  v_exp_f32 v101, v101
  v_mfma_f32_16x16x32_bf16 v[140:143], a[160:163], v[80:83], v[140:143]
  ds_read_b64_tr_b16 a[212:213], v20 offset:51200
  v_cvt_pk_bf16_f32 v200, v100, v101
  v_mfma_f32_16x16x32_bf16 v[156:159], a[176:179], v[80:83], v[236:239]
  v_exp_f32 v102, v102
  v_mfma_f32_16x16x32_bf16 v[156:159], a[180:183], v[84:87], v[156:159]
  s_waitcnt lgkmcnt(3)
  ds_read_b64_tr_b16 a[214:215], v20 offset:52224
  v_mfma_f32_16x16x32_bf16 v[156:159], a[184:187], v[88:91], v[156:159]
  v_exp_f32 v103, v103
  v_mfma_f32_16x16x32_bf16 v[156:159], a[188:191], v[92:95], v[156:159]
  ds_read_b64_tr_b16 a[216:217], v21 offset:49152
  v_cvt_pk_bf16_f32 v201, v102, v103
  v_mfma_f32_16x16x32_bf16 v[152:155], a[188:191], v[76:79], v[232:235]
  v_exp_f32 v104, v104
  v_mfma_f32_16x16x32_bf16 v[152:155], a[184:187], v[72:75], v[152:155]
  ds_read_b64_tr_b16 a[218:219], v21 offset:50176
  v_mfma_f32_16x16x32_bf16 v[152:155], a[180:183], v[68:71], v[152:155]
  v_exp_f32 v105, v105
  v_mfma_f32_16x16x32_bf16 v[152:155], a[176:179], v[64:67], v[152:155]
  ds_read_b64_tr_b16 a[220:221], v21 offset:51200
  v_cvt_pk_bf16_f32 v208, v104, v105
  v_mfma_f32_16x16x32_bf16 v[148:151], a[176:179], v[48:51], v[228:231]
  v_exp_f32 v106, v106
  v_mfma_f32_16x16x32_bf16 v[148:151], a[180:183], v[52:55], v[148:151]
  ds_read_b64_tr_b16 a[222:223], v21 offset:52224
  v_mfma_f32_16x16x32_bf16 v[148:151], a[184:187], v[56:59], v[148:151]
  v_exp_f32 v107, v107
  v_mfma_f32_16x16x32_bf16 v[148:151], a[188:191], v[60:63], v[148:151]
  ds_read_b64_tr_b16 a[224:225], v22 offset:49152
  v_cvt_pk_bf16_f32 v209, v106, v107
  v_mfma_f32_16x16x32_bf16 v[144:147], a[188:191], v[44:47], v[224:227]
  v_exp_f32 v108, v108
  v_mfma_f32_16x16x32_bf16 v[144:147], a[184:187], v[40:43], v[144:147]
  ds_read_b64_tr_b16 a[226:227], v22 offset:50176
  v_mfma_f32_16x16x32_bf16 v[144:147], a[180:183], v[36:39], v[144:147]
  s_cmp_lt_u32 s19, 8
  v_exp_f32 v109, v109
  v_mfma_f32_16x16x32_bf16 v[144:147], a[176:179], v[32:35], v[144:147]
  s_cselect_b32 s69, 0x10000000, s20
  ds_read_b64_tr_b16 a[228:229], v22 offset:51200
  v_cvt_pk_bf16_f32 v216, v108, v109
  v_smfmac_f32_16x16x64_bf16 v[240:243], v[248:251], v[160:167], v11
  buffer_load_dword v10, v7, s[60:63], s69 offen sc1
  v_smfmac_f32_16x16x64_bf16 v[240:243], v[252:255], v[168:175], v11
  v_smfmac_f32_16x16x64_bf16 v[244:247], v[248:251], v[176:183], v11
  v_smfmac_f32_16x16x64_bf16 v[244:247], v[252:255], v[184:191], v11
  v_mfma_f32_16x16x32_bf16 a[0:3], v[160:163], a[192:195], a[0:3]
  v_exp_f32 v110, v110
  v_mfma_f32_16x16x32_bf16 a[0:3], v[164:167], a[196:199], a[0:3]
  ds_read_b64_tr_b16 a[230:231], v22 offset:52224
  v_mfma_f32_16x16x32_bf16 a[4:7], v[172:175], a[196:199], a[4:7]
  v_exp_f32 v111, v111
  v_mfma_f32_16x16x32_bf16 a[4:7], v[168:171], a[192:195], a[4:7]
  ds_read_b64_tr_b16 a[232:233], v23 offset:49152
  v_cvt_pk_bf16_f32 v217, v110, v111
  v_mfma_f32_16x16x32_bf16 a[8:11], v[176:179], a[192:195], a[8:11]
  v_exp_f32 v124, v124
  v_mfma_f32_16x16x32_bf16 a[8:11], v[180:183], a[196:199], a[8:11]
  ds_read_b64_tr_b16 a[234:235], v23 offset:50176
  v_mfma_f32_16x16x32_bf16 a[12:15], v[188:191], a[196:199], a[12:15]
  v_exp_f32 v125, v125
  v_mfma_f32_16x16x32_bf16 a[12:15], v[184:187], a[192:195], a[12:15]
  ds_read_b64_tr_b16 a[236:237], v23 offset:51200
  v_cvt_pk_bf16_f32 v218, v124, v125
  v_mfma_f32_16x16x32_bf16 a[28:31], v[184:187], a[200:203], a[28:31]
  v_exp_f32 v126, v126
  v_mfma_f32_16x16x32_bf16 a[28:31], v[188:191], a[204:207], a[28:31]
  ds_read_b64_tr_b16 a[238:239], v23 offset:52224
  v_mfma_f32_16x16x32_bf16 a[24:27], v[180:183], a[204:207], a[24:27]
  v_exp_f32 v127, v127
  v_mfma_f32_16x16x32_bf16 a[24:27], v[176:179], a[200:203], a[24:27]
  ds_read_b64_tr_b16 a[240:241], v24 offset:49152
  v_cvt_pk_bf16_f32 v219, v126, v127
  v_mfma_f32_16x16x32_bf16 a[20:23], v[168:171], a[200:203], a[20:23]
  v_exp_f32 v120, v120
  v_mfma_f32_16x16x32_bf16 a[20:23], v[172:175], a[204:207], a[20:23]
  ds_read_b64_tr_b16 a[242:243], v24 offset:50176
  v_mfma_f32_16x16x32_bf16 a[16:19], v[164:167], a[204:207], a[16:19]
  v_exp_f32 v121, v121
  v_mfma_f32_16x16x32_bf16 a[16:19], v[160:163], a[200:203], a[16:19]
  s_waitcnt lgkmcnt(5)
  ds_read_b64_tr_b16 a[244:245], v24 offset:51200
  v_cvt_pk_bf16_f32 v210, v120, v121
  v_mfma_f32_16x16x32_bf16 a[32:35], v[160:163], a[208:211], a[32:35]
  v_exp_f32 v122, v122
  v_mfma_f32_16x16x32_bf16 a[32:35], v[164:167], a[212:215], a[32:35]
  ds_read_b64_tr_b16 a[246:247], v24 offset:52224
  v_mfma_f32_16x16x32_bf16 a[36:39], v[172:175], a[212:215], a[36:39]
  v_exp_f32 v123, v123
  v_mfma_f32_16x16x32_bf16 a[36:39], v[168:171], a[208:211], a[36:39]
  ds_read_b64_tr_b16 a[248:249], v25 offset:49152
  v_cvt_pk_bf16_f32 v211, v122, v123
  v_mfma_f32_16x16x32_bf16 a[40:43], v[176:179], a[208:211], a[40:43]
  v_exp_f32 v116, v116
  v_mfma_f32_16x16x32_bf16 a[40:43], v[180:183], a[212:215], a[40:43]
  ds_read_b64_tr_b16 a[250:251], v25 offset:50176
  v_mfma_f32_16x16x32_bf16 a[44:47], v[188:191], a[212:215], a[44:47]
  v_exp_f32 v117, v117
  v_mfma_f32_16x16x32_bf16 a[44:47], v[184:187], a[208:211], a[44:47]
  ds_read_b64_tr_b16 a[252:253], v25 offset:51200
  v_cvt_pk_bf16_f32 v202, v116, v117
  v_mfma_f32_16x16x32_bf16 a[60:63], v[184:187], a[216:219], a[60:63]
  v_exp_f32 v118, v118
  v_mfma_f32_16x16x32_bf16 a[60:63], v[188:191], a[220:223], a[60:63]
  ds_read_b64_tr_b16 a[254:255], v25 offset:52224
  v_mfma_f32_16x16x32_bf16 a[56:59], v[180:183], a[220:223], a[56:59]
  v_exp_f32 v119, v119
  v_mfma_f32_16x16x32_bf16 a[56:59], v[176:179], a[216:219], a[56:59]
  v_cvt_pk_bf16_f32 v203, v118, v119
  v_mfma_f32_16x16x32_bf16 a[52:55], v[168:171], a[216:219], a[52:55]
  v_exp_f32 v112, v112
  v_mfma_f32_16x16x32_bf16 a[52:55], v[172:175], a[220:223], a[52:55]
  v_mfma_f32_16x16x32_bf16 a[48:51], v[164:167], a[220:223], a[48:51]
  v_exp_f32 v113, v113
  v_mfma_f32_16x16x32_bf16 a[48:51], v[160:163], a[216:219], a[48:51]
  v_cvt_pk_bf16_f32 v194, v112, v113
  v_mfma_f32_16x16x32_bf16 a[64:67], v[160:163], a[224:227], a[64:67]
  v_exp_f32 v114, v114
  v_mfma_f32_16x16x32_bf16 a[64:67], v[164:167], a[228:231], a[64:67]
  v_mfma_f32_16x16x32_bf16 a[68:71], v[172:175], a[228:231], a[68:71]
  v_exp_f32 v115, v115
  v_mfma_f32_16x16x32_bf16 a[68:71], v[168:171], a[224:227], a[68:71]
  v_cvt_pk_bf16_f32 v195, v114, v115
  v_mfma_f32_16x16x32_bf16 a[72:75], v[176:179], a[224:227], a[72:75]
  v_exp_f32 v128, v128
  v_mfma_f32_16x16x32_bf16 a[72:75], v[180:183], a[228:231], a[72:75]
  s_waitcnt vmcnt(2) lgkmcnt(0)
  s_barrier
  v_mfma_f32_16x16x32_bf16 a[76:79], v[188:191], a[228:231], a[76:79]
  v_exp_f32 v129, v129
  v_mfma_f32_16x16x32_bf16 a[76:79], v[184:187], a[224:227], a[76:79]
  ds_read_b128 a[128:131], v14 offset:32768
  v_cvt_pk_bf16_f32 v196, v128, v129
  v_mfma_f32_16x16x32_bf16 a[92:95], v[184:187], a[232:235], a[92:95]
  v_exp_f32 v130, v130
  v_mfma_f32_16x16x32_bf16 a[92:95], v[188:191], a[236:239], a[92:95]
  ds_read_b128 a[132:135], v15 offset:32768
  v_mfma_f32_16x16x32_bf16 a[88:91], v[180:183], a[236:239], a[88:91]
  v_exp_f32 v131, v131
  v_mfma_f32_16x16x32_bf16 a[88:91], v[176:179], a[232:235], a[88:91]
  ds_read_b128 a[136:139], v16 offset:32768
  v_cvt_pk_bf16_f32 v197, v130, v131
  v_mfma_f32_16x16x32_bf16 a[84:87], v[168:171], a[232:235], a[84:87]
  v_exp_f32 v132, v132
  v_mfma_f32_16x16x32_bf16 a[84:87], v[172:175], a[236:239], a[84:87]
  ds_read_b128 a[140:143], v17 offset:32768
  v_mfma_f32_16x16x32_bf16 a[80:83], v[164:167], a[236:239], a[80:83]
  v_exp_f32 v133, v133
  v_mfma_f32_16x16x32_bf16 a[80:83], v[160:163], a[232:235], a[80:83]
  ds_read_b128 a[144:147], v14 offset:33792
  v_cvt_pk_bf16_f32 v204, v132, v133
  v_mfma_f32_16x16x32_bf16 a[96:99], v[160:163], a[240:243], a[96:99]
  v_exp_f32 v134, v134
  v_mfma_f32_16x16x32_bf16 a[96:99], v[164:167], a[244:247], a[96:99]
  ds_read_b128 a[148:151], v15 offset:33792
  v_mfma_f32_16x16x32_bf16 a[100:103], v[172:175], a[244:247], a[100:103]
  v_exp_f32 v135, v135
  v_mfma_f32_16x16x32_bf16 a[100:103], v[168:171], a[240:243], a[100:103]
  ds_read_b128 a[152:155], v16 offset:33792
  v_cvt_pk_bf16_f32 v205, v134, v135
  v_mfma_f32_16x16x32_bf16 a[104:107], v[176:179], a[240:243], a[104:107]
  s_add_u32 s83, s83, 0x4000
  v_exp_f32 v136, v136
  v_mfma_f32_16x16x32_bf16 a[104:107], v[180:183], a[244:247], a[104:107]
  s_and_b32 s83, s83, 0x7ffff
  ds_read_b128 a[156:159], v17 offset:33792
  v_mfma_f32_16x16x32_bf16 a[108:111], v[188:191], a[244:247], a[108:111]
  s_add_u32 m0, s85, 0
  v_exp_f32 v137, v137
  v_mfma_f32_16x16x32_bf16 a[108:111], v[184:187], a[240:243], a[108:111]
  buffer_load_dwordx4 v26, s[36:39], s83 offen lds
  v_mfma_f32_16x16x32_bf16 a[124:127], v[184:187], a[248:251], a[124:127]
  v_exp_f32 v138, v138
  v_mfma_f32_16x16x32_bf16 a[124:127], v[188:191], a[252:255], a[124:127]
  ds_read_b128 a[160:163], v14 offset:34816
  v_cvt_pk_bf16_f32 v212, v136, v137
  v_mfma_f32_16x16x32_bf16 a[120:123], v[180:183], a[252:255], a[120:123]
  v_exp_f32 v139, v139
  v_mfma_f32_16x16x32_bf16 a[120:123], v[176:179], a[248:251], a[120:123]
  ds_read_b128 a[164:167], v15 offset:34816
  v_cvt_pk_bf16_f32 v213, v138, v139
  v_mfma_f32_16x16x32_bf16 a[116:119], v[168:171], a[248:251], a[116:119]
  v_exp_f32 v140, v140
  v_mfma_f32_16x16x32_bf16 a[116:119], v[172:175], a[252:255], a[116:119]
  buffer_load_dwordx4 v26, s[36:39], s83 offen offset:1024 lds
  v_mfma_f32_16x16x32_bf16 a[112:115], v[164:167], a[252:255], a[112:115]
  s_add_u32 s86, s86, 1
  v_exp_f32 v141, v141
  v_mfma_f32_16x16x32_bf16 a[112:115], v[160:163], a[248:251], a[112:115]
  s_cmp_lt_u32 s86, 14
  s_cbranch_scc1 L_loop
L_tail:
  s_waitcnt lgkmcnt(3)
  v_mfma_f32_16x16x32_bf16 v[96:99], a[128:131], v[32:35], v[224:227]
  ds_read_b128 a[168:171], v16 offset:34816
  v_cvt_pk_bf16_f32 v220, v140, v141
  v_mfma_f32_16x16x32_bf16 v[96:99], a[132:135], v[36:39], v[96:99]
  v_exp_f32 v142, v142
  v_mfma_f32_16x16x32_bf16 v[96:99], a[136:139], v[40:43], v[96:99]
  ds_read_b128 a[172:175], v17 offset:34816
  v_mfma_f32_16x16x32_bf16 v[96:99], a[140:143], v[44:47], v[96:99]
  v_exp_f32 v143, v143
  v_mfma_f32_16x16x32_bf16 v[100:103], a[140:143], v[60:63], v[228:231]
  buffer_load_dwordx4 v26, s[36:39], s83 offen offset:2048 lds
  v_mfma_f32_16x16x32_bf16 v[100:103], a[136:139], v[56:59], v[100:103]
  v_exp_f32 v156, v156
  v_mfma_f32_16x16x32_bf16 v[100:103], a[132:135], v[52:55], v[100:103]
  ds_read_b128 a[176:179], v14 offset:35840
  v_cvt_pk_bf16_f32 v221, v142, v143
  v_mfma_f32_16x16x32_bf16 v[100:103], a[128:131], v[48:51], v[100:103]
  v_exp_f32 v157, v157
  v_mfma_f32_16x16x32_bf16 v[104:107], a[128:131], v[64:67], v[232:235]
  ds_read_b128 a[180:183], v15 offset:35840
  v_cvt_pk_bf16_f32 v222, v156, v157
  v_mfma_f32_16x16x32_bf16 v[104:107], a[132:135], v[68:71], v[104:107]
  v_exp_f32 v158, v158
  v_mfma_f32_16x16x32_bf16 v[104:107], a[136:139], v[72:75], v[104:107]
  buffer_load_dwordx4 v26, s[36:39], s83 offen offset:3072 lds
  v_mfma_f32_16x16x32_bf16 v[104:107], a[140:143], v[76:79], v[104:107]
  v_exp_f32 v159, v159
  v_mfma_f32_16x16x32_bf16 v[108:111], a[140:143], v[92:95], v[236:239]
  ds_read_b128 a[184:187], v16 offset:35840
  v_cvt_pk_bf16_f32 v223, v158, v159
  v_mfma_f32_16x16x32_bf16 v[108:111], a[136:139], v[88:91], v[108:111]
  s_add_u32 s84, s84, 0x4000
  v_exp_f32 v152, v152
  v_mfma_f32_16x16x32_bf16 v[108:111], a[132:135], v[84:87], v[108:111]
  s_and_b32 s84, s84, 0x7ffff
  ds_read_b128 a[188:191], v17 offset:35840
  v_mfma_f32_16x16x32_bf16 v[108:111], a[128:131], v[80:83], v[108:111]
  s_add_u32 m0, s85, 0xc000
  v_exp_f32 v153, v153
  v_mfma_f32_16x16x32_bf16 v[124:127], a[144:147], v[80:83], v[236:239]
  buffer_load_dwordx4 v27, s[40:43], s84 offen lds
  v_mfma_f32_16x16x32_bf16 v[124:127], a[148:151], v[84:87], v[124:127]
  v_exp_f32 v154, v154
  v_mfma_f32_16x16x32_bf16 v[124:127], a[152:155], v[88:91], v[124:127]
  s_waitcnt lgkmcnt(2)
  ds_read_b64_tr_b16 a[192:193], v18 offset:16384
  v_cvt_pk_bf16_f32 v214, v152, v153
  v_mfma_f32_16x16x32_bf16 v[124:127], a[156:159], v[92:95], v[124:127]
  v_exp_f32 v155, v155
  v_mfma_f32_16x16x32_bf16 v[120:123], a[156:159], v[76:79], v[232:235]
  ds_read_b64_tr_b16 a[194:195], v18 offset:17408
  v_cvt_pk_bf16_f32 v215, v154, v155
  v_mfma_f32_16x16x32_bf16 v[120:123], a[152:155], v[72:75], v[120:123]
  v_exp_f32 v148, v148
  v_mfma_f32_16x16x32_bf16 v[120:123], a[148:151], v[68:71], v[120:123]
  buffer_load_dwordx4 v27, s[40:43], s84 offen offset:1024 lds
  v_mfma_f32_16x16x32_bf16 v[120:123], a[144:147], v[64:67], v[120:123]
  v_exp_f32 v149, v149
  v_mfma_f32_16x16x32_bf16 v[116:119], a[144:147], v[48:51], v[228:231]
  ds_read_b64_tr_b16 a[196:197], v18 offset:18432
  v_cvt_pk_bf16_f32 v206, v148, v149
  v_mfma_f32_16x16x32_bf16 v[116:119], a[148:151], v[52:55], v[116:119]
  v_exp_f32 v150, v150
  v_mfma_f32_16x16x32_bf16 v[116:119], a[152:155], v[56:59], v[116:119]
  ds_read_b64_tr_b16 a[198:199], v18 offset:19456
  v_mfma_f32_16x16x32_bf16 v[116:119], a[156:159], v[60:63], v[116:119]
  v_exp_f32 v151, v151
  v_mfma_f32_16x16x32_bf16 v[112:115], a[156:159], v[44:47], v[224:227]
  buffer_load_dwordx4 v27, s[40:43], s84 offen offset:2048 lds
  v_mfma_f32_16x16x32_bf16 v[112:115], a[152:155], v[40:43], v[112:115]
  v_exp_f32 v144, v144
  v_mfma_f32_16x16x32_bf16 v[112:115], a[148:151], v[36:39], v[112:115]
  ds_read_b64_tr_b16 a[200:201], v19 offset:16384
  v_cvt_pk_bf16_f32 v207, v150, v151
  v_mfma_f32_16x16x32_bf16 v[112:115], a[144:147], v[32:35], v[112:115]
  v_exp_f32 v145, v145
  v_mfma_f32_16x16x32_bf16 v[128:131], a[160:163], v[32:35], v[224:227]
  ds_read_b64_tr_b16 a[202:203], v19 offset:17408
  v_cvt_pk_bf16_f32 v198, v144, v145
  v_mfma_f32_16x16x32_bf16 v[128:131], a[164:167], v[36:39], v[128:131]
  v_exp_f32 v146, v146
  v_mfma_f32_16x16x32_bf16 v[128:131], a[168:171], v[40:43], v[128:131]
  buffer_load_dwordx4 v27, s[40:43], s84 offen offset:3072 lds
  v_mfma_f32_16x16x32_bf16 v[128:131], a[172:175], v[44:47], v[128:131]
  v_exp_f32 v147, v147
  v_mfma_f32_16x16x32_bf16 v[132:135], a[172:175], v[60:63], v[228:231]
  ds_read_b64_tr_b16 a[204:205], v19 offset:18432
  v_cvt_pk_bf16_f32 v199, v146, v147
  v_mfma_f32_16x16x32_bf16 v[132:135], a[168:171], v[56:59], v[132:135]
  v_exp_f32 v96, v96
  v_mfma_f32_16x16x32_bf16 v[132:135], a[164:167], v[52:55], v[132:135]
  v_exp_f32 v97, v97
  v_mfma_f32_16x16x32_bf16 v[132:135], a[160:163], v[48:51], v[132:135]
  ds_read_b64_tr_b16 a[206:207], v19 offset:19456
  v_cvt_pk_bf16_f32 v160, v96, v97
  v_mfma_f32_16x16x32_bf16 v[136:139], a[160:163], v[64:67], v[232:235]
  v_exp_f32 v98, v98
  v_mfma_f32_16x16x32_bf16 v[136:139], a[164:167], v[68:71], v[136:139]
  buffer_load_dword v10, v7, s[48:51], s11 offen sc1
  v_mfma_f32_16x16x32_bf16 v[136:139], a[168:171], v[72:75], v[136:139]
  v_exp_f32 v99, v99
  v_mfma_f32_16x16x32_bf16 v[136:139], a[172:175], v[76:79], v[136:139]
  ds_read_b64_tr_b16 a[208:209], v20 offset:16384
  v_cvt_pk_bf16_f32 v161, v98, v99
  v_mfma_f32_16x16x32_bf16 v[140:143], a[172:175], v[92:95], v[236:239]
  v_exp_f32 v100, v100
  v_mfma_f32_16x16x32_bf16 v[140:143], a[168:171], v[88:91], v[140:143]
  ds_read_b64_tr_b16 a[210:211], v20 offset:17408
  v_mfma_f32_16x16x32_bf16 v[140:143], a[164:167], v[84:87], v[140:143]
  v_exp_f32 v101, v101
  v_mfma_f32_16x16x32_bf16 v[140:143], a[160:163], v[80:83], v[140:143]
  ds_read_b64_tr_b16 a[212:213], v20 offset:18432
  v_cvt_pk_bf16_f32 v168, v100, v101
  v_mfma_f32_16x16x32_bf16 v[156:159], a[176:179], v[80:83], v[236:239]
  v_exp_f32 v102, v102
  v_mfma_f32_16x16x32_bf16 v[156:159], a[180:183], v[84:87], v[156:159]
  s_waitcnt lgkmcnt(4)
  ds_read_b64_tr_b16 a[214:215], v20 offset:19456
  v_mfma_f32_16x16x32_bf16 v[156:159], a[184:187], v[88:91], v[156:159]
  v_exp_f32 v103, v103
  v_mfma_f32_16x16x32_bf16 v[156:159], a[188:191], v[92:95], v[156:159]
  ds_read_b64_tr_b16 a[216:217], v21 offset:16384
  v_cvt_pk_bf16_f32 v169, v102, v103
  v_mfma_f32_16x16x32_bf16 v[152:155], a[188:191], v[76:79], v[232:235]
  v_exp_f32 v104, v104
  v_mfma_f32_16x16x32_bf16 v[152:155], a[184:187], v[72:75], v[152:155]
  ds_read_b64_tr_b16 a[218:219], v21 offset:17408
  v_mfma_f32_16x16x32_bf16 v[152:155], a[180:183], v[68:71], v[152:155]
  v_exp_f32 v105, v105
  v_mfma_f32_16x16x32_bf16 v[152:155], a[176:179], v[64:67], v[152:155]
  ds_read_b64_tr_b16 a[220:221], v21 offset:18432
  v_cvt_pk_bf16_f32 v176, v104, v105
  v_mfma_f32_16x16x32_bf16 v[148:151], a[176:179], v[48:51], v[228:231]
  v_exp_f32 v106, v106
  v_mfma_f32_16x16x32_bf16 v[148:151], a[180:183], v[52:55], v[148:151]
  ds_read_b64_tr_b16 a[222:223], v21 offset:19456
  v_mfma_f32_16x16x32_bf16 v[148:151], a[184:187], v[56:59], v[148:151]
  v_exp_f32 v107, v107
  v_mfma_f32_16x16x32_bf16 v[148:151], a[188:191], v[60:63], v[148:151]
  ds_read_b64_tr_b16 a[224:225], v22 offset:16384
  v_cvt_pk_bf16_f32 v177, v106, v107
  v_mfma_f32_16x16x32_bf16 v[144:147], a[188:191], v[44:47], v[224:227]
  v_exp_f32 v108, v108
  v_mfma_f32_16x16x32_bf16 v[144:147], a[184:187], v[40:43], v[144:147]
  s_waitcnt vmcnt(0)
  ds_read_b64_tr_b16 a[226:227], v22 offset:17408
  v_readfirstlane_b32 s71, v10
  v_mfma_f32_16x16x32_bf16 v[144:147], a[180:183], v[36:39], v[144:147]
  v_exp_f32 v109, v109
  v_mfma_f32_16x16x32_bf16 v[144:147], a[176:179], v[32:35], v[144:147]
  s_cmp_lt_u32 s71, 8
  ds_read_b64_tr_b16 a[228:229], v22 offset:18432
  v_cvt_pk_bf16_f32 v184, v108, v109
  s_cbranch_scc1 L_cntwait
L_cntok:
  v_smfmac_f32_16x16x64_bf16 v[240:243], v[248:251], v[192:199], v11
  v_smfmac_f32_16x16x64_bf16 v[240:243], v[252:255], v[200:207], v11
  v_smfmac_f32_16x16x64_bf16 v[244:247], v[248:251], v[208:215], v11
  v_smfmac_f32_16x16x64_bf16 v[244:247], v[252:255], v[216:223], v11
  v_mfma_f32_16x16x32_bf16 a[0:3], v[192:195], a[192:195], a[0:3]
  v_exp_f32 v110, v110
  v_mfma_f32_16x16x32_bf16 a[0:3], v[196:199], a[196:199], a[0:3]
  ds_read_b64_tr_b16 a[230:231], v22 offset:19456
  v_mfma_f32_16x16x32_bf16 a[4:7], v[204:207], a[196:199], a[4:7]
  v_exp_f32 v111, v111
  v_mfma_f32_16x16x32_bf16 a[4:7], v[200:203], a[192:195], a[4:7]
  ds_read_b64_tr_b16 a[232:233], v23 offset:16384
  v_cvt_pk_bf16_f32 v185, v110, v111
  v_mfma_f32_16x16x32_bf16 a[8:11], v[208:211], a[192:195], a[8:11]
  v_exp_f32 v124, v124
  v_mfma_f32_16x16x32_bf16 a[8:11], v[212:215], a[196:199], a[8:11]
  ds_read_b64_tr_b16 a[234:235], v23 offset:17408
  v_mfma_f32_16x16x32_bf16 a[12:15], v[220:223], a[196:199], a[12:15]
  v_exp_f32 v125, v125
  v_mfma_f32_16x16x32_bf16 a[12:15], v[216:219], a[192:195], a[12:15]
  ds_read_b64_tr_b16 a[236:237], v23 offset:18432
  v_cvt_pk_bf16_f32 v186, v124, v125
  v_mfma_f32_16x16x32_bf16 a[28:31], v[216:219], a[200:203], a[28:31]
  s_waitcnt lgkmcnt(4)
  v_exp_f32 v126, v126
  v_mfma_f32_16x16x32_bf16 a[28:31], v[220:223], a[204:207], a[28:31]
  ds_read_b64_tr_b16 a[238:239], v23 offset:19456
  v_mfma_f32_16x16x32_bf16 a[24:27], v[212:215], a[204:207], a[24:27]
  v_exp_f32 v127, v127
  v_mfma_f32_16x16x32_bf16 a[24:27], v[208:211], a[200:203], a[24:27]
  ds_read_b64_tr_b16 a[240:241], v24 offset:16384
  v_cvt_pk_bf16_f32 v187, v126, v127
  v_mfma_f32_16x16x32_bf16 a[20:23], v[200:203], a[200:203], a[20:23]
  v_exp_f32 v120, v120
  v_mfma_f32_16x16x32_bf16 a[20:23], v[204:207], a[204:207], a[20:23]
  ds_read_b64_tr_b16 a[242:243], v24 offset:17408
  v_mfma_f32_16x16x32_bf16 a[16:19], v[196:199], a[204:207], a[16:19]
  v_exp_f32 v121, v121
  v_mfma_f32_16x16x32_bf16 a[16:19], v[192:195], a[200:203], a[16:19]
  ds_read_b64_tr_b16 a[244:245], v24 offset:18432
  v_cvt_pk_bf16_f32 v178, v120, v121
  v_mfma_f32_16x16x32_bf16 a[32:35], v[192:195], a[208:211], a[32:35]
  v_exp_f32 v122, v122
  v_mfma_f32_16x16x32_bf16 a[32:35], v[196:199], a[212:215], a[32:35]
  ds_read_b64_tr_b16 a[246:247], v24 offset:19456
  v_mfma_f32_16x16x32_bf16 a[36:39], v[204:207], a[212:215], a[36:39]
  v_exp_f32 v123, v123
  v_mfma_f32_16x16x32_bf16 a[36:39], v[200:203], a[208:211], a[36:39]
  ds_read_b64_tr_b16 a[248:249], v25 offset:16384
  v_cvt_pk_bf16_f32 v179, v122, v123
  v_mfma_f32_16x16x32_bf16 a[40:43], v[208:211], a[208:211], a[40:43]
  v_exp_f32 v116, v116
  v_mfma_f32_16x16x32_bf16 a[40:43], v[212:215], a[212:215], a[40:43]
  ds_read_b64_tr_b16 a[250:251], v25 offset:17408
  v_mfma_f32_16x16x32_bf16 a[44:47], v[220:223], a[212:215], a[44:47]
  v_exp_f32 v117, v117
  v_mfma_f32_16x16x32_bf16 a[44:47], v[216:219], a[208:211], a[44:47]
  ds_read_b64_tr_b16 a[252:253], v25 offset:18432
  v_cvt_pk_bf16_f32 v170, v116, v117
  v_mfma_f32_16x16x32_bf16 a[60:63], v[216:219], a[216:219], a[60:63]
  v_exp_f32 v118, v118
  v_mfma_f32_16x16x32_bf16 a[60:63], v[220:223], a[220:223], a[60:63]
  ds_read_b64_tr_b16 a[254:255], v25 offset:19456
  v_mfma_f32_16x16x32_bf16 a[56:59], v[212:215], a[220:223], a[56:59]
  v_exp_f32 v119, v119
  v_mfma_f32_16x16x32_bf16 a[56:59], v[208:211], a[216:219], a[56:59]
  v_cvt_pk_bf16_f32 v171, v118, v119
  v_mfma_f32_16x16x32_bf16 a[52:55], v[200:203], a[216:219], a[52:55]
  v_exp_f32 v112, v112
  v_mfma_f32_16x16x32_bf16 a[52:55], v[204:207], a[220:223], a[52:55]
  buffer_load_dword v10, v12, s[32:35], s10 offen
  v_mfma_f32_16x16x32_bf16 a[48:51], v[196:199], a[220:223], a[48:51]
  v_exp_f32 v113, v113
  v_mfma_f32_16x16x32_bf16 a[48:51], v[192:195], a[216:219], a[48:51]
  v_cvt_pk_bf16_f32 v162, v112, v113
  v_mfma_f32_16x16x32_bf16 a[64:67], v[192:195], a[224:227], a[64:67]
  s_waitcnt lgkmcnt(3)
  v_exp_f32 v114, v114
  v_mfma_f32_16x16x32_bf16 a[64:67], v[196:199], a[228:231], a[64:67]
  buffer_load_dword v10, v13, s[64:67], s28 offen
  v_mfma_f32_16x16x32_bf16 a[68:71], v[204:207], a[228:231], a[68:71]
  v_exp_f32 v115, v115
  v_mfma_f32_16x16x32_bf16 a[68:71], v[200:203], a[224:227], a[68:71]
  v_cvt_pk_bf16_f32 v163, v114, v115
  v_mfma_f32_16x16x32_bf16 a[72:75], v[208:211], a[224:227], a[72:75]
  v_exp_f32 v128, v128
  v_mfma_f32_16x16x32_bf16 a[72:75], v[212:215], a[228:231], a[72:75]
  s_waitcnt lgkmcnt(0)
  s_barrier
  v_mfma_f32_16x16x32_bf16 a[76:79], v[220:223], a[228:231], a[76:79]
  v_exp_f32 v129, v129
  v_mfma_f32_16x16x32_bf16 a[76:79], v[216:219], a[224:227], a[76:79]
  ds_read_b128 a[128:131], v14
  v_cvt_pk_bf16_f32 v164, v128, v129
  v_mfma_f32_16x16x32_bf16 a[92:95], v[216:219], a[232:235], a[92:95]
  v_exp_f32 v130, v130
  v_mfma_f32_16x16x32_bf16 a[92:95], v[220:223], a[236:239], a[92:95]
  ds_read_b128 a[132:135], v15
  v_mfma_f32_16x16x32_bf16 a[88:91], v[212:215], a[236:239], a[88:91]
  v_exp_f32 v131, v131
  v_mfma_f32_16x16x32_bf16 a[88:91], v[208:211], a[232:235], a[88:91]
  ds_read_b128 a[136:139], v16
  v_cvt_pk_bf16_f32 v165, v130, v131
  v_mfma_f32_16x16x32_bf16 a[84:87], v[200:203], a[232:235], a[84:87]
  v_exp_f32 v132, v132
  v_mfma_f32_16x16x32_bf16 a[84:87], v[204:207], a[236:239], a[84:87]
  ds_read_b128 a[140:143], v17
  v_mfma_f32_16x16x32_bf16 a[80:83], v[196:199], a[236:239], a[80:83]
  v_exp_f32 v133, v133
  v_mfma_f32_16x16x32_bf16 a[80:83], v[192:195], a[232:235], a[80:83]
  ds_read_b128 a[144:147], v14 offset:1024
  v_cvt_pk_bf16_f32 v172, v132, v133
  v_mfma_f32_16x16x32_bf16 a[96:99], v[192:195], a[240:243], a[96:99]
  v_exp_f32 v134, v134
  v_mfma_f32_16x16x32_bf16 a[96:99], v[196:199], a[244:247], a[96:99]
L_p4590:
  s_cmp_eq_u32 s95, 1
  s_cbranch_scc1 L_p6636
  ds_read_b128 a[148:151], v15 offset:1024
  v_mfma_f32_16x16x32_bf16 a[100:103], v[204:207], a[244:247], a[100:103]
  v_exp_f32 v135, v135
  v_mfma_f32_16x16x32_bf16 a[100:103], v[200:203], a[240:243], a[100:103]
  ds_read_b128 a[152:155], v16 offset:1024
  v_cvt_pk_bf16_f32 v173, v134, v135
  v_mfma_f32_16x16x32_bf16 a[104:107], v[208:211], a[240:243], a[104:107]
  v_exp_f32 v136, v136
  v_mfma_f32_16x16x32_bf16 a[104:107], v[212:215], a[244:247], a[104:107]
  ds_read_b128 a[156:159], v17 offset:1024
  v_mfma_f32_16x16x32_bf16 a[108:111], v[220:223], a[244:247], a[108:111]
  v_exp_f32 v137, v137
  v_mfma_f32_16x16x32_bf16 a[108:111], v[216:219], a[240:243], a[108:111]
  v_mfma_f32_16x16x32_bf16 a[124:127], v[216:219], a[248:251], a[124:127]
  v_exp_f32 v138, v138
  v_mfma_f32_16x16x32_bf16 a[124:127], v[220:223], a[252:255], a[124:127]
  ds_read_b128 a[160:163], v14 offset:2048
  v_cvt_pk_bf16_f32 v180, v136, v137
  v_mfma_f32_16x16x32_bf16 a[120:123], v[212:215], a[252:255], a[120:123]
  v_exp_f32 v139, v139
  v_mfma_f32_16x16x32_bf16 a[120:123], v[208:211], a[248:251], a[120:123]
  ds_read_b128 a[164:167], v15 offset:2048
  v_cvt_pk_bf16_f32 v181, v138, v139
  v_mfma_f32_16x16x32_bf16 a[116:119], v[200:203], a[248:251], a[116:119]
  v_exp_f32 v140, v140
  v_mfma_f32_16x16x32_bf16 a[116:119], v[204:207], a[252:255], a[116:119]
  v_mfma_f32_16x16x32_bf16 a[112:115], v[196:199], a[252:255], a[112:115]
  v_exp_f32 v141, v141
  v_mfma_f32_16x16x32_bf16 a[112:115], v[192:195], a[248:251], a[112:115]
  s_waitcnt lgkmcnt(4)
  v_mfma_f32_16x16x32_bf16 v[96:99], a[128:131], v[32:35], v[224:227]
  ds_read_b128 a[168:171], v16 offset:2048
  v_cvt_pk_bf16_f32 v188, v140, v141
  v_mfma_f32_16x16x32_bf16 v[96:99], a[132:135], v[36:39], v[96:99]
  v_exp_f32 v142, v142
  v_mfma_f32_16x16x32_bf16 v[96:99], a[136:139], v[40:43], v[96:99]
  ds_read_b128 a[172:175], v17 offset:2048
  v_mfma_f32_16x16x32_bf16 v[96:99], a[140:143], v[44:47], v[96:99]
  v_exp_f32 v143, v143
  v_mfma_f32_16x16x32_bf16 v[100:103], a[140:143], v[60:63], v[228:231]
  v_mfma_f32_16x16x32_bf16 v[100:103], a[136:139], v[56:59], v[100:103]
  v_exp_f32 v156, v156
  v_mfma_f32_16x16x32_bf16 v[100:103], a[132:135], v[52:55], v[100:103]
  ds_read_b128 a[176:179], v14 offset:3072
  v_cvt_pk_bf16_f32 v189, v142, v143
  v_mfma_f32_16x16x32_bf16 v[100:103], a[128:131], v[48:51], v[100:103]
  v_exp_f32 v157, v157
  v_mfma_f32_16x16x32_bf16 v[104:107], a[128:131], v[64:67], v[232:235]
  ds_read_b128 a[180:183], v15 offset:3072
  v_cvt_pk_bf16_f32 v190, v156, v157
  v_mfma_f32_16x16x32_bf16 v[104:107], a[132:135], v[68:71], v[104:107]
  v_exp_f32 v158, v158
  v_mfma_f32_16x16x32_bf16 v[104:107], a[136:139], v[72:75], v[104:107]
  v_mfma_f32_16x16x32_bf16 v[104:107], a[140:143], v[76:79], v[104:107]
  v_exp_f32 v159, v159
  v_mfma_f32_16x16x32_bf16 v[108:111], a[140:143], v[92:95], v[236:239]
  ds_read_b128 a[184:187], v16 offset:3072
  v_cvt_pk_bf16_f32 v191, v158, v159
  v_mfma_f32_16x16x32_bf16 v[108:111], a[136:139], v[88:91], v[108:111]
  s_add_u32 s84, s84, 0x4000
  v_exp_f32 v152, v152
  v_mfma_f32_16x16x32_bf16 v[108:111], a[132:135], v[84:87], v[108:111]
  s_and_b32 s84, s84, 0x7ffff
  ds_read_b128 a[188:191], v17 offset:3072
  v_mfma_f32_16x16x32_bf16 v[108:111], a[128:131], v[80:83], v[108:111]
  s_add_u32 m0, s85, 0x4000
  v_exp_f32 v153, v153
  v_mfma_f32_16x16x32_bf16 v[124:127], a[144:147], v[80:83], v[236:239]
  buffer_load_dwordx4 v27, s[40:43], s84 offen lds
  v_mfma_f32_16x16x32_bf16 v[124:127], a[148:151], v[84:87], v[124:127]
  s_waitcnt lgkmcnt(3)
  v_exp_f32 v154, v154
  v_mfma_f32_16x16x32_bf16 v[124:127], a[152:155], v[88:91], v[124:127]
  ds_read_b64_tr_b16 a[192:193], v18 offset:49152
  v_cvt_pk_bf16_f32 v182, v152, v153
  v_mfma_f32_16x16x32_bf16 v[124:127], a[156:159], v[92:95], v[124:127]
  v_exp_f32 v155, v155
  v_mfma_f32_16x16x32_bf16 v[120:123], a[156:159], v[76:79], v[232:235]
  ds_read_b64_tr_b16 a[194:195], v18 offset:50176
  v_cvt_pk_bf16_f32 v183, v154, v155
  v_mfma_f32_16x16x32_bf16 v[120:123], a[152:155], v[72:75], v[120:123]
  v_exp_f32 v148, v148
  v_mfma_f32_16x16x32_bf16 v[120:123], a[148:151], v[68:71], v[120:123]
  buffer_load_dwordx4 v27, s[40:43], s84 offen offset:1024 lds
  v_mfma_f32_16x16x32_bf16 v[120:123], a[144:147], v[64:67], v[120:123]
  v_exp_f32 v149, v149
  v_mfma_f32_16x16x32_bf16 v[116:119], a[144:147], v[48:51], v[228:231]
  ds_read_b64_tr_b16 a[196:197], v18 offset:51200
  v_cvt_pk_bf16_f32 v174, v148, v149
  v_mfma_f32_16x16x32_bf16 v[116:119], a[148:151], v[52:55], v[116:119]
  v_exp_f32 v150, v150
  v_mfma_f32_16x16x32_bf16 v[116:119], a[152:155], v[56:59], v[116:119]
  ds_read_b64_tr_b16 a[198:199], v18 offset:52224
  v_mfma_f32_16x16x32_bf16 v[116:119], a[156:159], v[60:63], v[116:119]
  v_exp_f32 v151, v151
  v_mfma_f32_16x16x32_bf16 v[112:115], a[156:159], v[44:47], v[224:227]
  buffer_load_dwordx4 v27, s[40:43], s84 offen offset:2048 lds
  v_mfma_f32_16x16x32_bf16 v[112:115], a[152:155], v[40:43], v[112:115]
  v_exp_f32 v144, v144
  v_mfma_f32_16x16x32_bf16 v[112:115], a[148:151], v[36:39], v[112:115]
  ds_read_b64_tr_b16 a[200:201], v19 offset:49152
  v_cvt_pk_bf16_f32 v175, v150, v151
  v_mfma_f32_16x16x32_bf16 v[112:115], a[144:147], v[32:35], v[112:115]
  v_exp_f32 v145, v145
  v_mfma_f32_16x16x32_bf16 v[128:131], a[160:163], v[32:35], v[224:227]
  ds_read_b64_tr_b16 a[202:203], v19 offset:50176
  v_cvt_pk_bf16_f32 v166, v144, v145
  v_mfma_f32_16x16x32_bf16 v[128:131], a[164:167], v[36:39], v[128:131]
  v_exp_f32 v146, v146
  v_mfma_f32_16x16x32_bf16 v[128:131], a[168:171], v[40:43], v[128:131]
  buffer_load_dwordx4 v27, s[40:43], s84 offen offset:3072 lds
  v_mfma_f32_16x16x32_bf16 v[128:131], a[172:175], v[44:47], v[128:131]
  v_exp_f32 v147, v147
  v_mfma_f32_16x16x32_bf16 v[132:135], a[172:175], v[60:63], v[228:231]
  ds_read_b64_tr_b16 a[204:205], v19 offset:51200
  v_cvt_pk_bf16_f32 v167, v146, v147
  v_mfma_f32_16x16x32_bf16 v[132:135], a[168:171], v[56:59], v[132:135]
  v_exp_f32 v96, v96
  v_mfma_f32_16x16x32_bf16 v[132:135], a[164:167], v[52:55], v[132:135]
  v_exp_f32 v97, v97
  v_mfma_f32_16x16x32_bf16 v[132:135], a[160:163], v[48:51], v[132:135]
  ds_read_b64_tr_b16 a[206:207], v19 offset:52224
  v_cvt_pk_bf16_f32 v192, v96, v97
  v_mfma_f32_16x16x32_bf16 v[136:139], a[160:163], v[64:67], v[232:235]
  v_exp_f32 v98, v98
  v_mfma_f32_16x16x32_bf16 v[136:139], a[164:167], v[68:71], v[136:139]
  v_mfma_f32_16x16x32_bf16 v[136:139], a[168:171], v[72:75], v[136:139]
  v_exp_f32 v99, v99
  v_mfma_f32_16x16x32_bf16 v[136:139], a[172:175], v[76:79], v[136:139]
  ds_read_b64_tr_b16 a[208:209], v20 offset:49152
  v_cvt_pk_bf16_f32 v193, v98, v99
  v_mfma_f32_16x16x32_bf16 v[140:143], a[172:175], v[92:95], v[236:239]
  v_exp_f32 v100, v100
  v_mfma_f32_16x16x32_bf16 v[140:143], a[168:171], v[88:91], v[140:143]
  ds_read_b64_tr_b16 a[210:211], v20 offset:50176
  v_mfma_f32_16x16x32_bf16 v[140:143], a[164:167], v[84:87], v[140:143]
  v_exp_f32 v101, v101
  v_mfma_f32_16x16x32_bf16 v[140:143], a[160:163], v[80:83], v[140:143]
  ds_read_b64_tr_b16 a[212:213], v20 offset:51200
  v_cvt_pk_bf16_f32 v200, v100, v101
  v_mfma_f32_16x16x32_bf16 v[156:159], a[176:179], v[80:83], v[236:239]
  s_waitcnt lgkmcnt(4)
  v_exp_f32 v102, v102
  v_mfma_f32_16x16x32_bf16 v[156:159], a[180:183], v[84:87], v[156:159]
  ds_read_b64_tr_b16 a[214:215], v20 offset:52224
  v_mfma_f32_16x16x32_bf16 v[156:159], a[184:187], v[88:91], v[156:159]
  v_exp_f32 v103, v103
  v_mfma_f32_16x16x32_bf16 v[156:159], a[188:191], v[92:95], v[156:159]
  ds_read_b64_tr_b16 a[216:217], v21 offset:49152
  v_cvt_pk_bf16_f32 v201, v102, v103
  v_mfma_f32_16x16x32_bf16 v[152:155], a[188:191], v[76:79], v[232:235]
  v_exp_f32 v104, v104
  v_mfma_f32_16x16x32_bf16 v[152:155], a[184:187], v[72:75], v[152:155]
  ds_read_b64_tr_b16 a[218:219], v21 offset:50176
  v_mfma_f32_16x16x32_bf16 v[152:155], a[180:183], v[68:71], v[152:155]
  v_exp_f32 v105, v105
  v_mfma_f32_16x16x32_bf16 v[152:155], a[176:179], v[64:67], v[152:155]
  ds_read_b64_tr_b16 a[220:221], v21 offset:51200
  v_cvt_pk_bf16_f32 v208, v104, v105
  v_mfma_f32_16x16x32_bf16 v[148:151], a[176:179], v[48:51], v[228:231]
  v_exp_f32 v106, v106
  v_mfma_f32_16x16x32_bf16 v[148:151], a[180:183], v[52:55], v[148:151]
  ds_read_b64_tr_b16 a[222:223], v21 offset:52224
  v_mfma_f32_16x16x32_bf16 v[148:151], a[184:187], v[56:59], v[148:151]
  v_exp_f32 v107, v107
  v_mfma_f32_16x16x32_bf16 v[148:151], a[188:191], v[60:63], v[148:151]
  ds_read_b64_tr_b16 a[224:225], v22 offset:49152
  v_cvt_pk_bf16_f32 v209, v106, v107
  v_mfma_f32_16x16x32_bf16 v[144:147], a[188:191], v[44:47], v[224:227]
  v_exp_f32 v108, v108
  v_mfma_f32_16x16x32_bf16 v[144:147], a[184:187], v[40:43], v[144:147]
  ds_read_b64_tr_b16 a[226:227], v22 offset:50176
  v_mfma_f32_16x16x32_bf16 v[144:147], a[180:183], v[36:39], v[144:147]
  v_exp_f32 v109, v109
  v_mfma_f32_16x16x32_bf16 v[144:147], a[176:179], v[32:35], v[144:147]
  ds_read_b64_tr_b16 a[228:229], v22 offset:51200
  v_cvt_pk_bf16_f32 v216, v108, v109
  v_smfmac_f32_16x16x64_bf16 v[240:243], v[248:251], v[160:167], v11
  ds_read_b64_tr_b16 a[128:129], v2
  v_smfmac_f32_16x16x64_bf16 v[240:243], v[252:255], v[168:175], v11
  ds_read_b64_tr_b16 a[136:137], v3
  v_smfmac_f32_16x16x64_bf16 v[244:247], v[248:251], v[176:183], v11
  ds_read_b64_tr_b16 a[144:145], v4
  v_smfmac_f32_16x16x64_bf16 v[244:247], v[252:255], v[184:191], v11
  ds_read_b64_tr_b16 a[152:153], v5
  v_mfma_f32_16x16x32_bf16 a[0:3], v[160:163], a[192:195], a[0:3]
  ds_read_b64_tr_b16 a[130:131], v2 offset:2048
  v_exp_f32 v110, v110
  v_mfma_f32_16x16x32_bf16 a[0:3], v[164:167], a[196:199], a[0:3]
  ds_read_b64_tr_b16 a[230:231], v22 offset:52224
  v_mfma_f32_16x16x32_bf16 a[4:7], v[172:175], a[196:199], a[4:7]
  ds_read_b64_tr_b16 a[138:139], v3 offset:2048
  v_exp_f32 v111, v111
  v_mfma_f32_16x16x32_bf16 a[4:7], v[168:171], a[192:195], a[4:7]
  ds_read_b64_tr_b16 a[232:233], v23 offset:49152
  v_cvt_pk_bf16_f32 v217, v110, v111
  v_mfma_f32_16x16x32_bf16 a[8:11], v[176:179], a[192:195], a[8:11]
  ds_read_b64_tr_b16 a[146:147], v4 offset:2048
  v_exp_f32 v124, v124
  v_mfma_f32_16x16x32_bf16 a[8:11], v[180:183], a[196:199], a[8:11]
  ds_read_b64_tr_b16 a[234:235], v23 offset:50176
  v_mfma_f32_16x16x32_bf16 a[12:15], v[188:191], a[196:199], a[12:15]
  ds_read_b64_tr_b16 a[154:155], v5 offset:2048
  v_exp_f32 v125, v125
  v_mfma_f32_16x16x32_bf16 a[12:15], v[184:187], a[192:195], a[12:15]
  ds_read_b64_tr_b16 a[236:237], v23 offset:51200
  v_cvt_pk_bf16_f32 v218, v124, v125
  v_mfma_f32_16x16x32_bf16 a[28:31], v[184:187], a[200:203], a[28:31]
  s_waitcnt lgkmcnt(8)
  ds_read_b64_tr_b16 a[132:133], v2 offset:4096
  v_exp_f32 v126, v126
  v_mfma_f32_16x16x32_bf16 a[28:31], v[188:191], a[204:207], a[28:31]
  ds_read_b64_tr_b16 a[238:239], v23 offset:52224
  v_mfma_f32_16x16x32_bf16 a[24:27], v[180:183], a[204:207], a[24:27]
  s_xor_b32 s73, s89, 0x30000
  ds_read_b64_tr_b16 a[140:141], v3 offset:4096
  v_exp_f32 v127, v127
  v_mfma_f32_16x16x32_bf16 a[24:27], v[176:179], a[200:203], a[24:27]
  s_add_u32 m0, s72, 0
  ds_read_b64_tr_b16 a[240:241], v24 offset:49152
  v_cvt_pk_bf16_f32 v219, v126, v127
  v_mfma_f32_16x16x32_bf16 a[20:23], v[168:171], a[200:203], a[20:23]
  buffer_load_dwordx4 v28, s[56:59], s73 offen lds
  v_exp_f32 v120, v120
  v_mfma_f32_16x16x32_bf16 a[20:23], v[172:175], a[204:207], a[20:23]
  ds_read_b64_tr_b16 a[242:243], v24 offset:50176
  v_mfma_f32_16x16x32_bf16 a[16:19], v[164:167], a[204:207], a[16:19]
  ds_read_b64_tr_b16 a[148:149], v4 offset:4096
  v_exp_f32 v121, v121
  v_mfma_f32_16x16x32_bf16 a[16:19], v[160:163], a[200:203], a[16:19]
  ds_read_b64_tr_b16 a[244:245], v24 offset:51200
  v_cvt_pk_bf16_f32 v210, v120, v121
  v_mfma_f32_16x16x32_bf16 a[32:35], v[160:163], a[208:211], a[32:35]
  buffer_load_dwordx4 v29, s[56:59], s73 offen offset:1024 lds
  v_exp_f32 v122, v122
  v_mfma_f32_16x16x32_bf16 a[32:35], v[164:167], a[212:215], a[32:35]
  ds_read_b64_tr_b16 a[246:247], v24 offset:52224
  v_mfma_f32_16x16x32_bf16 a[36:39], v[172:175], a[212:215], a[36:39]
  ds_read_b64_tr_b16 a[156:157], v5 offset:4096
  v_exp_f32 v123, v123
  v_mfma_f32_16x16x32_bf16 a[36:39], v[168:171], a[208:211], a[36:39]
  s_waitcnt lgkmcnt(6)
  ds_read_b64_tr_b16 a[248:249], v25 offset:49152
  v_cvt_pk_bf16_f32 v211, v122, v123
  v_mfma_f32_16x16x32_bf16 a[40:43], v[176:179], a[208:211], a[40:43]
  buffer_load_dwordx4 v30, s[56:59], s73 offen offset:2048 lds
  v_exp_f32 v116, v116
  v_mfma_f32_16x16x32_bf16 a[40:43], v[180:183], a[212:215], a[40:43]
  ds_read_b64_tr_b16 a[250:251], v25 offset:50176
  v_mfma_f32_16x16x32_bf16 a[44:47], v[188:191], a[212:215], a[44:47]
  ds_read_b64_tr_b16 a[134:135], v2 offset:6144
  v_exp_f32 v117, v117
  v_mfma_f32_16x16x32_bf16 a[44:47], v[184:187], a[208:211], a[44:47]
  ds_read_b64_tr_b16 a[252:253], v25 offset:51200
  v_cvt_pk_bf16_f32 v202, v116, v117
  v_mfma_f32_16x16x32_bf16 a[60:63], v[184:187], a[216:219], a[60:63]
  ds_read_b64_tr_b16 a[142:143], v3 offset:6144
  v_exp_f32 v118, v118
  v_mfma_f32_16x16x32_bf16 a[60:63], v[188:191], a[220:223], a[60:63]
  ds_read_b64_tr_b16 a[254:255], v25 offset:52224
  v_mfma_f32_16x16x32_bf16 a[56:59], v[180:183], a[220:223], a[56:59]
  ds_read_b64_tr_b16 a[150:151], v4 offset:6144
  v_exp_f32 v119, v119
  v_mfma_f32_16x16x32_bf16 a[56:59], v[176:179], a[216:219], a[56:59]
  buffer_load_dwordx4 v31, s[56:59], s73 offen offset:3072 lds
  v_cvt_pk_bf16_f32 v203, v118, v119
  v_mfma_f32_16x16x32_bf16 a[52:55], v[168:171], a[216:219], a[52:55]
  ds_read_b64_tr_b16 a[158:159], v5 offset:6144
  v_exp_f32 v112, v112
  v_mfma_f32_16x16x32_bf16 a[52:55], v[172:175], a[220:223], a[52:55]
  ds_read_b64_tr_b16 a[160:161], v2 offset:8192
  v_mfma_f32_16x16x32_bf16 a[48:51], v[164:167], a[220:223], a[48:51]
  ds_read_b64_tr_b16 a[168:169], v3 offset:8192
  v_exp_f32 v113, v113
  v_mfma_f32_16x16x32_bf16 a[48:51], v[160:163], a[216:219], a[48:51]
  ds_read_b64_tr_b16 a[176:177], v4 offset:8192
  v_cvt_pk_bf16_f32 v194, v112, v113
  v_mfma_f32_16x16x32_bf16 a[64:67], v[160:163], a[224:227], a[64:67]
  s_xor_b32 s74, s89, 0x38000
  ds_read_b64_tr_b16 a[184:185], v5 offset:8192
  v_exp_f32 v114, v114
  v_mfma_f32_16x16x32_bf16 a[64:67], v[164:167], a[228:231], a[64:67]
  s_add_u32 m0, s72, 0x1000
  ds_read_b64_tr_b16 a[162:163], v2 offset:10240
  v_mfma_f32_16x16x32_bf16 a[68:71], v[172:175], a[228:231], a[68:71]
  s_waitcnt lgkmcnt(7)
  ds_read_b64_tr_b16 a[170:171], v3 offset:10240
  v_exp_f32 v115, v115
  v_mfma_f32_16x16x32_bf16 a[68:71], v[168:171], a[224:227], a[68:71]
  buffer_load_dwordx4 v28, s[56:59], s74 offen lds
  v_cvt_pk_bf16_f32 v195, v114, v115
  v_mfma_f32_16x16x32_bf16 a[72:75], v[176:179], a[224:227], a[72:75]
  ds_read_b64_tr_b16 a[178:179], v4 offset:10240
  v_exp_f32 v128, v128
  v_mfma_f32_16x16x32_bf16 a[72:75], v[180:183], a[228:231], a[72:75]
  s_waitcnt vmcnt(5)
  s_barrier
  v_mfma_f32_16x16x32_bf16 a[76:79], v[188:191], a[228:231], a[76:79]
  ds_read_b64_tr_b16 a[186:187], v5 offset:10240
  v_exp_f32 v129, v129
  v_mfma_f32_16x16x32_bf16 a[76:79], v[184:187], a[224:227], a[76:79]
  ds_read_b64_tr_b16 a[192:193], v18 offset:16384
  v_cvt_pk_bf16_f32 v196, v128, v129
  v_mfma_f32_16x16x32_bf16 a[92:95], v[184:187], a[232:235], a[92:95]
  ds_read_b64_tr_b16 a[164:165], v2 offset:12288
  v_exp_f32 v130, v130
  v_mfma_f32_16x16x32_bf16 a[92:95], v[188:191], a[236:239], a[92:95]
  buffer_load_dwordx4 v29, s[56:59], s74 offen offset:1024 lds
  v_mfma_f32_16x16x32_bf16 a[88:91], v[180:183], a[236:239], a[88:91]
  ds_read_b64_tr_b16 a[172:173], v3 offset:12288
  v_exp_f32 v131, v131
  v_mfma_f32_16x16x32_bf16 a[88:91], v[176:179], a[232:235], a[88:91]
  ds_read_b64_tr_b16 a[194:195], v18 offset:17408
  v_cvt_pk_bf16_f32 v197, v130, v131
  v_mfma_f32_16x16x32_bf16 a[84:87], v[168:171], a[232:235], a[84:87]
  s_waitcnt lgkmcnt(6)
  ds_read_b64_tr_b16 a[180:181], v4 offset:12288
  v_exp_f32 v132, v132
  v_mfma_f32_16x16x32_bf16 a[84:87], v[172:175], a[236:239], a[84:87]
  buffer_load_dwordx4 v30, s[56:59], s74 offen offset:2048 lds
  v_mfma_f32_16x16x32_bf16 a[80:83], v[164:167], a[236:239], a[80:83]
  ds_read_b64_tr_b16 a[188:189], v5 offset:12288
  v_exp_f32 v133, v133
  v_mfma_f32_16x16x32_bf16 a[80:83], v[160:163], a[232:235], a[80:83]
  ds_read_b64_tr_b16 a[196:197], v18 offset:18432
  v_cvt_pk_bf16_f32 v204, v132, v133
  v_mfma_f32_16x16x32_bf16 a[96:99], v[160:163], a[240:243], a[96:99]
  ds_read_b64_tr_b16 a[166:167], v2 offset:14336
  v_exp_f32 v134, v134
  v_mfma_f32_16x16x32_bf16 a[96:99], v[164:167], a[244:247], a[96:99]
  buffer_load_dwordx4 v31, s[56:59], s74 offen offset:3072 lds
  v_mfma_f32_16x16x32_bf16 a[100:103], v[172:175], a[244:247], a[100:103]
  ds_read_b64_tr_b16 a[174:175], v3 offset:14336
  v_exp_f32 v135, v135
  v_mfma_f32_16x16x32_bf16 a[100:103], v[168:171], a[240:243], a[100:103]
  ds_read_b64_tr_b16 a[198:199], v18 offset:19456
  v_cvt_pk_bf16_f32 v205, v134, v135
  v_mfma_f32_16x16x32_bf16 a[104:107], v[176:179], a[240:243], a[104:107]
  ds_read_b64_tr_b16 a[182:183], v4 offset:14336
  v_exp_f32 v136, v136
  v_mfma_f32_16x16x32_bf16 a[104:107], v[180:183], a[244:247], a[104:107]
  ds_read_b64_tr_b16 a[190:191], v5 offset:14336
  v_mfma_f32_16x16x32_bf16 a[108:111], v[188:191], a[244:247], a[108:111]
  v_exp_f32 v137, v137
  v_mfma_f32_16x16x32_bf16 a[108:111], v[184:187], a[240:243], a[108:111]
  v_mfma_f32_16x16x32_bf16 a[124:127], v[184:187], a[248:251], a[124:127]
  v_exp_f32 v138, v138
  v_mfma_f32_16x16x32_bf16 a[124:127], v[188:191], a[252:255], a[124:127]
  ds_read_b64_tr_b16 a[200:201], v19 offset:16384
  v_cvt_pk_bf16_f32 v212, v136, v137
  v_mfma_f32_16x16x32_bf16 a[120:123], v[180:183], a[252:255], a[120:123]
  v_exp_f32 v139, v139
  v_mfma_f32_16x16x32_bf16 a[120:123], v[176:179], a[248:251], a[120:123]
  ds_read_b64_tr_b16 a[202:203], v19 offset:17408
  v_cvt_pk_bf16_f32 v213, v138, v139
  v_mfma_f32_16x16x32_bf16 a[116:119], v[168:171], a[248:251], a[116:119]
  v_exp_f32 v140, v140
  v_mfma_f32_16x16x32_bf16 a[116:119], v[172:175], a[252:255], a[116:119]
  v_mfma_f32_16x16x32_bf16 a[112:115], v[164:167], a[252:255], a[112:115]
  v_exp_f32 v141, v141
  v_mfma_f32_16x16x32_bf16 a[112:115], v[160:163], a[248:251], a[112:115]
  ds_read_b64_tr_b16 a[204:205], v19 offset:18432
  v_cvt_pk_bf16_f32 v220, v140, v141
  v_exp_f32 v142, v142
  v_exp_f32 v143, v143
  v_exp_f32 v156, v156
  ds_read_b64_tr_b16 a[206:207], v19 offset:19456
  v_cvt_pk_bf16_f32 v221, v142, v143
  v_exp_f32 v157, v157
  s_nop 0
  v_cvt_pk_bf16_f32 v222, v156, v157
  v_exp_f32 v158, v158
  ds_read_b64_tr_b16 a[208:209], v20 offset:16384
  v_exp_f32 v159, v159
  s_nop 0
  v_cvt_pk_bf16_f32 v223, v158, v159
  v_exp_f32 v152, v152
  v_exp_f32 v153, v153
  ds_read_b64_tr_b16 a[210:211], v20 offset:17408
  v_exp_f32 v154, v154
  v_cvt_pk_bf16_f32 v214, v152, v153
  v_exp_f32 v155, v155
  s_nop 0
  v_cvt_pk_bf16_f32 v215, v154, v155
  ds_read_b64_tr_b16 a[212:213], v20 offset:18432
  v_exp_f32 v148, v148
  v_exp_f32 v149, v149
  s_nop 0
  v_cvt_pk_bf16_f32 v206, v148, v149
  v_exp_f32 v150, v150
  ds_read_b64_tr_b16 a[214:215], v20 offset:19456
  v_exp_f32 v151, v151
  v_exp_f32 v144, v144
  v_cvt_pk_bf16_f32 v207, v150, v151
  v_exp_f32 v145, v145
  ds_read_b64_tr_b16 a[216:217], v21 offset:16384
  v_cvt_pk_bf16_f32 v198, v144, v145
  v_exp_f32 v146, v146
  v_exp_f32 v147, v147
  s_nop 0
  v_cvt_pk_bf16_f32 v199, v146, v147
  s_nop 1
  v_smfmac_f32_16x16x64_bf16 v[240:243], v[248:251], v[192:199], v11
  s_xor_b32 s73, s89, 0x40000
  ds_read_b64_tr_b16 a[218:219], v21 offset:17408
  v_add_u32 v132, s85, v6
  v_smfmac_f32_16x16x64_bf16 v[240:243], v[252:255], v[200:207], v11
  s_add_u32 m0, s72, 0x2000
  ds_read_b64_tr_b16 a[220:221], v21 offset:18432
  v_lshrrev_b32 v133, 8, v1
  v_smfmac_f32_16x16x64_bf16 v[244:247], v[248:251], v[208:215], v11
  s_waitcnt lgkmcnt(4)
  ds_read_b64_tr_b16 a[222:223], v21 offset:19456
  v_and_b32 v128, 48, v1
  v_smfmac_f32_16x16x64_bf16 v[244:247], v[252:255], v[216:223], v11
  buffer_load_dwordx4 v28, s[56:59], s73 offen lds
  ds_read_b64_tr_b16 a[224:225], v22 offset:16384
  v_mfma_f32_16x16x32_bf16 a[0:3], v[192:195], a[192:195], a[0:3]
  ds_read_b64_tr_b16 a[226:227], v22 offset:17408
  v_bfe_u32 v129, v1, 5, 2
  v_mfma_f32_16x16x32_bf16 a[0:3], v[196:199], a[196:199], a[0:3]
  ds_read_b64_tr_b16 a[228:229], v22 offset:18432
  v_xor_b32 v129, v129, v133
  v_mfma_f32_16x16x32_bf16 a[4:7], v[204:207], a[196:199], a[4:7]
  buffer_load_dwordx4 v29, s[56:59], s73 offen offset:1024 lds
  ds_read_b64_tr_b16 a[230:231], v22 offset:19456
  v_mfma_f32_16x16x32_bf16 a[4:7], v[200:203], a[192:195], a[4:7]
  ds_read_b64_tr_b16 a[232:233], v23 offset:16384
  v_lshlrev_b32 v129, 4, v129
  v_mfma_f32_16x16x32_bf16 a[8:11], v[208:211], a[192:195], a[8:11]
  ds_read_b64_tr_b16 a[234:235], v23 offset:17408
  v_lshl_add_u32 v129, v128, 2, v129
  v_mfma_f32_16x16x32_bf16 a[8:11], v[212:215], a[196:199], a[8:11]
  buffer_load_dwordx4 v30, s[56:59], s73 offen offset:2048 lds
  ds_read_b64_tr_b16 a[236:237], v23 offset:18432
  v_mfma_f32_16x16x32_bf16 a[12:15], v[220:223], a[196:199], a[12:15]
  ds_read_b64_tr_b16 a[238:239], v23 offset:19456
  v_and_b32 v128, 0xf0, v1
  v_mfma_f32_16x16x32_bf16 a[12:15], v[216:219], a[192:195], a[12:15]
  s_mov_b32 s98, 0
  ds_read_b64_tr_b16 a[240:241], v24 offset:16384
  v_lshl_add_u32 v129, v128, 4, v129
  v_mfma_f32_16x16x32_bf16 a[28:31], v[216:219], a[200:203], a[28:31]
  buffer_load_dwordx4 v31, s[56:59], s73 offen offset:3072 lds
  ds_read_b64_tr_b16 a[242:243], v24 offset:17408
  v_mfma_f32_16x16x32_bf16 a[28:31], v[220:223], a[204:207], a[28:31]
  s_mov_b32 s99, -1
  ds_read_b64_tr_b16 a[244:245], v24 offset:18432
  v_add_u32 v136, s85, v129
  v_mfma_f32_16x16x32_bf16 a[24:27], v[212:215], a[204:207], a[24:27]
  s_lshl_b32 s68, s3, 2
  ds_read_b64_tr_b16 a[246:247], v24 offset:19456
  v_lshl_add_u32 v133, v133, 4, s85
  v_mfma_f32_16x16x32_bf16 a[24:27], v[208:211], a[200:203], a[24:27]
  ds_read_b64_tr_b16 a[248:249], v25 offset:16384
  v_add_f32 v131, v240, v241
  v_mfma_f32_16x16x32_bf16 a[20:23], v[200:203], a[200:203], a[20:23]
  ds_read_b64_tr_b16 a[250:251], v25 offset:17408
  v_add_f32 v128, v244, v245
  v_mfma_f32_16x16x32_bf16 a[20:23], v[204:207], a[204:207], a[20:23]
  s_xor_b32 s74, s89, 0x48000
  ds_read_b64_tr_b16 a[252:253], v25 offset:18432
  v_cndmask_b32 v131, v131, v128, s[98:99]
  v_mfma_f32_16x16x32_bf16 a[16:19], v[196:199], a[204:207], a[16:19]
  s_add_u32 m0, s72, 0x3000
  ds_read_b64_tr_b16 a[254:255], v25 offset:19456
  v_subrev_u32 v129, 0x45000000, v131
  v_mfma_f32_16x16x32_bf16 a[16:19], v[192:195], a[200:203], a[16:19]
  buffer_load_dwordx4 v28, s[56:59], s74 offen lds
  v_mfma_f32_16x16x32_bf16 a[32:35], v[192:195], a[208:211], a[32:35]
  s_waitcnt lgkmcnt(7)
  ds_read_b64_tr_b16 v[160:161], v2 offset:16384
  v_cmp_lt_u32 vcc, 0x11800000, v129
  v_mfma_f32_16x16x32_bf16 a[32:35], v[196:199], a[212:215], a[32:35]
  ds_read_b64_tr_b16 v[168:169], v3 offset:16384
  v_rcp_f32 v131, v131
  v_mfma_f32_16x16x32_bf16 a[36:39], v[204:207], a[212:215], a[36:39]
  buffer_load_dwordx4 v29, s[56:59], s74 offen offset:1024 lds
  v_mfma_f32_16x16x32_bf16 a[36:39], v[200:203], a[208:211], a[36:39]
  s_or_b32 s70, vcc_lo, vcc_hi
  ds_write_b32 v132, v131 offset:49408
  ds_read_b64_tr_b16 v[176:177], v4 offset:16384
  v_lshl_add_u32 v130, v1, 8, s68
  v_mfma_f32_16x16x32_bf16 a[40:43], v[208:211], a[208:211], a[40:43]
  ds_read_b64_tr_b16 v[184:185], v5 offset:16384
  ds_read_b128 v[224:227], v133 offset:49408
  v_and_b32 v130, 0x3fff, v130
  v_mfma_f32_16x16x32_bf16 a[40:43], v[212:215], a[212:215], a[40:43]
  buffer_load_dwordx4 v30, s[56:59], s74 offen offset:2048 lds
  v_mov_b32 v129, s70
  v_mfma_f32_16x16x32_bf16 a[44:47], v[220:223], a[212:215], a[44:47]
  ds_write_b32 v130, v129 offset:49152
  ds_read_b64_tr_b16 v[162:163], v2 offset:18432
  ds_read_b128 v[228:231], v133 offset:49472
  v_mfma_f32_16x16x32_bf16 a[44:47], v[216:219], a[208:211], a[44:47]
  ds_read_b64_tr_b16 v[170:171], v3 offset:18432
  ds_read_b128 v[232:235], v133 offset:49536
  v_mfma_f32_16x16x32_bf16 a[60:63], v[216:219], a[216:219], a[60:63]
  buffer_load_dwordx4 v31, s[56:59], s74 offen offset:3072 lds
  v_mfma_f32_16x16x32_bf16 a[60:63], v[220:223], a[220:223], a[60:63]
  ds_read_b64_tr_b16 v[178:179], v4 offset:18432
  ds_read_b128 v[236:239], v133 offset:49600
  v_mfma_f32_16x16x32_bf16 a[56:59], v[212:215], a[220:223], a[56:59]
  ds_read_b64_tr_b16 v[186:187], v5 offset:18432
  v_mov_b32 v130, s85
  v_mfma_f32_16x16x32_bf16 a[56:59], v[208:211], a[216:219], a[56:59]
  s_xor_b32 s73, s89, 0x50000
  ds_read_b64_tr_b16 v[164:165], v2 offset:20480
  v_xor_b32 v137, 64, v136
  v_mfma_f32_16x16x32_bf16 a[52:55], v[200:203], a[216:219], a[52:55]
  s_add_u32 m0, s72, 0x4000
  ds_read_b64_tr_b16 v[172:173], v3 offset:20480
  v_xor_b32 v138, 0x80, v136
  v_mfma_f32_16x16x32_bf16 a[52:55], v[204:207], a[220:223], a[52:55]
  s_waitcnt lgkmcnt(10)
  ds_read_b64_tr_b16 v[180:181], v4 offset:20480
  v_xor_b32 v139, 0xc0, v136
  v_mfma_f32_16x16x32_bf16 a[48:51], v[196:199], a[220:223], a[48:51]
  buffer_load_dwordx4 v28, s[56:59], s73 offen lds
  v_mfma_f32_16x16x32_bf16 a[48:51], v[192:195], a[216:219], a[48:51]
  ds_read_b64_tr_b16 v[188:189], v5 offset:20480
  v_mul_f32 v144, -v246, v224
  v_mfma_f32_16x16x32_bf16 a[64:67], v[192:195], a[224:227], a[64:67]
  buffer_load_dwordx4 v29, s[56:59], s73 offen offset:1024 lds
  v_mfma_f32_16x16x32_bf16 a[64:67], v[196:199], a[228:231], a[64:67]
  s_waitcnt lgkmcnt(4)
  ds_read_b64_tr_b16 v[166:167], v2 offset:22528
  v_mul_f32 v145, -v246, v225
  v_mfma_f32_16x16x32_bf16 a[68:71], v[204:207], a[228:231], a[68:71]
  buffer_load_dwordx4 v30, s[56:59], s73 offen offset:2048 lds
  v_mfma_f32_16x16x32_bf16 a[68:71], v[200:203], a[224:227], a[68:71]
  ds_read_b64_tr_b16 v[174:175], v3 offset:22528
  v_mul_f32 v146, -v246, v226
  v_mfma_f32_16x16x32_bf16 a[72:75], v[208:211], a[224:227], a[72:75]
  buffer_load_dwordx4 v31, s[56:59], s73 offen offset:3072 lds
  v_mfma_f32_16x16x32_bf16 a[72:75], v[212:215], a[228:231], a[72:75]
  ds_read_b64_tr_b16 v[182:183], v4 offset:22528
  v_mul_f32 v147, -v246, v227
  v_mfma_f32_16x16x32_bf16 a[76:79], v[220:223], a[228:231], a[76:79]
  ds_read_b64_tr_b16 v[190:191], v5 offset:22528
  v_mul_f32 v148, -v246, v228
  v_mfma_f32_16x16x32_bf16 a[76:79], v[216:219], a[224:227], a[76:79]
  s_xor_b32 s74, s89, 0x58000
  s_barrier
  v_mfma_f32_16x16x32_bf16 a[92:95], v[216:219], a[232:235], a[92:95]
  s_add_u32 m0, s72, 0x5000
  ds_read_b128 v[140:143], v130 offset:49152
  v_mul_f32 v149, -v246, v229
  v_mfma_f32_16x16x32_bf16 a[92:95], v[220:223], a[236:239], a[92:95]
  s_waitcnt lgkmcnt(5)
  v_mul_f32 v150, -v246, v230
  v_mul_f32 v151, -v246, v231
  v_mfma_f32_16x16x32_bf16 a[88:91], v[212:215], a[236:239], a[88:91]
  buffer_load_dwordx4 v28, s[56:59], s74 offen lds
  v_mfma_f32_16x16x32_bf16 a[88:91], v[208:211], a[232:235], a[88:91]
  v_mul_f32 v152, -v246, v232
  v_mul_f32 v153, -v246, v233
  v_mfma_f32_16x16x32_bf16 a[84:87], v[200:203], a[232:235], a[84:87]
  buffer_load_dwordx4 v29, s[56:59], s74 offen offset:1024 lds
  v_mfma_f32_16x16x32_bf16 a[84:87], v[204:207], a[236:239], a[84:87]
  s_waitcnt lgkmcnt(1)
  v_mul_f32 v154, -v246, v234
  v_mul_f32 v155, -v246, v235
  v_mfma_f32_16x16x32_bf16 a[80:83], v[196:199], a[236:239], a[80:83]
  buffer_load_dwordx4 v30, s[56:59], s74 offen offset:2048 lds
  v_mfma_f32_16x16x32_bf16 a[80:83], v[192:195], a[232:235], a[80:83]
  v_mul_f32 v156, -v246, v236
  v_mul_f32 v157, -v246, v237
  v_mfma_f32_16x16x32_bf16 a[96:99], v[192:195], a[240:243], a[96:99]
  buffer_load_dwordx4 v31, s[56:59], s74 offen offset:3072 lds
  v_mfma_f32_16x16x32_bf16 a[96:99], v[196:199], a[244:247], a[96:99]
L_p5141:
  s_cmp_eq_u32 s95, 1
  s_cbranch_scc1 L_wback
  v_mul_f32 v158, -v246, v238
  v_mul_f32 v159, -v246, v239
  v_mfma_f32_16x16x32_bf16 a[100:103], v[204:207], a[244:247], a[100:103]
  v_accvgpr_read_b32 v96, a0
  v_accvgpr_read_b32 v97, a1
  v_mfma_f32_16x16x32_bf16 a[100:103], v[200:203], a[240:243], a[100:103]
  v_accvgpr_read_b32 v98, a2
  v_accvgpr_read_b32 v99, a3
  v_mfma_f32_16x16x32_bf16 a[104:107], v[208:211], a[240:243], a[104:107]
  v_accvgpr_read_b32 v100, a16
  v_accvgpr_read_b32 v101, a17
  v_mfma_f32_16x16x32_bf16 a[104:107], v[212:215], a[244:247], a[104:107]
  v_accvgpr_read_b32 v102, a18
  v_accvgpr_read_b32 v103, a19
  v_mfma_f32_16x16x32_bf16 a[108:111], v[220:223], a[244:247], a[108:111]
  v_accvgpr_read_b32 v104, a4
  v_accvgpr_read_b32 v105, a5
  v_mfma_f32_16x16x32_bf16 a[108:111], v[216:219], a[240:243], a[108:111]
  v_accvgpr_read_b32 v106, a6
  v_accvgpr_read_b32 v107, a7
  v_mfma_f32_16x16x32_bf16 a[124:127], v[216:219], a[248:251], a[124:127]
  v_accvgpr_read_b32 v108, a20
  v_accvgpr_read_b32 v109, a21
  v_mfma_f32_16x16x32_bf16 a[124:127], v[220:223], a[252:255], a[124:127]
  v_accvgpr_read_b32 v110, a22
  v_accvgpr_read_b32 v111, a23
  v_mfma_f32_16x16x32_bf16 a[120:123], v[212:215], a[252:255], a[120:123]
  v_accvgpr_read_b32 v112, a8
  v_accvgpr_read_b32 v113, a9
  v_mfma_f32_16x16x32_bf16 a[120:123], v[208:211], a[248:251], a[120:123]
  v_accvgpr_read_b32 v114, a10
  v_accvgpr_read_b32 v115, a11
  v_mfma_f32_16x16x32_bf16 a[116:119], v[200:203], a[248:251], a[116:119]
  v_accvgpr_read_b32 v116, a24
  v_accvgpr_read_b32 v117, a25
  v_mfma_f32_16x16x32_bf16 a[116:119], v[204:207], a[252:255], a[116:119]
  v_accvgpr_read_b32 v118, a26
  v_accvgpr_read_b32 v119, a27
  v_mfma_f32_16x16x32_bf16 a[112:115], v[196:199], a[252:255], a[112:115]
  v_accvgpr_read_b32 v120, a12
  v_accvgpr_read_b32 v121, a13
  v_mfma_f32_16x16x32_bf16 a[112:115], v[192:195], a[248:251], a[112:115]
  s_waitcnt lgkmcnt(0)
  v_accvgpr_read_b32 v122, a14
  v_accvgpr_read_b32 v123, a15
  v_or_b32 v128, v140, v141
  v_or3_b32 v128, v128, v142, v143
  s_nop 0
  v_readfirstlane_b32 s70, v128
  s_nop 1
  s_andn2_b32 s70, s70, s87
  s_cbranch_scc1 L_slow
  v_add_u32 v9, 0x1000, v1
  s_xor_b32 s68, s30, 7
  s_lshl_b32 s70, s68, 10
  s_and_b32 s69, s68, 3
  s_lshl_b32 s69, s69, 6
  v_bfe_u32 v15, v1, 7, 2
  v_lshlrev_b32 v15, 4, v15
  v_and_b32 v14, 0xf0, v1
  v_xor_b32 v14, v14, v15
  v_and_b32 v15, 0x3c0, v1
  v_lshl_add_u32 v14, v15, 2, v14
  v_bfe_u32 v15, v1, 8, 1
  v_lshl_add_u32 v14, v15, 3, v14
  v_xor_b32 v18, s69, v14
  v_xor_b32 v19, 8, v18
  v_xor_b32 v20, 64, v18
  v_xor_b32 v21, 0x48, v18
  v_xor_b32 v22, 0x80, v18
  v_xor_b32 v23, 0x88, v18
  v_xor_b32 v24, 0xc0, v18
  v_xor_b32 v25, 0xc8, v18
  s_xor_b32 s76, s9, 0
  s_xor_b32 s77, s9, 0x2000
  s_xor_b32 s78, s9, 0x10000
  s_xor_b32 s79, s9, 0x12000
  v_pk_fma_f32 v[96:97], v[96:97], v[224:225], v[144:145]
  v_pk_fma_f32 v[98:99], v[98:99], v[226:227], v[146:147]
  v_pk_fma_f32 v[100:101], v[100:101], v[224:225], v[144:145]
  v_pk_fma_f32 v[102:103], v[102:103], v[226:227], v[146:147]
  v_cvt_pk_bf16_f32 v96, v96, v97
  v_cvt_pk_bf16_f32 v97, v98, v99
  v_cvt_pk_bf16_f32 v98, v100, v101
  v_cvt_pk_bf16_f32 v99, v102, v103
  ds_write_b128 v136, v[96:99]
  buffer_load_dwordx4 v[32:35], v1, s[60:63], s78 offen sc1
  buffer_load_dwordx4 v[36:39], v1, s[60:63], s78 offen offset:1024 sc1
  v_pk_fma_f32 v[104:105], v[104:105], v[228:229], v[148:149]
  v_pk_fma_f32 v[106:107], v[106:107], v[230:231], v[150:151]
  v_pk_fma_f32 v[108:109], v[108:109], v[228:229], v[148:149]
  v_pk_fma_f32 v[110:111], v[110:111], v[230:231], v[150:151]
  v_cvt_pk_bf16_f32 v104, v104, v105
  v_cvt_pk_bf16_f32 v105, v106, v107
  v_cvt_pk_bf16_f32 v106, v108, v109
  v_cvt_pk_bf16_f32 v107, v110, v111
  ds_write_b128 v137, v[104:107]
  buffer_load_dwordx4 v[40:43], v1, s[60:63], s78 offen offset:2048 sc1
  buffer_load_dwordx4 v[44:47], v1, s[60:63], s78 offen offset:3072 sc1
  v_pk_fma_f32 v[112:113], v[112:113], v[232:233], v[152:153]
  v_pk_fma_f32 v[114:115], v[114:115], v[234:235], v[154:155]
  v_pk_fma_f32 v[116:117], v[116:117], v[232:233], v[152:153]
  v_pk_fma_f32 v[118:119], v[118:119], v[234:235], v[154:155]
  v_cvt_pk_bf16_f32 v112, v112, v113
  v_cvt_pk_bf16_f32 v113, v114, v115
  v_cvt_pk_bf16_f32 v114, v116, v117
  v_cvt_pk_bf16_f32 v115, v118, v119
  ds_write_b128 v138, v[112:115]
  buffer_load_dwordx4 v[48:51], v9, s[60:63], s78 offen sc1
  buffer_load_dwordx4 v[52:55], v9, s[60:63], s78 offen offset:1024 sc1
  v_accvgpr_read_b32 v124, a28
  v_accvgpr_read_b32 v125, a29
  v_accvgpr_read_b32 v126, a30
  v_accvgpr_read_b32 v127, a31
  v_pk_fma_f32 v[120:121], v[120:121], v[236:237], v[156:157]
  v_pk_fma_f32 v[122:123], v[122:123], v[238:239], v[158:159]
  v_pk_fma_f32 v[124:125], v[124:125], v[236:237], v[156:157]
  v_pk_fma_f32 v[126:127], v[126:127], v[238:239], v[158:159]
  v_cvt_pk_bf16_f32 v120, v120, v121
  v_cvt_pk_bf16_f32 v121, v122, v123
  v_cvt_pk_bf16_f32 v122, v124, v125
  v_cvt_pk_bf16_f32 v123, v126, v127
  ds_write_b128 v139, v[120:123]
  buffer_load_dwordx4 v[56:59], v9, s[60:63], s78 offen offset:2048 sc1
  buffer_load_dwordx4 v[60:63], v9, s[60:63], s78 offen offset:3072 sc1
  v_accvgpr_read_b32 v96, a32
  v_accvgpr_read_b32 v97, a33
  v_accvgpr_read_b32 v98, a34
  v_accvgpr_read_b32 v99, a35
  v_accvgpr_read_b32 v100, a48
  v_accvgpr_read_b32 v101, a49
  v_accvgpr_read_b32 v102, a50
  v_accvgpr_read_b32 v103, a51
  v_pk_fma_f32 v[96:97], v[96:97], v[224:225], v[144:145]
  v_pk_fma_f32 v[98:99], v[98:99], v[226:227], v[146:147]
  v_pk_fma_f32 v[100:101], v[100:101], v[224:225], v[144:145]
  v_pk_fma_f32 v[102:103], v[102:103], v[226:227], v[146:147]
  v_cvt_pk_bf16_f32 v96, v96, v97
  v_cvt_pk_bf16_f32 v97, v98, v99
  v_cvt_pk_bf16_f32 v98, v100, v101
  v_cvt_pk_bf16_f32 v99, v102, v103
  ds_write_b128 v136, v[96:99] offset:16384
  buffer_load_dwordx4 v[64:67], v1, s[60:63], s79 offen sc1
  v_accvgpr_read_b32 v104, a36
  v_accvgpr_read_b32 v105, a37
  v_accvgpr_read_b32 v106, a38
  v_accvgpr_read_b32 v107, a39
  v_accvgpr_read_b32 v108, a52
  v_accvgpr_read_b32 v109, a53
  v_accvgpr_read_b32 v110, a54
  v_accvgpr_read_b32 v111, a55
  v_pk_fma_f32 v[104:105], v[104:105], v[228:229], v[148:149]
  v_pk_fma_f32 v[106:107], v[106:107], v[230:231], v[150:151]
  v_pk_fma_f32 v[108:109], v[108:109], v[228:229], v[148:149]
  v_pk_fma_f32 v[110:111], v[110:111], v[230:231], v[150:151]
  v_cvt_pk_bf16_f32 v104, v104, v105
  v_cvt_pk_bf16_f32 v105, v106, v107
  v_cvt_pk_bf16_f32 v106, v108, v109
  v_cvt_pk_bf16_f32 v107, v110, v111
  ds_write_b128 v137, v[104:107] offset:16384
  buffer_load_dwordx4 v[68:71], v1, s[60:63], s79 offen offset:1024 sc1
  v_accvgpr_read_b32 v112, a40
  v_accvgpr_read_b32 v113, a41
  v_accvgpr_read_b32 v114, a42
  v_accvgpr_read_b32 v115, a43
  v_accvgpr_read_b32 v116, a56
  v_accvgpr_read_b32 v117, a57
  v_accvgpr_read_b32 v118, a58
  v_accvgpr_read_b32 v119, a59
  v_pk_fma_f32 v[112:113], v[112:113], v[232:233], v[152:153]
  v_pk_fma_f32 v[114:115], v[114:115], v[234:235], v[154:155]
  v_pk_fma_f32 v[116:117], v[116:117], v[232:233], v[152:153]
  v_pk_fma_f32 v[118:119], v[118:119], v[234:235], v[154:155]
  v_cvt_pk_bf16_f32 v112, v112, v113
  v_cvt_pk_bf16_f32 v113, v114, v115
  v_cvt_pk_bf16_f32 v114, v116, v117
  v_cvt_pk_bf16_f32 v115, v118, v119
  ds_write_b128 v138, v[112:115] offset:16384
  buffer_load_dwordx4 v[72:75], v1, s[60:63], s79 offen offset:2048 sc1
  v_accvgpr_read_b32 v120, a44
  v_accvgpr_read_b32 v121, a45
  v_accvgpr_read_b32 v122, a46
  v_accvgpr_read_b32 v123, a47
  v_accvgpr_read_b32 v124, a60
  v_accvgpr_read_b32 v125, a61
  v_accvgpr_read_b32 v126, a62
  v_accvgpr_read_b32 v127, a63
  v_pk_fma_f32 v[120:121], v[120:121], v[236:237], v[156:157]
  v_pk_fma_f32 v[122:123], v[122:123], v[238:239], v[158:159]
  v_pk_fma_f32 v[124:125], v[124:125], v[236:237], v[156:157]
  v_pk_fma_f32 v[126:127], v[126:127], v[238:239], v[158:159]
  v_cvt_pk_bf16_f32 v120, v120, v121
  v_cvt_pk_bf16_f32 v121, v122, v123
  v_cvt_pk_bf16_f32 v122, v124, v125
  v_cvt_pk_bf16_f32 v123, v126, v127
  ds_write_b128 v139, v[120:123] offset:16384
  buffer_load_dwordx4 v[76:79], v1, s[60:63], s79 offen offset:3072 sc1
  v_accvgpr_read_b32 v96, a64
  v_accvgpr_read_b32 v97, a65
  v_accvgpr_read_b32 v98, a66
  v_accvgpr_read_b32 v99, a67
  v_accvgpr_read_b32 v100, a80
  v_accvgpr_read_b32 v101, a81
  v_accvgpr_read_b32 v102, a82
  v_accvgpr_read_b32 v103, a83
  v_pk_fma_f32 v[96:97], v[96:97], v[224:225], v[144:145]
  v_pk_fma_f32 v[98:99], v[98:99], v[226:227], v[146:147]
  v_pk_fma_f32 v[100:101], v[100:101], v[224:225], v[144:145]
  v_pk_fma_f32 v[102:103], v[102:103], v[226:227], v[146:147]
  v_cvt_pk_bf16_f32 v96, v96, v97
  v_cvt_pk_bf16_f32 v97, v98, v99
  v_cvt_pk_bf16_f32 v98, v100, v101
  v_cvt_pk_bf16_f32 v99, v102, v103
  ds_write_b128 v136, v[96:99] offset:32768
  buffer_load_dwordx4 v[80:83], v9, s[60:63], s79 offen sc1
  v_accvgpr_read_b32 v104, a68
  v_accvgpr_read_b32 v105, a69
  v_accvgpr_read_b32 v106, a70
  v_accvgpr_read_b32 v107, a71
  v_accvgpr_read_b32 v108, a84
  v_accvgpr_read_b32 v109, a85
  v_accvgpr_read_b32 v110, a86
  v_accvgpr_read_b32 v111, a87
  v_pk_fma_f32 v[104:105], v[104:105], v[228:229], v[148:149]
  v_pk_fma_f32 v[106:107], v[106:107], v[230:231], v[150:151]
  v_pk_fma_f32 v[108:109], v[108:109], v[228:229], v[148:149]
  v_pk_fma_f32 v[110:111], v[110:111], v[230:231], v[150:151]
  v_cvt_pk_bf16_f32 v104, v104, v105
  v_cvt_pk_bf16_f32 v105, v106, v107
  v_cvt_pk_bf16_f32 v106, v108, v109
  v_cvt_pk_bf16_f32 v107, v110, v111
  ds_write_b128 v137, v[104:107] offset:32768
  buffer_load_dwordx4 v[84:87], v9, s[60:63], s79 offen offset:1024 sc1
  v_accvgpr_read_b32 v112, a72
  v_accvgpr_read_b32 v113, a73
  v_accvgpr_read_b32 v114, a74
  v_accvgpr_read_b32 v115, a75
  v_accvgpr_read_b32 v116, a88
  v_accvgpr_read_b32 v117, a89
  v_accvgpr_read_b32 v118, a90
  v_accvgpr_read_b32 v119, a91
  v_pk_fma_f32 v[112:113], v[112:113], v[232:233], v[152:153]
  v_pk_fma_f32 v[114:115], v[114:115], v[234:235], v[154:155]
  v_pk_fma_f32 v[116:117], v[116:117], v[232:233], v[152:153]
  v_pk_fma_f32 v[118:119], v[118:119], v[234:235], v[154:155]
  v_cvt_pk_bf16_f32 v112, v112, v113
  v_cvt_pk_bf16_f32 v113, v114, v115
  v_cvt_pk_bf16_f32 v114, v116, v117
  v_cvt_pk_bf16_f32 v115, v118, v119
  ds_write_b128 v138, v[112:115] offset:32768
  buffer_load_dwordx4 v[88:91], v9, s[60:63], s79 offen offset:2048 sc1
  v_accvgpr_read_b32 v120, a76
  v_accvgpr_read_b32 v121, a77
  v_accvgpr_read_b32 v122, a78
  v_accvgpr_read_b32 v123, a79
  v_accvgpr_read_b32 v124, a92
  v_accvgpr_read_b32 v125, a93
  v_accvgpr_read_b32 v126, a94
  v_accvgpr_read_b32 v127, a95
  v_pk_fma_f32 v[120:121], v[120:121], v[236:237], v[156:157]
  v_pk_fma_f32 v[122:123], v[122:123], v[238:239], v[158:159]
  v_pk_fma_f32 v[124:125], v[124:125], v[236:237], v[156:157]
  v_pk_fma_f32 v[126:127], v[126:127], v[238:239], v[158:159]
  v_cvt_pk_bf16_f32 v120, v120, v121
  v_cvt_pk_bf16_f32 v121, v122, v123
  v_cvt_pk_bf16_f32 v122, v124, v125
  v_cvt_pk_bf16_f32 v123, v126, v127
  ds_write_b128 v139, v[120:123] offset:32768
  buffer_load_dwordx4 v[92:95], v9, s[60:63], s79 offen offset:3072 sc1
  v_accvgpr_read_b32 v96, a96
  v_accvgpr_read_b32 v97, a97
  v_accvgpr_read_b32 v98, a98
  v_accvgpr_read_b32 v99, a99
  v_accvgpr_read_b32 v100, a112
  v_accvgpr_read_b32 v101, a113
  v_accvgpr_read_b32 v102, a114
  v_accvgpr_read_b32 v103, a115
  v_pk_fma_f32 v[96:97], v[96:97], v[224:225], v[144:145]
  v_pk_fma_f32 v[98:99], v[98:99], v[226:227], v[146:147]
  v_pk_fma_f32 v[100:101], v[100:101], v[224:225], v[144:145]
  v_pk_fma_f32 v[102:103], v[102:103], v[226:227], v[146:147]
  v_cvt_pk_bf16_f32 v96, v96, v97
  v_cvt_pk_bf16_f32 v97, v98, v99
  v_cvt_pk_bf16_f32 v98, v100, v101
  v_cvt_pk_bf16_f32 v99, v102, v103
  ds_write_b128 v136, v[96:99] offset:49152
  buffer_load_dwordx4 v[240:243], v12, s[32:35], s10 offen
  v_accvgpr_read_b32 v104, a100
  v_accvgpr_read_b32 v105, a101
  v_accvgpr_read_b32 v106, a102
  v_accvgpr_read_b32 v107, a103
  v_accvgpr_read_b32 v108, a116
  v_accvgpr_read_b32 v109, a117
  v_accvgpr_read_b32 v110, a118
  v_accvgpr_read_b32 v111, a119
  v_pk_fma_f32 v[104:105], v[104:105], v[228:229], v[148:149]
  v_pk_fma_f32 v[106:107], v[106:107], v[230:231], v[150:151]
  v_pk_fma_f32 v[108:109], v[108:109], v[228:229], v[148:149]
  v_pk_fma_f32 v[110:111], v[110:111], v[230:231], v[150:151]
  v_cvt_pk_bf16_f32 v104, v104, v105
  v_cvt_pk_bf16_f32 v105, v106, v107
  v_cvt_pk_bf16_f32 v106, v108, v109
  v_cvt_pk_bf16_f32 v107, v110, v111
  ds_write_b128 v137, v[104:107] offset:49152
  buffer_load_dwordx4 v[244:247], v12, s[32:35], s10 offen offset:64
  v_accvgpr_read_b32 v112, a104
  v_accvgpr_read_b32 v113, a105
  v_accvgpr_read_b32 v114, a106
  v_accvgpr_read_b32 v115, a107
  v_accvgpr_read_b32 v116, a120
  v_accvgpr_read_b32 v117, a121
  v_accvgpr_read_b32 v118, a122
  v_accvgpr_read_b32 v119, a123
  v_pk_fma_f32 v[112:113], v[112:113], v[232:233], v[152:153]
  v_pk_fma_f32 v[114:115], v[114:115], v[234:235], v[154:155]
  v_pk_fma_f32 v[116:117], v[116:117], v[232:233], v[152:153]
  v_pk_fma_f32 v[118:119], v[118:119], v[234:235], v[154:155]
  v_cvt_pk_bf16_f32 v112, v112, v113
  v_cvt_pk_bf16_f32 v113, v114, v115
  v_cvt_pk_bf16_f32 v114, v116, v117
  v_cvt_pk_bf16_f32 v115, v118, v119
  ds_write_b128 v138, v[112:115] offset:49152
  buffer_load_dwordx4 v[248:251], v13, s[64:67], s28 offen
  v_accvgpr_read_b32 v120, a108
  v_accvgpr_read_b32 v121, a109
  v_accvgpr_read_b32 v122, a110
  v_accvgpr_read_b32 v123, a111
  v_accvgpr_read_b32 v124, a124
  v_accvgpr_read_b32 v125, a125
  v_accvgpr_read_b32 v126, a126
  v_accvgpr_read_b32 v127, a127
  v_pk_fma_f32 v[120:121], v[120:121], v[236:237], v[156:157]
  v_pk_fma_f32 v[122:123], v[122:123], v[238:239], v[158:159]
  v_pk_fma_f32 v[124:125], v[124:125], v[236:237], v[156:157]
  v_pk_fma_f32 v[126:127], v[126:127], v[238:239], v[158:159]
  v_cvt_pk_bf16_f32 v120, v120, v121
  v_cvt_pk_bf16_f32 v121, v122, v123
  v_cvt_pk_bf16_f32 v122, v124, v125
  v_cvt_pk_bf16_f32 v123, v126, v127
  ds_write_b128 v139, v[120:123] offset:49152
  buffer_load_dwordx4 v[252:255], v13, s[64:67], s28 offen offset:64
  s_waitcnt lgkmcnt(0)
  s_barrier
  ds_read_b64_tr_b16 a[0:1], v18
  ds_read_b64_tr_b16 a[2:3], v19
  ds_read_b64_tr_b16 a[16:17], v18 offset:16384
  ds_read_b64_tr_b16 a[18:19], v19 offset:16384
  ds_read_b64_tr_b16 a[4:5], v20
  ds_read_b64_tr_b16 a[6:7], v21
  ds_read_b64_tr_b16 a[20:21], v20 offset:16384
  ds_read_b64_tr_b16 a[22:23], v21 offset:16384
  ds_read_b64_tr_b16 a[8:9], v22
  ds_read_b64_tr_b16 a[10:11], v23
  ds_read_b64_tr_b16 a[24:25], v22 offset:16384
  ds_read_b64_tr_b16 a[26:27], v23 offset:16384
  ds_read_b64_tr_b16 a[12:13], v24
  ds_read_b64_tr_b16 a[14:15], v25
  ds_read_b64_tr_b16 a[28:29], v24 offset:16384
  ds_read_b64_tr_b16 a[30:31], v25 offset:16384
  s_waitcnt lgkmcnt(14)
  v_mfma_f32_16x16x32_bf16 v[128:131], a[128:131], a[0:3], 0
  s_waitcnt vmcnt(42) lgkmcnt(12)
  ds_read_b64_tr_b16 a[224:225], v2
  ds_read_b64_tr_b16 a[232:233], v3
  v_mfma_f32_16x16x32_bf16 v[128:131], a[132:135], a[16:19], v[128:131]
  s_waitcnt lgkmcnt(10)
  ds_read_b64_tr_b16 a[240:241], v4
  ds_read_b64_tr_b16 a[248:249], v5
  v_mfma_f32_16x16x32_bf16 v[132:135], a[132:135], a[20:23], 0
  ds_read_b64_tr_b16 a[32:33], v18 offset:32768
  ds_read_b64_tr_b16 a[34:35], v19 offset:32768
  v_mfma_f32_16x16x32_bf16 v[132:135], a[128:131], a[4:7], v[132:135]
  s_waitcnt lgkmcnt(12)
  ds_read_b64_tr_b16 a[48:49], v18 offset:49152
  ds_read_b64_tr_b16 a[50:51], v19 offset:49152
  v_mfma_f32_16x16x32_bf16 v[136:139], a[128:131], a[8:11], 0
  s_waitcnt vmcnt(40) lgkmcnt(12)
  ds_read_b64_tr_b16 a[226:227], v2 offset:2048
  ds_read_b64_tr_b16 a[234:235], v3 offset:2048
  v_mfma_f32_16x16x32_bf16 v[136:139], a[132:135], a[24:27], v[136:139]
  s_xor_b32 s73, s89, 0x60000
  s_waitcnt lgkmcnt(10)
  ds_read_b64_tr_b16 a[242:243], v4 offset:2048
  v_mfma_f32_16x16x32_bf16 v[140:143], a[132:135], a[28:31], 0
  s_add_u32 m0, s72, 0
  s_waitcnt lgkmcnt(7)
  ds_read_b64_tr_b16 a[250:251], v5 offset:2048
  v_mfma_f32_16x16x32_bf16 v[140:143], a[128:131], a[12:15], v[140:143]
  buffer_load_dwordx4 v28, s[56:59], s73 offen lds
  v_mfma_f32_16x16x32_bf16 v[108:111], a[136:139], a[12:15], 0
  ds_read_b64_tr_b16 a[36:37], v20 offset:32768
  ds_read_b64_tr_b16 a[38:39], v21 offset:32768
  v_mfma_f32_16x16x32_bf16 v[108:111], a[140:143], a[28:31], v[108:111]
  ds_read_b64_tr_b16 a[52:53], v20 offset:49152
  v_mfma_f32_16x16x32_bf16 v[104:107], a[140:143], a[24:27], 0
  ds_read_b64_tr_b16 a[54:55], v21 offset:49152
  v_mfma_f32_16x16x32_bf16 v[104:107], a[136:139], a[8:11], v[104:107]
  buffer_load_dwordx4 v29, s[56:59], s73 offen offset:1024 lds
  v_mfma_f32_16x16x32_bf16 v[100:103], a[136:139], a[4:7], 0
  s_waitcnt vmcnt(40)
  ds_read_b64_tr_b16 a[228:229], v2 offset:4096
  ds_read_b64_tr_b16 a[236:237], v3 offset:4096
  v_mfma_f32_16x16x32_bf16 v[100:103], a[140:143], a[20:23], v[100:103]
  ds_read_b64_tr_b16 a[244:245], v4 offset:4096
  v_mfma_f32_16x16x32_bf16 v[96:99], a[140:143], a[16:19], 0
  s_waitcnt lgkmcnt(7)
  ds_read_b64_tr_b16 a[252:253], v5 offset:4096
  v_mfma_f32_16x16x32_bf16 v[96:99], a[136:139], a[0:3], v[96:99]
  buffer_load_dwordx4 v30, s[56:59], s73 offen offset:2048 lds
  v_mfma_f32_16x16x32_bf16 v[144:147], a[144:147], a[0:3], 0
  ds_read_b64_tr_b16 a[40:41], v22 offset:32768
  ds_read_b64_tr_b16 a[42:43], v23 offset:32768
  v_mfma_f32_16x16x32_bf16 v[144:147], a[148:151], a[16:19], v[144:147]
  ds_read_b64_tr_b16 a[56:57], v22 offset:49152
  v_mfma_f32_16x16x32_bf16 v[148:151], a[148:151], a[20:23], 0
  ds_read_b64_tr_b16 a[58:59], v23 offset:49152
  v_mfma_f32_16x16x32_bf16 v[148:151], a[144:147], a[4:7], v[148:151]
  buffer_load_dwordx4 v31, s[56:59], s73 offen offset:3072 lds
  v_mfma_f32_16x16x32_bf16 v[152:155], a[144:147], a[8:11], 0
  s_waitcnt vmcnt(40)
  ds_read_b64_tr_b16 a[230:231], v2 offset:6144
  ds_read_b64_tr_b16 a[238:239], v3 offset:6144
  v_mfma_f32_16x16x32_bf16 v[152:155], a[148:151], a[24:27], v[152:155]
  s_xor_b32 s74, s89, 0x68000
  ds_read_b64_tr_b16 a[246:247], v4 offset:6144
  v_mfma_f32_16x16x32_bf16 v[156:159], a[148:151], a[28:31], 0
  s_add_u32 m0, s72, 0x1000
  s_waitcnt lgkmcnt(7)
  ds_read_b64_tr_b16 a[254:255], v5 offset:6144
  v_mfma_f32_16x16x32_bf16 v[156:159], a[144:147], a[12:15], v[156:159]
  buffer_load_dwordx4 v28, s[56:59], s74 offen lds
  v_mfma_f32_16x16x32_bf16 v[124:127], a[152:155], a[12:15], 0
  ds_read_b64_tr_b16 a[44:45], v24 offset:32768
  ds_read_b64_tr_b16 a[46:47], v25 offset:32768
  v_mfma_f32_16x16x32_bf16 v[124:127], a[156:159], a[28:31], v[124:127]
  ds_read_b64_tr_b16 a[60:61], v24 offset:49152
  v_mfma_f32_16x16x32_bf16 v[120:123], a[156:159], a[24:27], 0
  ds_read_b64_tr_b16 a[62:63], v25 offset:49152
  v_mfma_f32_16x16x32_bf16 v[120:123], a[152:155], a[8:11], v[120:123]
  buffer_load_dwordx4 v29, s[56:59], s74 offen offset:1024 lds
  v_mfma_f32_16x16x32_bf16 v[116:119], a[152:155], a[4:7], 0
  s_waitcnt vmcnt(40)
  ds_read_b64_tr_b16 a[128:129], v2 offset:8192
  ds_read_b64_tr_b16 a[136:137], v3 offset:8192
  v_mfma_f32_16x16x32_bf16 v[116:119], a[156:159], a[20:23], v[116:119]
  ds_read_b64_tr_b16 a[144:145], v4 offset:8192
  v_mfma_f32_16x16x32_bf16 v[112:115], a[156:159], a[16:19], 0
  s_waitcnt lgkmcnt(7)
  v_mfma_f32_16x16x32_bf16 v[112:115], a[152:155], a[0:3], v[112:115]
  buffer_load_dwordx4 v30, s[56:59], s74 offen offset:2048 lds
  v_mfma_f32_16x16x32_bf16 v[128:131], a[160:163], a[32:35], v[128:131]
  ds_read_b64_tr_b16 a[152:153], v5 offset:8192
  ds_read_b64_tr_b16 a[64:65], v18 offset:4096
  ds_read_b64_tr_b16 a[66:67], v19 offset:4096
  v_mfma_f32_16x16x32_bf16 v[128:131], a[164:167], a[48:51], v[128:131]
  ds_read_b64_tr_b16 a[80:81], v18 offset:20480
  v_mfma_f32_16x16x32_bf16 v[132:135], a[164:167], a[52:55], v[132:135]
  ds_read_b64_tr_b16 a[82:83], v19 offset:20480
  v_mfma_f32_16x16x32_bf16 v[132:135], a[160:163], a[36:39], v[132:135]
  buffer_load_dwordx4 v31, s[56:59], s74 offen offset:3072 lds
  v_mfma_f32_16x16x32_bf16 v[136:139], a[160:163], a[40:43], v[136:139]
  s_waitcnt vmcnt(40)
  ds_read_b64_tr_b16 a[130:131], v2 offset:10240
  ds_read_b64_tr_b16 a[138:139], v3 offset:10240
  v_mfma_f32_16x16x32_bf16 v[136:139], a[164:167], a[56:59], v[136:139]
  s_xor_b32 s73, s89, 0x70000
  s_waitcnt lgkmcnt(10)
  ds_read_b64_tr_b16 a[146:147], v4 offset:10240
  v_mfma_f32_16x16x32_bf16 v[140:143], a[164:167], a[60:63], v[140:143]
  s_add_u32 m0, s72, 0x2000
  s_waitcnt lgkmcnt(7)
  ds_read_b64_tr_b16 a[154:155], v5 offset:10240
  v_mfma_f32_16x16x32_bf16 v[140:143], a[160:163], a[44:47], v[140:143]
  buffer_load_dwordx4 v28, s[56:59], s73 offen lds
  v_mfma_f32_16x16x32_bf16 v[108:111], a[168:171], a[44:47], v[108:111]
  ds_read_b64_tr_b16 a[68:69], v20 offset:4096
  ds_read_b64_tr_b16 a[70:71], v21 offset:4096
  v_mfma_f32_16x16x32_bf16 v[108:111], a[172:175], a[60:63], v[108:111]
  ds_read_b64_tr_b16 a[84:85], v20 offset:20480
  v_lshlrev_b32 v11, 6, v1
  v_mfma_f32_16x16x32_bf16 v[104:107], a[172:175], a[56:59], v[104:107]
  ds_read_b64_tr_b16 a[86:87], v21 offset:20480
  v_mfma_f32_16x16x32_bf16 v[104:107], a[168:171], a[40:43], v[104:107]
  buffer_load_dwordx4 v29, s[56:59], s73 offen offset:1024 lds
  v_mfma_f32_16x16x32_bf16 v[100:103], a[168:171], a[36:39], v[100:103]
  s_waitcnt vmcnt(40)
  ds_read_b64_tr_b16 a[132:133], v2 offset:12288
  ds_read_b64_tr_b16 a[140:141], v3 offset:12288
  v_mfma_f32_16x16x32_bf16 v[100:103], a[172:175], a[52:55], v[100:103]
  ds_read_b64_tr_b16 a[148:149], v4 offset:12288
  v_xor_b32 v11, s70, v11
  v_mfma_f32_16x16x32_bf16 v[96:99], a[172:175], a[48:51], v[96:99]
  s_waitcnt lgkmcnt(7)
  ds_read_b64_tr_b16 a[156:157], v5 offset:12288
  v_mfma_f32_16x16x32_bf16 v[96:99], a[168:171], a[32:35], v[96:99]
  buffer_load_dwordx4 v30, s[56:59], s73 offen offset:2048 lds
  v_mfma_f32_16x16x32_bf16 v[144:147], a[176:179], a[32:35], v[144:147]
  ds_read_b64_tr_b16 a[72:73], v22 offset:4096
  ds_read_b64_tr_b16 a[74:75], v23 offset:4096
  v_mfma_f32_16x16x32_bf16 v[144:147], a[180:183], a[48:51], v[144:147]
  ds_read_b64_tr_b16 a[88:89], v22 offset:20480
  v_add_u32 v11, v11, v6
  v_mfma_f32_16x16x32_bf16 v[148:151], a[180:183], a[52:55], v[148:151]
  ds_read_b64_tr_b16 a[90:91], v23 offset:20480
  v_mfma_f32_16x16x32_bf16 v[148:151], a[176:179], a[36:39], v[148:151]
  buffer_load_dwordx4 v31, s[56:59], s73 offen offset:3072 lds
  v_mfma_f32_16x16x32_bf16 v[152:155], a[176:179], a[40:43], v[152:155]
  s_waitcnt vmcnt(40)
  ds_read_b64_tr_b16 a[134:135], v2 offset:14336
  ds_read_b64_tr_b16 a[142:143], v3 offset:14336
  v_mfma_f32_16x16x32_bf16 v[152:155], a[180:183], a[56:59], v[152:155]
  s_xor_b32 s74, s89, 0x78000
  ds_read_b64_tr_b16 a[150:151], v4 offset:14336
  v_cmp_gt_u32 vcc, 28, v6
  v_mfma_f32_16x16x32_bf16 v[156:159], a[180:183], a[60:63], v[156:159]
  s_add_u32 m0, s72, 0x3000
  s_waitcnt lgkmcnt(7)
  ds_read_b64_tr_b16 a[158:159], v5 offset:14336
  v_mfma_f32_16x16x32_bf16 v[156:159], a[176:179], a[44:47], v[156:159]
  buffer_load_dwordx4 v28, s[56:59], s74 offen lds
  v_mfma_f32_16x16x32_bf16 v[124:127], a[184:187], a[44:47], v[124:127]
  ds_read_b64_tr_b16 a[76:77], v24 offset:4096
  ds_read_b64_tr_b16 a[78:79], v25 offset:4096
  v_mfma_f32_16x16x32_bf16 v[124:127], a[188:191], a[60:63], v[124:127]
  ds_read_b64_tr_b16 a[92:93], v24 offset:20480
  v_mov_b32 v27, 0x10000000
  v_mfma_f32_16x16x32_bf16 v[120:123], a[188:191], a[56:59], v[120:123]
  ds_read_b64_tr_b16 a[94:95], v25 offset:20480
  v_mfma_f32_16x16x32_bf16 v[120:123], a[184:187], a[40:43], v[120:123]
  buffer_load_dwordx4 v29, s[56:59], s74 offen offset:1024 lds
  v_mfma_f32_16x16x32_bf16 v[116:119], a[184:187], a[36:39], v[116:119]
  s_waitcnt vmcnt(40)
  ds_read_b64_tr_b16 a[160:161], v2 offset:16384
  ds_read_b64_tr_b16 a[168:169], v3 offset:16384
  v_mfma_f32_16x16x32_bf16 v[116:119], a[188:191], a[52:55], v[116:119]
  ds_read_b64_tr_b16 a[176:177], v4 offset:16384
  v_cndmask_b32 v11, v27, v11, vcc
  v_mfma_f32_16x16x32_bf16 v[112:115], a[188:191], a[48:51], v[112:115]
L_p5654:
  s_cmp_eq_u32 s95, 1
  s_cbranch_scc1 L_wback
  s_waitcnt lgkmcnt(7)
  v_mfma_f32_16x16x32_bf16 v[112:115], a[184:187], a[32:35], v[112:115]
  buffer_load_dwordx4 v30, s[56:59], s74 offen offset:2048 lds
  v_mfma_f32_16x16x32_bf16 v[128:131], v[160:163], a[64:67], v[128:131]
  ds_read_b64_tr_b16 a[184:185], v5 offset:16384
  ds_read_b64_tr_b16 a[96:97], v18 offset:36864
  ds_read_b64_tr_b16 a[98:99], v19 offset:36864
  v_mfma_f32_16x16x32_bf16 v[128:131], v[164:167], a[80:83], v[128:131]
  ds_read_b64_tr_b16 a[112:113], v18 offset:53248
  v_cmp_gt_u32 vcc, 64, v6
  v_mfma_f32_16x16x32_bf16 v[132:135], v[164:167], a[84:87], v[132:135]
  ds_read_b64_tr_b16 a[114:115], v19 offset:53248
  v_mfma_f32_16x16x32_bf16 v[132:135], v[160:163], a[68:71], v[132:135]
  buffer_load_dwordx4 v31, s[56:59], s74 offen offset:3072 lds
  v_mfma_f32_16x16x32_bf16 v[136:139], v[160:163], a[72:75], v[136:139]
  s_waitcnt vmcnt(40)
  ds_read_b64_tr_b16 a[162:163], v2 offset:18432
  ds_read_b64_tr_b16 a[170:171], v3 offset:18432
  v_mfma_f32_16x16x32_bf16 v[136:139], v[164:167], a[88:91], v[136:139]
  s_xor_b32 s73, s89, 0x70080
  s_waitcnt lgkmcnt(10)
  ds_read_b64_tr_b16 a[178:179], v4 offset:18432
  v_mov_b32 v10, 0
  v_mfma_f32_16x16x32_bf16 v[140:143], v[164:167], a[92:95], v[140:143]
  s_add_u32 m0, s72, 0x4000
  s_waitcnt lgkmcnt(7)
  ds_read_b64_tr_b16 a[186:187], v5 offset:18432
  v_mfma_f32_16x16x32_bf16 v[140:143], v[160:163], a[76:79], v[140:143]
  buffer_load_dwordx4 v28, s[56:59], s73 offen lds
  v_mfma_f32_16x16x32_bf16 v[108:111], v[168:171], a[76:79], v[108:111]
  ds_read_b64_tr_b16 a[100:101], v20 offset:36864
  ds_read_b64_tr_b16 a[102:103], v21 offset:36864
  v_mfma_f32_16x16x32_bf16 v[108:111], v[172:175], a[92:95], v[108:111]
  ds_read_b64_tr_b16 a[116:117], v20 offset:53248
  v_cndmask_b32 v26, v27, v6, vcc
  v_mfma_f32_16x16x32_bf16 v[104:107], v[172:175], a[88:91], v[104:107]
  ds_read_b64_tr_b16 a[118:119], v21 offset:53248
  v_mfma_f32_16x16x32_bf16 v[104:107], v[168:171], a[72:75], v[104:107]
  buffer_load_dwordx4 v29, s[56:59], s73 offen offset:1024 lds
  v_mfma_f32_16x16x32_bf16 v[100:103], v[168:171], a[68:71], v[100:103]
  s_waitcnt vmcnt(40)
  ds_read_b64_tr_b16 a[164:165], v2 offset:20480
  ds_read_b64_tr_b16 a[172:173], v3 offset:20480
  v_mfma_f32_16x16x32_bf16 v[100:103], v[172:175], a[84:87], v[100:103]
  ds_read_b64_tr_b16 a[180:181], v4 offset:20480
  v_mfma_f32_16x16x32_bf16 v[96:99], v[172:175], a[80:83], v[96:99]
  s_waitcnt lgkmcnt(7)
  ds_read_b64_tr_b16 a[188:189], v5 offset:20480
  v_mfma_f32_16x16x32_bf16 v[96:99], v[168:171], a[64:67], v[96:99]
  buffer_load_dwordx4 v30, s[56:59], s73 offen offset:2048 lds
  v_mfma_f32_16x16x32_bf16 v[144:147], v[176:179], a[64:67], v[144:147]
  ds_read_b64_tr_b16 a[104:105], v22 offset:36864
  ds_read_b64_tr_b16 a[106:107], v23 offset:36864
  v_mfma_f32_16x16x32_bf16 v[144:147], v[180:183], a[80:83], v[144:147]
  ds_read_b64_tr_b16 a[120:121], v22 offset:53248
  v_mfma_f32_16x16x32_bf16 v[148:151], v[180:183], a[84:87], v[148:151]
  ds_read_b64_tr_b16 a[122:123], v23 offset:53248
  v_mfma_f32_16x16x32_bf16 v[148:151], v[176:179], a[68:71], v[148:151]
  buffer_load_dwordx4 v31, s[56:59], s73 offen offset:3072 lds
  v_mfma_f32_16x16x32_bf16 v[152:155], v[176:179], a[72:75], v[152:155]
  s_waitcnt vmcnt(40)
  ds_read_b64_tr_b16 a[166:167], v2 offset:22528
  ds_read_b64_tr_b16 a[174:175], v3 offset:22528
  v_mfma_f32_16x16x32_bf16 v[152:155], v[180:183], a[88:91], v[152:155]
  s_xor_b32 s74, s89, 0x78080
  ds_read_b64_tr_b16 a[182:183], v4 offset:22528
  v_mfma_f32_16x16x32_bf16 v[156:159], v[180:183], a[92:95], v[156:159]
  s_add_u32 m0, s72, 0x5000
  s_waitcnt lgkmcnt(7)
  ds_read_b64_tr_b16 a[190:191], v5 offset:22528
  v_mfma_f32_16x16x32_bf16 v[156:159], v[176:179], a[76:79], v[156:159]
  buffer_load_dwordx4 v28, s[56:59], s74 offen lds
  v_mfma_f32_16x16x32_bf16 v[124:127], v[184:187], a[76:79], v[124:127]
  ds_read_b64_tr_b16 a[108:109], v24 offset:36864
  ds_read_b64_tr_b16 a[110:111], v25 offset:36864
  v_mfma_f32_16x16x32_bf16 v[124:127], v[188:191], a[92:95], v[124:127]
  ds_read_b64_tr_b16 a[124:125], v24 offset:53248
  v_mfma_f32_16x16x32_bf16 v[120:123], v[188:191], a[88:91], v[120:123]
  ds_read_b64_tr_b16 a[126:127], v25 offset:53248
  v_mfma_f32_16x16x32_bf16 v[120:123], v[184:187], a[72:75], v[120:123]
  buffer_load_dwordx4 v29, s[56:59], s74 offen offset:1024 lds
  v_mfma_f32_16x16x32_bf16 v[116:119], v[184:187], a[68:71], v[116:119]
  s_waitcnt vmcnt(20)
  ds_read_b64_tr_b16 a[192:193], v2
  ds_read_b64_tr_b16 a[200:201], v3
  v_mfma_f32_16x16x32_bf16 v[116:119], v[188:191], a[84:87], v[116:119]
  ds_read_b64_tr_b16 a[208:209], v4
  v_mfma_f32_16x16x32_bf16 v[112:115], v[188:191], a[80:83], v[112:115]
  s_waitcnt lgkmcnt(7)
  v_mfma_f32_16x16x32_bf16 v[112:115], v[184:187], a[64:67], v[112:115]
  buffer_load_dwordx4 v30, s[56:59], s74 offen offset:2048 lds
  v_mfma_f32_16x16x32_bf16 v[128:131], a[224:227], a[96:99], v[128:131]
  ds_read_b64_tr_b16 a[216:217], v5
  ds_read_b64_tr_b16 a[0:1], v18 offset:8192
  ds_read_b64_tr_b16 a[2:3], v19 offset:8192
  v_mfma_f32_16x16x32_bf16 v[128:131], a[228:231], a[112:115], v[128:131]
  ds_read_b64_tr_b16 a[16:17], v18 offset:24576
  v_mfma_f32_16x16x32_bf16 v[132:135], a[228:231], a[116:119], v[132:135]
  ds_read_b64_tr_b16 a[18:19], v19 offset:24576
  v_mfma_f32_16x16x32_bf16 v[132:135], a[224:227], a[100:103], v[132:135]
  buffer_load_dwordx4 v31, s[56:59], s74 offen offset:3072 lds
  v_mfma_f32_16x16x32_bf16 v[136:139], a[224:227], a[104:107], v[136:139]
  s_waitcnt vmcnt(20)
  ds_read_b64_tr_b16 a[194:195], v2 offset:2048
  ds_read_b64_tr_b16 a[202:203], v3 offset:2048
  v_mfma_f32_16x16x32_bf16 v[136:139], a[228:231], a[120:123], v[136:139]
  s_xor_b32 s73, s89, 0x60080
  s_waitcnt lgkmcnt(10)
  ds_read_b64_tr_b16 a[210:211], v4 offset:2048
  v_mfma_f32_16x16x32_bf16 v[140:143], a[228:231], a[124:127], v[140:143]
  s_add_u32 m0, s72, 0
  s_waitcnt lgkmcnt(7)
  ds_read_b64_tr_b16 a[218:219], v5 offset:2048
  v_mfma_f32_16x16x32_bf16 v[140:143], a[224:227], a[108:111], v[140:143]
  buffer_load_dwordx4 v28, s[56:59], s73 offen lds
  v_mfma_f32_16x16x32_bf16 v[108:111], a[232:235], a[108:111], v[108:111]
  ds_read_b64_tr_b16 a[4:5], v20 offset:8192
  ds_read_b64_tr_b16 a[6:7], v21 offset:8192
  v_mfma_f32_16x16x32_bf16 v[108:111], a[236:239], a[124:127], v[108:111]
  ds_read_b64_tr_b16 a[20:21], v20 offset:24576
  v_mfma_f32_16x16x32_bf16 v[104:107], a[236:239], a[120:123], v[104:107]
  ds_read_b64_tr_b16 a[22:23], v21 offset:24576
  v_mfma_f32_16x16x32_bf16 v[104:107], a[232:235], a[104:107], v[104:107]
  buffer_load_dwordx4 v29, s[56:59], s73 offen offset:1024 lds
  v_mfma_f32_16x16x32_bf16 v[100:103], a[232:235], a[100:103], v[100:103]
  s_waitcnt vmcnt(20)
  ds_read_b64_tr_b16 a[196:197], v2 offset:4096
  ds_read_b64_tr_b16 a[204:205], v3 offset:4096
  v_mfma_f32_16x16x32_bf16 v[100:103], a[236:239], a[116:119], v[100:103]
  ds_read_b64_tr_b16 a[212:213], v4 offset:4096
  v_mfma_f32_16x16x32_bf16 v[96:99], a[236:239], a[112:115], v[96:99]
  s_waitcnt lgkmcnt(7)
  ds_read_b64_tr_b16 a[220:221], v5 offset:4096
  v_mfma_f32_16x16x32_bf16 v[96:99], a[232:235], a[96:99], v[96:99]
  buffer_load_dwordx4 v30, s[56:59], s73 offen offset:2048 lds
  v_mfma_f32_16x16x32_bf16 v[144:147], a[240:243], a[96:99], v[144:147]
  ds_read_b64_tr_b16 a[8:9], v22 offset:8192
  ds_read_b64_tr_b16 a[10:11], v23 offset:8192
  v_mfma_f32_16x16x32_bf16 v[144:147], a[244:247], a[112:115], v[144:147]
  ds_read_b64_tr_b16 a[24:25], v22 offset:24576
  v_mfma_f32_16x16x32_bf16 v[148:151], a[244:247], a[116:119], v[148:151]
  ds_read_b64_tr_b16 a[26:27], v23 offset:24576
  v_mfma_f32_16x16x32_bf16 v[148:151], a[240:243], a[100:103], v[148:151]
  buffer_load_dwordx4 v31, s[56:59], s73 offen offset:3072 lds
  v_mfma_f32_16x16x32_bf16 v[152:155], a[240:243], a[104:107], v[152:155]
  s_waitcnt vmcnt(20)
  ds_read_b64_tr_b16 a[198:199], v2 offset:6144
  ds_read_b64_tr_b16 a[206:207], v3 offset:6144
  v_mfma_f32_16x16x32_bf16 v[152:155], a[244:247], a[120:123], v[152:155]
  s_xor_b32 s74, s89, 0x68080
  ds_read_b64_tr_b16 a[214:215], v4 offset:6144
  v_mfma_f32_16x16x32_bf16 v[156:159], a[244:247], a[124:127], v[156:159]
  s_add_u32 m0, s72, 0x1000
  s_waitcnt lgkmcnt(7)
  ds_read_b64_tr_b16 a[222:223], v5 offset:6144
  v_mfma_f32_16x16x32_bf16 v[156:159], a[240:243], a[108:111], v[156:159]
  buffer_load_dwordx4 v28, s[56:59], s74 offen lds
  v_mfma_f32_16x16x32_bf16 v[124:127], a[248:251], a[108:111], v[124:127]
  ds_read_b64_tr_b16 a[12:13], v24 offset:8192
  ds_read_b64_tr_b16 a[14:15], v25 offset:8192
  v_mfma_f32_16x16x32_bf16 v[124:127], a[252:255], a[124:127], v[124:127]
  ds_read_b64_tr_b16 a[28:29], v24 offset:24576
  v_mfma_f32_16x16x32_bf16 v[120:123], a[252:255], a[120:123], v[120:123]
  ds_read_b64_tr_b16 a[30:31], v25 offset:24576
  v_mfma_f32_16x16x32_bf16 v[120:123], a[248:251], a[104:107], v[120:123]
  buffer_load_dwordx4 v29, s[56:59], s74 offen offset:1024 lds
  v_mfma_f32_16x16x32_bf16 v[116:119], a[248:251], a[100:103], v[116:119]
  s_waitcnt vmcnt(20)
  ds_read_b64_tr_b16 a[224:225], v2 offset:8192
  ds_read_b64_tr_b16 a[232:233], v3 offset:8192
  v_mfma_f32_16x16x32_bf16 v[116:119], a[252:255], a[116:119], v[116:119]
  ds_read_b64_tr_b16 a[240:241], v4 offset:8192
  v_mfma_f32_16x16x32_bf16 v[112:115], a[252:255], a[112:115], v[112:115]
  s_waitcnt lgkmcnt(7)
  v_mfma_f32_16x16x32_bf16 v[112:115], a[248:251], a[96:99], v[112:115]
  buffer_load_dwordx4 v30, s[56:59], s74 offen offset:2048 lds
  v_mfma_f32_16x16x32_bf16 v[128:131], a[128:131], a[0:3], v[128:131]
  ds_read_b64_tr_b16 a[248:249], v5 offset:8192
  ds_read_b64_tr_b16 a[32:33], v18 offset:40960
  ds_read_b64_tr_b16 a[34:35], v19 offset:40960
  v_mfma_f32_16x16x32_bf16 v[128:131], a[132:135], a[16:19], v[128:131]
  ds_read_b64_tr_b16 a[48:49], v18 offset:57344
  v_mfma_f32_16x16x32_bf16 v[132:135], a[132:135], a[20:23], v[132:135]
  ds_read_b64_tr_b16 a[50:51], v19 offset:57344
  v_mfma_f32_16x16x32_bf16 v[132:135], a[128:131], a[4:7], v[132:135]
  buffer_load_dwordx4 v31, s[56:59], s74 offen offset:3072 lds
  v_mfma_f32_16x16x32_bf16 v[136:139], a[128:131], a[8:11], v[136:139]
  s_waitcnt vmcnt(20)
  ds_read_b64_tr_b16 a[226:227], v2 offset:10240
  ds_read_b64_tr_b16 a[234:235], v3 offset:10240
  v_mfma_f32_16x16x32_bf16 v[136:139], a[132:135], a[24:27], v[136:139]
  s_xor_b32 s73, s89, 0x50080
  s_waitcnt lgkmcnt(10)
  ds_read_b64_tr_b16 a[242:243], v4 offset:10240
  v_mfma_f32_16x16x32_bf16 v[140:143], a[132:135], a[28:31], v[140:143]
  s_add_u32 m0, s72, 0x2000
  s_waitcnt lgkmcnt(7)
  ds_read_b64_tr_b16 a[250:251], v5 offset:10240
  v_mfma_f32_16x16x32_bf16 v[140:143], a[128:131], a[12:15], v[140:143]
  buffer_load_dwordx4 v28, s[56:59], s73 offen lds
  v_mfma_f32_16x16x32_bf16 v[108:111], a[136:139], a[12:15], v[108:111]
  ds_read_b64_tr_b16 a[36:37], v20 offset:40960
  ds_read_b64_tr_b16 a[38:39], v21 offset:40960
  v_mfma_f32_16x16x32_bf16 v[108:111], a[140:143], a[28:31], v[108:111]
  ds_read_b64_tr_b16 a[52:53], v20 offset:57344
  v_mfma_f32_16x16x32_bf16 v[104:107], a[140:143], a[24:27], v[104:107]
  ds_read_b64_tr_b16 a[54:55], v21 offset:57344
  v_mfma_f32_16x16x32_bf16 v[104:107], a[136:139], a[8:11], v[104:107]
  buffer_load_dwordx4 v29, s[56:59], s73 offen offset:1024 lds
  v_mfma_f32_16x16x32_bf16 v[100:103], a[136:139], a[4:7], v[100:103]
  s_waitcnt vmcnt(20)
  ds_read_b64_tr_b16 a[228:229], v2 offset:12288
  ds_read_b64_tr_b16 a[236:237], v3 offset:12288
  v_mfma_f32_16x16x32_bf16 v[100:103], a[140:143], a[20:23], v[100:103]
  ds_read_b64_tr_b16 a[244:245], v4 offset:12288
  v_mfma_f32_16x16x32_bf16 v[96:99], a[140:143], a[16:19], v[96:99]
  s_waitcnt lgkmcnt(7)
  ds_read_b64_tr_b16 a[252:253], v5 offset:12288
  v_mfma_f32_16x16x32_bf16 v[96:99], a[136:139], a[0:3], v[96:99]
  buffer_load_dwordx4 v30, s[56:59], s73 offen offset:2048 lds
  v_mfma_f32_16x16x32_bf16 v[144:147], a[144:147], a[0:3], v[144:147]
  ds_read_b64_tr_b16 a[40:41], v22 offset:40960
  ds_read_b64_tr_b16 a[42:43], v23 offset:40960
  v_mfma_f32_16x16x32_bf16 v[144:147], a[148:151], a[16:19], v[144:147]
  ds_read_b64_tr_b16 a[56:57], v22 offset:57344
  v_mfma_f32_16x16x32_bf16 v[148:151], a[148:151], a[20:23], v[148:151]
  ds_read_b64_tr_b16 a[58:59], v23 offset:57344
  v_mfma_f32_16x16x32_bf16 v[148:151], a[144:147], a[4:7], v[148:151]
  buffer_load_dwordx4 v31, s[56:59], s73 offen offset:3072 lds
  v_mfma_f32_16x16x32_bf16 v[152:155], a[144:147], a[8:11], v[152:155]
  s_waitcnt vmcnt(20)
  ds_read_b64_tr_b16 a[230:231], v2 offset:14336
  ds_read_b64_tr_b16 a[238:239], v3 offset:14336
  v_mfma_f32_16x16x32_bf16 v[152:155], a[148:151], a[24:27], v[152:155]
  s_xor_b32 s74, s89, 0x58080
  ds_read_b64_tr_b16 a[246:247], v4 offset:14336
  v_mfma_f32_16x16x32_bf16 v[156:159], a[148:151], a[28:31], v[156:159]
  s_add_u32 m0, s72, 0x3000
  s_waitcnt lgkmcnt(7)
  ds_read_b64_tr_b16 a[254:255], v5 offset:14336
  v_mfma_f32_16x16x32_bf16 v[156:159], a[144:147], a[12:15], v[156:159]
  buffer_load_dwordx4 v28, s[56:59], s74 offen lds
  v_mfma_f32_16x16x32_bf16 v[124:127], a[152:155], a[12:15], v[124:127]
  ds_read_b64_tr_b16 a[44:45], v24 offset:40960
  ds_read_b64_tr_b16 a[46:47], v25 offset:40960
  v_mfma_f32_16x16x32_bf16 v[124:127], a[156:159], a[28:31], v[124:127]
  ds_read_b64_tr_b16 a[60:61], v24 offset:57344
  v_mfma_f32_16x16x32_bf16 v[120:123], a[156:159], a[24:27], v[120:123]
  ds_read_b64_tr_b16 a[62:63], v25 offset:57344
  v_mfma_f32_16x16x32_bf16 v[120:123], a[152:155], a[8:11], v[120:123]
  buffer_load_dwordx4 v29, s[56:59], s74 offen offset:1024 lds
  v_mfma_f32_16x16x32_bf16 v[116:119], a[152:155], a[4:7], v[116:119]
  s_waitcnt vmcnt(20)
  ds_read_b64_tr_b16 a[128:129], v2 offset:16384
  ds_read_b64_tr_b16 a[136:137], v3 offset:16384
  v_mfma_f32_16x16x32_bf16 v[116:119], a[156:159], a[20:23], v[116:119]
  ds_read_b64_tr_b16 a[144:145], v4 offset:16384
  v_mfma_f32_16x16x32_bf16 v[112:115], a[156:159], a[16:19], v[112:115]
  s_waitcnt lgkmcnt(7)
  v_mfma_f32_16x16x32_bf16 v[112:115], a[152:155], a[0:3], v[112:115]
  buffer_load_dwordx4 v30, s[56:59], s74 offen offset:2048 lds
  v_mfma_f32_16x16x32_bf16 v[128:131], a[160:163], a[32:35], v[128:131]
  ds_read_b64_tr_b16 a[152:153], v5 offset:16384
  ds_read_b64_tr_b16 a[64:65], v18 offset:12288
  ds_read_b64_tr_b16 a[66:67], v19 offset:12288
  v_mfma_f32_16x16x32_bf16 v[128:131], a[164:167], a[48:51], v[128:131]
  ds_read_b64_tr_b16 a[80:81], v18 offset:28672
  v_mfma_f32_16x16x32_bf16 v[132:135], a[164:167], a[52:55], v[132:135]
  ds_read_b64_tr_b16 a[82:83], v19 offset:28672
  v_mfma_f32_16x16x32_bf16 v[132:135], a[160:163], a[36:39], v[132:135]
  buffer_load_dwordx4 v31, s[56:59], s74 offen offset:3072 lds
  v_mfma_f32_16x16x32_bf16 v[136:139], a[160:163], a[40:43], v[136:139]
  s_waitcnt vmcnt(20)
  ds_read_b64_tr_b16 a[130:131], v2 offset:18432
  ds_read_b64_tr_b16 a[138:139], v3 offset:18432
  v_mfma_f32_16x16x32_bf16 v[136:139], a[164:167], a[56:59], v[136:139]
  s_xor_b32 s73, s89, 0x40080
  s_waitcnt lgkmcnt(10)
  ds_read_b64_tr_b16 a[146:147], v4 offset:18432
  v_mfma_f32_16x16x32_bf16 v[140:143], a[164:167], a[60:63], v[140:143]
  s_add_u32 m0, s72, 0x4000
  s_waitcnt lgkmcnt(7)
  ds_read_b64_tr_b16 a[154:155], v5 offset:18432
  v_mfma_f32_16x16x32_bf16 v[140:143], a[160:163], a[44:47], v[140:143]
  buffer_load_dwordx4 v28, s[56:59], s73 offen lds
  v_mfma_f32_16x16x32_bf16 v[108:111], a[168:171], a[44:47], v[108:111]
  ds_read_b64_tr_b16 a[68:69], v20 offset:12288
  ds_read_b64_tr_b16 a[70:71], v21 offset:12288
  v_mfma_f32_16x16x32_bf16 v[108:111], a[172:175], a[60:63], v[108:111]
  ds_read_b64_tr_b16 a[84:85], v20 offset:28672
  v_mfma_f32_16x16x32_bf16 v[104:107], a[172:175], a[56:59], v[104:107]
  ds_read_b64_tr_b16 a[86:87], v21 offset:28672
  v_mfma_f32_16x16x32_bf16 v[104:107], a[168:171], a[40:43], v[104:107]
  buffer_load_dwordx4 v29, s[56:59], s73 offen offset:1024 lds
  v_mfma_f32_16x16x32_bf16 v[100:103], a[168:171], a[36:39], v[100:103]
  s_waitcnt vmcnt(20)
  ds_read_b64_tr_b16 a[132:133], v2 offset:20480
  ds_read_b64_tr_b16 a[140:141], v3 offset:20480
  v_mfma_f32_16x16x32_bf16 v[100:103], a[172:175], a[52:55], v[100:103]
  ds_read_b64_tr_b16 a[148:149], v4 offset:20480
  v_mfma_f32_16x16x32_bf16 v[96:99], a[172:175], a[48:51], v[96:99]
  s_waitcnt lgkmcnt(7)
  ds_read_b64_tr_b16 a[156:157], v5 offset:20480
  v_mfma_f32_16x16x32_bf16 v[96:99], a[168:171], a[32:35], v[96:99]
  buffer_load_dwordx4 v30, s[56:59], s73 offen offset:2048 lds
  v_mfma_f32_16x16x32_bf16 v[144:147], a[176:179], a[32:35], v[144:147]
  ds_read_b64_tr_b16 a[72:73], v22 offset:12288
  ds_read_b64_tr_b16 a[74:75], v23 offset:12288
  v_mfma_f32_16x16x32_bf16 v[144:147], a[180:183], a[48:51], v[144:147]
  ds_read_b64_tr_b16 a[88:89], v22 offset:28672
  v_mfma_f32_16x16x32_bf16 v[148:151], a[180:183], a[52:55], v[148:151]
  ds_read_b64_tr_b16 a[90:91], v23 offset:28672
  v_mfma_f32_16x16x32_bf16 v[148:151], a[176:179], a[36:39], v[148:151]
  buffer_load_dwordx4 v31, s[56:59], s73 offen offset:3072 lds
  v_mfma_f32_16x16x32_bf16 v[152:155], a[176:179], a[40:43], v[152:155]
  s_waitcnt vmcnt(20)
  ds_read_b64_tr_b16 a[134:135], v2 offset:22528
  ds_read_b64_tr_b16 a[142:143], v3 offset:22528
  v_mfma_f32_16x16x32_bf16 v[152:155], a[180:183], a[56:59], v[152:155]
  s_xor_b32 s74, s89, 0x48080
  ds_read_b64_tr_b16 a[150:151], v4 offset:22528
  v_mfma_f32_16x16x32_bf16 v[156:159], a[180:183], a[60:63], v[156:159]
  s_add_u32 m0, s72, 0x5000
  s_waitcnt lgkmcnt(7)
  ds_read_b64_tr_b16 a[158:159], v5 offset:22528
  v_mfma_f32_16x16x32_bf16 v[156:159], a[176:179], a[44:47], v[156:159]
  buffer_load_dwordx4 v28, s[56:59], s74 offen lds
  v_mfma_f32_16x16x32_bf16 v[124:127], a[184:187], a[44:47], v[124:127]
  ds_read_b64_tr_b16 a[76:77], v24 offset:12288
  ds_read_b64_tr_b16 a[78:79], v25 offset:12288
  v_mfma_f32_16x16x32_bf16 v[124:127], a[188:191], a[60:63], v[124:127]
  ds_read_b64_tr_b16 a[92:93], v24 offset:28672
  v_mfma_f32_16x16x32_bf16 v[120:123], a[188:191], a[56:59], v[120:123]
  ds_read_b64_tr_b16 a[94:95], v25 offset:28672
  v_mfma_f32_16x16x32_bf16 v[120:123], a[184:187], a[40:43], v[120:123]
  buffer_load_dwordx4 v29, s[56:59], s74 offen offset:1024 lds
  v_mfma_f32_16x16x32_bf16 v[116:119], a[184:187], a[36:39], v[116:119]
  s_waitcnt vmcnt(20)
  ds_read_b64_tr_b16 a[160:161], v2
  ds_read_b64_tr_b16 a[168:169], v3
  v_mfma_f32_16x16x32_bf16 v[116:119], a[188:191], a[52:55], v[116:119]
  ds_read_b64_tr_b16 a[176:177], v4
  v_mfma_f32_16x16x32_bf16 v[112:115], a[188:191], a[48:51], v[112:115]
  s_waitcnt lgkmcnt(7)
  v_mfma_f32_16x16x32_bf16 v[112:115], a[184:187], a[32:35], v[112:115]
  buffer_load_dwordx4 v30, s[56:59], s74 offen offset:2048 lds
  v_mfma_f32_16x16x32_bf16 v[128:131], a[192:195], a[64:67], v[128:131]
  ds_read_b64_tr_b16 a[184:185], v5
  ds_read_b64_tr_b16 a[96:97], v18 offset:45056
  ds_read_b64_tr_b16 a[98:99], v19 offset:45056
  v_mfma_f32_16x16x32_bf16 v[128:131], a[196:199], a[80:83], v[128:131]
  ds_read_b64_tr_b16 a[112:113], v18 offset:61440
  v_mfma_f32_16x16x32_bf16 v[132:135], a[196:199], a[84:87], v[132:135]
  ds_read_b64_tr_b16 a[114:115], v19 offset:61440
  v_mfma_f32_16x16x32_bf16 v[132:135], a[192:195], a[68:71], v[132:135]
  buffer_load_dwordx4 v31, s[56:59], s74 offen offset:3072 lds
  v_mfma_f32_16x16x32_bf16 v[136:139], a[192:195], a[72:75], v[136:139]
  s_waitcnt vmcnt(20)
  ds_read_b64_tr_b16 a[162:163], v2 offset:2048
  ds_read_b64_tr_b16 a[170:171], v3 offset:2048
  v_mfma_f32_16x16x32_bf16 v[136:139], a[196:199], a[88:91], v[136:139]
  s_xor_b32 s73, s89, 0x30080
  s_waitcnt lgkmcnt(10)
  ds_read_b64_tr_b16 a[178:179], v4 offset:2048
  v_mfma_f32_16x16x32_bf16 v[140:143], a[196:199], a[92:95], v[140:143]
  s_add_u32 m0, s72, 0
  s_waitcnt lgkmcnt(7)
  ds_read_b64_tr_b16 a[186:187], v5 offset:2048
  v_mfma_f32_16x16x32_bf16 v[140:143], a[192:195], a[76:79], v[140:143]
  buffer_load_dwordx4 v28, s[56:59], s73 offen lds
  v_mfma_f32_16x16x32_bf16 v[108:111], a[200:203], a[76:79], v[108:111]
  ds_read_b64_tr_b16 a[100:101], v20 offset:45056
  ds_read_b64_tr_b16 a[102:103], v21 offset:45056
  v_mfma_f32_16x16x32_bf16 v[108:111], a[204:207], a[92:95], v[108:111]
  ds_read_b64_tr_b16 a[116:117], v20 offset:61440
  v_mfma_f32_16x16x32_bf16 v[104:107], a[204:207], a[88:91], v[104:107]
  ds_read_b64_tr_b16 a[118:119], v21 offset:61440
  v_mfma_f32_16x16x32_bf16 v[104:107], a[200:203], a[72:75], v[104:107]
  buffer_load_dwordx4 v29, s[56:59], s73 offen offset:1024 lds
  v_mfma_f32_16x16x32_bf16 v[100:103], a[200:203], a[68:71], v[100:103]
  s_waitcnt vmcnt(20)
  ds_read_b64_tr_b16 a[164:165], v2 offset:4096
  ds_read_b64_tr_b16 a[172:173], v3 offset:4096
  v_mfma_f32_16x16x32_bf16 v[100:103], a[204:207], a[84:87], v[100:103]
  ds_read_b64_tr_b16 a[180:181], v4 offset:4096
  v_mfma_f32_16x16x32_bf16 v[96:99], a[204:207], a[80:83], v[96:99]
  s_waitcnt lgkmcnt(7)
  ds_read_b64_tr_b16 a[188:189], v5 offset:4096
  v_mfma_f32_16x16x32_bf16 v[96:99], a[200:203], a[64:67], v[96:99]
  buffer_load_dwordx4 v30, s[56:59], s73 offen offset:2048 lds
  v_mfma_f32_16x16x32_bf16 v[144:147], a[208:211], a[64:67], v[144:147]
  ds_read_b64_tr_b16 a[104:105], v22 offset:45056
  ds_read_b64_tr_b16 a[106:107], v23 offset:45056
  v_mfma_f32_16x16x32_bf16 v[144:147], a[212:215], a[80:83], v[144:147]
  ds_read_b64_tr_b16 a[120:121], v22 offset:61440
  v_mfma_f32_16x16x32_bf16 v[148:151], a[212:215], a[84:87], v[148:151]
  ds_read_b64_tr_b16 a[122:123], v23 offset:61440
  v_mfma_f32_16x16x32_bf16 v[148:151], a[208:211], a[68:71], v[148:151]
  buffer_load_dwordx4 v31, s[56:59], s73 offen offset:3072 lds
  v_mfma_f32_16x16x32_bf16 v[152:155], a[208:211], a[72:75], v[152:155]
  s_waitcnt vmcnt(20)
  ds_read_b64_tr_b16 a[166:167], v2 offset:6144
  ds_read_b64_tr_b16 a[174:175], v3 offset:6144
  v_mfma_f32_16x16x32_bf16 v[152:155], a[212:215], a[88:91], v[152:155]
  s_xor_b32 s74, s89, 0x38080
  ds_read_b64_tr_b16 a[182:183], v4 offset:6144
  v_mfma_f32_16x16x32_bf16 v[156:159], a[212:215], a[92:95], v[156:159]
  s_add_u32 m0, s72, 0x1000
  s_waitcnt lgkmcnt(7)
  ds_read_b64_tr_b16 a[190:191], v5 offset:6144
  v_mfma_f32_16x16x32_bf16 v[156:159], a[208:211], a[76:79], v[156:159]
  buffer_load_dwordx4 v28, s[56:59], s74 offen lds
  v_mfma_f32_16x16x32_bf16 v[124:127], a[216:219], a[76:79], v[124:127]
  ds_read_b64_tr_b16 a[108:109], v24 offset:45056
  ds_read_b64_tr_b16 a[110:111], v25 offset:45056
  v_mfma_f32_16x16x32_bf16 v[124:127], a[220:223], a[92:95], v[124:127]
  ds_read_b64_tr_b16 a[124:125], v24 offset:61440
  v_mfma_f32_16x16x32_bf16 v[120:123], a[220:223], a[88:91], v[120:123]
  ds_read_b64_tr_b16 a[126:127], v25 offset:61440
  v_mfma_f32_16x16x32_bf16 v[120:123], a[216:219], a[72:75], v[120:123]
  buffer_load_dwordx4 v29, s[56:59], s74 offen offset:1024 lds
  v_mfma_f32_16x16x32_bf16 v[116:119], a[216:219], a[68:71], v[116:119]
  s_waitcnt vmcnt(20)
  ds_read_b64_tr_b16 a[192:193], v2 offset:8192
  v_mfma_f32_16x16x32_bf16 v[116:119], a[220:223], a[84:87], v[116:119]
  ds_read_b64_tr_b16 a[200:201], v3 offset:8192
  v_mfma_f32_16x16x32_bf16 v[112:115], a[220:223], a[80:83], v[112:115]
  s_waitcnt lgkmcnt(6)
  v_mfma_f32_16x16x32_bf16 v[112:115], a[216:219], a[64:67], v[112:115]
  buffer_load_dwordx4 v30, s[56:59], s74 offen offset:2048 lds
  v_mfma_f32_16x16x32_bf16 v[128:131], a[224:227], a[96:99], v[128:131]
  ds_read_b64_tr_b16 a[208:209], v4 offset:8192
  v_mfma_f32_16x16x32_bf16 v[128:131], a[228:231], a[112:115], v[128:131]
  ds_read_b64_tr_b16 a[216:217], v5 offset:8192
  v_mfma_f32_16x16x32_bf16 v[132:135], a[228:231], a[116:119], v[132:135]
  v_mfma_f32_16x16x32_bf16 v[132:135], a[224:227], a[100:103], v[132:135]
  buffer_load_dwordx4 v31, s[56:59], s74 offen offset:3072 lds
  v_mfma_f32_16x16x32_bf16 v[136:139], a[224:227], a[104:107], v[136:139]
  s_xor_b32 s73, s89, 0x20080
  s_waitcnt vmcnt(20)
  ds_read_b64_tr_b16 a[194:195], v2 offset:10240
  v_mfma_f32_16x16x32_bf16 v[136:139], a[228:231], a[120:123], v[136:139]
  s_waitcnt lgkmcnt(5)
  ds_read_b64_tr_b16 a[202:203], v3 offset:10240
  v_cvt_pk_bf16_f32 v128, v128, v129
  v_mfma_f32_16x16x32_bf16 v[140:143], a[228:231], a[124:127], v[140:143]
  s_add_u32 m0, s72, 0x2000
  s_waitcnt lgkmcnt(2)
  v_cvt_pk_bf16_f32 v129, v130, v131
  v_mfma_f32_16x16x32_bf16 v[140:143], a[224:227], a[108:111], v[140:143]
  buffer_load_dwordx4 v28, s[56:59], s73 offen lds
  v_mfma_f32_16x16x32_bf16 v[108:111], a[232:235], a[108:111], v[108:111]
  ds_read_b64_tr_b16 a[210:211], v4 offset:10240
  v_mfma_f32_16x16x32_bf16 v[108:111], a[236:239], a[124:127], v[108:111]
  ds_read_b64_tr_b16 a[218:219], v5 offset:10240
  v_mfma_f32_16x16x32_bf16 v[104:107], a[236:239], a[120:123], v[104:107]
  v_mfma_f32_16x16x32_bf16 v[104:107], a[232:235], a[104:107], v[104:107]
  buffer_load_dwordx4 v29, s[56:59], s73 offen offset:1024 lds
  v_mfma_f32_16x16x32_bf16 v[100:103], a[232:235], a[100:103], v[100:103]
  s_waitcnt vmcnt(20)
  ds_read_b64_tr_b16 a[196:197], v2 offset:12288
  v_mfma_f32_16x16x32_bf16 v[100:103], a[236:239], a[116:119], v[100:103]
  ds_read_b64_tr_b16 a[204:205], v3 offset:12288
  v_mfma_f32_16x16x32_bf16 v[96:99], a[236:239], a[112:115], v[96:99]
  s_waitcnt lgkmcnt(2)
  v_mfma_f32_16x16x32_bf16 v[96:99], a[232:235], a[96:99], v[96:99]
  buffer_load_dwordx4 v30, s[56:59], s73 offen offset:2048 lds
  v_mfma_f32_16x16x32_bf16 v[144:147], a[240:243], a[96:99], v[144:147]
  ds_read_b64_tr_b16 a[212:213], v4 offset:12288
  v_mfma_f32_16x16x32_bf16 v[144:147], a[244:247], a[112:115], v[144:147]
  ds_read_b64_tr_b16 a[220:221], v5 offset:12288
  v_mfma_f32_16x16x32_bf16 v[148:151], a[244:247], a[116:119], v[148:151]
  v_mfma_f32_16x16x32_bf16 v[148:151], a[240:243], a[100:103], v[148:151]
  buffer_load_dwordx4 v31, s[56:59], s73 offen offset:3072 lds
  v_mfma_f32_16x16x32_bf16 v[152:155], a[240:243], a[104:107], v[152:155]
  s_waitcnt vmcnt(20)
  ds_read_b64_tr_b16 a[198:199], v2 offset:14336
  v_cvt_pk_bf16_f32 v130, v96, v97
  v_mfma_f32_16x16x32_bf16 v[152:155], a[244:247], a[120:123], v[152:155]
  s_xor_b32 s74, s89, 0x28080
  ds_read_b64_tr_b16 a[206:207], v3 offset:14336
  v_cvt_pk_bf16_f32 v131, v98, v99
  v_mfma_f32_16x16x32_bf16 v[156:159], a[244:247], a[124:127], v[156:159]
  s_add_u32 m0, s72, 0x3000
  s_waitcnt lgkmcnt(2)
  v_cvt_pk_bf16_f32 v132, v132, v133
  v_cvt_pk_bf16_f32 v133, v134, v135
  v_mfma_f32_16x16x32_bf16 v[156:159], a[240:243], a[108:111], v[156:159]
  buffer_load_dwordx4 v28, s[56:59], s74 offen lds
  v_mfma_f32_16x16x32_bf16 v[124:127], a[248:251], a[108:111], v[124:127]
  ds_read_b64_tr_b16 a[214:215], v4 offset:14336
  v_cvt_pk_bf16_f32 v134, v100, v101
  v_mfma_f32_16x16x32_bf16 v[124:127], a[252:255], a[124:127], v[124:127]
  ds_read_b64_tr_b16 a[222:223], v5 offset:14336
  v_cvt_pk_bf16_f32 v135, v102, v103
  v_mfma_f32_16x16x32_bf16 v[120:123], a[252:255], a[120:123], v[120:123]
  v_cvt_pk_bf16_f32 v136, v136, v137
  v_cvt_pk_bf16_f32 v137, v138, v139
  v_mfma_f32_16x16x32_bf16 v[120:123], a[248:251], a[104:107], v[120:123]
  buffer_load_dwordx4 v29, s[56:59], s74 offen offset:1024 lds
  v_mfma_f32_16x16x32_bf16 v[116:119], a[248:251], a[100:103], v[116:119]
  s_waitcnt vmcnt(20)
  ds_read_b64_tr_b16 a[224:225], v2 offset:16384
  v_cvt_pk_bf16_f32 v138, v104, v105
  v_mfma_f32_16x16x32_bf16 v[116:119], a[252:255], a[116:119], v[116:119]
  ds_read_b64_tr_b16 a[232:233], v3 offset:16384
  v_cvt_pk_bf16_f32 v139, v106, v107
  v_mfma_f32_16x16x32_bf16 v[112:115], a[252:255], a[112:115], v[112:115]
  s_waitcnt lgkmcnt(2)
  v_cvt_pk_bf16_f32 v140, v140, v141
  v_cvt_pk_bf16_f32 v141, v142, v143
  v_mfma_f32_16x16x32_bf16 v[112:115], a[248:251], a[96:99], v[112:115]
  buffer_load_dwordx4 v30, s[56:59], s74 offen offset:2048 lds
  v_mfma_f32_16x16x32_bf16 v[192:195], a[128:131], a[96:99], 0
  ds_read_b64_tr_b16 a[240:241], v4 offset:16384
  v_cvt_pk_bf16_f32 v142, v108, v109
  v_mfma_f32_16x16x32_bf16 v[192:195], a[132:135], a[112:115], v[192:195]
  ds_read_b64_tr_b16 a[248:249], v5 offset:16384
  v_cvt_pk_bf16_f32 v143, v110, v111
  v_mfma_f32_16x16x32_bf16 v[196:199], a[132:135], a[116:119], 0
  v_cvt_pk_bf16_f32 v144, v144, v145
  v_cvt_pk_bf16_f32 v145, v146, v147
  v_mfma_f32_16x16x32_bf16 v[196:199], a[128:131], a[100:103], v[196:199]
  buffer_load_dwordx4 v31, s[56:59], s74 offen offset:3072 lds
  v_mfma_f32_16x16x32_bf16 v[200:203], a[128:131], a[104:107], 0
  s_waitcnt vmcnt(20)
  ds_read_b64_tr_b16 a[226:227], v2 offset:18432
  v_cvt_pk_bf16_f32 v146, v112, v113
  v_mfma_f32_16x16x32_bf16 v[200:203], a[132:135], a[120:123], v[200:203]
  s_xor_b32 s73, s89, 0x10080
  ds_read_b64_tr_b16 a[234:235], v3 offset:18432
  v_cvt_pk_bf16_f32 v147, v114, v115
  v_mfma_f32_16x16x32_bf16 v[204:207], a[132:135], a[124:127], 0
  s_add_u32 m0, s72, 0x4000
  s_waitcnt lgkmcnt(2)
  v_cvt_pk_bf16_f32 v148, v148, v149
  v_cvt_pk_bf16_f32 v149, v150, v151
  v_mfma_f32_16x16x32_bf16 v[204:207], a[128:131], a[108:111], v[204:207]
  buffer_load_dwordx4 v28, s[56:59], s73 offen lds
  v_mfma_f32_16x16x32_bf16 v[172:175], a[136:139], a[108:111], 0
L_p6137:
  s_cmp_eq_u32 s95, 1
  s_cbranch_scc1 L_wback
  ds_read_b64_tr_b16 a[242:243], v4 offset:18432
  v_cvt_pk_bf16_f32 v150, v116, v117
  v_mfma_f32_16x16x32_bf16 v[172:175], a[140:143], a[124:127], v[172:175]
  ds_read_b64_tr_b16 a[250:251], v5 offset:18432
  v_cvt_pk_bf16_f32 v151, v118, v119
  v_mfma_f32_16x16x32_bf16 v[168:171], a[140:143], a[120:123], 0
  v_cvt_pk_bf16_f32 v152, v152, v153
  v_cvt_pk_bf16_f32 v153, v154, v155
  v_mfma_f32_16x16x32_bf16 v[168:171], a[136:139], a[104:107], v[168:171]
  buffer_load_dwordx4 v29, s[56:59], s73 offen offset:1024 lds
  v_mfma_f32_16x16x32_bf16 v[164:167], a[136:139], a[100:103], 0
  s_waitcnt vmcnt(20)
  ds_read_b64_tr_b16 a[228:229], v2 offset:20480
  v_cvt_pk_bf16_f32 v154, v120, v121
  v_mfma_f32_16x16x32_bf16 v[164:167], a[140:143], a[116:119], v[164:167]
  ds_read_b64_tr_b16 a[236:237], v3 offset:20480
  v_cvt_pk_bf16_f32 v155, v122, v123
  v_mfma_f32_16x16x32_bf16 v[160:163], a[140:143], a[112:115], 0
  s_waitcnt lgkmcnt(2)
  v_cvt_pk_bf16_f32 v156, v156, v157
  v_cvt_pk_bf16_f32 v157, v158, v159
  v_mfma_f32_16x16x32_bf16 v[160:163], a[136:139], a[96:99], v[160:163]
  buffer_load_dwordx4 v30, s[56:59], s73 offen offset:2048 lds
  v_mfma_f32_16x16x32_bf16 v[208:211], a[144:147], a[96:99], 0
  ds_read_b64_tr_b16 a[244:245], v4 offset:20480
  v_cvt_pk_bf16_f32 v158, v124, v125
  v_mfma_f32_16x16x32_bf16 v[208:211], a[148:151], a[112:115], v[208:211]
  ds_read_b64_tr_b16 a[252:253], v5 offset:20480
  v_cvt_pk_bf16_f32 v159, v126, v127
  v_mfma_f32_16x16x32_bf16 v[212:215], a[148:151], a[116:119], 0
  v_mfma_f32_16x16x32_bf16 v[212:215], a[144:147], a[100:103], v[212:215]
  buffer_load_dwordx4 v31, s[56:59], s73 offen offset:3072 lds
  v_mfma_f32_16x16x32_bf16 v[216:219], a[144:147], a[104:107], 0
  s_waitcnt vmcnt(20)
  ds_read_b64_tr_b16 a[230:231], v2 offset:22528
  v_mfma_f32_16x16x32_bf16 v[216:219], a[148:151], a[120:123], v[216:219]
  s_xor_b32 s74, s89, 0x18080
  ds_read_b64_tr_b16 a[238:239], v3 offset:22528
  v_mfma_f32_16x16x32_bf16 v[220:223], a[148:151], a[124:127], 0
  s_add_u32 m0, s72, 0x5000
  s_waitcnt lgkmcnt(2)
  v_mfma_f32_16x16x32_bf16 v[220:223], a[144:147], a[108:111], v[220:223]
  buffer_load_dwordx4 v28, s[56:59], s74 offen lds
  v_mfma_f32_16x16x32_bf16 v[188:191], a[152:155], a[108:111], 0
  ds_read_b64_tr_b16 a[246:247], v4 offset:22528
  v_mfma_f32_16x16x32_bf16 v[188:191], a[156:159], a[124:127], v[188:191]
  ds_read_b64_tr_b16 a[254:255], v5 offset:22528
  v_mfma_f32_16x16x32_bf16 v[184:187], a[156:159], a[120:123], 0
  v_mfma_f32_16x16x32_bf16 v[184:187], a[152:155], a[104:107], v[184:187]
  buffer_load_dwordx4 v29, s[56:59], s74 offen offset:1024 lds
  v_mfma_f32_16x16x32_bf16 v[180:183], a[152:155], a[100:103], 0
  s_waitcnt vmcnt(20)
  ds_read_b64_tr_b16 a[128:129], v2
  ds_read_b64_tr_b16 a[136:137], v3
  v_mfma_f32_16x16x32_bf16 v[180:183], a[156:159], a[116:119], v[180:183]
  ds_read_b64_tr_b16 a[144:145], v4
  v_mfma_f32_16x16x32_bf16 v[176:179], a[156:159], a[112:115], 0
  s_waitcnt lgkmcnt(3)
  v_mfma_f32_16x16x32_bf16 v[176:179], a[152:155], a[96:99], v[176:179]
  buffer_load_dwordx4 v30, s[56:59], s74 offen offset:2048 lds
  v_mfma_f32_16x16x32_bf16 v[192:195], a[160:163], a[64:67], v[192:195]
  ds_read_b64_tr_b16 a[152:153], v5
  ds_read_b64_tr_b16 a[96:97], v18 offset:36864
  ds_read_b64_tr_b16 a[98:99], v19 offset:36864
  v_mfma_f32_16x16x32_bf16 v[192:195], a[164:167], a[80:83], v[192:195]
  ds_read_b64_tr_b16 a[112:113], v18 offset:53248
  v_mfma_f32_16x16x32_bf16 v[196:199], a[164:167], a[84:87], v[196:199]
  ds_read_b64_tr_b16 a[114:115], v19 offset:53248
  v_mfma_f32_16x16x32_bf16 v[196:199], a[160:163], a[68:71], v[196:199]
  buffer_load_dwordx4 v31, s[56:59], s74 offen offset:3072 lds
  v_mfma_f32_16x16x32_bf16 v[200:203], a[160:163], a[72:75], v[200:203]
  s_waitcnt vmcnt(20)
  ds_read_b64_tr_b16 a[130:131], v2 offset:2048
  ds_read_b64_tr_b16 a[138:139], v3 offset:2048
  v_mfma_f32_16x16x32_bf16 v[200:203], a[164:167], a[88:91], v[200:203]
  s_xor_b32 s73, s89, 0x80
  ds_read_b64_tr_b16 a[146:147], v4 offset:2048
  v_mfma_f32_16x16x32_bf16 v[204:207], a[164:167], a[92:95], v[204:207]
  s_add_u32 m0, s72, 0
  s_waitcnt lgkmcnt(7)
  ds_read_b64_tr_b16 a[154:155], v5 offset:2048
  v_mfma_f32_16x16x32_bf16 v[204:207], a[160:163], a[76:79], v[204:207]
  buffer_load_dwordx4 v28, s[56:59], s73 offen lds
  v_mfma_f32_16x16x32_bf16 v[172:175], a[168:171], a[76:79], v[172:175]
  ds_read_b64_tr_b16 a[100:101], v20 offset:36864
  ds_read_b64_tr_b16 a[102:103], v21 offset:36864
  v_mfma_f32_16x16x32_bf16 v[172:175], a[172:175], a[92:95], v[172:175]
  ds_read_b64_tr_b16 a[116:117], v20 offset:53248
  v_mfma_f32_16x16x32_bf16 v[168:171], a[172:175], a[88:91], v[168:171]
  ds_read_b64_tr_b16 a[118:119], v21 offset:53248
  v_mfma_f32_16x16x32_bf16 v[168:171], a[168:171], a[72:75], v[168:171]
  buffer_load_dwordx4 v29, s[56:59], s73 offen offset:1024 lds
  v_mfma_f32_16x16x32_bf16 v[164:167], a[168:171], a[68:71], v[164:167]
  s_waitcnt vmcnt(20)
  ds_read_b64_tr_b16 a[132:133], v2 offset:4096
  ds_read_b64_tr_b16 a[140:141], v3 offset:4096
  v_mfma_f32_16x16x32_bf16 v[164:167], a[172:175], a[84:87], v[164:167]
  ds_read_b64_tr_b16 a[148:149], v4 offset:4096
  v_mfma_f32_16x16x32_bf16 v[160:163], a[172:175], a[80:83], v[160:163]
  s_waitcnt lgkmcnt(7)
  ds_read_b64_tr_b16 a[156:157], v5 offset:4096
  v_mfma_f32_16x16x32_bf16 v[160:163], a[168:171], a[64:67], v[160:163]
  buffer_load_dwordx4 v30, s[56:59], s73 offen offset:2048 lds
  v_mfma_f32_16x16x32_bf16 v[208:211], a[176:179], a[64:67], v[208:211]
  ds_read_b64_tr_b16 a[104:105], v22 offset:36864
  ds_read_b64_tr_b16 a[106:107], v23 offset:36864
  v_mfma_f32_16x16x32_bf16 v[208:211], a[180:183], a[80:83], v[208:211]
  ds_read_b64_tr_b16 a[120:121], v22 offset:53248
  v_mfma_f32_16x16x32_bf16 v[212:215], a[180:183], a[84:87], v[212:215]
  ds_read_b64_tr_b16 a[122:123], v23 offset:53248
  v_mfma_f32_16x16x32_bf16 v[212:215], a[176:179], a[68:71], v[212:215]
  buffer_load_dwordx4 v31, s[56:59], s73 offen offset:3072 lds
  v_mfma_f32_16x16x32_bf16 v[216:219], a[176:179], a[72:75], v[216:219]
  s_waitcnt vmcnt(20)
  ds_read_b64_tr_b16 a[134:135], v2 offset:6144
  ds_read_b64_tr_b16 a[142:143], v3 offset:6144
  v_mfma_f32_16x16x32_bf16 v[216:219], a[180:183], a[88:91], v[216:219]
  s_xor_b32 s74, s89, 0x8080
  ds_read_b64_tr_b16 a[150:151], v4 offset:6144
  v_mfma_f32_16x16x32_bf16 v[220:223], a[180:183], a[92:95], v[220:223]
  s_add_u32 m0, s72, 0x1000
  s_waitcnt lgkmcnt(7)
  ds_read_b64_tr_b16 a[158:159], v5 offset:6144
  v_mfma_f32_16x16x32_bf16 v[220:223], a[176:179], a[76:79], v[220:223]
  buffer_load_dwordx4 v28, s[56:59], s74 offen lds
  v_mfma_f32_16x16x32_bf16 v[188:191], a[184:187], a[76:79], v[188:191]
  ds_read_b64_tr_b16 a[108:109], v24 offset:36864
  ds_read_b64_tr_b16 a[110:111], v25 offset:36864
  v_mfma_f32_16x16x32_bf16 v[188:191], a[188:191], a[92:95], v[188:191]
  ds_read_b64_tr_b16 a[124:125], v24 offset:53248
  v_mfma_f32_16x16x32_bf16 v[184:187], a[188:191], a[88:91], v[184:187]
  ds_read_b64_tr_b16 a[126:127], v25 offset:53248
  v_mfma_f32_16x16x32_bf16 v[184:187], a[184:187], a[72:75], v[184:187]
  buffer_load_dwordx4 v29, s[56:59], s74 offen offset:1024 lds
  v_mfma_f32_16x16x32_bf16 v[180:183], a[184:187], a[68:71], v[180:183]
  s_waitcnt vmcnt(20)
  ds_read_b64_tr_b16 a[160:161], v2 offset:8192
  ds_read_b64_tr_b16 a[168:169], v3 offset:8192
  v_mfma_f32_16x16x32_bf16 v[180:183], a[188:191], a[84:87], v[180:183]
  ds_read_b64_tr_b16 a[176:177], v4 offset:8192
  v_mfma_f32_16x16x32_bf16 v[176:179], a[188:191], a[80:83], v[176:179]
  s_waitcnt lgkmcnt(7)
  v_mfma_f32_16x16x32_bf16 v[176:179], a[184:187], a[64:67], v[176:179]
  buffer_load_dwordx4 v30, s[56:59], s74 offen offset:2048 lds
  v_mfma_f32_16x16x32_bf16 v[192:195], a[192:195], a[32:35], v[192:195]
  ds_read_b64_tr_b16 a[184:185], v5 offset:8192
  ds_read_b64_tr_b16 a[64:65], v18 offset:4096
  ds_read_b64_tr_b16 a[66:67], v19 offset:4096
  v_mfma_f32_16x16x32_bf16 v[192:195], a[196:199], a[48:51], v[192:195]
  ds_read_b64_tr_b16 a[80:81], v18 offset:20480
  v_mfma_f32_16x16x32_bf16 v[196:199], a[196:199], a[52:55], v[196:199]
  ds_read_b64_tr_b16 a[82:83], v19 offset:20480
  v_mfma_f32_16x16x32_bf16 v[196:199], a[192:195], a[36:39], v[196:199]
  buffer_load_dwordx4 v31, s[56:59], s74 offen offset:3072 lds
  v_mfma_f32_16x16x32_bf16 v[200:203], a[192:195], a[40:43], v[200:203]
  s_xor_b32 s90, s82, 0
  s_waitcnt vmcnt(20)
  ds_read_b64_tr_b16 a[162:163], v2 offset:10240
  v_mfma_f32_16x16x32_bf16 v[200:203], a[196:199], a[56:59], v[200:203]
  buffer_store_dwordx4 v[128:131], v1, s[60:63], s90 offen sc1
  ds_read_b64_tr_b16 a[170:171], v3 offset:10240
  v_mfma_f32_16x16x32_bf16 v[204:207], a[196:199], a[60:63], v[204:207]
  ds_read_b64_tr_b16 a[178:179], v4 offset:10240
  v_mfma_f32_16x16x32_bf16 v[204:207], a[192:195], a[44:47], v[204:207]
  ds_read_b64_tr_b16 a[186:187], v5 offset:10240
  v_mfma_f32_16x16x32_bf16 v[172:175], a[200:203], a[44:47], v[172:175]
  ds_read_b64_tr_b16 a[68:69], v20 offset:4096
  v_mfma_f32_16x16x32_bf16 v[172:175], a[204:207], a[60:63], v[172:175]
  ds_read_b64_tr_b16 a[70:71], v21 offset:4096
  v_mfma_f32_16x16x32_bf16 v[168:171], a[204:207], a[56:59], v[168:171]
  ds_read_b64_tr_b16 a[84:85], v20 offset:20480
  v_mfma_f32_16x16x32_bf16 v[168:171], a[200:203], a[40:43], v[168:171]
  ds_read_b64_tr_b16 a[86:87], v21 offset:20480
  v_mfma_f32_16x16x32_bf16 v[164:167], a[200:203], a[36:39], v[164:167]
  s_waitcnt vmcnt(19)
  ds_read_b64_tr_b16 a[164:165], v2 offset:12288
  v_mfma_f32_16x16x32_bf16 v[164:167], a[204:207], a[52:55], v[164:167]
  s_xor_b32 s91, s82, 0x400400
  ds_read_b64_tr_b16 a[172:173], v3 offset:12288
  v_mfma_f32_16x16x32_bf16 v[160:163], a[204:207], a[48:51], v[160:163]
  buffer_store_dwordx4 v[132:135], v1, s[60:63], s91 offen sc1
  ds_read_b64_tr_b16 a[180:181], v4 offset:12288
  v_mfma_f32_16x16x32_bf16 v[160:163], a[200:203], a[32:35], v[160:163]
  ds_read_b64_tr_b16 a[188:189], v5 offset:12288
  v_mfma_f32_16x16x32_bf16 v[208:211], a[208:211], a[32:35], v[208:211]
  ds_read_b64_tr_b16 a[72:73], v22 offset:4096
  v_mfma_f32_16x16x32_bf16 v[208:211], a[212:215], a[48:51], v[208:211]
  ds_read_b64_tr_b16 a[74:75], v23 offset:4096
  v_mfma_f32_16x16x32_bf16 v[212:215], a[212:215], a[52:55], v[212:215]
  ds_read_b64_tr_b16 a[88:89], v22 offset:20480
  v_mfma_f32_16x16x32_bf16 v[212:215], a[208:211], a[36:39], v[212:215]
  ds_read_b64_tr_b16 a[90:91], v23 offset:20480
  v_mfma_f32_16x16x32_bf16 v[216:219], a[208:211], a[40:43], v[216:219]
  s_waitcnt vmcnt(18)
  ds_read_b64_tr_b16 a[166:167], v2 offset:14336
  v_mfma_f32_16x16x32_bf16 v[216:219], a[212:215], a[56:59], v[216:219]
  ds_read_b64_tr_b16 a[174:175], v3 offset:14336
  v_mfma_f32_16x16x32_bf16 v[220:223], a[212:215], a[60:63], v[220:223]
  s_xor_b32 s90, s82, 0x800800
  ds_read_b64_tr_b16 a[182:183], v4 offset:14336
  v_mfma_f32_16x16x32_bf16 v[220:223], a[208:211], a[44:47], v[220:223]
  buffer_store_dwordx4 v[136:139], v1, s[60:63], s90 offen sc1
  ds_read_b64_tr_b16 a[190:191], v5 offset:14336
  v_mfma_f32_16x16x32_bf16 v[188:191], a[216:219], a[44:47], v[188:191]
  ds_read_b64_tr_b16 a[76:77], v24 offset:4096
  v_mfma_f32_16x16x32_bf16 v[188:191], a[220:223], a[60:63], v[188:191]
  ds_read_b64_tr_b16 a[78:79], v25 offset:4096
  v_mfma_f32_16x16x32_bf16 v[184:187], a[220:223], a[56:59], v[184:187]
  ds_read_b64_tr_b16 a[92:93], v24 offset:20480
  v_mfma_f32_16x16x32_bf16 v[184:187], a[216:219], a[40:43], v[184:187]
  ds_read_b64_tr_b16 a[94:95], v25 offset:20480
  v_mfma_f32_16x16x32_bf16 v[180:183], a[216:219], a[36:39], v[180:183]
  s_waitcnt vmcnt(17)
  ds_read_b64_tr_b16 a[192:193], v2 offset:16384
  v_mfma_f32_16x16x32_bf16 v[180:183], a[220:223], a[52:55], v[180:183]
  ds_read_b64_tr_b16 a[200:201], v3 offset:16384
  v_mfma_f32_16x16x32_bf16 v[176:179], a[220:223], a[48:51], v[176:179]
  ds_read_b64_tr_b16 a[208:209], v4 offset:16384
  v_mfma_f32_16x16x32_bf16 v[176:179], a[216:219], a[32:35], v[176:179]
  s_xor_b32 s91, s82, 0xc00c00
  ds_read_b64_tr_b16 a[216:217], v5 offset:16384
  v_mfma_f32_16x16x32_bf16 v[192:195], a[224:227], a[0:3], v[192:195]
  buffer_store_dwordx4 v[140:143], v1, s[60:63], s91 offen sc1
  ds_read_b64_tr_b16 a[32:33], v18 offset:32768
  v_mfma_f32_16x16x32_bf16 v[192:195], a[228:231], a[16:19], v[192:195]
  ds_read_b64_tr_b16 a[34:35], v19 offset:32768
  v_mfma_f32_16x16x32_bf16 v[196:199], a[228:231], a[20:23], v[196:199]
  ds_read_b64_tr_b16 a[48:49], v18 offset:49152
  v_mfma_f32_16x16x32_bf16 v[196:199], a[224:227], a[4:7], v[196:199]
  ds_read_b64_tr_b16 a[50:51], v19 offset:49152
  v_mfma_f32_16x16x32_bf16 v[200:203], a[224:227], a[8:11], v[200:203]
  s_waitcnt vmcnt(16)
  ds_read_b64_tr_b16 a[194:195], v2 offset:18432
  v_mfma_f32_16x16x32_bf16 v[200:203], a[228:231], a[24:27], v[200:203]
  ds_read_b64_tr_b16 a[202:203], v3 offset:18432
  v_mfma_f32_16x16x32_bf16 v[204:207], a[228:231], a[28:31], v[204:207]
  ds_read_b64_tr_b16 a[210:211], v4 offset:18432
  v_mfma_f32_16x16x32_bf16 v[204:207], a[224:227], a[12:15], v[204:207]
  ds_read_b64_tr_b16 a[218:219], v5 offset:18432
  v_mfma_f32_16x16x32_bf16 v[172:175], a[232:235], a[12:15], v[172:175]
  s_xor_b32 s90, s82, 0x2000
  ds_read_b64_tr_b16 a[36:37], v20 offset:32768
  v_mfma_f32_16x16x32_bf16 v[172:175], a[236:239], a[28:31], v[172:175]
  buffer_store_dwordx4 v[144:147], v1, s[60:63], s90 offen sc1
  ds_read_b64_tr_b16 a[38:39], v21 offset:32768
  v_mfma_f32_16x16x32_bf16 v[168:171], a[236:239], a[24:27], v[168:171]
  ds_read_b64_tr_b16 a[52:53], v20 offset:49152
  v_mfma_f32_16x16x32_bf16 v[168:171], a[232:235], a[8:11], v[168:171]
  ds_read_b64_tr_b16 a[54:55], v21 offset:49152
  v_mfma_f32_16x16x32_bf16 v[164:167], a[232:235], a[4:7], v[164:167]
  s_waitcnt vmcnt(15)
  ds_read_b64_tr_b16 a[196:197], v2 offset:20480
  v_mfma_f32_16x16x32_bf16 v[164:167], a[236:239], a[20:23], v[164:167]
  ds_read_b64_tr_b16 a[204:205], v3 offset:20480
  v_mfma_f32_16x16x32_bf16 v[160:163], a[236:239], a[16:19], v[160:163]
  ds_read_b64_tr_b16 a[212:213], v4 offset:20480
  v_mfma_f32_16x16x32_bf16 v[160:163], a[232:235], a[0:3], v[160:163]
  ds_read_b64_tr_b16 a[220:221], v5 offset:20480
  v_mfma_f32_16x16x32_bf16 v[208:211], a[240:243], a[0:3], v[208:211]
  ds_read_b64_tr_b16 a[40:41], v22 offset:32768
  v_mfma_f32_16x16x32_bf16 v[208:211], a[244:247], a[16:19], v[208:211]
  s_xor_b32 s91, s82, 0x402400
  ds_read_b64_tr_b16 a[42:43], v23 offset:32768
  v_mfma_f32_16x16x32_bf16 v[212:215], a[244:247], a[20:23], v[212:215]
  buffer_store_dwordx4 v[148:151], v1, s[60:63], s91 offen sc1
  ds_read_b64_tr_b16 a[56:57], v22 offset:49152
  v_mfma_f32_16x16x32_bf16 v[212:215], a[240:243], a[4:7], v[212:215]
  ds_read_b64_tr_b16 a[58:59], v23 offset:49152
  v_mfma_f32_16x16x32_bf16 v[216:219], a[240:243], a[8:11], v[216:219]
  s_waitcnt vmcnt(14)
  ds_read_b64_tr_b16 a[198:199], v2 offset:22528
  v_mfma_f32_16x16x32_bf16 v[216:219], a[244:247], a[24:27], v[216:219]
  ds_read_b64_tr_b16 a[206:207], v3 offset:22528
  v_mfma_f32_16x16x32_bf16 v[220:223], a[244:247], a[28:31], v[220:223]
  ds_read_b64_tr_b16 a[214:215], v4 offset:22528
  v_mfma_f32_16x16x32_bf16 v[220:223], a[240:243], a[12:15], v[220:223]
  ds_read_b64_tr_b16 a[222:223], v5 offset:22528
  v_mfma_f32_16x16x32_bf16 v[188:191], a[248:251], a[12:15], v[188:191]
  ds_read_b64_tr_b16 a[44:45], v24 offset:32768
  v_mfma_f32_16x16x32_bf16 v[188:191], a[252:255], a[28:31], v[188:191]
  ds_read_b64_tr_b16 a[46:47], v25 offset:32768
  v_mfma_f32_16x16x32_bf16 v[184:187], a[252:255], a[24:27], v[184:187]
  s_xor_b32 s90, s82, 0x802800
  ds_read_b64_tr_b16 a[60:61], v24 offset:49152
  v_mfma_f32_16x16x32_bf16 v[184:187], a[248:251], a[8:11], v[184:187]
  buffer_store_dwordx4 v[152:155], v1, s[60:63], s90 offen sc1
  ds_read_b64_tr_b16 a[62:63], v25 offset:49152
  v_mfma_f32_16x16x32_bf16 v[180:183], a[248:251], a[4:7], v[180:183]
  s_waitcnt vmcnt(13)
  ds_read_b64_tr_b16 a[224:225], v2
  v_mfma_f32_16x16x32_bf16 v[180:183], a[252:255], a[20:23], v[180:183]
  ds_read_b64_tr_b16 a[232:233], v3
  v_mfma_f32_16x16x32_bf16 v[176:179], a[252:255], a[16:19], v[176:179]
  ds_read_b64_tr_b16 a[240:241], v4
  v_mfma_f32_16x16x32_bf16 v[176:179], a[248:251], a[0:3], v[176:179]
  ds_read_b64_tr_b16 a[248:249], v5
  v_mfma_f32_16x16x32_bf16 v[192:195], a[128:131], a[96:99], v[192:195]
  ds_read_b64_tr_b16 a[0:1], v18
  v_mfma_f32_16x16x32_bf16 v[192:195], a[132:135], a[112:115], v[192:195]
  ds_read_b64_tr_b16 a[2:3], v19
  v_mfma_f32_16x16x32_bf16 v[196:199], a[132:135], a[116:119], v[196:199]
  ds_read_b64_tr_b16 a[16:17], v18 offset:16384
  v_mfma_f32_16x16x32_bf16 v[196:199], a[128:131], a[100:103], v[196:199]
  s_xor_b32 s91, s82, 0xc02c00
  s_waitcnt vmcnt(11)
  ds_read_b64_tr_b16 a[18:19], v19 offset:16384
  v_mfma_f32_16x16x32_bf16 v[200:203], a[128:131], a[104:107], v[200:203]
  buffer_store_dwordx4 v[156:159], v1, s[60:63], s91 offen sc1
  ds_read_b64_tr_b16 a[226:227], v2 offset:2048
  v_mfma_f32_16x16x32_bf16 v[200:203], a[132:135], a[120:123], v[200:203]
  s_waitcnt lgkmcnt(11)
  ds_read_b64_tr_b16 a[234:235], v3 offset:2048
  v_mfma_f32_16x16x32_bf16 v[204:207], a[132:135], a[124:127], v[204:207]
  ds_read_b64_tr_b16 a[242:243], v4 offset:2048
  v_mfma_f32_16x16x32_bf16 v[204:207], a[128:131], a[108:111], v[204:207]
  ds_read_b64_tr_b16 a[250:251], v5 offset:2048
  v_mfma_f32_16x16x32_bf16 v[172:175], a[136:139], a[108:111], v[172:175]
  ds_read_b64_tr_b16 a[4:5], v20
  v_mfma_f32_16x16x32_bf16 v[172:175], a[140:143], a[124:127], v[172:175]
  ds_read_b64_tr_b16 a[6:7], v21
  v_mfma_f32_16x16x32_bf16 v[168:171], a[140:143], a[120:123], v[168:171]
  ds_read_b64_tr_b16 a[20:21], v20 offset:16384
  v_mfma_f32_16x16x32_bf16 v[168:171], a[136:139], a[104:107], v[168:171]
  ds_read_b64_tr_b16 a[22:23], v21 offset:16384
  v_mfma_f32_16x16x32_bf16 v[164:167], a[136:139], a[100:103], v[164:167]
  s_waitcnt vmcnt(10)
  ds_read_b64_tr_b16 a[228:229], v2 offset:4096
  v_mfma_f32_16x16x32_bf16 v[164:167], a[140:143], a[116:119], v[164:167]
  ds_read_b64_tr_b16 a[236:237], v3 offset:4096
  v_mfma_f32_16x16x32_bf16 v[160:163], a[140:143], a[112:115], v[160:163]
  ds_read_b64_tr_b16 a[244:245], v4 offset:4096
  v_mfma_f32_16x16x32_bf16 v[160:163], a[136:139], a[96:99], v[160:163]
  ds_read_b64_tr_b16 a[252:253], v5 offset:4096
  v_mfma_f32_16x16x32_bf16 v[208:211], a[144:147], a[96:99], v[208:211]
  ds_read_b64_tr_b16 a[8:9], v22
  v_mfma_f32_16x16x32_bf16 v[208:211], a[148:151], a[112:115], v[208:211]
  ds_read_b64_tr_b16 a[10:11], v23
  v_mfma_f32_16x16x32_bf16 v[212:215], a[148:151], a[116:119], v[212:215]
  ds_read_b64_tr_b16 a[24:25], v22 offset:16384
  v_mfma_f32_16x16x32_bf16 v[212:215], a[144:147], a[100:103], v[212:215]
  ds_read_b64_tr_b16 a[26:27], v23 offset:16384
  v_mfma_f32_16x16x32_bf16 v[216:219], a[144:147], a[104:107], v[216:219]
  s_waitcnt vmcnt(8)
  ds_read_b64_tr_b16 a[230:231], v2 offset:6144
  v_mfma_f32_16x16x32_bf16 v[216:219], a[148:151], a[120:123], v[216:219]
  ds_read_b64_tr_b16 a[238:239], v3 offset:6144
  v_mfma_f32_16x16x32_bf16 v[220:223], a[148:151], a[124:127], v[220:223]
  ds_read_b64_tr_b16 a[246:247], v4 offset:6144
  v_mfma_f32_16x16x32_bf16 v[220:223], a[144:147], a[108:111], v[220:223]
  ds_read_b64_tr_b16 a[254:255], v5 offset:6144
  v_mfma_f32_16x16x32_bf16 v[188:191], a[152:155], a[108:111], v[188:191]
  ds_read_b64_tr_b16 a[12:13], v24
  v_mfma_f32_16x16x32_bf16 v[188:191], a[156:159], a[124:127], v[188:191]
  ds_read_b64_tr_b16 a[14:15], v25
  v_mfma_f32_16x16x32_bf16 v[184:187], a[156:159], a[120:123], v[184:187]
  ds_read_b64_tr_b16 a[28:29], v24 offset:16384
  v_mfma_f32_16x16x32_bf16 v[184:187], a[152:155], a[104:107], v[184:187]
  ds_read_b64_tr_b16 a[30:31], v25 offset:16384
  v_mfma_f32_16x16x32_bf16 v[180:183], a[152:155], a[100:103], v[180:183]
  v_mfma_f32_16x16x32_bf16 v[180:183], a[156:159], a[116:119], v[180:183]
  v_mfma_f32_16x16x32_bf16 v[176:179], a[156:159], a[112:115], v[176:179]
  v_mfma_f32_16x16x32_bf16 v[176:179], a[152:155], a[96:99], v[176:179]
  v_mfma_f32_16x16x32_bf16 v[192:195], a[160:163], a[64:67], v[192:195]
  v_mfma_f32_16x16x32_bf16 v[192:195], a[164:167], a[80:83], v[192:195]
  v_mfma_f32_16x16x32_bf16 v[192:195], a[192:195], a[32:35], v[192:195]
  v_mfma_f32_16x16x32_bf16 v[192:195], a[196:199], a[48:51], v[192:195]
  s_waitcnt lgkmcnt(9)
  v_mfma_f32_16x16x32_bf16 v[192:195], a[224:227], a[0:3], v[192:195]
  s_waitcnt lgkmcnt(7)
  v_mfma_f32_16x16x32_bf16 v[192:195], a[228:231], a[16:19], v[192:195]
  s_waitcnt lgkmcnt(6)
  v_mfma_f32_16x16x32_bf16 v[160:163], a[236:239], a[16:19], v[160:163]
  v_mfma_f32_16x16x32_bf16 v[160:163], a[232:235], a[0:3], v[160:163]
  v_mfma_f32_16x16x32_bf16 v[160:163], a[204:207], a[48:51], v[160:163]
  v_mfma_f32_16x16x32_bf16 v[160:163], a[200:203], a[32:35], v[160:163]
  v_mfma_f32_16x16x32_bf16 v[160:163], a[172:175], a[80:83], v[160:163]
  v_mfma_f32_16x16x32_bf16 v[160:163], a[168:171], a[64:67], v[160:163]
  v_mfma_f32_16x16x32_bf16 v[208:211], a[176:179], a[64:67], v[208:211]
  v_cvt_pk_bf16_f32 v192, v192, v193
  v_cvt_pk_bf16_f32 v193, v194, v195
  v_mfma_f32_16x16x32_bf16 v[208:211], a[180:183], a[80:83], v[208:211]
  v_mfma_f32_16x16x32_bf16 v[208:211], a[208:211], a[32:35], v[208:211]
  v_mfma_f32_16x16x32_bf16 v[208:211], a[212:215], a[48:51], v[208:211]
  v_mfma_f32_16x16x32_bf16 v[208:211], a[240:243], a[0:3], v[208:211]
  s_waitcnt lgkmcnt(1)
  v_mfma_f32_16x16x32_bf16 v[208:211], a[244:247], a[16:19], v[208:211]
  v_mfma_f32_16x16x32_bf16 v[176:179], a[252:255], a[16:19], v[176:179]
  s_xor_b32 s90, s82, 0x1001000
  v_cvt_pk_bf16_f32 v194, v160, v161
  v_cvt_pk_bf16_f32 v195, v162, v163
  v_mfma_f32_16x16x32_bf16 v[176:179], a[248:251], a[0:3], v[176:179]
  buffer_store_dwordx4 v[192:195], v1, s[60:63], s90 offen sc1
  v_mfma_f32_16x16x32_bf16 v[176:179], a[220:223], a[48:51], v[176:179]
  v_mfma_f32_16x16x32_bf16 v[176:179], a[216:219], a[32:35], v[176:179]
  v_mfma_f32_16x16x32_bf16 v[176:179], a[188:191], a[80:83], v[176:179]
  v_mfma_f32_16x16x32_bf16 v[176:179], a[184:187], a[64:67], v[176:179]
  v_mfma_f32_16x16x32_bf16 v[180:183], a[184:187], a[68:71], v[180:183]
  v_cvt_pk_bf16_f32 v208, v208, v209
  v_cvt_pk_bf16_f32 v209, v210, v211
  v_mfma_f32_16x16x32_bf16 v[180:183], a[188:191], a[84:87], v[180:183]
  v_mfma_f32_16x16x32_bf16 v[180:183], a[216:219], a[36:39], v[180:183]
  v_mfma_f32_16x16x32_bf16 v[180:183], a[220:223], a[52:55], v[180:183]
  v_mfma_f32_16x16x32_bf16 v[180:183], a[248:251], a[4:7], v[180:183]
  v_mfma_f32_16x16x32_bf16 v[180:183], a[252:255], a[20:23], v[180:183]
  v_mfma_f32_16x16x32_bf16 v[212:215], a[244:247], a[20:23], v[212:215]
  s_xor_b32 s91, s82, 0x1003000
  v_cvt_pk_bf16_f32 v210, v176, v177
  v_cvt_pk_bf16_f32 v211, v178, v179
  v_mfma_f32_16x16x32_bf16 v[212:215], a[240:243], a[4:7], v[212:215]
  buffer_store_dwordx4 v[208:211], v1, s[60:63], s91 offen sc1
  v_mfma_f32_16x16x32_bf16 v[212:215], a[212:215], a[52:55], v[212:215]
  v_mfma_f32_16x16x32_bf16 v[212:215], a[208:211], a[36:39], v[212:215]
  v_mfma_f32_16x16x32_bf16 v[212:215], a[180:183], a[84:87], v[212:215]
  v_mfma_f32_16x16x32_bf16 v[212:215], a[176:179], a[68:71], v[212:215]
  v_mfma_f32_16x16x32_bf16 v[164:167], a[168:171], a[68:71], v[164:167]
  v_mfma_f32_16x16x32_bf16 v[164:167], a[172:175], a[84:87], v[164:167]
  v_mfma_f32_16x16x32_bf16 v[164:167], a[200:203], a[36:39], v[164:167]
  v_mfma_f32_16x16x32_bf16 v[164:167], a[204:207], a[52:55], v[164:167]
  v_mfma_f32_16x16x32_bf16 v[164:167], a[232:235], a[4:7], v[164:167]
  v_mfma_f32_16x16x32_bf16 v[164:167], a[236:239], a[20:23], v[164:167]
  v_mfma_f32_16x16x32_bf16 v[196:199], a[228:231], a[20:23], v[196:199]
  s_nop 0
  v_cvt_pk_bf16_f32 v212, v212, v213
  v_cvt_pk_bf16_f32 v213, v214, v215
  v_mfma_f32_16x16x32_bf16 v[196:199], a[224:227], a[4:7], v[196:199]
  s_xor_b32 s90, s82, 0x1403400
  v_cvt_pk_bf16_f32 v214, v180, v181
  v_cvt_pk_bf16_f32 v215, v182, v183
  v_mfma_f32_16x16x32_bf16 v[196:199], a[196:199], a[52:55], v[196:199]
  buffer_store_dwordx4 v[212:215], v1, s[60:63], s90 offen sc1
  v_mfma_f32_16x16x32_bf16 v[196:199], a[192:195], a[36:39], v[196:199]
  v_mfma_f32_16x16x32_bf16 v[196:199], a[164:167], a[84:87], v[196:199]
  v_mfma_f32_16x16x32_bf16 v[196:199], a[160:163], a[68:71], v[196:199]
  v_mfma_f32_16x16x32_bf16 v[200:203], a[160:163], a[72:75], v[200:203]
  v_mfma_f32_16x16x32_bf16 v[200:203], a[164:167], a[88:91], v[200:203]
  v_mfma_f32_16x16x32_bf16 v[200:203], a[192:195], a[40:43], v[200:203]
  v_mfma_f32_16x16x32_bf16 v[200:203], a[196:199], a[56:59], v[200:203]
  v_mfma_f32_16x16x32_bf16 v[200:203], a[224:227], a[8:11], v[200:203]
  v_mfma_f32_16x16x32_bf16 v[200:203], a[228:231], a[24:27], v[200:203]
  v_mfma_f32_16x16x32_bf16 v[168:171], a[236:239], a[24:27], v[168:171]
  s_nop 0
  v_cvt_pk_bf16_f32 v196, v196, v197
  v_cvt_pk_bf16_f32 v197, v198, v199
  v_mfma_f32_16x16x32_bf16 v[168:171], a[232:235], a[8:11], v[168:171]
  s_xor_b32 s91, s82, 0x1401400
  v_cvt_pk_bf16_f32 v198, v164, v165
  v_cvt_pk_bf16_f32 v199, v166, v167
  v_mfma_f32_16x16x32_bf16 v[168:171], a[204:207], a[56:59], v[168:171]
  buffer_store_dwordx4 v[196:199], v1, s[60:63], s91 offen sc1
  v_mfma_f32_16x16x32_bf16 v[168:171], a[200:203], a[40:43], v[168:171]
  v_mfma_f32_16x16x32_bf16 v[168:171], a[172:175], a[88:91], v[168:171]
  v_mfma_f32_16x16x32_bf16 v[168:171], a[168:171], a[72:75], v[168:171]
  v_mfma_f32_16x16x32_bf16 v[216:219], a[176:179], a[72:75], v[216:219]
  v_cvt_pk_bf16_f32 v200, v200, v201
  v_cvt_pk_bf16_f32 v201, v202, v203
  v_mfma_f32_16x16x32_bf16 v[216:219], a[180:183], a[88:91], v[216:219]
  v_mfma_f32_16x16x32_bf16 v[216:219], a[208:211], a[40:43], v[216:219]
  v_mfma_f32_16x16x32_bf16 v[216:219], a[212:215], a[56:59], v[216:219]
  v_mfma_f32_16x16x32_bf16 v[216:219], a[240:243], a[8:11], v[216:219]
  v_mfma_f32_16x16x32_bf16 v[216:219], a[244:247], a[24:27], v[216:219]
  v_mfma_f32_16x16x32_bf16 v[184:187], a[252:255], a[24:27], v[184:187]
  s_xor_b32 s90, s82, 0x1801800
  v_cvt_pk_bf16_f32 v202, v168, v169
  v_cvt_pk_bf16_f32 v203, v170, v171
  v_mfma_f32_16x16x32_bf16 v[184:187], a[248:251], a[8:11], v[184:187]
  buffer_store_dwordx4 v[200:203], v1, s[60:63], s90 offen sc1
  v_mfma_f32_16x16x32_bf16 v[184:187], a[220:223], a[56:59], v[184:187]
  v_mfma_f32_16x16x32_bf16 v[184:187], a[216:219], a[40:43], v[184:187]
  v_mfma_f32_16x16x32_bf16 v[184:187], a[188:191], a[88:91], v[184:187]
  v_mfma_f32_16x16x32_bf16 v[184:187], a[184:187], a[72:75], v[184:187]
  v_mfma_f32_16x16x32_bf16 v[188:191], a[184:187], a[76:79], v[188:191]
  v_cvt_pk_bf16_f32 v216, v216, v217
  v_cvt_pk_bf16_f32 v217, v218, v219
  v_mfma_f32_16x16x32_bf16 v[188:191], a[188:191], a[92:95], v[188:191]
  v_mfma_f32_16x16x32_bf16 v[188:191], a[216:219], a[44:47], v[188:191]
  v_mfma_f32_16x16x32_bf16 v[188:191], a[220:223], a[60:63], v[188:191]
  v_mfma_f32_16x16x32_bf16 v[188:191], a[248:251], a[12:15], v[188:191]
  s_waitcnt lgkmcnt(0)
  v_mfma_f32_16x16x32_bf16 v[188:191], a[252:255], a[28:31], v[188:191]
  v_mfma_f32_16x16x32_bf16 v[220:223], a[244:247], a[28:31], v[220:223]
  s_xor_b32 s91, s82, 0x1803800
  v_cvt_pk_bf16_f32 v218, v184, v185
  v_cvt_pk_bf16_f32 v219, v186, v187
  v_mfma_f32_16x16x32_bf16 v[220:223], a[240:243], a[12:15], v[220:223]
  buffer_store_dwordx4 v[216:219], v1, s[60:63], s91 offen sc1
  v_mfma_f32_16x16x32_bf16 v[220:223], a[212:215], a[60:63], v[220:223]
  v_mfma_f32_16x16x32_bf16 v[220:223], a[208:211], a[44:47], v[220:223]
  v_mfma_f32_16x16x32_bf16 v[220:223], a[180:183], a[92:95], v[220:223]
  s_mov_b32 s83, 0x4100
  v_mfma_f32_16x16x32_bf16 v[220:223], a[176:179], a[76:79], v[220:223]
  s_mov_b32 s84, 0x41000000
  v_mfma_f32_16x16x32_bf16 v[172:175], a[168:171], a[76:79], v[172:175]
  s_mov_b32 s94, 0x3f800000
  v_mfma_f32_16x16x32_bf16 v[172:175], a[172:175], a[92:95], v[172:175]
  v_mfma_f32_16x16x32_bf16 v[172:175], a[200:203], a[44:47], v[172:175]
  v_mfma_f32_16x16x32_bf16 v[172:175], a[204:207], a[60:63], v[172:175]
  v_mfma_f32_16x16x32_bf16 v[172:175], a[232:235], a[12:15], v[172:175]
  v_mfma_f32_16x16x32_bf16 v[172:175], a[236:239], a[28:31], v[172:175]
  v_mfma_f32_16x16x32_bf16 v[204:207], a[228:231], a[28:31], v[204:207]
  v_mfma_f32_16x16x32_bf16 v[204:207], a[224:227], a[12:15], v[204:207]
  v_mfma_f32_16x16x32_bf16 v[204:207], a[196:199], a[60:63], v[204:207]
  v_mfma_f32_16x16x32_bf16 v[204:207], a[192:195], a[44:47], v[204:207]
  v_mfma_f32_16x16x32_bf16 v[204:207], a[164:167], a[92:95], v[204:207]
  v_mfma_f32_16x16x32_bf16 v[204:207], a[160:163], a[76:79], v[204:207]
  v_permlane16_swap_b32 v240, v242
  v_permlane16_swap_b32 v241, v243
  v_permlane16_swap_b32 v248, v250
  v_permlane16_swap_b32 v249, v251
  v_permlane16_swap_b32 v244, v246
  v_permlane16_swap_b32 v245, v247
  v_permlane16_swap_b32 v252, v254
  v_permlane16_swap_b32 v253, v255
  v_lshlrev_b32 v224, 16, v248
  v_and_b32 v225, 0xffff0000, v248
  v_lshlrev_b32 v226, 16, v249
  v_and_b32 v227, 0xffff0000, v249
  v_lshlrev_b32 v228, 16, v250
  v_and_b32 v229, 0xffff0000, v250
  v_lshlrev_b32 v230, 16, v251
  v_and_b32 v231, 0xffff0000, v251
  v_lshlrev_b32 v232, 16, v252
  v_and_b32 v233, 0xffff0000, v252
  v_lshlrev_b32 v234, 16, v253
  v_and_b32 v235, 0xffff0000, v253
  v_lshlrev_b32 v236, 16, v254
  v_and_b32 v237, 0xffff0000, v254
  v_lshlrev_b32 v238, 16, v255
  v_and_b32 v239, 0xffff0000, v255
  buffer_load_dword v10, v26, s[60:63], s7 offen sc1
  v_dot2_f32_bf16 v224, v32, s83, v224
  v_dot2_f32_bf16 v225, v32, s84, v225
  v_dot2_f32_bf16 v226, v33, s83, v226
L_p6636:
  s_cmp_eq_u32 s95, 1
  s_cbranch_scc1 L_wback
  v_dot2_f32_bf16 v227, v33, s84, v227
  v_dot2_f32_bf16 v228, v34, s83, v228
  v_dot2_f32_bf16 v229, v34, s84, v229
  v_dot2_f32_bf16 v230, v35, s83, v230
  v_dot2_f32_bf16 v231, v35, s84, v231
  v_dot2_f32_bf16 v232, v64, s83, v232
  v_dot2_f32_bf16 v233, v64, s84, v233
  v_dot2_f32_bf16 v234, v65, s83, v234
  v_dot2_f32_bf16 v235, v65, s84, v235
  v_dot2_f32_bf16 v236, v66, s83, v236
  v_dot2_f32_bf16 v237, v66, s84, v237
  v_dot2_f32_bf16 v238, v67, s83, v238
  v_dot2_f32_bf16 v239, v67, s84, v239
  v_dot2_f32_bf16 v224, v36, s83, v224
  v_dot2_f32_bf16 v225, v36, s84, v225
  v_dot2_f32_bf16 v226, v37, s83, v226
  v_dot2_f32_bf16 v227, v37, s84, v227
  v_dot2_f32_bf16 v228, v38, s83, v228
  v_dot2_f32_bf16 v229, v38, s84, v229
  v_dot2_f32_bf16 v230, v39, s83, v230
  v_dot2_f32_bf16 v231, v39, s84, v231
  v_dot2_f32_bf16 v232, v68, s83, v232
  v_dot2_f32_bf16 v233, v68, s84, v233
  v_dot2_f32_bf16 v234, v69, s83, v234
  v_dot2_f32_bf16 v235, v69, s84, v235
  v_dot2_f32_bf16 v236, v70, s83, v236
  v_dot2_f32_bf16 v237, v70, s84, v237
  v_dot2_f32_bf16 v238, v71, s83, v238
  v_dot2_f32_bf16 v239, v71, s84, v239
  s_waitcnt vmcnt(1)
  buffer_store_dword v8, v11, s[60:63], s8 offen sc1
  s_waitcnt vmcnt(1)
  v_cmp_eq_u32 vcc, 1, v10
  s_nop 1
  s_and_b32 s12, vcc_lo, 0x7f
  s_waitcnt vmcnt(6)
  s_bitcmp1_b32 s12, 0
  s_cselect_b32 s73, s76, 0x10000000
  buffer_load_dwordx4 v[96:99], v1, s[60:63], s73 offen sc1
  v_dot2_f32_bf16 v224, v40, s83, v224
  v_dot2_f32_bf16 v225, v40, s84, v225
  v_dot2_f32_bf16 v226, v41, s83, v226
  v_dot2_f32_bf16 v227, v41, s84, v227
  v_dot2_f32_bf16 v228, v42, s83, v228
  v_dot2_f32_bf16 v229, v42, s84, v229
  v_dot2_f32_bf16 v230, v43, s83, v230
  v_dot2_f32_bf16 v231, v43, s84, v231
  s_waitcnt vmcnt(6)
  s_bitcmp1_b32 s12, 1
  s_cselect_b32 s74, s76, 0x10000000
  buffer_load_dwordx4 v[100:103], v1, s[60:63], s74 offen offset:1024 sc1
  v_dot2_f32_bf16 v232, v72, s83, v232
  v_dot2_f32_bf16 v233, v72, s84, v233
  v_dot2_f32_bf16 v234, v73, s83, v234
  v_dot2_f32_bf16 v235, v73, s84, v235
  v_dot2_f32_bf16 v236, v74, s83, v236
  v_dot2_f32_bf16 v237, v74, s84, v237
  v_dot2_f32_bf16 v238, v75, s83, v238
  v_dot2_f32_bf16 v239, v75, s84, v239
  s_waitcnt vmcnt(6)
  s_bitcmp1_b32 s12, 2
  s_cselect_b32 s73, s76, 0x10000000
  buffer_load_dwordx4 v[104:107], v1, s[60:63], s73 offen offset:2048 sc1
  v_dot2_f32_bf16 v224, v44, s83, v224
  v_dot2_f32_bf16 v225, v44, s84, v225
  v_dot2_f32_bf16 v226, v45, s83, v226
  v_dot2_f32_bf16 v227, v45, s84, v227
  v_dot2_f32_bf16 v228, v46, s83, v228
  v_dot2_f32_bf16 v229, v46, s84, v229
  v_dot2_f32_bf16 v230, v47, s83, v230
  v_dot2_f32_bf16 v231, v47, s84, v231
  s_waitcnt vmcnt(6)
  s_bitcmp1_b32 s12, 3
  s_cselect_b32 s74, s76, 0x10000000
  buffer_load_dwordx4 v[108:111], v1, s[60:63], s74 offen offset:3072 sc1
  v_dot2_f32_bf16 v232, v76, s83, v232
  v_dot2_f32_bf16 v233, v76, s84, v233
  v_dot2_f32_bf16 v234, v77, s83, v234
  v_dot2_f32_bf16 v235, v77, s84, v235
  v_dot2_f32_bf16 v236, v78, s83, v236
  v_dot2_f32_bf16 v237, v78, s84, v237
  v_dot2_f32_bf16 v238, v79, s83, v238
  v_dot2_f32_bf16 v239, v79, s84, v239
  s_waitcnt vmcnt(6)
  s_bitcmp1_b32 s12, 4
  s_cselect_b32 s73, s76, 0x10000000
  buffer_load_dwordx4 v[112:115], v9, s[60:63], s73 offen sc1
  v_dot2_f32_bf16 v224, v48, s83, v224
  v_dot2_f32_bf16 v225, v48, s84, v225
  v_dot2_f32_bf16 v226, v49, s83, v226
  v_dot2_f32_bf16 v227, v49, s84, v227
  v_dot2_f32_bf16 v228, v50, s83, v228
  v_dot2_f32_bf16 v229, v50, s84, v229
  v_dot2_f32_bf16 v230, v51, s83, v230
  v_dot2_f32_bf16 v231, v51, s84, v231
  s_waitcnt vmcnt(6)
  s_bitcmp1_b32 s12, 5
  s_cselect_b32 s74, s76, 0x10000000
  buffer_load_dwordx4 v[116:119], v9, s[60:63], s74 offen offset:1024 sc1
  v_dot2_f32_bf16 v232, v80, s83, v232
  v_dot2_f32_bf16 v233, v80, s84, v233
  v_dot2_f32_bf16 v234, v81, s83, v234
  v_dot2_f32_bf16 v235, v81, s84, v235
  v_dot2_f32_bf16 v236, v82, s83, v236
  v_dot2_f32_bf16 v237, v82, s84, v237
  v_dot2_f32_bf16 v238, v83, s83, v238
  v_dot2_f32_bf16 v239, v83, s84, v239
  s_waitcnt vmcnt(6)
  s_bitcmp1_b32 s12, 6
  s_cselect_b32 s73, s76, 0x10000000
  buffer_load_dwordx4 v[120:123], v9, s[60:63], s73 offen offset:2048 sc1
  v_dot2_f32_bf16 v224, v52, s83, v224
  v_dot2_f32_bf16 v225, v52, s84, v225
  v_dot2_f32_bf16 v226, v53, s83, v226
  v_dot2_f32_bf16 v227, v53, s84, v227
  v_dot2_f32_bf16 v228, v54, s83, v228
  v_dot2_f32_bf16 v229, v54, s84, v229
  v_dot2_f32_bf16 v230, v55, s83, v230
  v_dot2_f32_bf16 v231, v55, s84, v231
  s_waitcnt vmcnt(6)
  s_bitcmp1_b32 s12, 0
  s_cselect_b32 s73, s77, 0x10000000
  buffer_load_dwordx4 v[124:127], v1, s[60:63], s73 offen sc1
  v_dot2_f32_bf16 v232, v84, s83, v232
  v_dot2_f32_bf16 v233, v84, s84, v233
  v_dot2_f32_bf16 v234, v85, s83, v234
  v_dot2_f32_bf16 v235, v85, s84, v235
  v_dot2_f32_bf16 v236, v86, s83, v236
  v_dot2_f32_bf16 v237, v86, s84, v237
  v_dot2_f32_bf16 v238, v87, s83, v238
  v_dot2_f32_bf16 v239, v87, s84, v239
  s_waitcnt vmcnt(6)
  s_bitcmp1_b32 s12, 1
  s_cselect_b32 s74, s77, 0x10000000
  buffer_load_dwordx4 v[128:131], v1, s[60:63], s74 offen offset:1024 sc1
  v_dot2_f32_bf16 v224, v56, s83, v224
  v_dot2_f32_bf16 v225, v56, s84, v225
  v_dot2_f32_bf16 v226, v57, s83, v226
  v_dot2_f32_bf16 v227, v57, s84, v227
  v_dot2_f32_bf16 v228, v58, s83, v228
  v_dot2_f32_bf16 v229, v58, s84, v229
  v_dot2_f32_bf16 v230, v59, s83, v230
  v_dot2_f32_bf16 v231, v59, s84, v231
  s_waitcnt vmcnt(6)
  s_bitcmp1_b32 s12, 2
  s_cselect_b32 s73, s77, 0x10000000
  buffer_load_dwordx4 v[132:135], v1, s[60:63], s73 offen offset:2048 sc1
  v_dot2_f32_bf16 v232, v88, s83, v232
  v_dot2_f32_bf16 v233, v88, s84, v233
  v_dot2_f32_bf16 v234, v89, s83, v234
  v_dot2_f32_bf16 v235, v89, s84, v235
  v_dot2_f32_bf16 v236, v90, s83, v236
  v_dot2_f32_bf16 v237, v90, s84, v237
  v_dot2_f32_bf16 v238, v91, s83, v238
  v_dot2_f32_bf16 v239, v91, s84, v239
  s_waitcnt vmcnt(6)
  s_bitcmp1_b32 s12, 3
  s_cselect_b32 s74, s77, 0x10000000
  buffer_load_dwordx4 v[136:139], v1, s[60:63], s74 offen offset:3072 sc1
  v_dot2_f32_bf16 v224, v60, s83, v224
  v_dot2_f32_bf16 v225, v60, s84, v225
  v_dot2_f32_bf16 v226, v61, s83, v226
  v_dot2_f32_bf16 v227, v61, s84, v227
  v_dot2_f32_bf16 v228, v62, s83, v228
  v_dot2_f32_bf16 v229, v62, s84, v229
  v_dot2_f32_bf16 v230, v63, s83, v230
  v_dot2_f32_bf16 v231, v63, s84, v231
  s_waitcnt vmcnt(6)
  s_bitcmp1_b32 s12, 4
  s_cselect_b32 s73, s77, 0x10000000
  buffer_load_dwordx4 v[140:143], v9, s[60:63], s73 offen sc1
  v_dot2_f32_bf16 v232, v92, s83, v232
  v_dot2_f32_bf16 v233, v92, s84, v233
  v_dot2_f32_bf16 v234, v93, s83, v234
  v_dot2_f32_bf16 v235, v93, s84, v235
  v_dot2_f32_bf16 v236, v94, s83, v236
  v_dot2_f32_bf16 v237, v94, s84, v237
  v_dot2_f32_bf16 v238, v95, s83, v238
  v_dot2_f32_bf16 v239, v95, s84, v239
  s_mov_b32 s16, 0x100000
  s_mov_b32 s71, 0xbfb8aa3b
  s_waitcnt vmcnt(6)
  s_bitcmp1_b32 s12, 5
  s_cselect_b32 s74, s77, 0x10000000
  buffer_load_dwordx4 v[144:147], v9, s[60:63], s74 offen offset:1024 sc1
  v_mul_f32 v48, s71, v224
  v_mul_f32 v49, s71, v225
  v_mul_f32 v50, s71, v226
  v_mul_f32 v51, s71, v227
  v_mul_f32 v52, s71, v228
  v_mul_f32 v53, s71, v229
  v_mul_f32 v54, s71, v230
  v_mul_f32 v55, s71, v231
  v_mul_f32 v56, s71, v232
  v_mul_f32 v57, s71, v233
  v_mul_f32 v58, s71, v234
  v_mul_f32 v59, s71, v235
  v_mul_f32 v60, s71, v236
  v_mul_f32 v61, s71, v237
  v_mul_f32 v62, s71, v238
  v_mul_f32 v63, s71, v239
  v_exp_f32 v48, v48
  v_exp_f32 v49, v49
  v_exp_f32 v50, v50
  v_exp_f32 v51, v51
  v_exp_f32 v52, v52
  v_exp_f32 v53, v53
  v_exp_f32 v54, v54
  v_exp_f32 v55, v55
  v_exp_f32 v56, v56
  v_exp_f32 v57, v57
  v_exp_f32 v58, v58
  v_exp_f32 v59, v59
  v_exp_f32 v60, v60
  v_exp_f32 v61, v61
  v_exp_f32 v62, v62
  v_exp_f32 v63, v63
  s_waitcnt vmcnt(6)
  s_bitcmp1_b32 s12, 6
  s_cselect_b32 s73, s77, 0x10000000
  buffer_load_dwordx4 v[148:151], v9, s[60:63], s73 offen offset:2048 sc1
  v_add_f32 v48, 0x3f800000, v48
  v_add_f32 v49, 0x3f800000, v49
  v_add_f32 v50, 0x3f800000, v50
  v_add_f32 v51, 0x3f800000, v51
  v_add_f32 v52, 0x3f800000, v52
  v_add_f32 v53, 0x3f800000, v53
  v_add_f32 v54, 0x3f800000, v54
  v_add_f32 v55, 0x3f800000, v55
  v_add_f32 v56, 0x3f800000, v56
  v_add_f32 v57, 0x3f800000, v57
  v_add_f32 v58, 0x3f800000, v58
  v_add_f32 v59, 0x3f800000, v59
  v_add_f32 v60, 0x3f800000, v60
  v_add_f32 v61, 0x3f800000, v61
  v_add_f32 v62, 0x3f800000, v62
  v_add_f32 v63, 0x3f800000, v63
  v_rcp_f32 v48, v48
  v_rcp_f32 v49, v49
  v_rcp_f32 v50, v50
  v_rcp_f32 v51, v51
  v_rcp_f32 v52, v52
  v_rcp_f32 v53, v53
  v_rcp_f32 v54, v54
  v_rcp_f32 v55, v55
  v_rcp_f32 v56, v56
  v_rcp_f32 v57, v57
  v_rcp_f32 v58, v58
  v_rcp_f32 v59, v59
  v_rcp_f32 v60, v60
  v_rcp_f32 v61, v61
  v_rcp_f32 v62, v62
  v_rcp_f32 v63, v63
  buffer_load_dword v10, v26, s[60:63], s7 offen sc1
  v_mul_f32 v224, v224, v48
  v_mul_f32 v225, v225, v49
  v_mul_f32 v226, v226, v50
  v_mul_f32 v227, v227, v51
  v_mul_f32 v228, v228, v52
  v_mul_f32 v229, v229, v53
  v_mul_f32 v230, v230, v54
  v_mul_f32 v231, v231, v55
  v_mul_f32 v232, v232, v56
  v_mul_f32 v233, v233, v57
  v_mul_f32 v234, v234, v58
  v_mul_f32 v235, v235, v59
  v_mul_f32 v236, v236, v60
  v_mul_f32 v237, v237, v61
  v_mul_f32 v238, v238, v62
  v_mul_f32 v239, v239, v63
  v_lshlrev_b32 v32, 16, v240
  v_and_b32 v33, 0xffff0000, v240
  v_lshlrev_b32 v34, 16, v241
  v_and_b32 v35, 0xffff0000, v241
  v_lshlrev_b32 v36, 16, v242
  v_and_b32 v37, 0xffff0000, v242
  v_lshlrev_b32 v38, 16, v243
  v_and_b32 v39, 0xffff0000, v243
  v_lshlrev_b32 v40, 16, v244
  v_and_b32 v41, 0xffff0000, v244
  v_lshlrev_b32 v42, 16, v245
  v_and_b32 v43, 0xffff0000, v245
  v_lshlrev_b32 v44, 16, v246
  v_and_b32 v45, 0xffff0000, v246
  v_lshlrev_b32 v46, 16, v247
  v_and_b32 v47, 0xffff0000, v247
  s_cmp_eq_u32 s12, 0x7f
  s_cbranch_scc1 L_all1
L_poll:
  s_waitcnt vmcnt(0) lgkmcnt(0)
  v_cmp_eq_u32 vcc, 1, v10
  s_nop 1
  s_and_b32 s13, vcc_lo, 0x7f
  s_andn2_b32 s13, s13, s12
  s_cbranch_scc0 L_noc
  s_or_b32 s12, s12, s13
  s_bitcmp1_b32 s13, 0
  s_cbranch_scc0 L_skc00
  s_waitcnt vmcnt(5)
  buffer_load_dwordx4 v[96:99], v1, s[60:63], s76 offen sc1
  s_waitcnt vmcnt(5)
  buffer_load_dwordx4 v[124:127], v1, s[60:63], s77 offen sc1
L_skc00:
  s_bitcmp1_b32 s13, 1
  s_cbranch_scc0 L_skc01
  s_waitcnt vmcnt(5)
  buffer_load_dwordx4 v[100:103], v1, s[60:63], s76 offen offset:1024 sc1
  s_waitcnt vmcnt(5)
  buffer_load_dwordx4 v[128:131], v1, s[60:63], s77 offen offset:1024 sc1
L_skc01:
  s_bitcmp1_b32 s13, 2
  s_cbranch_scc0 L_skc02
  s_waitcnt vmcnt(5)
  buffer_load_dwordx4 v[104:107], v1, s[60:63], s76 offen offset:2048 sc1
  s_waitcnt vmcnt(5)
  buffer_load_dwordx4 v[132:135], v1, s[60:63], s77 offen offset:2048 sc1
L_skc02:
  s_bitcmp1_b32 s13, 3
  s_cbranch_scc0 L_skc03
  s_waitcnt vmcnt(5)
  buffer_load_dwordx4 v[108:111], v1, s[60:63], s76 offen offset:3072 sc1
  s_waitcnt vmcnt(5)
  buffer_load_dwordx4 v[136:139], v1, s[60:63], s77 offen offset:3072 sc1
L_skc03:
  s_bitcmp1_b32 s13, 4
  s_cbranch_scc0 L_skc04
  s_waitcnt vmcnt(5)
  buffer_load_dwordx4 v[112:115], v9, s[60:63], s76 offen sc1
  s_waitcnt vmcnt(5)
  buffer_load_dwordx4 v[140:143], v9, s[60:63], s77 offen sc1
L_skc04:
  s_bitcmp1_b32 s13, 5
  s_cbranch_scc0 L_skc05
  s_waitcnt vmcnt(5)
  buffer_load_dwordx4 v[116:119], v9, s[60:63], s76 offen offset:1024 sc1
  s_waitcnt vmcnt(5)
  buffer_load_dwordx4 v[144:147], v9, s[60:63], s77 offen offset:1024 sc1
L_skc05:
  s_bitcmp1_b32 s13, 6
  s_cbranch_scc0 L_skc06
  s_waitcnt vmcnt(5)
  buffer_load_dwordx4 v[120:123], v9, s[60:63], s76 offen offset:2048 sc1
  s_waitcnt vmcnt(5)
  buffer_load_dwordx4 v[148:151], v9, s[60:63], s77 offen offset:2048 sc1
L_skc06:
L_noc:
  s_cmp_eq_u32 s12, 0x7f
  s_cbranch_scc1 L_all1
  buffer_load_dword v10, v26, s[60:63], s7 offen sc1
  s_sub_u32 s16, s16, 1
  s_cbranch_scc0 L_poll
L_all1:
  s_waitcnt vmcnt(0) lgkmcnt(0)
  v_dot2_f32_bf16 v204, v96, s92, v204
  v_dot2_f32_bf16 v205, v96, s93, v205
  v_dot2_f32_bf16 v206, v97, s92, v206
  v_dot2_f32_bf16 v207, v97, s93, v207
  v_dot2_f32_bf16 v172, v98, s92, v172
  v_dot2_f32_bf16 v173, v98, s93, v173
  v_dot2_f32_bf16 v174, v99, s92, v174
  v_dot2_f32_bf16 v175, v99, s93, v175
  v_dot2_f32_bf16 v204, v100, s92, v204
  v_dot2_f32_bf16 v205, v100, s93, v205
  v_dot2_f32_bf16 v206, v101, s92, v206
  v_dot2_f32_bf16 v207, v101, s93, v207
  v_dot2_f32_bf16 v172, v102, s92, v172
  v_dot2_f32_bf16 v173, v102, s93, v173
  v_dot2_f32_bf16 v174, v103, s92, v174
  v_dot2_f32_bf16 v175, v103, s93, v175
  v_dot2_f32_bf16 v204, v104, s92, v204
  v_dot2_f32_bf16 v205, v104, s93, v205
  v_dot2_f32_bf16 v206, v105, s92, v206
  v_dot2_f32_bf16 v207, v105, s93, v207
  v_dot2_f32_bf16 v172, v106, s92, v172
  v_dot2_f32_bf16 v173, v106, s93, v173
  v_dot2_f32_bf16 v174, v107, s92, v174
  v_dot2_f32_bf16 v175, v107, s93, v175
  v_dot2_f32_bf16 v204, v108, s92, v204
  v_dot2_f32_bf16 v205, v108, s93, v205
  v_dot2_f32_bf16 v206, v109, s92, v206
  v_dot2_f32_bf16 v207, v109, s93, v207
  v_dot2_f32_bf16 v172, v110, s92, v172
  v_dot2_f32_bf16 v173, v110, s93, v173
  v_dot2_f32_bf16 v174, v111, s92, v174
  v_dot2_f32_bf16 v175, v111, s93, v175
  v_dot2_f32_bf16 v204, v112, s92, v204
  v_dot2_f32_bf16 v205, v112, s93, v205
  v_dot2_f32_bf16 v206, v113, s92, v206
  v_dot2_f32_bf16 v207, v113, s93, v207
  v_dot2_f32_bf16 v172, v114, s92, v172
  v_dot2_f32_bf16 v173, v114, s93, v173
  v_dot2_f32_bf16 v174, v115, s92, v174
  v_dot2_f32_bf16 v175, v115, s93, v175
  v_dot2_f32_bf16 v204, v116, s92, v204
  v_dot2_f32_bf16 v205, v116, s93, v205
  v_dot2_f32_bf16 v206, v117, s92, v206
  v_dot2_f32_bf16 v207, v117, s93, v207
  v_dot2_f32_bf16 v172, v118, s92, v172
  v_dot2_f32_bf16 v173, v118, s93, v173
  v_dot2_f32_bf16 v174, v119, s92, v174
  v_dot2_f32_bf16 v175, v119, s93, v175
  v_dot2_f32_bf16 v204, v120, s92, v204
  v_dot2_f32_bf16 v205, v120, s93, v205
  v_dot2_f32_bf16 v206, v121, s92, v206
  v_dot2_f32_bf16 v207, v121, s93, v207
  v_dot2_f32_bf16 v172, v122, s92, v172
  v_dot2_f32_bf16 v173, v122, s93, v173
  v_dot2_f32_bf16 v174, v123, s92, v174
  v_dot2_f32_bf16 v175, v123, s93, v175
  v_fma_f32 v32, v204, v224, v32
  v_fma_f32 v33, v205, v225, v33
  v_fma_f32 v34, v206, v226, v34
  v_fma_f32 v35, v207, v227, v35
  v_fma_f32 v36, v172, v228, v36
  v_fma_f32 v37, v173, v229, v37
  v_fma_f32 v38, v174, v230, v38
  v_fma_f32 v39, v175, v231, v39
  v_cvt_pk_bf16_f32 v240, v32, v33
  v_cvt_pk_bf16_f32 v241, v34, v35
  v_cvt_pk_bf16_f32 v242, v36, v37
  v_cvt_pk_bf16_f32 v243, v38, v39
  s_nop 0
  v_permlane16_swap_b32 v240, v242
  v_permlane16_swap_b32 v241, v243
  buffer_store_dwordx4 v[240:243], v12, s[44:47], s10 offen
  v_dot2_f32_bf16 v220, v124, s92, v220
  v_dot2_f32_bf16 v221, v124, s93, v221
  v_dot2_f32_bf16 v222, v125, s92, v222
  v_dot2_f32_bf16 v223, v125, s93, v223
  v_dot2_f32_bf16 v188, v126, s92, v188
  v_dot2_f32_bf16 v189, v126, s93, v189
  v_dot2_f32_bf16 v190, v127, s92, v190
  v_dot2_f32_bf16 v191, v127, s93, v191
  v_dot2_f32_bf16 v220, v128, s92, v220
  v_dot2_f32_bf16 v221, v128, s93, v221
  v_dot2_f32_bf16 v222, v129, s92, v222
  v_dot2_f32_bf16 v223, v129, s93, v223
  v_dot2_f32_bf16 v188, v130, s92, v188
  v_dot2_f32_bf16 v189, v130, s93, v189
  v_dot2_f32_bf16 v190, v131, s92, v190
  v_dot2_f32_bf16 v191, v131, s93, v191
  v_dot2_f32_bf16 v220, v132, s92, v220
  v_dot2_f32_bf16 v221, v132, s93, v221
  v_dot2_f32_bf16 v222, v133, s92, v222
  v_dot2_f32_bf16 v223, v133, s93, v223
  v_dot2_f32_bf16 v188, v134, s92, v188
  v_dot2_f32_bf16 v189, v134, s93, v189
  v_dot2_f32_bf16 v190, v135, s92, v190
  v_dot2_f32_bf16 v191, v135, s93, v191
  v_dot2_f32_bf16 v220, v136, s92, v220
  v_dot2_f32_bf16 v221, v136, s93, v221
  v_dot2_f32_bf16 v222, v137, s92, v222
  v_dot2_f32_bf16 v223, v137, s93, v223
  v_dot2_f32_bf16 v188, v138, s92, v188
  v_dot2_f32_bf16 v189, v138, s93, v189
  v_dot2_f32_bf16 v190, v139, s92, v190
  v_dot2_f32_bf16 v191, v139, s93, v191
  v_dot2_f32_bf16 v220, v140, s92, v220
  v_dot2_f32_bf16 v221, v140, s93, v221
  v_dot2_f32_bf16 v222, v141, s92, v222
  v_dot2_f32_bf16 v223, v141, s93, v223
  v_dot2_f32_bf16 v188, v142, s92, v188
  v_dot2_f32_bf16 v189, v142, s93, v189
  v_dot2_f32_bf16 v190, v143, s92, v190
  v_dot2_f32_bf16 v191, v143, s93, v191
  v_dot2_f32_bf16 v220, v144, s92, v220
  v_dot2_f32_bf16 v221, v144, s93, v221
  v_dot2_f32_bf16 v222, v145, s92, v222
  v_dot2_f32_bf16 v223, v145, s93, v223
  v_dot2_f32_bf16 v188, v146, s92, v188
  v_dot2_f32_bf16 v189, v146, s93, v189
  v_dot2_f32_bf16 v190, v147, s92, v190
  v_dot2_f32_bf16 v191, v147, s93, v191
  v_dot2_f32_bf16 v220, v148, s92, v220
  v_dot2_f32_bf16 v221, v148, s93, v221
  v_dot2_f32_bf16 v222, v149, s92, v222
  v_dot2_f32_bf16 v223, v149, s93, v223
  v_dot2_f32_bf16 v188, v150, s92, v188
  v_dot2_f32_bf16 v189, v150, s93, v189
  v_dot2_f32_bf16 v190, v151, s92, v190
  v_dot2_f32_bf16 v191, v151, s93, v191
  v_fma_f32 v40, v220, v232, v40
  v_fma_f32 v41, v221, v233, v41
  v_fma_f32 v42, v222, v234, v42
  v_fma_f32 v43, v223, v235, v43
  v_fma_f32 v44, v188, v236, v44
  v_fma_f32 v45, v189, v237, v45
  v_fma_f32 v46, v190, v238, v46
  v_fma_f32 v47, v191, v239, v47
  v_cvt_pk_bf16_f32 v244, v40, v41
  v_cvt_pk_bf16_f32 v245, v42, v43
  v_cvt_pk_bf16_f32 v246, v44, v45
  v_cvt_pk_bf16_f32 v247, v46, v47
  s_nop 0
  v_permlane16_swap_b32 v244, v246
  v_permlane16_swap_b32 v245, v247
  buffer_store_dwordx4 v[244:247], v12, s[44:47], s10 offen offset:64
L_end:
  s_endpgm
L_t30:
  v_bfe_u32 v242, v1, 7, 2
  v_lshlrev_b32 v242, 13, v242
  v_and_b32 v243, 0x70, v1
  v_lshl_add_u32 v242, v243, 3, v242
  s_xor_b32 s68, s31, 31
  s_lshl_b32 s68, s68, 17
  s_lshl_b32 s69, s30, 10
  s_add_u32 s68, s68, s69
  s_lshl_b32 s69, s3, 15
  s_add_u32 s68, s68, s69
  buffer_load_dword v244, v242, s[44:47], s68 offen
  v_min_u32 v243, 0xb0, v1
  v_lshlrev_b32 v243, 3, v243
  s_lshl_b32 s68, s31, 2
  s_add_u32 s68, s68, s3
  s_mul_i32 s68, s68, 0x600
  s_add_u32 s68, s68, s88
  buffer_load_dword v244, v243, s[52:55], s68 offen
  s_branch L_r30
L_t31:
  v_bfe_u32 v242, v1, 7, 2
  v_lshlrev_b32 v242, 13, v242
  v_and_b32 v243, 0x70, v1
  v_lshl_add_u32 v242, v243, 3, v242
  s_xor_b32 s68, s31, 31
  s_lshl_b32 s68, s68, 17
  s_lshl_b32 s69, s30, 10
  s_add_u32 s68, s68, s69
  s_lshl_b32 s69, s3, 15
  s_add_u32 s68, s68, s69
  buffer_load_dword v244, v242, s[44:47], s68 offen
  v_min_u32 v243, 0xb0, v1
  v_lshlrev_b32 v243, 3, v243
  s_lshl_b32 s68, s31, 2
  s_add_u32 s68, s68, s3
  s_mul_i32 s68, s68, 0x600
  s_add_u32 s68, s68, s88
  buffer_load_dword v244, v243, s[52:55], s68 offen
  s_branch L_r31
L_t32:
  v_bfe_u32 v242, v1, 7, 2
  v_lshlrev_b32 v242, 13, v242
  v_and_b32 v243, 0x70, v1
  v_lshl_add_u32 v242, v243, 3, v242
  s_xor_b32 s68, s31, 31
  s_lshl_b32 s68, s68, 17
  s_lshl_b32 s69, s30, 10
  s_add_u32 s68, s68, s69
  s_lshl_b32 s69, s3, 15
  s_add_u32 s68, s68, s69
  buffer_load_dword v244, v242, s[44:47], s68 offen
  v_min_u32 v243, 0xb0, v1
  v_lshlrev_b32 v243, 3, v243
  s_lshl_b32 s68, s31, 2
  s_add_u32 s68, s68, s3
  s_mul_i32 s68, s68, 0x600
  s_add_u32 s68, s68, s88
  buffer_load_dword v244, v243, s[52:55], s68 offen
  s_branch L_r32
L_t33:
  v_bfe_u32 v242, v1, 7, 2
  v_lshlrev_b32 v242, 13, v242
  v_and_b32 v243, 0x70, v1
  v_lshl_add_u32 v242, v243, 3, v242
  s_xor_b32 s68, s31, 31
  s_lshl_b32 s68, s68, 17
  s_lshl_b32 s69, s30, 10
  s_add_u32 s68, s68, s69
  s_lshl_b32 s69, s3, 15
  s_add_u32 s68, s68, s69
  buffer_load_dword v244, v242, s[44:47], s68 offen
  v_min_u32 v243, 0xb0, v1
  v_lshlrev_b32 v243, 3, v243
  s_lshl_b32 s68, s31, 2
  s_add_u32 s68, s68, s3
  s_mul_i32 s68, s68, 0x600
  s_add_u32 s68, s68, s88
  buffer_load_dword v244, v243, s[52:55], s68 offen
  s_branch L_r33
L_t34:
  v_bfe_u32 v242, v1, 7, 2
  v_lshlrev_b32 v242, 13, v242
  v_and_b32 v243, 0x70, v1
  v_lshl_add_u32 v242, v243, 3, v242
  s_xor_b32 s68, s31, 31
  s_lshl_b32 s68, s68, 17
  s_lshl_b32 s69, s30, 10
  s_add_u32 s68, s68, s69
  s_lshl_b32 s69, s3, 15
  s_add_u32 s68, s68, s69
  buffer_load_dword v244, v242, s[44:47], s68 offen
  v_min_u32 v243, 0xb0, v1
  v_lshlrev_b32 v243, 3, v243
  s_lshl_b32 s68, s31, 2
  s_add_u32 s68, s68, s3
  s_mul_i32 s68, s68, 0x600
  s_add_u32 s68, s68, s88
  buffer_load_dword v244, v243, s[52:55], s68 offen
  s_branch L_r34
L_t35:
  v_bfe_u32 v242, v1, 7, 2
  v_lshlrev_b32 v242, 13, v242
  v_and_b32 v243, 0x70, v1
  v_lshl_add_u32 v242, v243, 3, v242
  s_xor_b32 s68, s31, 31
  s_lshl_b32 s68, s68, 17
  s_lshl_b32 s69, s30, 10
  s_add_u32 s68, s68, s69
  s_lshl_b32 s69, s3, 15
  s_add_u32 s68, s68, s69
  buffer_load_dword v244, v242, s[44:47], s68 offen
  v_min_u32 v243, 0xb0, v1
  v_lshlrev_b32 v243, 3, v243
  s_lshl_b32 s68, s31, 2
  s_add_u32 s68, s68, s3
  s_mul_i32 s68, s68, 0x600
  s_add_u32 s68, s68, s88
  buffer_load_dword v244, v243, s[52:55], s68 offen
  s_branch L_r35
L_t36:
  v_bfe_u32 v242, v1, 7, 2
  v_lshlrev_b32 v242, 13, v242
  v_and_b32 v243, 0x70, v1
  v_lshl_add_u32 v242, v243, 3, v242
  s_xor_b32 s68, s31, 31
  s_lshl_b32 s68, s68, 17
  s_lshl_b32 s69, s30, 10
  s_add_u32 s68, s68, s69
  s_lshl_b32 s69, s3, 15
  s_add_u32 s68, s68, s69
  buffer_load_dword v244, v242, s[44:47], s68 offen
  v_min_u32 v243, 0xb0, v1
  v_lshlrev_b32 v243, 3, v243
  s_lshl_b32 s68, s31, 2
  s_add_u32 s68, s68, s3
  s_mul_i32 s68, s68, 0x600
  s_add_u32 s68, s68, s88
  buffer_load_dword v244, v243, s[52:55], s68 offen
  s_branch L_r36
L_t37:
  v_bfe_u32 v242, v1, 7, 2
  v_lshlrev_b32 v242, 13, v242
  v_and_b32 v243, 0x70, v1
  v_lshl_add_u32 v242, v243, 3, v242
  s_xor_b32 s68, s31, 31
  s_lshl_b32 s68, s68, 17
  s_lshl_b32 s69, s30, 10
  s_add_u32 s68, s68, s69
  s_lshl_b32 s69, s3, 15
  s_add_u32 s68, s68, s69
  buffer_load_dword v244, v242, s[44:47], s68 offen
  v_min_u32 v243, 0xb0, v1
  v_lshlrev_b32 v243, 3, v243
  s_lshl_b32 s68, s31, 2
  s_add_u32 s68, s68, s3
  s_mul_i32 s68, s68, 0x600
  s_add_u32 s68, s68, s88
  buffer_load_dword v244, v243, s[52:55], s68 offen
  s_branch L_r37
L_t38:
  v_bfe_u32 v242, v1, 7, 2
  v_lshlrev_b32 v242, 13, v242
  v_and_b32 v243, 0x70, v1
  v_lshl_add_u32 v242, v243, 3, v242
  s_xor_b32 s68, s31, 31
  s_lshl_b32 s68, s68, 17
  s_lshl_b32 s69, s30, 10
  s_add_u32 s68, s68, s69
  s_lshl_b32 s69, s3, 15
  s_add_u32 s68, s68, s69
  buffer_load_dword v244, v242, s[44:47], s68 offen
  v_min_u32 v243, 0xb0, v1
  v_lshlrev_b32 v243, 3, v243
  s_lshl_b32 s68, s31, 2
  s_add_u32 s68, s68, s3
  s_mul_i32 s68, s68, 0x600
  s_add_u32 s68, s68, s88
  buffer_load_dword v244, v243, s[52:55], s68 offen
  s_branch L_r38
L_t39:
  v_bfe_u32 v242, v1, 7, 2
  v_lshlrev_b32 v242, 13, v242
  v_and_b32 v243, 0x70, v1
  v_lshl_add_u32 v242, v243, 3, v242
  s_xor_b32 s68, s31, 31
  s_lshl_b32 s68, s68, 17
  s_lshl_b32 s69, s30, 10
  s_add_u32 s68, s68, s69
  s_lshl_b32 s69, s3, 15
  s_add_u32 s68, s68, s69
  buffer_load_dword v244, v242, s[44:47], s68 offen
  v_min_u32 v243, 0xb0, v1
  v_lshlrev_b32 v243, 3, v243
  s_lshl_b32 s68, s31, 2
  s_add_u32 s68, s68, s3
  s_mul_i32 s68, s68, 0x600
  s_add_u32 s68, s68, s88
  buffer_load_dword v244, v243, s[52:55], s68 offen
  s_branch L_r39
L_t310:
  v_bfe_u32 v242, v1, 7, 2
  v_lshlrev_b32 v242, 13, v242
  v_and_b32 v243, 0x70, v1
  v_lshl_add_u32 v242, v243, 3, v242
  s_xor_b32 s68, s31, 31
  s_lshl_b32 s68, s68, 17
  s_lshl_b32 s69, s30, 10
  s_add_u32 s68, s68, s69
  s_lshl_b32 s69, s3, 15
  s_add_u32 s68, s68, s69
  buffer_load_dword v244, v242, s[44:47], s68 offen
  v_min_u32 v243, 0xb0, v1
  v_lshlrev_b32 v243, 3, v243
  s_lshl_b32 s68, s31, 2
  s_add_u32 s68, s68, s3
  s_mul_i32 s68, s68, 0x600
  s_add_u32 s68, s68, s88
  buffer_load_dword v244, v243, s[52:55], s68 offen
  s_branch L_r310
L_t311:
  v_bfe_u32 v242, v1, 7, 2
  v_lshlrev_b32 v242, 13, v242
  v_and_b32 v243, 0x70, v1
  v_lshl_add_u32 v242, v243, 3, v242
  s_xor_b32 s68, s31, 31
  s_lshl_b32 s68, s68, 17
  s_lshl_b32 s69, s30, 10
  s_add_u32 s68, s68, s69
  s_lshl_b32 s69, s3, 15
  s_add_u32 s68, s68, s69
  buffer_load_dword v244, v242, s[44:47], s68 offen
  v_min_u32 v243, 0xb0, v1
  v_lshlrev_b32 v243, 3, v243
  s_lshl_b32 s68, s31, 2
  s_add_u32 s68, s68, s3
  s_mul_i32 s68, s68, 0x600
  s_add_u32 s68, s68, s88
  buffer_load_dword v244, v243, s[52:55], s68 offen
  s_branch L_r311
L_t312:
  v_bfe_u32 v242, v1, 7, 2
  v_lshlrev_b32 v242, 13, v242
  v_and_b32 v243, 0x70, v1
  v_lshl_add_u32 v242, v243, 3, v242
  s_xor_b32 s68, s31, 31
  s_lshl_b32 s68, s68, 17
  s_lshl_b32 s69, s30, 10
  s_add_u32 s68, s68, s69
  s_lshl_b32 s69, s3, 15
  s_add_u32 s68, s68, s69
  buffer_load_dword v244, v242, s[44:47], s68 offen
  v_min_u32 v243, 0xb0, v1
  v_lshlrev_b32 v243, 3, v243
  s_lshl_b32 s68, s31, 2
  s_add_u32 s68, s68, s3
  s_mul_i32 s68, s68, 0x600
  s_add_u32 s68, s68, s88
  buffer_load_dword v244, v243, s[52:55], s68 offen
  s_branch L_r312
L_t313:
  v_bfe_u32 v242, v1, 7, 2
  v_lshlrev_b32 v242, 13, v242
  v_and_b32 v243, 0x70, v1
  v_lshl_add_u32 v242, v243, 3, v242
  s_xor_b32 s68, s31, 31
  s_lshl_b32 s68, s68, 17
  s_lshl_b32 s69, s30, 10
  s_add_u32 s68, s68, s69
  s_lshl_b32 s69, s3, 15
  s_add_u32 s68, s68, s69
  buffer_load_dword v244, v242, s[44:47], s68 offen
  v_min_u32 v243, 0xb0, v1
  v_lshlrev_b32 v243, 3, v243
  s_lshl_b32 s68, s31, 2
  s_add_u32 s68, s68, s3
  s_mul_i32 s68, s68, 0x600
  s_add_u32 s68, s68, s88
  buffer_load_dword v244, v243, s[52:55], s68 offen
  s_branch L_r313
L_t314:
  v_bfe_u32 v242, v1, 7, 2
  v_lshlrev_b32 v242, 13, v242
  v_and_b32 v243, 0x70, v1
  v_lshl_add_u32 v242, v243, 3, v242
  s_xor_b32 s68, s31, 31
  s_lshl_b32 s68, s68, 17
  s_lshl_b32 s69, s30, 10
  s_add_u32 s68, s68, s69
  s_lshl_b32 s69, s3, 15
  s_add_u32 s68, s68, s69
  buffer_load_dword v244, v242, s[44:47], s68 offen
  v_min_u32 v243, 0xb0, v1
  v_lshlrev_b32 v243, 3, v243
  s_lshl_b32 s68, s31, 2
  s_add_u32 s68, s68, s3
  s_mul_i32 s68, s68, 0x600
  s_add_u32 s68, s68, s88
  buffer_load_dword v244, v243, s[52:55], s68 offen
  s_branch L_r314
L_t315:
  v_bfe_u32 v242, v1, 7, 2
  v_lshlrev_b32 v242, 13, v242
  v_and_b32 v243, 0x70, v1
  v_lshl_add_u32 v242, v243, 3, v242
  s_xor_b32 s68, s31, 31
  s_lshl_b32 s68, s68, 17
  s_lshl_b32 s69, s30, 10
  s_add_u32 s68, s68, s69
  s_lshl_b32 s69, s3, 15
  s_add_u32 s68, s68, s69
  buffer_load_dword v244, v242, s[44:47], s68 offen
  v_min_u32 v243, 0xb0, v1
  v_lshlrev_b32 v243, 3, v243
  s_lshl_b32 s68, s31, 2
  s_add_u32 s68, s68, s3
  s_mul_i32 s68, s68, 0x600
  s_add_u32 s68, s68, s88
  buffer_load_dword v244, v243, s[52:55], s68 offen
  s_branch L_r315
.p2align 12
L_wide:
L_w3:
L_p7451:
  s_cmp_eq_u32 s95, 1
  s_cbranch_scc1 L_p9590
  v_mul_u32_u24 v236, 0xe00, v225
  v_add3_u32 v6, v236, v229, s76
  v_add_u32 v7, 0xdc00, v6
  v_add_u32 v8, 0x3000, v6
  v_add_u32 v9, 0x10c00, v6
  s_waitcnt vmcnt(19)
  v_lshlrev_b32 v245, 16, v32
  v_xor_b32 v245, 0x80000000, v245
  s_nop 1
  v_mov_b32_dpp v245, v245 quad_perm:[0,0,0,0] row_mask:0xf bank_mask:0xf
  v_dot2_f32_bf16 v96, v32, s92, v245
  v_dot2_f32_bf16 v97, v32, s93, v245
  v_dot2_f32_bf16 v98, v33, s92, v245
  v_dot2_f32_bf16 v99, v33, s93, v245
  v_dot2_f32_bf16 v100, v34, s92, v245
  v_dot2_f32_bf16 v101, v34, s93, v245
  v_dot2_f32_bf16 v102, v35, s92, v245
  v_dot2_f32_bf16 v103, v35, s93, v245
  v_pk_mul_f32 v[252:253], v[96:97], v[96:97]
  v_pk_mul_f32 v[254:255], v[98:99], v[98:99]
  v_pk_fma_f32 v[252:253], v[100:101], v[100:101], v[252:253]
  v_pk_fma_f32 v[254:255], v[102:103], v[102:103], v[254:255]
  v_pk_add_f32 v[248:249], v[100:101], v[96:97]
  v_pk_add_f32 v[250:251], v[102:103], v[98:99]
  s_waitcnt vmcnt(18)
  v_dot2_f32_bf16 v104, v36, s92, v245
  v_dot2_f32_bf16 v105, v36, s93, v245
  v_dot2_f32_bf16 v106, v37, s92, v245
  v_dot2_f32_bf16 v107, v37, s93, v245
  v_dot2_f32_bf16 v108, v38, s92, v245
  v_dot2_f32_bf16 v109, v38, s93, v245
  v_dot2_f32_bf16 v110, v39, s92, v245
  v_dot2_f32_bf16 v111, v39, s93, v245
  v_pk_fma_f32 v[252:253], v[104:105], v[104:105], v[252:253]
  v_pk_fma_f32 v[254:255], v[106:107], v[106:107], v[254:255]
  v_pk_fma_f32 v[252:253], v[108:109], v[108:109], v[252:253]
  v_pk_fma_f32 v[254:255], v[110:111], v[110:111], v[254:255]
  v_pk_add_f32 v[248:249], v[104:105], v[248:249]
  v_pk_add_f32 v[250:251], v[106:107], v[250:251]
  v_pk_add_f32 v[248:249], v[108:109], v[248:249]
  v_pk_add_f32 v[250:251], v[110:111], v[250:251]
  s_waitcnt vmcnt(17)
  v_dot2_f32_bf16 v112, v40, s92, v245
  v_dot2_f32_bf16 v113, v40, s93, v245
  v_dot2_f32_bf16 v114, v41, s92, v245
  v_dot2_f32_bf16 v115, v41, s93, v245
  v_dot2_f32_bf16 v116, v42, s92, v245
  v_dot2_f32_bf16 v117, v42, s93, v245
  v_dot2_f32_bf16 v118, v43, s92, v245
  v_dot2_f32_bf16 v119, v43, s93, v245
  v_pk_fma_f32 v[252:253], v[112:113], v[112:113], v[252:253]
  v_pk_fma_f32 v[254:255], v[114:115], v[114:115], v[254:255]
  v_pk_fma_f32 v[252:253], v[116:117], v[116:117], v[252:253]
  v_pk_fma_f32 v[254:255], v[118:119], v[118:119], v[254:255]
  v_pk_add_f32 v[248:249], v[112:113], v[248:249]
  v_pk_add_f32 v[250:251], v[114:115], v[250:251]
  v_pk_add_f32 v[248:249], v[116:117], v[248:249]
  v_pk_add_f32 v[250:251], v[118:119], v[250:251]
  s_waitcnt vmcnt(16)
  v_dot2_f32_bf16 v120, v44, s92, v245
  v_dot2_f32_bf16 v121, v44, s93, v245
  v_dot2_f32_bf16 v122, v45, s92, v245
  v_dot2_f32_bf16 v123, v45, s93, v245
  v_dot2_f32_bf16 v124, v46, s92, v245
  v_dot2_f32_bf16 v125, v46, s93, v245
  v_dot2_f32_bf16 v126, v47, s92, v245
  v_dot2_f32_bf16 v127, v47, s93, v245
  v_pk_fma_f32 v[252:253], v[120:121], v[120:121], v[252:253]
  v_pk_fma_f32 v[254:255], v[122:123], v[122:123], v[254:255]
  v_pk_fma_f32 v[252:253], v[124:125], v[124:125], v[252:253]
  v_pk_fma_f32 v[254:255], v[126:127], v[126:127], v[254:255]
  v_pk_add_f32 v[248:249], v[120:121], v[248:249]
  v_pk_add_f32 v[250:251], v[122:123], v[250:251]
  v_pk_add_f32 v[248:249], v[124:125], v[248:249]
  v_pk_add_f32 v[250:251], v[126:127], v[250:251]
  s_waitcnt vmcnt(15)
  v_dot2_f32_bf16 v128, v48, s92, v245
  v_dot2_f32_bf16 v129, v48, s93, v245
  v_dot2_f32_bf16 v130, v49, s92, v245
  v_dot2_f32_bf16 v131, v49, s93, v245
  v_dot2_f32_bf16 v132, v50, s92, v245
  v_dot2_f32_bf16 v133, v50, s93, v245
  v_dot2_f32_bf16 v134, v51, s92, v245
  v_dot2_f32_bf16 v135, v51, s93, v245
  v_pk_fma_f32 v[252:253], v[128:129], v[128:129], v[252:253]
  v_pk_fma_f32 v[254:255], v[130:131], v[130:131], v[254:255]
  v_pk_fma_f32 v[252:253], v[132:133], v[132:133], v[252:253]
  v_pk_fma_f32 v[254:255], v[134:135], v[134:135], v[254:255]
  v_pk_add_f32 v[248:249], v[128:129], v[248:249]
  v_pk_add_f32 v[250:251], v[130:131], v[250:251]
  v_pk_add_f32 v[248:249], v[132:133], v[248:249]
  v_pk_add_f32 v[250:251], v[134:135], v[250:251]
  s_waitcnt vmcnt(14)
  v_dot2_f32_bf16 v136, v52, s92, v245
  v_dot2_f32_bf16 v137, v52, s93, v245
  v_dot2_f32_bf16 v138, v53, s92, v245
  v_dot2_f32_bf16 v139, v53, s93, v245
  v_dot2_f32_bf16 v140, v54, s92, v245
  v_dot2_f32_bf16 v141, v54, s93, v245
  v_dot2_f32_bf16 v142, v55, s92, v245
  v_dot2_f32_bf16 v143, v55, s93, v245
  v_pk_fma_f32 v[252:253], v[136:137], v[136:137], v[252:253]
  v_pk_fma_f32 v[254:255], v[138:139], v[138:139], v[254:255]
  v_pk_fma_f32 v[252:253], v[140:141], v[140:141], v[252:253]
  v_pk_fma_f32 v[254:255], v[142:143], v[142:143], v[254:255]
  v_pk_add_f32 v[248:249], v[136:137], v[248:249]
  v_pk_add_f32 v[250:251], v[138:139], v[250:251]
  v_pk_add_f32 v[248:249], v[140:141], v[248:249]
  v_pk_add_f32 v[250:251], v[142:143], v[250:251]
  s_waitcnt vmcnt(13)
  v_dot2_f32_bf16 v144, v56, s92, v245
  v_dot2_f32_bf16 v145, v56, s93, v245
  v_dot2_f32_bf16 v146, v57, s92, v245
  v_dot2_f32_bf16 v147, v57, s93, v245
  v_dot2_f32_bf16 v148, v58, s92, v245
  v_dot2_f32_bf16 v149, v58, s93, v245
  v_dot2_f32_bf16 v150, v59, s92, v245
  v_dot2_f32_bf16 v151, v59, s93, v245
  v_pk_fma_f32 v[252:253], v[144:145], v[144:145], v[252:253]
  v_pk_fma_f32 v[254:255], v[146:147], v[146:147], v[254:255]
  v_pk_fma_f32 v[252:253], v[148:149], v[148:149], v[252:253]
  v_pk_fma_f32 v[254:255], v[150:151], v[150:151], v[254:255]
  v_pk_add_f32 v[248:249], v[144:145], v[248:249]
  v_pk_add_f32 v[250:251], v[146:147], v[250:251]
  v_pk_add_f32 v[248:249], v[148:149], v[248:249]
  v_pk_add_f32 v[250:251], v[150:151], v[250:251]
  s_mov_b32 s73, 0
  s_add_u32 m0, s72, 0
  s_nop 0
  buffer_load_dwordx4 v6, s[48:51], s73 offen lds
  s_waitcnt vmcnt(13)
  v_dot2_f32_bf16 v152, v60, s92, v245
  v_dot2_f32_bf16 v153, v60, s93, v245
  v_dot2_f32_bf16 v154, v61, s92, v245
  v_dot2_f32_bf16 v155, v61, s93, v245
  v_dot2_f32_bf16 v156, v62, s92, v245
  v_dot2_f32_bf16 v157, v62, s93, v245
  v_dot2_f32_bf16 v158, v63, s92, v245
  v_dot2_f32_bf16 v159, v63, s93, v245
  v_pk_fma_f32 v[252:253], v[152:153], v[152:153], v[252:253]
  v_pk_fma_f32 v[254:255], v[154:155], v[154:155], v[254:255]
  v_pk_fma_f32 v[252:253], v[156:157], v[156:157], v[252:253]
  v_pk_fma_f32 v[254:255], v[158:159], v[158:159], v[254:255]
  v_pk_add_f32 v[248:249], v[152:153], v[248:249]
  v_pk_add_f32 v[250:251], v[154:155], v[250:251]
  v_pk_add_f32 v[248:249], v[156:157], v[248:249]
  v_pk_add_f32 v[250:251], v[158:159], v[250:251]
  buffer_load_dwordx4 v7, s[48:51], s73 offen offset:1024 lds
  s_waitcnt vmcnt(13)
  v_dot2_f32_bf16 v160, v64, s92, v245
  v_dot2_f32_bf16 v161, v64, s93, v245
  v_dot2_f32_bf16 v162, v65, s92, v245
  v_dot2_f32_bf16 v163, v65, s93, v245
  v_dot2_f32_bf16 v164, v66, s92, v245
  v_dot2_f32_bf16 v165, v66, s93, v245
  v_dot2_f32_bf16 v166, v67, s92, v245
  v_dot2_f32_bf16 v167, v67, s93, v245
  v_pk_fma_f32 v[252:253], v[160:161], v[160:161], v[252:253]
  v_pk_fma_f32 v[254:255], v[162:163], v[162:163], v[254:255]
  v_pk_fma_f32 v[252:253], v[164:165], v[164:165], v[252:253]
  v_pk_fma_f32 v[254:255], v[166:167], v[166:167], v[254:255]
  v_pk_add_f32 v[248:249], v[160:161], v[248:249]
  v_pk_add_f32 v[250:251], v[162:163], v[250:251]
  v_pk_add_f32 v[248:249], v[164:165], v[248:249]
  v_pk_add_f32 v[250:251], v[166:167], v[250:251]
  buffer_load_dwordx4 v8, s[48:51], s73 offen offset:2048 lds
  s_waitcnt vmcnt(13)
  v_dot2_f32_bf16 v168, v68, s92, v245
  v_dot2_f32_bf16 v169, v68, s93, v245
  v_dot2_f32_bf16 v170, v69, s92, v245
  v_dot2_f32_bf16 v171, v69, s93, v245
  v_dot2_f32_bf16 v172, v70, s92, v245
  v_dot2_f32_bf16 v173, v70, s93, v245
  v_dot2_f32_bf16 v174, v71, s92, v245
  v_dot2_f32_bf16 v175, v71, s93, v245
  v_pk_fma_f32 v[252:253], v[168:169], v[168:169], v[252:253]
  v_pk_fma_f32 v[254:255], v[170:171], v[170:171], v[254:255]
  v_pk_fma_f32 v[252:253], v[172:173], v[172:173], v[252:253]
  v_pk_fma_f32 v[254:255], v[174:175], v[174:175], v[254:255]
  v_pk_add_f32 v[248:249], v[168:169], v[248:249]
  v_pk_add_f32 v[250:251], v[170:171], v[250:251]
  v_pk_add_f32 v[248:249], v[172:173], v[248:249]
  v_pk_add_f32 v[250:251], v[174:175], v[250:251]
  buffer_load_dwordx4 v9, s[48:51], s73 offen offset:3072 lds
  s_waitcnt vmcnt(13)
  v_accvgpr_read_b32 v225, a64
  v_accvgpr_read_b32 v227, a65
  s_waitcnt vmcnt(12)
  v_accvgpr_read_b32 v229, a66
  v_accvgpr_read_b32 v231, a67
  s_waitcnt vmcnt(11)
  v_accvgpr_read_b32 v233, a68
  v_accvgpr_read_b32 v235, a69
  s_waitcnt vmcnt(10)
  v_accvgpr_read_b32 v237, a70
  v_accvgpr_read_b32 v239, a71
  v_lshlrev_b32 v224, 16, v225
  v_and_b32 v225, 0xffff0000, v225
  v_lshlrev_b32 v226, 16, v227
  v_and_b32 v227, 0xffff0000, v227
  v_lshlrev_b32 v228, 16, v229
  v_and_b32 v229, 0xffff0000, v229
  v_lshlrev_b32 v230, 16, v231
  v_and_b32 v231, 0xffff0000, v231
  v_lshlrev_b32 v232, 16, v233
  v_and_b32 v233, 0xffff0000, v233
  v_lshlrev_b32 v234, 16, v235
  v_and_b32 v235, 0xffff0000, v235
  v_lshlrev_b32 v236, 16, v237
  v_and_b32 v237, 0xffff0000, v237
  v_lshlrev_b32 v238, 16, v239
  v_and_b32 v239, 0xffff0000, v239
  v_pk_mul_f32 v[224:225], v[224:225], s[80:81] op_sel:[0,1] op_sel_hi:[1,1]
  v_pk_mul_f32 v[226:227], v[226:227], s[80:81] op_sel:[0,1] op_sel_hi:[1,1]
  v_pk_mul_f32 v[228:229], v[228:229], s[80:81] op_sel:[0,1] op_sel_hi:[1,1]
  v_pk_mul_f32 v[230:231], v[230:231], s[80:81] op_sel:[0,1] op_sel_hi:[1,1]
  v_pk_mul_f32 v[232:233], v[232:233], s[80:81] op_sel:[0,1] op_sel_hi:[1,1]
  v_pk_mul_f32 v[234:235], v[234:235], s[80:81] op_sel:[0,1] op_sel_hi:[1,1]
  v_pk_mul_f32 v[236:237], v[236:237], s[80:81] op_sel:[0,1] op_sel_hi:[1,1]
  v_pk_mul_f32 v[238:239], v[238:239], s[80:81] op_sel:[0,1] op_sel_hi:[1,1]
  s_waitcnt vmcnt(9)
  v_dot2_f32_bf16 v176, v72, s92, v245
  v_dot2_f32_bf16 v177, v72, s93, v245
  v_dot2_f32_bf16 v178, v73, s92, v245
  v_dot2_f32_bf16 v179, v73, s93, v245
  v_dot2_f32_bf16 v180, v74, s92, v245
  v_dot2_f32_bf16 v181, v74, s93, v245
  v_dot2_f32_bf16 v182, v75, s92, v245
  v_dot2_f32_bf16 v183, v75, s93, v245
  v_pk_fma_f32 v[252:253], v[176:177], v[176:177], v[252:253]
  v_pk_fma_f32 v[254:255], v[178:179], v[178:179], v[254:255]
  v_pk_fma_f32 v[252:253], v[180:181], v[180:181], v[252:253]
  v_pk_fma_f32 v[254:255], v[182:183], v[182:183], v[254:255]
  v_pk_add_f32 v[248:249], v[176:177], v[248:249]
  v_pk_add_f32 v[250:251], v[178:179], v[250:251]
  v_pk_add_f32 v[248:249], v[180:181], v[248:249]
  v_pk_add_f32 v[250:251], v[182:183], v[250:251]
  s_mov_b32 s74, 0x1c000
  s_add_u32 m0, s72, 0x1000
  s_nop 0
  buffer_load_dwordx4 v6, s[48:51], s74 offen lds
  s_waitcnt vmcnt(9)
  v_dot2_f32_bf16 v184, v76, s92, v245
  v_dot2_f32_bf16 v185, v76, s93, v245
  v_dot2_f32_bf16 v186, v77, s92, v245
  v_dot2_f32_bf16 v187, v77, s93, v245
  v_dot2_f32_bf16 v188, v78, s92, v245
  v_dot2_f32_bf16 v189, v78, s93, v245
  v_dot2_f32_bf16 v190, v79, s92, v245
  v_dot2_f32_bf16 v191, v79, s93, v245
  v_pk_fma_f32 v[252:253], v[184:185], v[184:185], v[252:253]
  v_pk_fma_f32 v[254:255], v[186:187], v[186:187], v[254:255]
  v_pk_fma_f32 v[252:253], v[188:189], v[188:189], v[252:253]
  v_pk_fma_f32 v[254:255], v[190:191], v[190:191], v[254:255]
  v_pk_add_f32 v[248:249], v[184:185], v[248:249]
  v_pk_add_f32 v[250:251], v[186:187], v[250:251]
  v_pk_add_f32 v[248:249], v[188:189], v[248:249]
  v_pk_add_f32 v[250:251], v[190:191], v[250:251]
  buffer_load_dwordx4 v7, s[48:51], s74 offen offset:1024 lds
  s_waitcnt vmcnt(9)
  v_dot2_f32_bf16 v192, v80, s92, v245
  v_dot2_f32_bf16 v193, v80, s93, v245
  v_dot2_f32_bf16 v194, v81, s92, v245
  v_dot2_f32_bf16 v195, v81, s93, v245
  v_dot2_f32_bf16 v196, v82, s92, v245
  v_dot2_f32_bf16 v197, v82, s93, v245
  v_dot2_f32_bf16 v198, v83, s92, v245
  v_dot2_f32_bf16 v199, v83, s93, v245
  v_pk_fma_f32 v[252:253], v[192:193], v[192:193], v[252:253]
  v_pk_fma_f32 v[254:255], v[194:195], v[194:195], v[254:255]
  v_pk_fma_f32 v[252:253], v[196:197], v[196:197], v[252:253]
  v_pk_fma_f32 v[254:255], v[198:199], v[198:199], v[254:255]
  v_pk_add_f32 v[248:249], v[192:193], v[248:249]
  v_pk_add_f32 v[250:251], v[194:195], v[250:251]
  v_pk_add_f32 v[248:249], v[196:197], v[248:249]
  v_pk_add_f32 v[250:251], v[198:199], v[250:251]
  buffer_load_dwordx4 v8, s[48:51], s74 offen offset:2048 lds
  s_waitcnt vmcnt(9)
  v_dot2_f32_bf16 v200, v84, s92, v245
  v_dot2_f32_bf16 v201, v84, s93, v245
  v_dot2_f32_bf16 v202, v85, s92, v245
  v_dot2_f32_bf16 v203, v85, s93, v245
  v_dot2_f32_bf16 v204, v86, s92, v245
  v_dot2_f32_bf16 v205, v86, s93, v245
  v_dot2_f32_bf16 v206, v87, s92, v245
  v_dot2_f32_bf16 v207, v87, s93, v245
  v_pk_fma_f32 v[252:253], v[200:201], v[200:201], v[252:253]
  v_pk_fma_f32 v[254:255], v[202:203], v[202:203], v[254:255]
  v_pk_fma_f32 v[252:253], v[204:205], v[204:205], v[252:253]
  v_pk_fma_f32 v[254:255], v[206:207], v[206:207], v[254:255]
  v_pk_add_f32 v[248:249], v[200:201], v[248:249]
  v_pk_add_f32 v[250:251], v[202:203], v[250:251]
  v_pk_add_f32 v[248:249], v[204:205], v[248:249]
  v_pk_add_f32 v[250:251], v[206:207], v[250:251]
  buffer_load_dwordx4 v9, s[48:51], s74 offen offset:3072 lds
  s_waitcnt vmcnt(9)
  v_dot2_f32_bf16 v208, v88, s92, v245
  v_dot2_f32_bf16 v209, v88, s93, v245
  v_dot2_f32_bf16 v210, v89, s92, v245
  v_dot2_f32_bf16 v211, v89, s93, v245
  v_dot2_f32_bf16 v212, v90, s92, v245
  v_dot2_f32_bf16 v213, v90, s93, v245
  v_dot2_f32_bf16 v214, v91, s92, v245
  v_dot2_f32_bf16 v215, v91, s93, v245
  v_pk_fma_f32 v[252:253], v[208:209], v[208:209], v[252:253]
  v_pk_fma_f32 v[254:255], v[210:211], v[210:211], v[254:255]
  v_pk_fma_f32 v[252:253], v[212:213], v[212:213], v[252:253]
  v_pk_fma_f32 v[254:255], v[214:215], v[214:215], v[254:255]
  v_pk_add_f32 v[248:249], v[208:209], v[248:249]
  v_pk_add_f32 v[250:251], v[210:211], v[250:251]
  v_pk_add_f32 v[248:249], v[212:213], v[248:249]
  v_pk_add_f32 v[250:251], v[214:215], v[250:251]
  s_mov_b32 s73, 0x38000
  s_add_u32 m0, s72, 0x2000
  s_nop 0
  buffer_load_dwordx4 v6, s[48:51], s73 offen lds
  s_waitcnt vmcnt(9)
  v_dot2_f32_bf16 v216, v92, s92, v245
  v_dot2_f32_bf16 v217, v92, s93, v245
  v_dot2_f32_bf16 v218, v93, s92, v245
  v_dot2_f32_bf16 v219, v93, s93, v245
  v_dot2_f32_bf16 v220, v94, s92, v245
  v_dot2_f32_bf16 v221, v94, s93, v245
  v_dot2_f32_bf16 v222, v95, s92, v245
  v_dot2_f32_bf16 v223, v95, s93, v245
  v_pk_fma_f32 v[252:253], v[216:217], v[216:217], v[252:253]
  v_pk_fma_f32 v[254:255], v[218:219], v[218:219], v[254:255]
  v_pk_fma_f32 v[252:253], v[220:221], v[220:221], v[252:253]
  v_pk_fma_f32 v[254:255], v[222:223], v[222:223], v[254:255]
  v_pk_add_f32 v[248:249], v[216:217], v[248:249]
  v_pk_add_f32 v[250:251], v[218:219], v[250:251]
  v_pk_add_f32 v[248:249], v[220:221], v[248:249]
  v_pk_add_f32 v[250:251], v[222:223], v[250:251]
  buffer_load_dwordx4 v7, s[48:51], s73 offen offset:1024 lds
  v_pk_add_f32 v[248:249], v[248:249], v[250:251]
  v_pk_add_f32 v[252:253], v[252:253], v[254:255]
  v_add_f32 v248, v248, v249
  v_add_f32 v252, v252, v253
  v_mov_b32 v250, 0x3727c5ac
  v_add_f32_dpp v248, v248, v248 quad_perm:[1,0,3,2] row_mask:0xf bank_mask:0xf
  v_add_f32_dpp v252, v252, v252 quad_perm:[1,0,3,2] row_mask:0xf bank_mask:0xf
  s_nop 0
  v_add_f32_dpp v248, v248, v248 quad_perm:[2,3,0,1] row_mask:0xf bank_mask:0xf
  v_add_f32_dpp v252, v252, v252 quad_perm:[2,3,0,1] row_mask:0xf bank_mask:0xf
  v_mul_f32 v248, 0x3b000000, v248
  v_fmac_f32 v250, 0x3b000000, v252
  v_fma_f32 v250, -v248, v248, v250
  v_max_f32 v250, 0x3727c5ac, v250
  v_rsq_f32 v250, v250
  s_nop 0
  v_mul_f32 v250, s81, v250
  v_mul_f32 v254, -v248, v250
  v_pk_fma_f32 v[96:97], v[96:97], v[250:251], v[254:255] op_sel_hi:[1,0,0]
  v_pk_fma_f32 v[98:99], v[98:99], v[250:251], v[254:255] op_sel_hi:[1,0,0]
  v_pk_fma_f32 v[100:101], v[100:101], v[250:251], v[254:255] op_sel_hi:[1,0,0]
  v_pk_fma_f32 v[102:103], v[102:103], v[250:251], v[254:255] op_sel_hi:[1,0,0]
  v_cvt_pk_bf16_f32 v32, v96, v97
  v_cvt_pk_bf16_f32 v33, v98, v99
  v_cvt_pk_bf16_f32 v34, v100, v101
  v_cvt_pk_bf16_f32 v35, v102, v103
  ds_write_b128 v246, v[32:35]
  buffer_load_dwordx4 v8, s[48:51], s73 offen offset:2048 lds
  v_pk_fma_f32 v[104:105], v[104:105], v[250:251], v[254:255] op_sel_hi:[1,0,0]
  v_pk_fma_f32 v[106:107], v[106:107], v[250:251], v[254:255] op_sel_hi:[1,0,0]
  v_pk_fma_f32 v[108:109], v[108:109], v[250:251], v[254:255] op_sel_hi:[1,0,0]
  v_pk_fma_f32 v[110:111], v[110:111], v[250:251], v[254:255] op_sel_hi:[1,0,0]
  v_cvt_pk_bf16_f32 v36, v104, v105
  v_cvt_pk_bf16_f32 v37, v106, v107
  v_cvt_pk_bf16_f32 v38, v108, v109
  v_cvt_pk_bf16_f32 v39, v110, v111
  ds_write_b128 v246, v[36:39] offset:4096
  buffer_load_dwordx4 v9, s[48:51], s73 offen offset:3072 lds
  v_pk_fma_f32 v[112:113], v[112:113], v[250:251], v[254:255] op_sel_hi:[1,0,0]
  v_pk_fma_f32 v[114:115], v[114:115], v[250:251], v[254:255] op_sel_hi:[1,0,0]
  v_pk_fma_f32 v[116:117], v[116:117], v[250:251], v[254:255] op_sel_hi:[1,0,0]
  v_pk_fma_f32 v[118:119], v[118:119], v[250:251], v[254:255] op_sel_hi:[1,0,0]
  v_cvt_pk_bf16_f32 v40, v112, v113
  v_cvt_pk_bf16_f32 v41, v114, v115
  v_cvt_pk_bf16_f32 v42, v116, v117
  v_cvt_pk_bf16_f32 v43, v118, v119
  ds_write_b128 v246, v[40:43] offset:8192
  s_mov_b32 s74, 0x54000
  s_add_u32 m0, s72, 0x3000
  s_nop 0
  buffer_load_dwordx4 v6, s[48:51], s74 offen lds
  v_pk_fma_f32 v[120:121], v[120:121], v[250:251], v[254:255] op_sel_hi:[1,0,0]
  v_pk_fma_f32 v[122:123], v[122:123], v[250:251], v[254:255] op_sel_hi:[1,0,0]
  v_pk_fma_f32 v[124:125], v[124:125], v[250:251], v[254:255] op_sel_hi:[1,0,0]
  v_pk_fma_f32 v[126:127], v[126:127], v[250:251], v[254:255] op_sel_hi:[1,0,0]
  v_cvt_pk_bf16_f32 v44, v120, v121
  v_cvt_pk_bf16_f32 v45, v122, v123
  v_cvt_pk_bf16_f32 v46, v124, v125
  v_cvt_pk_bf16_f32 v47, v126, v127
  ds_write_b128 v246, v[44:47] offset:12288
  buffer_load_dwordx4 v7, s[48:51], s74 offen offset:1024 lds
  v_pk_fma_f32 v[128:129], v[128:129], v[250:251], v[254:255] op_sel_hi:[1,0,0]
  v_pk_fma_f32 v[130:131], v[130:131], v[250:251], v[254:255] op_sel_hi:[1,0,0]
  v_pk_fma_f32 v[132:133], v[132:133], v[250:251], v[254:255] op_sel_hi:[1,0,0]
  v_pk_fma_f32 v[134:135], v[134:135], v[250:251], v[254:255] op_sel_hi:[1,0,0]
  v_cvt_pk_bf16_f32 v48, v128, v129
  v_cvt_pk_bf16_f32 v49, v130, v131
  v_cvt_pk_bf16_f32 v50, v132, v133
  v_cvt_pk_bf16_f32 v51, v134, v135
  ds_write_b128 v246, v[48:51] offset:16384
  buffer_load_dwordx4 v8, s[48:51], s74 offen offset:2048 lds
  v_pk_fma_f32 v[136:137], v[136:137], v[250:251], v[254:255] op_sel_hi:[1,0,0]
  v_pk_fma_f32 v[138:139], v[138:139], v[250:251], v[254:255] op_sel_hi:[1,0,0]
  v_pk_fma_f32 v[140:141], v[140:141], v[250:251], v[254:255] op_sel_hi:[1,0,0]
  v_pk_fma_f32 v[142:143], v[142:143], v[250:251], v[254:255] op_sel_hi:[1,0,0]
  v_cvt_pk_bf16_f32 v52, v136, v137
  v_cvt_pk_bf16_f32 v53, v138, v139
  v_cvt_pk_bf16_f32 v54, v140, v141
  v_cvt_pk_bf16_f32 v55, v142, v143
  ds_write_b128 v246, v[52:55] offset:20480
  buffer_load_dwordx4 v9, s[48:51], s74 offen offset:3072 lds
  v_pk_fma_f32 v[144:145], v[144:145], v[250:251], v[254:255] op_sel_hi:[1,0,0]
  v_pk_fma_f32 v[146:147], v[146:147], v[250:251], v[254:255] op_sel_hi:[1,0,0]
  v_pk_fma_f32 v[148:149], v[148:149], v[250:251], v[254:255] op_sel_hi:[1,0,0]
  v_pk_fma_f32 v[150:151], v[150:151], v[250:251], v[254:255] op_sel_hi:[1,0,0]
  v_cvt_pk_bf16_f32 v56, v144, v145
  v_cvt_pk_bf16_f32 v57, v146, v147
  v_cvt_pk_bf16_f32 v58, v148, v149
  v_cvt_pk_bf16_f32 v59, v150, v151
  ds_write_b128 v246, v[56:59] offset:24576
  s_mov_b32 s73, 0x70000
  s_add_u32 m0, s72, 0x4000
  s_nop 0
  buffer_load_dwordx4 v6, s[48:51], s73 offen lds
  v_pk_fma_f32 v[152:153], v[152:153], v[250:251], v[254:255] op_sel_hi:[1,0,0]
  v_pk_fma_f32 v[154:155], v[154:155], v[250:251], v[254:255] op_sel_hi:[1,0,0]
  v_pk_fma_f32 v[156:157], v[156:157], v[250:251], v[254:255] op_sel_hi:[1,0,0]
  v_pk_fma_f32 v[158:159], v[158:159], v[250:251], v[254:255] op_sel_hi:[1,0,0]
  v_cvt_pk_bf16_f32 v60, v152, v153
  v_cvt_pk_bf16_f32 v61, v154, v155
  v_cvt_pk_bf16_f32 v62, v156, v157
  v_cvt_pk_bf16_f32 v63, v158, v159
  ds_write_b128 v246, v[60:63] offset:28672
  buffer_load_dwordx4 v7, s[48:51], s73 offen offset:1024 lds
  v_pk_fma_f32 v[160:161], v[160:161], v[250:251], v[254:255] op_sel_hi:[1,0,0]
  v_pk_fma_f32 v[162:163], v[162:163], v[250:251], v[254:255] op_sel_hi:[1,0,0]
  v_pk_fma_f32 v[164:165], v[164:165], v[250:251], v[254:255] op_sel_hi:[1,0,0]
  v_pk_fma_f32 v[166:167], v[166:167], v[250:251], v[254:255] op_sel_hi:[1,0,0]
  v_cvt_pk_bf16_f32 v64, v160, v161
  v_cvt_pk_bf16_f32 v65, v162, v163
  v_cvt_pk_bf16_f32 v66, v164, v165
  v_cvt_pk_bf16_f32 v67, v166, v167
  ds_write_b128 v246, v[64:67] offset:32768
  buffer_load_dwordx4 v8, s[48:51], s73 offen offset:2048 lds
  v_pk_fma_f32 v[168:169], v[168:169], v[250:251], v[254:255] op_sel_hi:[1,0,0]
  v_pk_fma_f32 v[170:171], v[170:171], v[250:251], v[254:255] op_sel_hi:[1,0,0]
  v_pk_fma_f32 v[172:173], v[172:173], v[250:251], v[254:255] op_sel_hi:[1,0,0]
  v_pk_fma_f32 v[174:175], v[174:175], v[250:251], v[254:255] op_sel_hi:[1,0,0]
  v_cvt_pk_bf16_f32 v68, v168, v169
  v_cvt_pk_bf16_f32 v69, v170, v171
  v_cvt_pk_bf16_f32 v70, v172, v173
  v_cvt_pk_bf16_f32 v71, v174, v175
  ds_write_b128 v246, v[68:71] offset:36864
  buffer_load_dwordx4 v9, s[48:51], s73 offen offset:3072 lds
  v_pk_fma_f32 v[176:177], v[176:177], v[250:251], v[254:255] op_sel_hi:[1,0,0]
  v_pk_fma_f32 v[178:179], v[178:179], v[250:251], v[254:255] op_sel_hi:[1,0,0]
  v_pk_fma_f32 v[180:181], v[180:181], v[250:251], v[254:255] op_sel_hi:[1,0,0]
  v_pk_fma_f32 v[182:183], v[182:183], v[250:251], v[254:255] op_sel_hi:[1,0,0]
  v_cvt_pk_bf16_f32 v72, v176, v177
  v_cvt_pk_bf16_f32 v73, v178, v179
  v_cvt_pk_bf16_f32 v74, v180, v181
  v_cvt_pk_bf16_f32 v75, v182, v183
  ds_write_b128 v246, v[72:75] offset:40960
  s_mov_b32 s74, 0x8c000
  s_add_u32 m0, s72, 0x5000
  s_nop 0
  buffer_load_dwordx4 v6, s[48:51], s74 offen lds
  v_pk_fma_f32 v[184:185], v[184:185], v[250:251], v[254:255] op_sel_hi:[1,0,0]
  v_pk_fma_f32 v[186:187], v[186:187], v[250:251], v[254:255] op_sel_hi:[1,0,0]
  v_pk_fma_f32 v[188:189], v[188:189], v[250:251], v[254:255] op_sel_hi:[1,0,0]
  v_pk_fma_f32 v[190:191], v[190:191], v[250:251], v[254:255] op_sel_hi:[1,0,0]
  v_cvt_pk_bf16_f32 v76, v184, v185
  v_cvt_pk_bf16_f32 v77, v186, v187
  v_cvt_pk_bf16_f32 v78, v188, v189
  v_cvt_pk_bf16_f32 v79, v190, v191
  ds_write_b128 v246, v[76:79] offset:45056
  buffer_load_dwordx4 v7, s[48:51], s74 offen offset:1024 lds
  v_pk_fma_f32 v[192:193], v[192:193], v[250:251], v[254:255] op_sel_hi:[1,0,0]
  v_pk_fma_f32 v[194:195], v[194:195], v[250:251], v[254:255] op_sel_hi:[1,0,0]
  v_pk_fma_f32 v[196:197], v[196:197], v[250:251], v[254:255] op_sel_hi:[1,0,0]
  v_pk_fma_f32 v[198:199], v[198:199], v[250:251], v[254:255] op_sel_hi:[1,0,0]
  v_cvt_pk_bf16_f32 v80, v192, v193
  v_cvt_pk_bf16_f32 v81, v194, v195
  v_cvt_pk_bf16_f32 v82, v196, v197
  v_cvt_pk_bf16_f32 v83, v198, v199
  ds_write_b128 v246, v[80:83] offset:49152
  s_waitcnt vmcnt(20)
  ds_read_b64_tr_b16 a[192:193], v2
  ds_read_b64_tr_b16 a[200:201], v3
  ds_read_b64_tr_b16 a[208:209], v4
  ds_read_b64_tr_b16 a[216:217], v5
  buffer_load_dwordx4 v8, s[48:51], s74 offen offset:2048 lds
  v_pk_fma_f32 v[200:201], v[200:201], v[250:251], v[254:255] op_sel_hi:[1,0,0]
  v_pk_fma_f32 v[202:203], v[202:203], v[250:251], v[254:255] op_sel_hi:[1,0,0]
  v_pk_fma_f32 v[204:205], v[204:205], v[250:251], v[254:255] op_sel_hi:[1,0,0]
  v_pk_fma_f32 v[206:207], v[206:207], v[250:251], v[254:255] op_sel_hi:[1,0,0]
  v_cvt_pk_bf16_f32 v84, v200, v201
  v_cvt_pk_bf16_f32 v85, v202, v203
  v_cvt_pk_bf16_f32 v86, v204, v205
  v_cvt_pk_bf16_f32 v87, v206, v207
  ds_write_b128 v246, v[84:87] offset:53248
  s_waitcnt vmcnt(19)
  ds_read_b64_tr_b16 a[194:195], v2 offset:2048
  ds_read_b64_tr_b16 a[202:203], v3 offset:2048
  ds_read_b64_tr_b16 a[210:211], v4 offset:2048
  ds_read_b64_tr_b16 a[218:219], v5 offset:2048
  buffer_load_dwordx4 v9, s[48:51], s74 offen offset:3072 lds
  v_pk_fma_f32 v[208:209], v[208:209], v[250:251], v[254:255] op_sel_hi:[1,0,0]
  v_pk_fma_f32 v[210:211], v[210:211], v[250:251], v[254:255] op_sel_hi:[1,0,0]
  v_pk_fma_f32 v[212:213], v[212:213], v[250:251], v[254:255] op_sel_hi:[1,0,0]
  v_pk_fma_f32 v[214:215], v[214:215], v[250:251], v[254:255] op_sel_hi:[1,0,0]
  v_cvt_pk_bf16_f32 v88, v208, v209
  v_cvt_pk_bf16_f32 v89, v210, v211
  v_cvt_pk_bf16_f32 v90, v212, v213
  v_cvt_pk_bf16_f32 v91, v214, v215
  ds_write_b128 v246, v[88:91] offset:57344
  s_waitcnt vmcnt(18)
  ds_read_b64_tr_b16 a[196:197], v2 offset:4096
  ds_read_b64_tr_b16 a[204:205], v3 offset:4096
  ds_read_b64_tr_b16 a[212:213], v4 offset:4096
  ds_read_b64_tr_b16 a[220:221], v5 offset:4096
  v_pk_fma_f32 v[216:217], v[216:217], v[250:251], v[254:255] op_sel_hi:[1,0,0]
  v_pk_fma_f32 v[218:219], v[218:219], v[250:251], v[254:255] op_sel_hi:[1,0,0]
  v_pk_fma_f32 v[220:221], v[220:221], v[250:251], v[254:255] op_sel_hi:[1,0,0]
  v_pk_fma_f32 v[222:223], v[222:223], v[250:251], v[254:255] op_sel_hi:[1,0,0]
  v_cvt_pk_bf16_f32 v92, v216, v217
  v_cvt_pk_bf16_f32 v93, v218, v219
  v_cvt_pk_bf16_f32 v94, v220, v221
  v_cvt_pk_bf16_f32 v95, v222, v223
  ds_write_b128 v246, v[92:95] offset:61440
  s_waitcnt vmcnt(16)
  ds_read_b64_tr_b16 a[198:199], v2 offset:6144
L_w2:
L_p7954:
  s_cmp_eq_u32 s95, 1
  s_cbranch_scc1 L_p10121
  ds_read_b64_tr_b16 a[206:207], v3 offset:6144
  ds_read_b64_tr_b16 a[214:215], v4 offset:6144
  ds_read_b64_tr_b16 a[222:223], v5 offset:6144
  v_mov_b32 v248, 0xc1906ebb
  s_waitcnt lgkmcnt(4)
  s_barrier
  ds_read_b128 a[0:3], v247
  ds_read_b128 a[16:19], v247 offset:4096
  ds_read_b128 a[4:7], v247 offset:1024
  ds_read_b128 a[20:23], v247 offset:5120
  ds_read_b128 a[8:11], v247 offset:2048
  ds_read_b128 a[24:27], v247 offset:6144
  ds_read_b128 a[12:15], v247 offset:3072
  ds_read_b128 a[28:31], v247 offset:7168
  s_waitcnt lgkmcnt(7)
  v_mfma_f32_16x16x32_bf16 v[96:99], a[192:195], a[0:3], v[224:227]
  s_mov_b32 s73, 0xa8000
  s_waitcnt vmcnt(14) lgkmcnt(6)
  ds_read_b64_tr_b16 a[224:225], v2 offset:8192
  ds_read_b64_tr_b16 a[232:233], v3 offset:8192
  v_mfma_f32_16x16x32_bf16 v[96:99], a[196:199], a[16:19], v[96:99]
  s_add_u32 m0, s72, 0
  s_waitcnt lgkmcnt(6)
  ds_read_b64_tr_b16 a[240:241], v4 offset:8192
  ds_read_b64_tr_b16 a[248:249], v5 offset:8192
  v_mfma_f32_16x16x32_bf16 v[100:103], a[196:199], a[20:23], v[224:227]
  buffer_load_dwordx4 v6, s[48:51], s73 offen lds
  v_mfma_f32_16x16x32_bf16 v[100:103], a[192:195], a[4:7], v[100:103]
  s_waitcnt lgkmcnt(6)
  ds_read_b128 a[32:35], v247 offset:8192
  ds_read_b128 a[48:51], v247 offset:12288
  v_mfma_f32_16x16x32_bf16 v[104:107], a[192:195], a[8:11], v[224:227]
  buffer_load_dwordx4 v7, s[48:51], s73 offen offset:1024 lds
  v_mfma_f32_16x16x32_bf16 v[104:107], a[196:199], a[24:27], v[104:107]
  s_waitcnt vmcnt(14) lgkmcnt(6)
  ds_read_b64_tr_b16 a[226:227], v2 offset:10240
  ds_read_b64_tr_b16 a[234:235], v3 offset:10240
  v_mfma_f32_16x16x32_bf16 v[108:111], a[196:199], a[28:31], v[224:227]
  ds_read_b64_tr_b16 a[242:243], v4 offset:10240
  s_cmp_eq_u32 s14, 0
  s_cbranch_scc1 L_t40
L_r40:
  v_mfma_f32_16x16x32_bf16 v[108:111], a[192:195], a[12:15], v[108:111]
  buffer_load_dwordx4 v8, s[48:51], s73 offen offset:2048 lds
  v_mfma_f32_16x16x32_bf16 v[124:127], a[200:203], a[12:15], v[228:231]
  ds_read_b64_tr_b16 a[250:251], v5 offset:10240
  v_mfma_f32_16x16x32_bf16 v[124:127], a[204:207], a[28:31], v[124:127]
  ds_read_b128 a[36:39], v247 offset:9216
  v_mfma_f32_16x16x32_bf16 v[120:123], a[204:207], a[24:27], v[228:231]
  ds_read_b128 a[52:55], v247 offset:13312
  v_mfma_f32_16x16x32_bf16 v[120:123], a[200:203], a[8:11], v[120:123]
  buffer_load_dwordx4 v9, s[48:51], s73 offen offset:3072 lds
  v_mfma_f32_16x16x32_bf16 v[116:119], a[200:203], a[4:7], v[228:231]
  s_waitcnt vmcnt(14)
  ds_read_b64_tr_b16 a[228:229], v2 offset:12288
  v_mfma_f32_16x16x32_bf16 v[116:119], a[204:207], a[20:23], v[116:119]
  s_mov_b32 s74, 0xc4000
  ds_read_b64_tr_b16 a[236:237], v3 offset:12288
  v_mfma_f32_16x16x32_bf16 v[112:115], a[204:207], a[16:19], v[228:231]
  s_add_u32 m0, s72, 0x1000
  ds_read_b64_tr_b16 a[244:245], v4 offset:12288
  v_mfma_f32_16x16x32_bf16 v[112:115], a[200:203], a[0:3], v[112:115]
  buffer_load_dwordx4 v6, s[48:51], s74 offen lds
  v_mfma_f32_16x16x32_bf16 v[128:131], a[208:211], a[0:3], v[232:235]
  ds_read_b64_tr_b16 a[252:253], v5 offset:12288
  v_mfma_f32_16x16x32_bf16 v[128:131], a[212:215], a[16:19], v[128:131]
  ds_read_b128 a[40:43], v247 offset:10240
  v_mfma_f32_16x16x32_bf16 v[132:135], a[212:215], a[20:23], v[232:235]
  ds_read_b128 a[56:59], v247 offset:14336
  v_mfma_f32_16x16x32_bf16 v[132:135], a[208:211], a[4:7], v[132:135]
  buffer_load_dwordx4 v7, s[48:51], s74 offen offset:1024 lds
  v_mfma_f32_16x16x32_bf16 v[136:139], a[208:211], a[8:11], v[232:235]
  s_waitcnt vmcnt(14)
  ds_read_b64_tr_b16 a[230:231], v2 offset:14336
  v_mfma_f32_16x16x32_bf16 v[136:139], a[212:215], a[24:27], v[136:139]
  ds_read_b64_tr_b16 a[238:239], v3 offset:14336
  v_mfma_f32_16x16x32_bf16 v[140:143], a[212:215], a[28:31], v[232:235]
  ds_read_b64_tr_b16 a[246:247], v4 offset:14336
  v_mfma_f32_16x16x32_bf16 v[140:143], a[208:211], a[12:15], v[140:143]
  buffer_load_dwordx4 v8, s[48:51], s74 offen offset:2048 lds
  v_mfma_f32_16x16x32_bf16 v[156:159], a[216:219], a[12:15], v[236:239]
  ds_read_b64_tr_b16 a[254:255], v5 offset:14336
  v_mfma_f32_16x16x32_bf16 v[156:159], a[220:223], a[28:31], v[156:159]
  ds_read_b128 a[44:47], v247 offset:11264
  v_mfma_f32_16x16x32_bf16 v[152:155], a[220:223], a[24:27], v[236:239]
  ds_read_b128 a[60:63], v247 offset:15360
  v_mfma_f32_16x16x32_bf16 v[152:155], a[216:219], a[8:11], v[152:155]
  buffer_load_dwordx4 v9, s[48:51], s74 offen offset:3072 lds
  v_mfma_f32_16x16x32_bf16 v[148:151], a[216:219], a[4:7], v[236:239]
  s_waitcnt vmcnt(14)
  ds_read_b64_tr_b16 a[192:193], v2 offset:16384
  v_mfma_f32_16x16x32_bf16 v[148:151], a[220:223], a[20:23], v[148:151]
  s_mov_b32 s73, 0xe0000
  ds_read_b64_tr_b16 a[200:201], v3 offset:16384
  v_mfma_f32_16x16x32_bf16 v[144:147], a[220:223], a[16:19], v[236:239]
  s_add_u32 m0, s72, 0x2000
  s_waitcnt lgkmcnt(8)
  ds_read_b64_tr_b16 a[208:209], v4 offset:16384
  v_mfma_f32_16x16x32_bf16 v[144:147], a[216:219], a[0:3], v[144:147]
  buffer_load_dwordx4 v6, s[48:51], s73 offen lds
  v_mfma_f32_16x16x32_bf16 v[96:99], a[224:227], a[32:35], v[96:99]
  s_waitcnt lgkmcnt(8)
  ds_read_b64_tr_b16 a[216:217], v5 offset:16384
  v_mfma_f32_16x16x32_bf16 v[96:99], a[228:231], a[48:51], v[96:99]
  ds_read_b128 a[64:67], v247 offset:16384
  s_cmp_eq_u32 s14, 1
  s_cbranch_scc1 L_t41
L_r41:
  v_mfma_f32_16x16x32_bf16 v[100:103], a[228:231], a[52:55], v[100:103]
  ds_read_b128 a[80:83], v247 offset:20480
  v_mfma_f32_16x16x32_bf16 v[100:103], a[224:227], a[36:39], v[100:103]
  buffer_load_dwordx4 v7, s[48:51], s73 offen offset:1024 lds
  v_mfma_f32_16x16x32_bf16 v[104:107], a[224:227], a[40:43], v[104:107]
  s_waitcnt vmcnt(14)
  ds_read_b64_tr_b16 a[194:195], v2 offset:18432
  v_mfma_f32_16x16x32_bf16 v[104:107], a[228:231], a[56:59], v[104:107]
  s_waitcnt lgkmcnt(7)
  ds_read_b64_tr_b16 a[202:203], v3 offset:18432
  v_mfma_f32_16x16x32_bf16 v[108:111], a[228:231], a[60:63], v[108:111]
  ds_read_b64_tr_b16 a[210:211], v4 offset:18432
  v_mfma_f32_16x16x32_bf16 v[108:111], a[224:227], a[44:47], v[108:111]
  buffer_load_dwordx4 v8, s[48:51], s73 offen offset:2048 lds
  v_mfma_f32_16x16x32_bf16 v[124:127], a[232:235], a[44:47], v[124:127]
  ds_read_b64_tr_b16 a[218:219], v5 offset:18432
  v_mfma_f32_16x16x32_bf16 v[124:127], a[236:239], a[60:63], v[124:127]
  ds_read_b128 a[68:71], v247 offset:17408
  v_mfma_f32_16x16x32_bf16 v[120:123], a[236:239], a[56:59], v[120:123]
  ds_read_b128 a[84:87], v247 offset:21504
  v_mfma_f32_16x16x32_bf16 v[120:123], a[232:235], a[40:43], v[120:123]
  buffer_load_dwordx4 v9, s[48:51], s73 offen offset:3072 lds
  v_mfma_f32_16x16x32_bf16 v[116:119], a[232:235], a[36:39], v[116:119]
  s_waitcnt vmcnt(14)
  ds_read_b64_tr_b16 a[196:197], v2 offset:20480
  v_mfma_f32_16x16x32_bf16 v[116:119], a[236:239], a[52:55], v[116:119]
  s_mov_b32 s74, 0xfc000
  ds_read_b64_tr_b16 a[204:205], v3 offset:20480
  v_mfma_f32_16x16x32_bf16 v[112:115], a[236:239], a[48:51], v[112:115]
  s_add_u32 m0, s72, 0x3000
  ds_read_b64_tr_b16 a[212:213], v4 offset:20480
  v_mfma_f32_16x16x32_bf16 v[112:115], a[232:235], a[32:35], v[112:115]
  buffer_load_dwordx4 v6, s[48:51], s74 offen lds
  v_mfma_f32_16x16x32_bf16 v[128:131], a[240:243], a[32:35], v[128:131]
  ds_read_b64_tr_b16 a[220:221], v5 offset:20480
  v_mfma_f32_16x16x32_bf16 v[128:131], a[244:247], a[48:51], v[128:131]
  ds_read_b128 a[72:75], v247 offset:18432
  v_mfma_f32_16x16x32_bf16 v[132:135], a[244:247], a[52:55], v[132:135]
  ds_read_b128 a[88:91], v247 offset:22528
  v_mfma_f32_16x16x32_bf16 v[132:135], a[240:243], a[36:39], v[132:135]
  buffer_load_dwordx4 v7, s[48:51], s74 offen offset:1024 lds
  v_mfma_f32_16x16x32_bf16 v[136:139], a[240:243], a[40:43], v[136:139]
  s_waitcnt vmcnt(14)
  ds_read_b64_tr_b16 a[198:199], v2 offset:22528
  v_mfma_f32_16x16x32_bf16 v[136:139], a[244:247], a[56:59], v[136:139]
  ds_read_b64_tr_b16 a[206:207], v3 offset:22528
  v_mfma_f32_16x16x32_bf16 v[140:143], a[244:247], a[60:63], v[140:143]
  ds_read_b64_tr_b16 a[214:215], v4 offset:22528
  v_mfma_f32_16x16x32_bf16 v[140:143], a[240:243], a[44:47], v[140:143]
  buffer_load_dwordx4 v8, s[48:51], s74 offen offset:2048 lds
  v_mfma_f32_16x16x32_bf16 v[156:159], a[248:251], a[44:47], v[156:159]
  ds_read_b64_tr_b16 a[222:223], v5 offset:22528
  v_mfma_f32_16x16x32_bf16 v[156:159], a[252:255], a[60:63], v[156:159]
  ds_read_b128 a[76:79], v247 offset:19456
  v_mfma_f32_16x16x32_bf16 v[152:155], a[252:255], a[56:59], v[152:155]
  ds_read_b128 a[92:95], v247 offset:23552
  v_mfma_f32_16x16x32_bf16 v[152:155], a[248:251], a[40:43], v[152:155]
  buffer_load_dwordx4 v9, s[48:51], s74 offen offset:3072 lds
  v_mfma_f32_16x16x32_bf16 v[148:151], a[248:251], a[36:39], v[148:151]
  s_waitcnt vmcnt(14)
  ds_read_b64_tr_b16 a[224:225], v2
  v_mfma_f32_16x16x32_bf16 v[148:151], a[252:255], a[52:55], v[148:151]
  s_mov_b32 s73, 0x118000
  ds_read_b64_tr_b16 a[232:233], v3
  v_mfma_f32_16x16x32_bf16 v[144:147], a[252:255], a[48:51], v[144:147]
  s_add_u32 m0, s72, 0x4000
  s_waitcnt lgkmcnt(8)
  ds_read_b64_tr_b16 a[240:241], v4
  v_mfma_f32_16x16x32_bf16 v[144:147], a[248:251], a[32:35], v[144:147]
  buffer_load_dwordx4 v6, s[48:51], s73 offen lds
  v_mfma_f32_16x16x32_bf16 v[96:99], a[192:195], a[64:67], v[96:99]
  s_waitcnt lgkmcnt(8)
  ds_read_b64_tr_b16 a[248:249], v5
  v_mfma_f32_16x16x32_bf16 v[96:99], a[196:199], a[80:83], v[96:99]
  ds_read_b128 a[96:99], v247 offset:24576
  s_cmp_eq_u32 s14, 2
  s_cbranch_scc1 L_t42
L_r42:
  v_mfma_f32_16x16x32_bf16 v[100:103], a[196:199], a[84:87], v[100:103]
  ds_read_b128 a[112:115], v247 offset:28672
  v_mfma_f32_16x16x32_bf16 v[100:103], a[192:195], a[68:71], v[100:103]
  buffer_load_dwordx4 v7, s[48:51], s73 offen offset:1024 lds
  v_mfma_f32_16x16x32_bf16 v[104:107], a[192:195], a[72:75], v[104:107]
  s_waitcnt vmcnt(14)
  ds_read_b64_tr_b16 a[226:227], v2 offset:2048
  v_mfma_f32_16x16x32_bf16 v[104:107], a[196:199], a[88:91], v[104:107]
  s_waitcnt lgkmcnt(7)
  ds_read_b64_tr_b16 a[234:235], v3 offset:2048
  v_mfma_f32_16x16x32_bf16 v[108:111], a[196:199], a[92:95], v[108:111]
  ds_read_b64_tr_b16 a[242:243], v4 offset:2048
  v_mfma_f32_16x16x32_bf16 v[108:111], a[192:195], a[76:79], v[108:111]
  buffer_load_dwordx4 v8, s[48:51], s73 offen offset:2048 lds
  v_mfma_f32_16x16x32_bf16 v[124:127], a[200:203], a[76:79], v[124:127]
  ds_read_b64_tr_b16 a[250:251], v5 offset:2048
  v_mfma_f32_16x16x32_bf16 v[124:127], a[204:207], a[92:95], v[124:127]
  ds_read_b128 a[100:103], v247 offset:25600
  v_mfma_f32_16x16x32_bf16 v[120:123], a[204:207], a[88:91], v[120:123]
  ds_read_b128 a[116:119], v247 offset:29696
  v_mfma_f32_16x16x32_bf16 v[120:123], a[200:203], a[72:75], v[120:123]
  buffer_load_dwordx4 v9, s[48:51], s73 offen offset:3072 lds
  v_mfma_f32_16x16x32_bf16 v[116:119], a[200:203], a[68:71], v[116:119]
  s_waitcnt vmcnt(14)
  ds_read_b64_tr_b16 a[228:229], v2 offset:4096
  v_mfma_f32_16x16x32_bf16 v[116:119], a[204:207], a[84:87], v[116:119]
  s_mov_b32 s74, 0x134000
  ds_read_b64_tr_b16 a[236:237], v3 offset:4096
  v_mfma_f32_16x16x32_bf16 v[112:115], a[204:207], a[80:83], v[112:115]
  s_add_u32 m0, s72, 0x5000
  ds_read_b64_tr_b16 a[244:245], v4 offset:4096
  v_mfma_f32_16x16x32_bf16 v[112:115], a[200:203], a[64:67], v[112:115]
  buffer_load_dwordx4 v6, s[48:51], s74 offen lds
  v_mfma_f32_16x16x32_bf16 v[128:131], a[208:211], a[64:67], v[128:131]
  ds_read_b64_tr_b16 a[252:253], v5 offset:4096
  v_mfma_f32_16x16x32_bf16 v[128:131], a[212:215], a[80:83], v[128:131]
  ds_read_b128 a[104:107], v247 offset:26624
  v_mfma_f32_16x16x32_bf16 v[132:135], a[212:215], a[84:87], v[132:135]
  ds_read_b128 a[120:123], v247 offset:30720
  v_mfma_f32_16x16x32_bf16 v[132:135], a[208:211], a[68:71], v[132:135]
  buffer_load_dwordx4 v7, s[48:51], s74 offen offset:1024 lds
  v_mfma_f32_16x16x32_bf16 v[136:139], a[208:211], a[72:75], v[136:139]
  s_waitcnt vmcnt(14)
  ds_read_b64_tr_b16 a[230:231], v2 offset:6144
  v_mfma_f32_16x16x32_bf16 v[136:139], a[212:215], a[88:91], v[136:139]
  ds_read_b64_tr_b16 a[238:239], v3 offset:6144
  v_mfma_f32_16x16x32_bf16 v[140:143], a[212:215], a[92:95], v[140:143]
  ds_read_b64_tr_b16 a[246:247], v4 offset:6144
  v_mfma_f32_16x16x32_bf16 v[140:143], a[208:211], a[76:79], v[140:143]
  buffer_load_dwordx4 v8, s[48:51], s74 offen offset:2048 lds
  v_mfma_f32_16x16x32_bf16 v[156:159], a[216:219], a[76:79], v[156:159]
  ds_read_b64_tr_b16 a[254:255], v5 offset:6144
  v_mfma_f32_16x16x32_bf16 v[156:159], a[220:223], a[92:95], v[156:159]
  ds_read_b128 a[108:111], v247 offset:27648
  v_mfma_f32_16x16x32_bf16 v[152:155], a[220:223], a[88:91], v[152:155]
  ds_read_b128 a[124:127], v247 offset:31744
  v_mfma_f32_16x16x32_bf16 v[152:155], a[216:219], a[72:75], v[152:155]
  buffer_load_dwordx4 v9, s[48:51], s74 offen offset:3072 lds
  v_mfma_f32_16x16x32_bf16 v[148:151], a[216:219], a[68:71], v[148:151]
  s_waitcnt vmcnt(14)
  ds_read_b64_tr_b16 a[192:193], v2 offset:8192
  v_mfma_f32_16x16x32_bf16 v[148:151], a[220:223], a[84:87], v[148:151]
  s_mov_b32 s73, 0x150000
  ds_read_b64_tr_b16 a[200:201], v3 offset:8192
  v_mfma_f32_16x16x32_bf16 v[144:147], a[220:223], a[80:83], v[144:147]
  s_add_u32 m0, s72, 0
  s_waitcnt lgkmcnt(8)
  ds_read_b64_tr_b16 a[208:209], v4 offset:8192
  v_mfma_f32_16x16x32_bf16 v[144:147], a[216:219], a[64:67], v[144:147]
  buffer_load_dwordx4 v6, s[48:51], s73 offen lds
  v_mfma_f32_16x16x32_bf16 v[96:99], a[224:227], a[96:99], v[96:99]
  s_waitcnt lgkmcnt(8)
  ds_read_b64_tr_b16 a[216:217], v5 offset:8192
  v_mfma_f32_16x16x32_bf16 v[96:99], a[228:231], a[112:115], v[96:99]
  ds_read_b128 a[128:131], v247 offset:32768
  s_cmp_eq_u32 s14, 3
  s_cbranch_scc1 L_t43
L_r43:
  v_mfma_f32_16x16x32_bf16 v[100:103], a[228:231], a[116:119], v[100:103]
  ds_read_b128 a[144:147], v247 offset:36864
  v_mfma_f32_16x16x32_bf16 v[100:103], a[224:227], a[100:103], v[100:103]
  buffer_load_dwordx4 v7, s[48:51], s73 offen offset:1024 lds
  v_mfma_f32_16x16x32_bf16 v[104:107], a[224:227], a[104:107], v[104:107]
  s_waitcnt vmcnt(14)
  ds_read_b64_tr_b16 a[194:195], v2 offset:10240
  v_mfma_f32_16x16x32_bf16 v[104:107], a[228:231], a[120:123], v[104:107]
  s_waitcnt lgkmcnt(7)
  ds_read_b64_tr_b16 a[202:203], v3 offset:10240
  v_mfma_f32_16x16x32_bf16 v[108:111], a[228:231], a[124:127], v[108:111]
  ds_read_b64_tr_b16 a[210:211], v4 offset:10240
  v_mfma_f32_16x16x32_bf16 v[108:111], a[224:227], a[108:111], v[108:111]
  buffer_load_dwordx4 v8, s[48:51], s73 offen offset:2048 lds
  v_mfma_f32_16x16x32_bf16 v[124:127], a[232:235], a[108:111], v[124:127]
  ds_read_b64_tr_b16 a[218:219], v5 offset:10240
  v_mfma_f32_16x16x32_bf16 v[124:127], a[236:239], a[124:127], v[124:127]
  ds_read_b128 a[132:135], v247 offset:33792
  v_mfma_f32_16x16x32_bf16 v[120:123], a[236:239], a[120:123], v[120:123]
  ds_read_b128 a[148:151], v247 offset:37888
  v_mfma_f32_16x16x32_bf16 v[120:123], a[232:235], a[104:107], v[120:123]
  buffer_load_dwordx4 v9, s[48:51], s73 offen offset:3072 lds
  v_mfma_f32_16x16x32_bf16 v[116:119], a[232:235], a[100:103], v[116:119]
  s_waitcnt vmcnt(14)
  ds_read_b64_tr_b16 a[196:197], v2 offset:12288
  v_mfma_f32_16x16x32_bf16 v[116:119], a[236:239], a[116:119], v[116:119]
  s_mov_b32 s74, 0x16c000
  ds_read_b64_tr_b16 a[204:205], v3 offset:12288
  v_mfma_f32_16x16x32_bf16 v[112:115], a[236:239], a[112:115], v[112:115]
  s_add_u32 m0, s72, 0x1000
  ds_read_b64_tr_b16 a[212:213], v4 offset:12288
  v_mfma_f32_16x16x32_bf16 v[112:115], a[232:235], a[96:99], v[112:115]
  buffer_load_dwordx4 v6, s[48:51], s74 offen lds
  v_mfma_f32_16x16x32_bf16 v[128:131], a[240:243], a[96:99], v[128:131]
  ds_read_b64_tr_b16 a[220:221], v5 offset:12288
  v_mfma_f32_16x16x32_bf16 v[128:131], a[244:247], a[112:115], v[128:131]
  ds_read_b128 a[136:139], v247 offset:34816
  v_mfma_f32_16x16x32_bf16 v[132:135], a[244:247], a[116:119], v[132:135]
  ds_read_b128 a[152:155], v247 offset:38912
  v_mfma_f32_16x16x32_bf16 v[132:135], a[240:243], a[100:103], v[132:135]
  buffer_load_dwordx4 v7, s[48:51], s74 offen offset:1024 lds
  v_mfma_f32_16x16x32_bf16 v[136:139], a[240:243], a[104:107], v[136:139]
  s_waitcnt vmcnt(14)
  ds_read_b64_tr_b16 a[198:199], v2 offset:14336
  v_mfma_f32_16x16x32_bf16 v[136:139], a[244:247], a[120:123], v[136:139]
  ds_read_b64_tr_b16 a[206:207], v3 offset:14336
  v_mfma_f32_16x16x32_bf16 v[140:143], a[244:247], a[124:127], v[140:143]
  ds_read_b64_tr_b16 a[214:215], v4 offset:14336
  v_mfma_f32_16x16x32_bf16 v[140:143], a[240:243], a[108:111], v[140:143]
  buffer_load_dwordx4 v8, s[48:51], s74 offen offset:2048 lds
  v_mfma_f32_16x16x32_bf16 v[156:159], a[248:251], a[108:111], v[156:159]
  ds_read_b64_tr_b16 a[222:223], v5 offset:14336
  v_mfma_f32_16x16x32_bf16 v[156:159], a[252:255], a[124:127], v[156:159]
  ds_read_b128 a[140:143], v247 offset:35840
  v_mfma_f32_16x16x32_bf16 v[152:155], a[252:255], a[120:123], v[152:155]
  ds_read_b128 a[156:159], v247 offset:39936
  v_mfma_f32_16x16x32_bf16 v[152:155], a[248:251], a[104:107], v[152:155]
  buffer_load_dwordx4 v9, s[48:51], s74 offen offset:3072 lds
  v_mfma_f32_16x16x32_bf16 v[148:151], a[248:251], a[100:103], v[148:151]
  s_waitcnt vmcnt(14)
  ds_read_b64_tr_b16 a[224:225], v2 offset:16384
  v_mfma_f32_16x16x32_bf16 v[148:151], a[252:255], a[116:119], v[148:151]
  s_mov_b32 s73, 0x188000
  ds_read_b64_tr_b16 a[232:233], v3 offset:16384
  v_mfma_f32_16x16x32_bf16 v[144:147], a[252:255], a[112:115], v[144:147]
  s_add_u32 m0, s72, 0x2000
  s_waitcnt lgkmcnt(8)
  ds_read_b64_tr_b16 a[240:241], v4 offset:16384
  v_mfma_f32_16x16x32_bf16 v[144:147], a[248:251], a[96:99], v[144:147]
  buffer_load_dwordx4 v6, s[48:51], s73 offen lds
  v_mfma_f32_16x16x32_bf16 v[96:99], a[192:195], a[128:131], v[96:99]
  s_waitcnt lgkmcnt(8)
  ds_read_b64_tr_b16 a[248:249], v5 offset:16384
  v_mfma_f32_16x16x32_bf16 v[96:99], a[196:199], a[144:147], v[96:99]
  ds_read_b128 a[160:163], v247 offset:40960
  s_cmp_eq_u32 s14, 4
  s_cbranch_scc1 L_t44
L_r44:
  v_mfma_f32_16x16x32_bf16 v[100:103], a[196:199], a[148:151], v[100:103]
  ds_read_b128 a[176:179], v247 offset:45056
  v_mfma_f32_16x16x32_bf16 v[100:103], a[192:195], a[132:135], v[100:103]
  buffer_load_dwordx4 v7, s[48:51], s73 offen offset:1024 lds
  v_mfma_f32_16x16x32_bf16 v[104:107], a[192:195], a[136:139], v[104:107]
  s_waitcnt vmcnt(14)
  ds_read_b64_tr_b16 a[226:227], v2 offset:18432
  v_mfma_f32_16x16x32_bf16 v[104:107], a[196:199], a[152:155], v[104:107]
  s_waitcnt lgkmcnt(7)
  ds_read_b64_tr_b16 a[234:235], v3 offset:18432
  v_mfma_f32_16x16x32_bf16 v[108:111], a[196:199], a[156:159], v[108:111]
  ds_read_b64_tr_b16 a[242:243], v4 offset:18432
  v_mfma_f32_16x16x32_bf16 v[108:111], a[192:195], a[140:143], v[108:111]
  buffer_load_dwordx4 v8, s[48:51], s73 offen offset:2048 lds
  v_mfma_f32_16x16x32_bf16 v[124:127], a[200:203], a[140:143], v[124:127]
  ds_read_b64_tr_b16 a[250:251], v5 offset:18432
  v_mfma_f32_16x16x32_bf16 v[124:127], a[204:207], a[156:159], v[124:127]
  ds_read_b128 a[164:167], v247 offset:41984
  v_mfma_f32_16x16x32_bf16 v[120:123], a[204:207], a[152:155], v[120:123]
  ds_read_b128 a[180:183], v247 offset:46080
  v_mfma_f32_16x16x32_bf16 v[120:123], a[200:203], a[136:139], v[120:123]
  buffer_load_dwordx4 v9, s[48:51], s73 offen offset:3072 lds
  v_mfma_f32_16x16x32_bf16 v[116:119], a[200:203], a[132:135], v[116:119]
  s_waitcnt vmcnt(14)
  ds_read_b64_tr_b16 a[228:229], v2 offset:20480
  v_mfma_f32_16x16x32_bf16 v[116:119], a[204:207], a[148:151], v[116:119]
  s_mov_b32 s74, 0x1a4000
  ds_read_b64_tr_b16 a[236:237], v3 offset:20480
  v_mfma_f32_16x16x32_bf16 v[112:115], a[204:207], a[144:147], v[112:115]
  s_add_u32 m0, s72, 0x3000
  ds_read_b64_tr_b16 a[244:245], v4 offset:20480
  v_mfma_f32_16x16x32_bf16 v[112:115], a[200:203], a[128:131], v[112:115]
  buffer_load_dwordx4 v6, s[48:51], s74 offen lds
  v_mfma_f32_16x16x32_bf16 v[128:131], a[208:211], a[128:131], v[128:131]
  ds_read_b64_tr_b16 a[252:253], v5 offset:20480
  v_mfma_f32_16x16x32_bf16 v[128:131], a[212:215], a[144:147], v[128:131]
  ds_read_b128 a[168:171], v247 offset:43008
  v_mfma_f32_16x16x32_bf16 v[132:135], a[212:215], a[148:151], v[132:135]
  ds_read_b128 a[184:187], v247 offset:47104
  v_mfma_f32_16x16x32_bf16 v[132:135], a[208:211], a[132:135], v[132:135]
  buffer_load_dwordx4 v7, s[48:51], s74 offen offset:1024 lds
  v_mfma_f32_16x16x32_bf16 v[136:139], a[208:211], a[136:139], v[136:139]
  s_waitcnt vmcnt(14)
  ds_read_b64_tr_b16 a[230:231], v2 offset:22528
  v_mfma_f32_16x16x32_bf16 v[136:139], a[212:215], a[152:155], v[136:139]
  ds_read_b64_tr_b16 a[238:239], v3 offset:22528
  v_mfma_f32_16x16x32_bf16 v[140:143], a[212:215], a[156:159], v[140:143]
  ds_read_b64_tr_b16 a[246:247], v4 offset:22528
  v_mfma_f32_16x16x32_bf16 v[140:143], a[208:211], a[140:143], v[140:143]
  buffer_load_dwordx4 v8, s[48:51], s74 offen offset:2048 lds
  v_mfma_f32_16x16x32_bf16 v[156:159], a[216:219], a[140:143], v[156:159]
  ds_read_b64_tr_b16 a[254:255], v5 offset:22528
  v_mfma_f32_16x16x32_bf16 v[156:159], a[220:223], a[156:159], v[156:159]
  ds_read_b128 a[172:175], v247 offset:44032
  v_mfma_f32_16x16x32_bf16 v[152:155], a[220:223], a[152:155], v[152:155]
  ds_read_b128 a[188:191], v247 offset:48128
  v_mfma_f32_16x16x32_bf16 v[152:155], a[216:219], a[136:139], v[152:155]
  buffer_load_dwordx4 v9, s[48:51], s74 offen offset:3072 lds
  v_mfma_f32_16x16x32_bf16 v[148:151], a[216:219], a[132:135], v[148:151]
  s_waitcnt vmcnt(14)
  ds_read_b64_tr_b16 a[192:193], v2
  v_mfma_f32_16x16x32_bf16 v[148:151], a[220:223], a[148:151], v[148:151]
  s_mov_b32 s73, 0x380000
  ds_read_b64_tr_b16 a[200:201], v3
  v_mfma_f32_16x16x32_bf16 v[144:147], a[220:223], a[144:147], v[144:147]
  s_add_u32 m0, s72, 0x4000
  s_waitcnt lgkmcnt(8)
  ds_read_b64_tr_b16 a[208:209], v4
  v_mfma_f32_16x16x32_bf16 v[144:147], a[216:219], a[128:131], v[144:147]
  buffer_load_dwordx4 v10, s[44:47], s73 offen lds
  v_mfma_f32_16x16x32_bf16 v[96:99], a[224:227], a[160:163], v[96:99]
  s_waitcnt lgkmcnt(8)
  ds_read_b64_tr_b16 a[216:217], v5
  v_mfma_f32_16x16x32_bf16 v[96:99], a[228:231], a[176:179], v[96:99]
  ds_read_b128 a[0:3], v247 offset:49152
  s_cmp_eq_u32 s14, 5
  s_cbranch_scc1 L_t45
L_r45:
  v_mfma_f32_16x16x32_bf16 v[100:103], a[228:231], a[180:183], v[100:103]
  ds_read_b128 a[16:19], v247 offset:53248
  v_mfma_f32_16x16x32_bf16 v[100:103], a[224:227], a[164:167], v[100:103]
  buffer_load_dwordx4 v11, s[44:47], s73 offen offset:1024 lds
  v_mfma_f32_16x16x32_bf16 v[104:107], a[224:227], a[168:171], v[104:107]
  s_waitcnt vmcnt(14)
  ds_read_b64_tr_b16 a[194:195], v2 offset:2048
  v_mfma_f32_16x16x32_bf16 v[104:107], a[228:231], a[184:187], v[104:107]
  s_waitcnt lgkmcnt(7)
  ds_read_b64_tr_b16 a[202:203], v3 offset:2048
  v_mfma_f32_16x16x32_bf16 v[108:111], a[228:231], a[188:191], v[108:111]
  ds_read_b64_tr_b16 a[210:211], v4 offset:2048
  v_mfma_f32_16x16x32_bf16 v[108:111], a[224:227], a[172:175], v[108:111]
  buffer_load_dwordx4 v12, s[44:47], s73 offen offset:2048 lds
  v_mfma_f32_16x16x32_bf16 v[124:127], a[232:235], a[172:175], v[124:127]
  ds_read_b64_tr_b16 a[218:219], v5 offset:2048
  v_mfma_f32_16x16x32_bf16 v[124:127], a[236:239], a[188:191], v[124:127]
  ds_read_b128 a[4:7], v247 offset:50176
  v_mfma_f32_16x16x32_bf16 v[120:123], a[236:239], a[184:187], v[120:123]
  ds_read_b128 a[20:23], v247 offset:54272
  v_mfma_f32_16x16x32_bf16 v[120:123], a[232:235], a[168:171], v[120:123]
  buffer_load_dwordx4 v13, s[44:47], s73 offen offset:3072 lds
  v_mfma_f32_16x16x32_bf16 v[116:119], a[232:235], a[164:167], v[116:119]
  s_waitcnt vmcnt(14)
  ds_read_b64_tr_b16 a[196:197], v2 offset:4096
  v_mfma_f32_16x16x32_bf16 v[116:119], a[236:239], a[180:183], v[116:119]
  s_mov_b32 s74, 0x3c0000
  ds_read_b64_tr_b16 a[204:205], v3 offset:4096
  v_mfma_f32_16x16x32_bf16 v[112:115], a[236:239], a[176:179], v[112:115]
  s_add_u32 m0, s72, 0x5000
  ds_read_b64_tr_b16 a[212:213], v4 offset:4096
  v_mfma_f32_16x16x32_bf16 v[112:115], a[232:235], a[160:163], v[112:115]
  buffer_load_dwordx4 v10, s[44:47], s74 offen lds
  v_mfma_f32_16x16x32_bf16 v[128:131], a[240:243], a[160:163], v[128:131]
  ds_read_b64_tr_b16 a[220:221], v5 offset:4096
  v_mfma_f32_16x16x32_bf16 v[128:131], a[244:247], a[176:179], v[128:131]
  ds_read_b128 a[8:11], v247 offset:51200
  v_mfma_f32_16x16x32_bf16 v[132:135], a[244:247], a[180:183], v[132:135]
  ds_read_b128 a[24:27], v247 offset:55296
  v_mfma_f32_16x16x32_bf16 v[132:135], a[240:243], a[164:167], v[132:135]
  buffer_load_dwordx4 v11, s[44:47], s74 offen offset:1024 lds
  v_mfma_f32_16x16x32_bf16 v[136:139], a[240:243], a[168:171], v[136:139]
  s_waitcnt vmcnt(14)
  ds_read_b64_tr_b16 a[198:199], v2 offset:6144
  v_mfma_f32_16x16x32_bf16 v[136:139], a[244:247], a[184:187], v[136:139]
  ds_read_b64_tr_b16 a[206:207], v3 offset:6144
  v_mfma_f32_16x16x32_bf16 v[140:143], a[244:247], a[188:191], v[140:143]
  ds_read_b64_tr_b16 a[214:215], v4 offset:6144
  v_mfma_f32_16x16x32_bf16 v[140:143], a[240:243], a[172:175], v[140:143]
  buffer_load_dwordx4 v12, s[44:47], s74 offen offset:2048 lds
  v_mfma_f32_16x16x32_bf16 v[156:159], a[248:251], a[172:175], v[156:159]
  ds_read_b64_tr_b16 a[222:223], v5 offset:6144
  v_mfma_f32_16x16x32_bf16 v[156:159], a[252:255], a[188:191], v[156:159]
  ds_read_b128 a[12:15], v247 offset:52224
  v_mfma_f32_16x16x32_bf16 v[152:155], a[252:255], a[184:187], v[152:155]
  ds_read_b128 a[28:31], v247 offset:56320
  v_mfma_f32_16x16x32_bf16 v[152:155], a[248:251], a[168:171], v[152:155]
  buffer_load_dwordx4 v13, s[44:47], s74 offen offset:3072 lds
  v_mfma_f32_16x16x32_bf16 v[148:151], a[248:251], a[164:167], v[148:151]
  s_waitcnt vmcnt(14)
  ds_read_b64_tr_b16 a[224:225], v2 offset:8192
  v_mfma_f32_16x16x32_bf16 v[148:151], a[252:255], a[180:183], v[148:151]
  s_mov_b32 s73, 0x380080
  ds_read_b64_tr_b16 a[232:233], v3 offset:8192
  v_mfma_f32_16x16x32_bf16 v[144:147], a[252:255], a[176:179], v[144:147]
  s_add_u32 m0, s72, 0
  s_waitcnt lgkmcnt(8)
  ds_read_b64_tr_b16 a[240:241], v4 offset:8192
  v_mfma_f32_16x16x32_bf16 v[144:147], a[248:251], a[160:163], v[144:147]
  buffer_load_dwordx4 v10, s[44:47], s73 offen lds
  v_mfma_f32_16x16x32_bf16 v[96:99], a[192:195], a[0:3], v[96:99]
  s_waitcnt lgkmcnt(8)
  ds_read_b64_tr_b16 a[248:249], v5 offset:8192
  v_mfma_f32_16x16x32_bf16 v[96:99], a[196:199], a[16:19], v[96:99]
  ds_read_b128 a[32:35], v247 offset:57344
  s_cmp_eq_u32 s14, 6
  s_cbranch_scc1 L_t46
L_r46:
  v_mfma_f32_16x16x32_bf16 v[100:103], a[196:199], a[20:23], v[100:103]
  ds_read_b128 a[48:51], v247 offset:61440
  v_mfma_f32_16x16x32_bf16 v[100:103], a[192:195], a[4:7], v[100:103]
  buffer_load_dwordx4 v11, s[44:47], s73 offen offset:1024 lds
  v_mfma_f32_16x16x32_bf16 v[104:107], a[192:195], a[8:11], v[104:107]
  s_waitcnt vmcnt(14)
  ds_read_b64_tr_b16 a[226:227], v2 offset:10240
  v_mfma_f32_16x16x32_bf16 v[104:107], a[196:199], a[24:27], v[104:107]
  s_waitcnt lgkmcnt(7)
  ds_read_b64_tr_b16 a[234:235], v3 offset:10240
  v_mfma_f32_16x16x32_bf16 v[108:111], a[196:199], a[28:31], v[108:111]
  ds_read_b64_tr_b16 a[242:243], v4 offset:10240
  v_mfma_f32_16x16x32_bf16 v[108:111], a[192:195], a[12:15], v[108:111]
  buffer_load_dwordx4 v12, s[44:47], s73 offen offset:2048 lds
  v_mfma_f32_16x16x32_bf16 v[124:127], a[200:203], a[12:15], v[124:127]
  ds_read_b64_tr_b16 a[250:251], v5 offset:10240
  v_mfma_f32_16x16x32_bf16 v[124:127], a[204:207], a[28:31], v[124:127]
  ds_read_b128 a[36:39], v247 offset:58368
  v_mfma_f32_16x16x32_bf16 v[120:123], a[204:207], a[24:27], v[120:123]
  ds_read_b128 a[52:55], v247 offset:62464
  v_mfma_f32_16x16x32_bf16 v[120:123], a[200:203], a[8:11], v[120:123]
  buffer_load_dwordx4 v13, s[44:47], s73 offen offset:3072 lds
  v_mfma_f32_16x16x32_bf16 v[116:119], a[200:203], a[4:7], v[116:119]
  s_waitcnt vmcnt(14)
  ds_read_b64_tr_b16 a[228:229], v2 offset:12288
  v_mfma_f32_16x16x32_bf16 v[116:119], a[204:207], a[20:23], v[116:119]
  s_mov_b32 s74, 0x3c0080
  ds_read_b64_tr_b16 a[236:237], v3 offset:12288
  v_mfma_f32_16x16x32_bf16 v[112:115], a[204:207], a[16:19], v[112:115]
  s_add_u32 m0, s72, 0x1000
  ds_read_b64_tr_b16 a[244:245], v4 offset:12288
  v_mfma_f32_16x16x32_bf16 v[112:115], a[200:203], a[0:3], v[112:115]
  buffer_load_dwordx4 v10, s[44:47], s74 offen lds
  v_mfma_f32_16x16x32_bf16 v[128:131], a[208:211], a[0:3], v[128:131]
  ds_read_b64_tr_b16 a[252:253], v5 offset:12288
  v_mfma_f32_16x16x32_bf16 v[128:131], a[212:215], a[16:19], v[128:131]
  ds_read_b128 a[40:43], v247 offset:59392
  v_mfma_f32_16x16x32_bf16 v[132:135], a[212:215], a[20:23], v[132:135]
  ds_read_b128 a[56:59], v247 offset:63488
  v_mfma_f32_16x16x32_bf16 v[132:135], a[208:211], a[4:7], v[132:135]
  buffer_load_dwordx4 v11, s[44:47], s74 offen offset:1024 lds
  v_mfma_f32_16x16x32_bf16 v[136:139], a[208:211], a[8:11], v[136:139]
  s_waitcnt vmcnt(14)
  ds_read_b64_tr_b16 a[230:231], v2 offset:14336
  v_mfma_f32_16x16x32_bf16 v[136:139], a[212:215], a[24:27], v[136:139]
  ds_read_b64_tr_b16 a[238:239], v3 offset:14336
  v_mfma_f32_16x16x32_bf16 v[140:143], a[212:215], a[28:31], v[140:143]
  ds_read_b64_tr_b16 a[246:247], v4 offset:14336
  v_mfma_f32_16x16x32_bf16 v[140:143], a[208:211], a[12:15], v[140:143]
  buffer_load_dwordx4 v12, s[44:47], s74 offen offset:2048 lds
  v_mfma_f32_16x16x32_bf16 v[156:159], a[216:219], a[12:15], v[156:159]
  ds_read_b64_tr_b16 a[254:255], v5 offset:14336
  v_mfma_f32_16x16x32_bf16 v[156:159], a[220:223], a[28:31], v[156:159]
L_w1:
L_p8455:
  s_cmp_eq_u32 s95, 1
  s_cbranch_scc1 L_p10655
  ds_read_b128 a[44:47], v247 offset:60416
  v_mfma_f32_16x16x32_bf16 v[152:155], a[220:223], a[24:27], v[152:155]
  ds_read_b128 a[60:63], v247 offset:64512
  v_mfma_f32_16x16x32_bf16 v[152:155], a[216:219], a[8:11], v[152:155]
  buffer_load_dwordx4 v13, s[44:47], s74 offen offset:3072 lds
  v_mfma_f32_16x16x32_bf16 v[148:151], a[216:219], a[4:7], v[148:151]
  s_waitcnt vmcnt(14)
  ds_read_b64_tr_b16 a[192:193], v2 offset:16384
  v_mfma_f32_16x16x32_bf16 v[148:151], a[220:223], a[20:23], v[148:151]
  s_mov_b32 s73, 0x300000
  ds_read_b64_tr_b16 a[200:201], v3 offset:16384
  v_mfma_f32_16x16x32_bf16 v[144:147], a[220:223], a[16:19], v[144:147]
  s_add_u32 m0, s72, 0x2000
  s_waitcnt lgkmcnt(9)
  v_mfma_f32_16x16x32_bf16 v[144:147], a[216:219], a[0:3], v[144:147]
  buffer_load_dwordx4 v10, s[44:47], s73 offen lds
  v_mfma_f32_16x16x32_bf16 v[96:99], a[224:227], a[32:35], v[96:99]
  s_waitcnt lgkmcnt(7)
  ds_read_b64_tr_b16 a[208:209], v4 offset:16384
  v_mfma_f32_16x16x32_bf16 v[96:99], a[228:231], a[48:51], v[96:99]
  ds_read_b64_tr_b16 a[216:217], v5 offset:16384
  v_mfma_f32_16x16x32_bf16 v[100:103], a[228:231], a[52:55], v[100:103]
  s_cmp_eq_u32 s14, 7
  s_cbranch_scc1 L_t47
L_r47:
  v_mfma_f32_16x16x32_bf16 v[100:103], a[224:227], a[36:39], v[100:103]
  buffer_load_dwordx4 v11, s[44:47], s73 offen offset:1024 lds
  v_mfma_f32_16x16x32_bf16 v[104:107], a[224:227], a[40:43], v[104:107]
  s_waitcnt vmcnt(14)
  ds_read_b64_tr_b16 a[194:195], v2 offset:18432
  v_mfma_f32_16x16x32_bf16 v[104:107], a[228:231], a[56:59], v[104:107]
  s_waitcnt lgkmcnt(5)
  ds_read_b64_tr_b16 a[202:203], v3 offset:18432
  v_mfma_f32_16x16x32_bf16 v[108:111], a[228:231], a[60:63], v[108:111]
  v_mfma_f32_16x16x32_bf16 v[108:111], a[224:227], a[44:47], v[108:111]
  buffer_load_dwordx4 v12, s[44:47], s73 offen offset:2048 lds
  v_mfma_f32_16x16x32_bf16 v[124:127], a[232:235], a[44:47], v[124:127]
  ds_read_b64_tr_b16 a[210:211], v4 offset:18432
  v_mfma_f32_16x16x32_bf16 v[124:127], a[236:239], a[60:63], v[124:127]
  ds_read_b64_tr_b16 a[218:219], v5 offset:18432
  v_mfma_f32_16x16x32_bf16 v[120:123], a[236:239], a[56:59], v[120:123]
  v_mfma_f32_16x16x32_bf16 v[120:123], a[232:235], a[40:43], v[120:123]
  buffer_load_dwordx4 v13, s[44:47], s73 offen offset:3072 lds
  v_mfma_f32_16x16x32_bf16 v[116:119], a[232:235], a[36:39], v[116:119]
  s_waitcnt vmcnt(14)
  ds_read_b64_tr_b16 a[196:197], v2 offset:20480
  v_mfma_f32_16x16x32_bf16 v[116:119], a[236:239], a[52:55], v[116:119]
  s_mov_b32 s74, 0x340000
  ds_read_b64_tr_b16 a[204:205], v3 offset:20480
  v_mfma_f32_16x16x32_bf16 v[112:115], a[236:239], a[48:51], v[112:115]
  s_add_u32 m0, s72, 0x3000
  v_mfma_f32_16x16x32_bf16 v[112:115], a[232:235], a[32:35], v[112:115]
  buffer_load_dwordx4 v10, s[44:47], s74 offen lds
  v_mfma_f32_16x16x32_bf16 v[128:131], a[240:243], a[32:35], v[128:131]
  ds_read_b64_tr_b16 a[212:213], v4 offset:20480
  v_mfma_f32_16x16x32_bf16 v[128:131], a[244:247], a[48:51], v[128:131]
  ds_read_b64_tr_b16 a[220:221], v5 offset:20480
  v_mfma_f32_16x16x32_bf16 v[132:135], a[244:247], a[52:55], v[132:135]
  v_mfma_f32_16x16x32_bf16 v[132:135], a[240:243], a[36:39], v[132:135]
  buffer_load_dwordx4 v11, s[44:47], s74 offen offset:1024 lds
  v_mfma_f32_16x16x32_bf16 v[136:139], a[240:243], a[40:43], v[136:139]
  s_waitcnt vmcnt(14)
  ds_read_b64_tr_b16 a[198:199], v2 offset:22528
  v_mul_f32 v249, v96, v96
  v_mfma_f32_16x16x32_bf16 v[136:139], a[244:247], a[56:59], v[136:139]
  ds_read_b64_tr_b16 a[206:207], v3 offset:22528
  v_fma_f32 v249, v249, s80, v248
  v_mfma_f32_16x16x32_bf16 v[140:143], a[244:247], a[60:63], v[140:143]
  v_mul_f32 v249, v249, v96
  v_mfma_f32_16x16x32_bf16 v[140:143], a[240:243], a[44:47], v[140:143]
  buffer_load_dwordx4 v12, s[44:47], s74 offen offset:2048 lds
  v_mfma_f32_16x16x32_bf16 v[156:159], a[248:251], a[44:47], v[156:159]
  ds_read_b64_tr_b16 a[214:215], v4 offset:22528
  v_mfma_f32_16x16x32_bf16 v[156:159], a[252:255], a[60:63], v[156:159]
  ds_read_b64_tr_b16 a[222:223], v5 offset:22528
  v_mfma_f32_16x16x32_bf16 v[152:155], a[252:255], a[56:59], v[152:155]
  v_exp_f32 v249, v249
  v_mfma_f32_16x16x32_bf16 v[152:155], a[248:251], a[40:43], v[152:155]
  buffer_load_dwordx4 v13, s[44:47], s74 offen offset:3072 lds
  v_mfma_f32_16x16x32_bf16 v[148:151], a[248:251], a[36:39], v[148:151]
  s_waitcnt vmcnt(14)
  ds_read_b64_tr_b16 a[224:225], v2
  v_fma_f32 v249, v249, s15, s15
  v_mfma_f32_16x16x32_bf16 v[148:151], a[252:255], a[52:55], v[148:151]
  s_mov_b32 s73, 0x300080
  ds_read_b64_tr_b16 a[232:233], v3
  v_mul_f32 v250, v97, v97
  v_mfma_f32_16x16x32_bf16 v[144:147], a[252:255], a[48:51], v[144:147]
  s_add_u32 m0, s72, 0x4000
  s_waitcnt lgkmcnt(5)
  v_rcp_f32 v249, v249
  v_mfma_f32_16x16x32_bf16 v[144:147], a[248:251], a[32:35], v[144:147]
  buffer_load_dwordx4 v10, s[44:47], s73 offen lds
  v_mfma_f32_16x16x32_bf16 v[32:35], a[192:195], a[32:35], 0
  ds_read_b64_tr_b16 a[240:241], v4
  v_mul_f32 v96, v96, v249
  v_mfma_f32_16x16x32_bf16 v[32:35], a[196:199], a[48:51], v[32:35]
  ds_read_b64_tr_b16 a[248:249], v5
  v_fma_f32 v250, v250, s80, v248
  v_mfma_f32_16x16x32_bf16 v[48:51], a[196:199], a[52:55], 0
  s_cmp_eq_u32 s14, 8
  s_cbranch_scc1 L_t48
L_r48:
  v_mfma_f32_16x16x32_bf16 v[48:51], a[192:195], a[36:39], v[48:51]
  buffer_load_dwordx4 v11, s[44:47], s73 offen offset:1024 lds
  v_mfma_f32_16x16x32_bf16 v[64:67], a[192:195], a[40:43], 0
  s_waitcnt vmcnt(14)
  ds_read_b64_tr_b16 a[226:227], v2 offset:2048
  v_mul_f32 v250, v250, v97
  v_mfma_f32_16x16x32_bf16 v[64:67], a[196:199], a[56:59], v[64:67]
  ds_read_b64_tr_b16 a[234:235], v3 offset:2048
  v_mul_f32 v251, v98, v98
  v_mfma_f32_16x16x32_bf16 v[80:83], a[196:199], a[60:63], 0
  v_exp_f32 v250, v250
  v_mfma_f32_16x16x32_bf16 v[80:83], a[192:195], a[44:47], v[80:83]
  buffer_load_dwordx4 v12, s[44:47], s73 offen offset:2048 lds
  v_mfma_f32_16x16x32_bf16 v[208:211], a[200:203], a[44:47], 0
  s_waitcnt lgkmcnt(4)
  ds_read_b64_tr_b16 a[242:243], v4 offset:2048
  v_fma_f32 v250, v250, s15, s15
  v_mul_f32 v252, v99, v99
  v_mfma_f32_16x16x32_bf16 v[208:211], a[204:207], a[60:63], v[208:211]
  ds_read_b64_tr_b16 a[250:251], v5 offset:2048
  v_fma_f32 v251, v251, s80, v248
  v_fma_f32 v252, v252, s80, v248
  v_mfma_f32_16x16x32_bf16 v[192:195], a[204:207], a[56:59], 0
  v_rcp_f32 v250, v250
  v_mul_f32 v252, v252, v99
  v_mfma_f32_16x16x32_bf16 v[192:195], a[200:203], a[40:43], v[192:195]
  buffer_load_dwordx4 v13, s[44:47], s73 offen offset:3072 lds
  v_exp_f32 v252, v252
  v_mfma_f32_16x16x32_bf16 v[176:179], a[200:203], a[36:39], 0
  s_waitcnt vmcnt(14)
  ds_read_b64_tr_b16 a[228:229], v2 offset:4096
  v_mul_f32 v97, v97, v250
  v_mfma_f32_16x16x32_bf16 v[176:179], a[204:207], a[52:55], v[176:179]
  s_mov_b32 s74, 0x340080
  ds_read_b64_tr_b16 a[236:237], v3 offset:4096
  v_mul_f32 v251, v251, v98
  v_cvt_pk_bf16_f32 v96, v96, v97
  v_mfma_f32_16x16x32_bf16 v[160:163], a[204:207], a[48:51], 0
  s_add_u32 m0, s72, 0x5000
  v_exp_f32 v251, v251
  v_mfma_f32_16x16x32_bf16 v[160:163], a[200:203], a[32:35], v[160:163]
  buffer_load_dwordx4 v10, s[44:47], s74 offen lds
  v_mul_f32 v253, v100, v100
  v_mfma_f32_16x16x32_bf16 v[36:39], a[208:211], a[32:35], 0
  ds_read_b64_tr_b16 a[244:245], v4 offset:4096
  v_fma_f32 v251, v251, s15, s15
  v_mfma_f32_16x16x32_bf16 v[36:39], a[212:215], a[48:51], v[36:39]
  ds_read_b64_tr_b16 a[252:253], v5 offset:4096
  v_fma_f32 v252, v252, s15, s15
  v_mfma_f32_16x16x32_bf16 v[52:55], a[212:215], a[52:55], 0
  v_rcp_f32 v251, v251
  v_mfma_f32_16x16x32_bf16 v[52:55], a[208:211], a[36:39], v[52:55]
  buffer_load_dwordx4 v11, s[44:47], s74 offen offset:1024 lds
  v_mfma_f32_16x16x32_bf16 v[68:71], a[208:211], a[40:43], 0
  s_waitcnt vmcnt(14)
  ds_read_b64_tr_b16 a[230:231], v2 offset:6144
  v_mul_f32 v98, v98, v251
  v_mfma_f32_16x16x32_bf16 v[68:71], a[212:215], a[56:59], v[68:71]
  ds_read_b64_tr_b16 a[238:239], v3 offset:6144
  v_fma_f32 v253, v253, s80, v248
  v_mfma_f32_16x16x32_bf16 v[84:87], a[212:215], a[60:63], 0
  v_rcp_f32 v252, v252
  v_mfma_f32_16x16x32_bf16 v[84:87], a[208:211], a[44:47], v[84:87]
  buffer_load_dwordx4 v12, s[44:47], s74 offen offset:2048 lds
  v_mfma_f32_16x16x32_bf16 v[212:215], a[216:219], a[44:47], 0
  ds_read_b64_tr_b16 a[246:247], v4 offset:6144
  v_mul_f32 v99, v99, v252
  v_mfma_f32_16x16x32_bf16 v[212:215], a[220:223], a[60:63], v[212:215]
  ds_read_b64_tr_b16 a[254:255], v5 offset:6144
  v_cvt_pk_bf16_f32 v97, v98, v99
  v_mfma_f32_16x16x32_bf16 v[196:199], a[220:223], a[56:59], 0
  s_mul_i32 s77, s3, 0x2000
  v_mul_f32 v253, v253, v100
  v_mul_f32 v254, v101, v101
  v_mfma_f32_16x16x32_bf16 v[196:199], a[216:219], a[40:43], v[196:199]
  buffer_load_dwordx4 v13, s[44:47], s74 offen offset:3072 lds
  v_mfma_f32_16x16x32_bf16 v[180:183], a[216:219], a[36:39], 0
  s_waitcnt vmcnt(14)
  ds_read_b64_tr_b16 a[192:193], v2 offset:8192
  v_fma_f32 v254, v254, s80, v248
  v_mfma_f32_16x16x32_bf16 v[180:183], a[220:223], a[52:55], v[180:183]
  s_mov_b32 s73, 0x280000
  ds_read_b64_tr_b16 a[200:201], v3 offset:8192
  v_mul_f32 v254, v254, v101
  v_mfma_f32_16x16x32_bf16 v[164:167], a[220:223], a[48:51], 0
  s_add_u32 m0, s72, 0
  s_waitcnt lgkmcnt(4)
  v_exp_f32 v253, v253
  v_mfma_f32_16x16x32_bf16 v[164:167], a[216:219], a[32:35], v[164:167]
  buffer_load_dwordx4 v10, s[44:47], s73 offen lds
  v_mfma_f32_16x16x32_bf16 v[40:43], a[224:227], a[32:35], 0
  ds_read_b64_tr_b16 a[208:209], v4 offset:8192
  v_fma_f32 v253, v253, s15, s15
  v_mfma_f32_16x16x32_bf16 v[40:43], a[228:231], a[48:51], v[40:43]
  ds_read_b64_tr_b16 a[216:217], v5 offset:8192
  v_exp_f32 v254, v254
  v_mfma_f32_16x16x32_bf16 v[56:59], a[228:231], a[52:55], 0
  v_mul_f32 v255, v102, v102
  s_cmp_eq_u32 s14, 9
  s_cbranch_scc1 L_t49
L_r49:
  v_mfma_f32_16x16x32_bf16 v[56:59], a[224:227], a[36:39], v[56:59]
  buffer_load_dwordx4 v11, s[44:47], s73 offen offset:1024 lds
  v_mul_f32 v249, v103, v103
  v_mfma_f32_16x16x32_bf16 v[72:75], a[224:227], a[40:43], 0
  s_waitcnt vmcnt(14)
  ds_read_b64_tr_b16 a[194:195], v2 offset:10240
  v_fma_f32 v254, v254, s15, s15
  v_fma_f32 v249, v249, s80, v248
  v_mfma_f32_16x16x32_bf16 v[72:75], a[228:231], a[56:59], v[72:75]
  ds_read_b64_tr_b16 a[202:203], v3 offset:10240
  v_fma_f32 v255, v255, s80, v248
  v_mul_f32 v249, v249, v103
  v_mfma_f32_16x16x32_bf16 v[88:91], a[228:231], a[60:63], 0
  v_rcp_f32 v253, v253
  v_exp_f32 v249, v249
  v_mfma_f32_16x16x32_bf16 v[88:91], a[224:227], a[44:47], v[88:91]
  buffer_load_dwordx4 v12, s[44:47], s73 offen offset:2048 lds
  v_fma_f32 v249, v249, s15, s15
  v_mfma_f32_16x16x32_bf16 v[216:219], a[232:235], a[44:47], 0
  ds_read_b64_tr_b16 a[210:211], v4 offset:10240
  v_mul_f32 v100, v100, v253
  v_mfma_f32_16x16x32_bf16 v[216:219], a[236:239], a[60:63], v[216:219]
  ds_read_b64_tr_b16 a[218:219], v5 offset:10240
  v_mul_f32 v255, v255, v102
  v_mfma_f32_16x16x32_bf16 v[200:203], a[236:239], a[56:59], 0
  v_rcp_f32 v254, v254
  v_mul_f32 v250, v104, v104
  v_mfma_f32_16x16x32_bf16 v[200:203], a[232:235], a[40:43], v[200:203]
  buffer_load_dwordx4 v13, s[44:47], s73 offen offset:3072 lds
  v_fma_f32 v250, v250, s80, v248
  v_mfma_f32_16x16x32_bf16 v[184:187], a[232:235], a[36:39], 0
  s_waitcnt vmcnt(14)
  ds_read_b64_tr_b16 a[196:197], v2 offset:12288
  v_mul_f32 v101, v101, v254
  v_mul_f32 v250, v250, v104
  v_mfma_f32_16x16x32_bf16 v[184:187], a[236:239], a[52:55], v[184:187]
  s_mov_b32 s74, 0x2c0000
  ds_read_b64_tr_b16 a[204:205], v3 offset:12288
  v_rcp_f32 v249, v249
  v_cvt_pk_bf16_f32 v98, v100, v101
  v_exp_f32 v250, v250
  v_mfma_f32_16x16x32_bf16 v[168:171], a[236:239], a[48:51], 0
  s_add_u32 m0, s72, 0x1000
  v_exp_f32 v255, v255
  v_fma_f32 v250, v250, s15, s15
  v_mfma_f32_16x16x32_bf16 v[168:171], a[232:235], a[32:35], v[168:171]
  buffer_load_dwordx4 v10, s[44:47], s74 offen lds
  v_rcp_f32 v250, v250
  v_mfma_f32_16x16x32_bf16 v[44:47], a[240:243], a[32:35], 0
  s_waitcnt lgkmcnt(2)
  ds_read_b64_tr_b16 a[212:213], v4 offset:12288
  v_fma_f32 v255, v255, s15, s15
  v_mul_f32 v104, v104, v250
  v_mfma_f32_16x16x32_bf16 v[44:47], a[244:247], a[48:51], v[44:47]
  ds_read_b64_tr_b16 a[220:221], v5 offset:12288
  v_mul_f32 v103, v103, v249
  v_mfma_f32_16x16x32_bf16 v[60:63], a[244:247], a[52:55], 0
  v_rcp_f32 v255, v255
  v_mfma_f32_16x16x32_bf16 v[60:63], a[240:243], a[36:39], v[60:63]
  buffer_load_dwordx4 v11, s[44:47], s74 offen offset:1024 lds
  v_mfma_f32_16x16x32_bf16 v[76:79], a[240:243], a[40:43], 0
  s_waitcnt vmcnt(14)
  ds_read_b64_tr_b16 a[198:199], v2 offset:14336
  v_mul_f32 v102, v102, v255
  v_mfma_f32_16x16x32_bf16 v[76:79], a[244:247], a[56:59], v[76:79]
  ds_read_b64_tr_b16 a[206:207], v3 offset:14336
  v_cvt_pk_bf16_f32 v99, v102, v103
  v_mfma_f32_16x16x32_bf16 v[92:95], a[244:247], a[60:63], 0
  v_mul_f32 v251, v105, v105
  v_add_u32 v241, 8, v1
  v_mfma_f32_16x16x32_bf16 v[92:95], a[240:243], a[44:47], v[92:95]
  buffer_load_dwordx4 v12, s[44:47], s74 offen offset:2048 lds
  v_mfma_f32_16x16x32_bf16 v[220:223], a[248:251], a[44:47], 0
  ds_read_b64_tr_b16 a[214:215], v4 offset:14336
  v_fma_f32 v251, v251, s80, v248
  v_mfma_f32_16x16x32_bf16 v[220:223], a[252:255], a[60:63], v[220:223]
  ds_read_b64_tr_b16 a[222:223], v5 offset:14336
  v_mul_f32 v251, v251, v105
  v_mfma_f32_16x16x32_bf16 v[204:207], a[252:255], a[56:59], 0
  v_exp_f32 v251, v251
  v_mfma_f32_16x16x32_bf16 v[204:207], a[248:251], a[40:43], v[204:207]
  buffer_load_dwordx4 v13, s[44:47], s74 offen offset:3072 lds
  v_mfma_f32_16x16x32_bf16 v[188:191], a[248:251], a[36:39], 0
  s_waitcnt vmcnt(14)
  ds_read_b64_tr_b16 a[224:225], v2 offset:16384
  v_fma_f32 v251, v251, s15, s15
  v_mfma_f32_16x16x32_bf16 v[188:191], a[252:255], a[52:55], v[188:191]
  s_mov_b32 s73, 0x280080
  ds_read_b64_tr_b16 a[232:233], v3 offset:16384
  v_mul_f32 v252, v106, v106
  v_mfma_f32_16x16x32_bf16 v[172:175], a[252:255], a[48:51], 0
  s_add_u32 m0, s72, 0x2000
  v_rcp_f32 v251, v251
  v_mfma_f32_16x16x32_bf16 v[172:175], a[248:251], a[32:35], v[172:175]
  buffer_load_dwordx4 v10, s[44:47], s73 offen lds
  v_mfma_f32_16x16x32_bf16 v[32:35], a[192:195], a[0:3], v[32:35]
  s_waitcnt lgkmcnt(4)
  ds_read_b64_tr_b16 a[240:241], v4 offset:16384
  v_mul_f32 v105, v105, v251
  v_mfma_f32_16x16x32_bf16 v[32:35], a[196:199], a[16:19], v[32:35]
  ds_read_b64_tr_b16 a[248:249], v5 offset:16384
  v_fma_f32 v252, v252, s80, v248
  v_cvt_pk_bf16_f32 v104, v104, v105
  v_mfma_f32_16x16x32_bf16 v[48:51], a[196:199], a[20:23], v[48:51]
  v_mul_f32 v253, v107, v107
  s_cmp_eq_u32 s14, 10
  s_cbranch_scc1 L_t410
L_r410:
  v_mfma_f32_16x16x32_bf16 v[48:51], a[192:195], a[4:7], v[48:51]
  buffer_load_dwordx4 v11, s[44:47], s73 offen offset:1024 lds
  v_mfma_f32_16x16x32_bf16 v[64:67], a[192:195], a[8:11], v[64:67]
  s_waitcnt vmcnt(14)
  ds_read_b64_tr_b16 a[226:227], v2 offset:18432
  v_mul_f32 v252, v252, v106
  v_mfma_f32_16x16x32_bf16 v[64:67], a[196:199], a[24:27], v[64:67]
  ds_read_b64_tr_b16 a[234:235], v3 offset:18432
  v_fma_f32 v253, v253, s80, v248
  v_mfma_f32_16x16x32_bf16 v[80:83], a[196:199], a[28:31], v[80:83]
  v_exp_f32 v252, v252
  v_mul_f32 v254, v108, v108
  v_mfma_f32_16x16x32_bf16 v[80:83], a[192:195], a[12:15], v[80:83]
  buffer_load_dwordx4 v12, s[44:47], s73 offen offset:2048 lds
  v_fma_f32 v254, v254, s80, v248
  v_mfma_f32_16x16x32_bf16 v[208:211], a[200:203], a[12:15], v[208:211]
  ds_read_b64_tr_b16 a[242:243], v4 offset:18432
  v_fma_f32 v252, v252, s15, s15
  v_mfma_f32_16x16x32_bf16 v[208:211], a[204:207], a[28:31], v[208:211]
  ds_read_b64_tr_b16 a[250:251], v5 offset:18432
  v_mul_f32 v253, v253, v107
  v_mfma_f32_16x16x32_bf16 v[192:195], a[204:207], a[24:27], v[192:195]
  v_rcp_f32 v252, v252
  v_mfma_f32_16x16x32_bf16 v[192:195], a[200:203], a[8:11], v[192:195]
  buffer_load_dwordx4 v13, s[44:47], s73 offen offset:3072 lds
  v_mfma_f32_16x16x32_bf16 v[176:179], a[200:203], a[4:7], v[176:179]
  s_waitcnt vmcnt(14)
  ds_read_b64_tr_b16 a[228:229], v2 offset:20480
  v_mul_f32 v106, v106, v252
  v_mul_f32 v255, v109, v109
  v_mfma_f32_16x16x32_bf16 v[176:179], a[204:207], a[20:23], v[176:179]
  s_mov_b32 s74, 0x2c0080
  ds_read_b64_tr_b16 a[236:237], v3 offset:20480
  v_mul_f32 v254, v254, v108
  v_fma_f32 v255, v255, s80, v248
  v_mfma_f32_16x16x32_bf16 v[160:163], a[204:207], a[16:19], v[160:163]
  s_add_u32 m0, s72, 0x3000
  v_exp_f32 v253, v253
  v_mul_f32 v255, v255, v109
  v_mfma_f32_16x16x32_bf16 v[160:163], a[200:203], a[0:3], v[160:163]
  buffer_load_dwordx4 v10, s[44:47], s74 offen lds
  v_exp_f32 v255, v255
  v_mfma_f32_16x16x32_bf16 v[36:39], a[208:211], a[0:3], v[36:39]
  s_waitcnt lgkmcnt(3)
  ds_read_b64_tr_b16 a[244:245], v4 offset:20480
  v_fma_f32 v253, v253, s15, s15
  v_fma_f32 v255, v255, s15, s15
  v_mfma_f32_16x16x32_bf16 v[36:39], a[212:215], a[16:19], v[36:39]
  ds_read_b64_tr_b16 a[252:253], v5 offset:20480
  v_exp_f32 v254, v254
  v_mfma_f32_16x16x32_bf16 v[52:55], a[212:215], a[20:23], v[52:55]
  v_rcp_f32 v253, v253
  v_mfma_f32_16x16x32_bf16 v[52:55], a[208:211], a[4:7], v[52:55]
  buffer_load_dwordx4 v11, s[44:47], s74 offen offset:1024 lds
  v_mul_f32 v249, v110, v110
  v_mfma_f32_16x16x32_bf16 v[68:71], a[208:211], a[8:11], v[68:71]
  s_waitcnt vmcnt(14)
  ds_read_b64_tr_b16 a[230:231], v2 offset:22528
  v_mul_f32 v107, v107, v253
  v_mfma_f32_16x16x32_bf16 v[68:71], a[212:215], a[24:27], v[68:71]
  ds_read_b64_tr_b16 a[238:239], v3 offset:22528
  v_cvt_pk_bf16_f32 v105, v106, v107
  v_mfma_f32_16x16x32_bf16 v[84:87], a[212:215], a[28:31], v[84:87]
  v_fma_f32 v254, v254, s15, s15
  v_rcp_f32 v255, v255
  v_mfma_f32_16x16x32_bf16 v[84:87], a[208:211], a[12:15], v[84:87]
  buffer_load_dwordx4 v12, s[44:47], s74 offen offset:2048 lds
  v_mfma_f32_16x16x32_bf16 v[212:215], a[216:219], a[12:15], v[212:215]
  ds_read_b64_tr_b16 a[246:247], v4 offset:22528
  v_mul_f32 v109, v109, v255
  v_mfma_f32_16x16x32_bf16 v[212:215], a[220:223], a[28:31], v[212:215]
  ds_read_b64_tr_b16 a[254:255], v5 offset:22528
  v_fma_f32 v249, v249, s80, v248
  v_mfma_f32_16x16x32_bf16 v[196:199], a[220:223], a[24:27], v[196:199]
  v_rcp_f32 v254, v254
  v_mul_f32 v250, v111, v111
  v_mfma_f32_16x16x32_bf16 v[196:199], a[216:219], a[8:11], v[196:199]
  buffer_load_dwordx4 v13, s[44:47], s74 offen offset:3072 lds
  v_fma_f32 v250, v250, s80, v248
  v_mfma_f32_16x16x32_bf16 v[180:183], a[216:219], a[4:7], v[180:183]
  s_waitcnt vmcnt(14)
  ds_read_b64_tr_b16 a[192:193], v2
  v_mul_f32 v108, v108, v254
  v_mfma_f32_16x16x32_bf16 v[180:183], a[220:223], a[20:23], v[180:183]
  s_mov_b32 s73, 0x200000
  ds_read_b64_tr_b16 a[200:201], v3
  v_mul_f32 v249, v249, v110
  v_cvt_pk_bf16_f32 v106, v108, v109
  v_mfma_f32_16x16x32_bf16 v[164:167], a[220:223], a[16:19], v[164:167]
  s_add_u32 m0, s72, 0x4000
  v_exp_f32 v249, v249
  v_mfma_f32_16x16x32_bf16 v[164:167], a[216:219], a[0:3], v[164:167]
  buffer_load_dwordx4 v10, s[44:47], s73 offen lds
  v_mfma_f32_16x16x32_bf16 v[40:43], a[224:227], a[0:3], v[40:43]
  s_waitcnt lgkmcnt(4)
  ds_read_b64_tr_b16 a[208:209], v4
  v_fma_f32 v249, v249, s15, s15
  v_mfma_f32_16x16x32_bf16 v[40:43], a[228:231], a[16:19], v[40:43]
  ds_read_b64_tr_b16 a[216:217], v5
  v_mul_f32 v250, v250, v111
  v_mfma_f32_16x16x32_bf16 v[56:59], a[228:231], a[20:23], v[56:59]
  v_exp_f32 v250, v250
  s_cmp_eq_u32 s14, 11
  s_cbranch_scc1 L_t411
L_r411:
  v_mfma_f32_16x16x32_bf16 v[56:59], a[224:227], a[4:7], v[56:59]
  buffer_load_dwordx4 v11, s[44:47], s73 offen offset:1024 lds
  v_mfma_f32_16x16x32_bf16 v[72:75], a[224:227], a[8:11], v[72:75]
  s_waitcnt vmcnt(14)
  ds_read_b64_tr_b16 a[194:195], v2 offset:2048
  v_fma_f32 v250, v250, s15, s15
  v_mfma_f32_16x16x32_bf16 v[72:75], a[228:231], a[24:27], v[72:75]
  ds_read_b64_tr_b16 a[202:203], v3 offset:2048
  v_mul_f32 v251, v112, v112
  v_mfma_f32_16x16x32_bf16 v[88:91], a[228:231], a[28:31], v[88:91]
  v_rcp_f32 v249, v249
  v_mfma_f32_16x16x32_bf16 v[88:91], a[224:227], a[12:15], v[88:91]
  buffer_load_dwordx4 v12, s[44:47], s73 offen offset:2048 lds
  v_mfma_f32_16x16x32_bf16 v[216:219], a[232:235], a[12:15], v[216:219]
  ds_read_b64_tr_b16 a[210:211], v4 offset:2048
  v_mul_f32 v110, v110, v249
  v_mul_f32 v252, v113, v113
  v_mfma_f32_16x16x32_bf16 v[216:219], a[236:239], a[28:31], v[216:219]
  ds_read_b64_tr_b16 a[218:219], v5 offset:2048
  v_fma_f32 v251, v251, s80, v248
  v_mfma_f32_16x16x32_bf16 v[200:203], a[236:239], a[24:27], v[200:203]
  v_rcp_f32 v250, v250
  v_mfma_f32_16x16x32_bf16 v[200:203], a[232:235], a[8:11], v[200:203]
  buffer_load_dwordx4 v13, s[44:47], s73 offen offset:3072 lds
  v_mfma_f32_16x16x32_bf16 v[184:187], a[232:235], a[4:7], v[184:187]
  s_waitcnt vmcnt(14)
  ds_read_b64_tr_b16 a[196:197], v2 offset:4096
  v_mul_f32 v111, v111, v250
  v_mfma_f32_16x16x32_bf16 v[184:187], a[236:239], a[20:23], v[184:187]
  s_mov_b32 s74, 0x240000
  ds_read_b64_tr_b16 a[204:205], v3 offset:4096
  v_cvt_pk_bf16_f32 v107, v110, v111
  v_mfma_f32_16x16x32_bf16 v[168:171], a[236:239], a[16:19], v[168:171]
  s_add_u32 m0, s72, 0x5000
  v_mul_f32 v251, v251, v112
  v_fma_f32 v252, v252, s80, v248
  v_mfma_f32_16x16x32_bf16 v[168:171], a[232:235], a[0:3], v[168:171]
  buffer_load_dwordx4 v10, s[44:47], s74 offen lds
  v_mul_f32 v253, v114, v114
  v_mfma_f32_16x16x32_bf16 v[44:47], a[240:243], a[0:3], v[44:47]
  s_waitcnt lgkmcnt(3)
  ds_read_b64_tr_b16 a[212:213], v4 offset:4096
  v_mul_f32 v252, v252, v113
  v_fma_f32 v253, v253, s80, v248
  v_mfma_f32_16x16x32_bf16 v[44:47], a[244:247], a[16:19], v[44:47]
  ds_read_b64_tr_b16 a[220:221], v5 offset:4096
  v_exp_f32 v252, v252
  v_mul_f32 v253, v253, v114
  v_mfma_f32_16x16x32_bf16 v[60:63], a[244:247], a[20:23], v[60:63]
  v_exp_f32 v251, v251
  v_exp_f32 v253, v253
  v_mfma_f32_16x16x32_bf16 v[60:63], a[240:243], a[4:7], v[60:63]
  buffer_load_dwordx4 v11, s[44:47], s74 offen offset:1024 lds
  v_fma_f32 v253, v253, s15, s15
  v_mfma_f32_16x16x32_bf16 v[76:79], a[240:243], a[8:11], v[76:79]
  s_waitcnt vmcnt(14)
  ds_read_b64_tr_b16 a[198:199], v2 offset:6144
  v_fma_f32 v251, v251, s15, s15
  v_mfma_f32_16x16x32_bf16 v[76:79], a[244:247], a[24:27], v[76:79]
  ds_read_b64_tr_b16 a[206:207], v3 offset:6144
  v_fma_f32 v252, v252, s15, s15
  v_mfma_f32_16x16x32_bf16 v[92:95], a[244:247], a[28:31], v[92:95]
  v_rcp_f32 v251, v251
  v_mul_f32 v254, v115, v115
  v_mfma_f32_16x16x32_bf16 v[92:95], a[240:243], a[12:15], v[92:95]
  buffer_load_dwordx4 v12, s[44:47], s74 offen offset:2048 lds
  v_fma_f32 v254, v254, s80, v248
  v_mfma_f32_16x16x32_bf16 v[220:223], a[248:251], a[12:15], v[220:223]
  ds_read_b64_tr_b16 a[214:215], v4 offset:6144
  v_mul_f32 v112, v112, v251
  v_mul_f32 v254, v254, v115
  v_mfma_f32_16x16x32_bf16 v[220:223], a[252:255], a[28:31], v[220:223]
  ds_read_b64_tr_b16 a[222:223], v5 offset:6144
  v_rcp_f32 v253, v253
  v_mfma_f32_16x16x32_bf16 v[204:207], a[252:255], a[24:27], v[204:207]
  v_rcp_f32 v252, v252
  v_mfma_f32_16x16x32_bf16 v[204:207], a[248:251], a[8:11], v[204:207]
  buffer_load_dwordx4 v13, s[44:47], s74 offen offset:3072 lds
  v_mfma_f32_16x16x32_bf16 v[188:191], a[248:251], a[4:7], v[188:191]
  s_waitcnt vmcnt(14)
  ds_read_b64_tr_b16 a[224:225], v2 offset:8192
  v_mul_f32 v113, v113, v252
  v_mul_f32 v255, v116, v116
  v_mfma_f32_16x16x32_bf16 v[188:191], a[252:255], a[20:23], v[188:191]
  s_mov_b32 s73, 0x200080
  ds_read_b64_tr_b16 a[232:233], v3 offset:8192
  v_mul_f32 v114, v114, v253
  v_cvt_pk_bf16_f32 v112, v112, v113
  v_mfma_f32_16x16x32_bf16 v[172:175], a[252:255], a[16:19], v[172:175]
  s_add_u32 m0, s72, 0
  v_exp_f32 v254, v254
  v_mfma_f32_16x16x32_bf16 v[172:175], a[248:251], a[0:3], v[172:175]
  buffer_load_dwordx4 v10, s[44:47], s73 offen lds
  v_mfma_f32_16x16x32_bf16 v[32:35], a[192:195], a[160:163], v[32:35]
  s_waitcnt lgkmcnt(4)
  ds_read_b64_tr_b16 a[240:241], v4 offset:8192
  v_fma_f32 v254, v254, s15, s15
  v_mfma_f32_16x16x32_bf16 v[32:35], a[196:199], a[176:179], v[32:35]
  ds_read_b64_tr_b16 a[248:249], v5 offset:8192
  v_rcp_f32 v254, v254
  v_mfma_f32_16x16x32_bf16 v[48:51], a[196:199], a[180:183], v[48:51]
  v_fma_f32 v255, v255, s80, v248
  s_cmp_eq_u32 s14, 12
  s_cbranch_scc1 L_t412
L_r412:
  v_mfma_f32_16x16x32_bf16 v[48:51], a[192:195], a[164:167], v[48:51]
  buffer_load_dwordx4 v11, s[44:47], s73 offen offset:1024 lds
  v_mfma_f32_16x16x32_bf16 v[64:67], a[192:195], a[168:171], v[64:67]
  s_waitcnt vmcnt(14)
  ds_read_b64_tr_b16 a[226:227], v2 offset:10240
  v_mul_f32 v115, v115, v254
  v_mfma_f32_16x16x32_bf16 v[64:67], a[196:199], a[184:187], v[64:67]
  ds_read_b64_tr_b16 a[234:235], v3 offset:10240
  v_cvt_pk_bf16_f32 v113, v114, v115
  v_mfma_f32_16x16x32_bf16 v[80:83], a[196:199], a[188:191], v[80:83]
  ds_read_b64_tr_b16 a[242:243], v4 offset:10240
  v_mul_f32 v255, v255, v116
  v_mfma_f32_16x16x32_bf16 v[80:83], a[192:195], a[172:175], v[80:83]
  buffer_load_dwordx4 v12, s[44:47], s73 offen offset:2048 lds
  v_mfma_f32_16x16x32_bf16 v[208:211], a[200:203], a[172:175], v[208:211]
  ds_read_b64_tr_b16 a[250:251], v5 offset:10240
  v_mul_f32 v249, v117, v117
  v_mfma_f32_16x16x32_bf16 v[208:211], a[204:207], a[188:191], v[208:211]
  ds_read_b128 a[32:35], v247 offset:8192
  v_fma_f32 v249, v249, s80, v248
  v_mfma_f32_16x16x32_bf16 v[192:195], a[204:207], a[184:187], v[192:195]
  v_exp_f32 v255, v255
  v_mul_f32 v250, v118, v118
  v_mfma_f32_16x16x32_bf16 v[192:195], a[200:203], a[168:171], v[192:195]
  buffer_load_dwordx4 v13, s[44:47], s73 offen offset:3072 lds
  v_fma_f32 v250, v250, s80, v248
  v_mfma_f32_16x16x32_bf16 v[176:179], a[200:203], a[164:167], v[176:179]
  s_waitcnt vmcnt(14)
  ds_read_b64_tr_b16 a[228:229], v2 offset:12288
  v_fma_f32 v255, v255, s15, s15
  v_mfma_f32_16x16x32_bf16 v[176:179], a[204:207], a[180:183], v[176:179]
  s_mov_b32 s74, 0x240080
  ds_read_b64_tr_b16 a[236:237], v3 offset:12288
  v_mul_f32 v249, v249, v117
  v_mfma_f32_16x16x32_bf16 v[160:163], a[204:207], a[176:179], v[160:163]
  s_add_u32 m0, s72, 0x1000
  v_rcp_f32 v255, v255
  v_mfma_f32_16x16x32_bf16 v[160:163], a[200:203], a[160:163], v[160:163]
  buffer_load_dwordx4 v10, s[44:47], s74 offen lds
  v_mfma_f32_16x16x32_bf16 v[36:39], a[208:211], a[160:163], v[36:39]
  s_waitcnt lgkmcnt(4)
  ds_read_b64_tr_b16 a[244:245], v4 offset:12288
  v_mul_f32 v116, v116, v255
  v_mfma_f32_16x16x32_bf16 v[36:39], a[212:215], a[176:179], v[36:39]
  ds_read_b64_tr_b16 a[252:253], v5 offset:12288
  v_mul_f32 v250, v250, v118
  v_mul_f32 v251, v119, v119
  v_mfma_f32_16x16x32_bf16 v[52:55], a[212:215], a[180:183], v[52:55]
  v_exp_f32 v249, v249
  v_fma_f32 v251, v251, s80, v248
  v_mfma_f32_16x16x32_bf16 v[52:55], a[208:211], a[164:167], v[52:55]
  buffer_load_dwordx4 v11, s[44:47], s74 offen offset:1024 lds
  v_mul_f32 v251, v251, v119
  v_mfma_f32_16x16x32_bf16 v[68:71], a[208:211], a[168:171], v[68:71]
  s_waitcnt vmcnt(14)
  ds_read_b64_tr_b16 a[230:231], v2 offset:14336
  v_fma_f32 v249, v249, s15, s15
  v_exp_f32 v251, v251
  v_mfma_f32_16x16x32_bf16 v[68:71], a[212:215], a[184:187], v[68:71]
  ds_read_b64_tr_b16 a[238:239], v3 offset:14336
  v_exp_f32 v250, v250
  v_fma_f32 v251, v251, s15, s15
  v_mfma_f32_16x16x32_bf16 v[84:87], a[212:215], a[188:191], v[84:87]
  ds_read_b64_tr_b16 a[246:247], v4 offset:14336
  v_fma_f32 v250, v250, s15, s15
  v_rcp_f32 v251, v251
  v_mfma_f32_16x16x32_bf16 v[84:87], a[208:211], a[172:175], v[84:87]
  buffer_load_dwordx4 v12, s[44:47], s74 offen offset:2048 lds
  v_mul_f32 v119, v119, v251
  v_mfma_f32_16x16x32_bf16 v[212:215], a[216:219], a[172:175], v[212:215]
  ds_read_b64_tr_b16 a[254:255], v5 offset:14336
  v_rcp_f32 v250, v250
  v_mul_f32 v252, v120, v120
  v_mfma_f32_16x16x32_bf16 v[212:215], a[220:223], a[188:191], v[212:215]
  ds_read_b128 a[48:51], v247 offset:12288
  v_mul_f32 v118, v118, v250
  v_mfma_f32_16x16x32_bf16 v[196:199], a[220:223], a[184:187], v[196:199]
  v_rcp_f32 v249, v249
  v_mfma_f32_16x16x32_bf16 v[196:199], a[216:219], a[168:171], v[196:199]
  buffer_load_dwordx4 v13, s[44:47], s74 offen offset:3072 lds
  v_mfma_f32_16x16x32_bf16 v[180:183], a[216:219], a[164:167], v[180:183]
L_w0:
L_p9021:
  s_cmp_eq_u32 s95, 1
  s_cbranch_scc1 L_p3427
  s_waitcnt vmcnt(14)
  ds_read_b64_tr_b16 a[192:193], v2 offset:16384
  v_mul_f32 v117, v117, v249
  v_mfma_f32_16x16x32_bf16 v[180:183], a[220:223], a[180:183], v[180:183]
  s_mov_b32 s73, 0x180000
  ds_read_b64_tr_b16 a[200:201], v3 offset:16384
  v_cvt_pk_bf16_f32 v114, v116, v117
  v_mfma_f32_16x16x32_bf16 v[164:167], a[220:223], a[176:179], v[164:167]
  s_add_u32 m0, s72, 0x2000
  v_cvt_pk_bf16_f32 v115, v118, v119
  v_fma_f32 v252, v252, s80, v248
  v_mfma_f32_16x16x32_bf16 v[164:167], a[216:219], a[160:163], v[164:167]
  buffer_load_dwordx4 v10, s[44:47], s73 offen lds
  v_mfma_f32_16x16x32_bf16 v[40:43], a[224:227], a[160:163], v[40:43]
  s_waitcnt lgkmcnt(4)
  ds_read_b64_tr_b16 a[208:209], v4 offset:16384
  v_mul_f32 v252, v252, v120
  v_mfma_f32_16x16x32_bf16 v[40:43], a[228:231], a[176:179], v[40:43]
  ds_read_b64_tr_b16 a[216:217], v5 offset:16384
  v_exp_f32 v252, v252
  v_mfma_f32_16x16x32_bf16 v[56:59], a[228:231], a[180:183], v[56:59]
  v_mul_f32 v253, v121, v121
  s_cmp_eq_u32 s14, 13
  s_cbranch_scc1 L_t413
L_r413:
  v_mfma_f32_16x16x32_bf16 v[56:59], a[224:227], a[164:167], v[56:59]
  buffer_load_dwordx4 v11, s[44:47], s73 offen offset:1024 lds
  v_mfma_f32_16x16x32_bf16 v[72:75], a[224:227], a[168:171], v[72:75]
  s_waitcnt vmcnt(14)
  ds_read_b64_tr_b16 a[194:195], v2 offset:18432
  v_fma_f32 v252, v252, s15, s15
  v_mfma_f32_16x16x32_bf16 v[72:75], a[228:231], a[184:187], v[72:75]
  ds_read_b64_tr_b16 a[202:203], v3 offset:18432
  v_fma_f32 v253, v253, s80, v248
  v_mul_f32 v254, v122, v122
  v_mfma_f32_16x16x32_bf16 v[88:91], a[228:231], a[188:191], v[88:91]
  ds_read_b64_tr_b16 a[210:211], v4 offset:18432
  v_mul_f32 v253, v253, v121
  v_fma_f32 v254, v254, s80, v248
  v_mfma_f32_16x16x32_bf16 v[88:91], a[224:227], a[172:175], v[88:91]
  buffer_load_dwordx4 v12, s[44:47], s73 offen offset:2048 lds
  v_mul_f32 v254, v254, v122
  v_mfma_f32_16x16x32_bf16 v[216:219], a[232:235], a[172:175], v[216:219]
  ds_read_b64_tr_b16 a[218:219], v5 offset:18432
  v_exp_f32 v253, v253
  v_mfma_f32_16x16x32_bf16 v[216:219], a[236:239], a[188:191], v[216:219]
  ds_read_b128 a[36:39], v247 offset:9216
  v_fma_f32 v253, v253, s15, s15
  v_mfma_f32_16x16x32_bf16 v[200:203], a[236:239], a[184:187], v[200:203]
  v_rcp_f32 v252, v252
  v_mfma_f32_16x16x32_bf16 v[200:203], a[232:235], a[168:171], v[200:203]
  buffer_load_dwordx4 v13, s[44:47], s73 offen offset:3072 lds
  v_mfma_f32_16x16x32_bf16 v[184:187], a[232:235], a[164:167], v[184:187]
  s_waitcnt vmcnt(14)
  ds_read_b64_tr_b16 a[196:197], v2 offset:20480
  v_mul_f32 v120, v120, v252
  v_mul_f32 v255, v123, v123
  v_mfma_f32_16x16x32_bf16 v[184:187], a[236:239], a[180:183], v[184:187]
  s_mov_b32 s74, 0x1c0000
  ds_read_b64_tr_b16 a[204:205], v3 offset:20480
  v_exp_f32 v254, v254
  v_fma_f32 v255, v255, s80, v248
  v_mfma_f32_16x16x32_bf16 v[168:171], a[236:239], a[176:179], v[168:171]
  s_add_u32 m0, s72, 0x3000
  v_rcp_f32 v253, v253
  v_mul_f32 v255, v255, v123
  v_mfma_f32_16x16x32_bf16 v[168:171], a[232:235], a[160:163], v[168:171]
  buffer_load_dwordx4 v10, s[44:47], s74 offen lds
  v_exp_f32 v255, v255
  v_mfma_f32_16x16x32_bf16 v[44:47], a[240:243], a[160:163], v[44:47]
  ds_read_b64_tr_b16 a[212:213], v4 offset:20480
  v_mul_f32 v121, v121, v253
  v_mfma_f32_16x16x32_bf16 v[44:47], a[244:247], a[176:179], v[44:47]
  ds_read_b64_tr_b16 a[220:221], v5 offset:20480
  v_fma_f32 v254, v254, s15, s15
  v_cvt_pk_bf16_f32 v120, v120, v121
  v_mfma_f32_16x16x32_bf16 v[60:63], a[244:247], a[180:183], v[60:63]
  v_rcp_f32 v254, v254
  v_mfma_f32_16x16x32_bf16 v[60:63], a[240:243], a[164:167], v[60:63]
  buffer_load_dwordx4 v11, s[44:47], s74 offen offset:1024 lds
  v_mfma_f32_16x16x32_bf16 v[76:79], a[240:243], a[168:171], v[76:79]
  s_waitcnt vmcnt(14)
  ds_read_b64_tr_b16 a[198:199], v2 offset:22528
  v_mul_f32 v122, v122, v254
  v_mfma_f32_16x16x32_bf16 v[76:79], a[244:247], a[184:187], v[76:79]
  ds_read_b64_tr_b16 a[206:207], v3 offset:22528
  v_fma_f32 v255, v255, s15, s15
  v_mfma_f32_16x16x32_bf16 v[92:95], a[244:247], a[188:191], v[92:95]
  s_waitcnt lgkmcnt(4)
  ds_read_b64_tr_b16 a[214:215], v4 offset:22528
  v_mul_f32 v249, v124, v124
  v_mfma_f32_16x16x32_bf16 v[92:95], a[240:243], a[172:175], v[92:95]
  buffer_load_dwordx4 v12, s[44:47], s74 offen offset:2048 lds
  v_mfma_f32_16x16x32_bf16 v[220:223], a[248:251], a[172:175], v[220:223]
  ds_read_b64_tr_b16 a[222:223], v5 offset:22528
  v_fma_f32 v249, v249, s80, v248
  v_mfma_f32_16x16x32_bf16 v[220:223], a[252:255], a[188:191], v[220:223]
  ds_read_b128 a[52:55], v247 offset:13312
  v_mul_f32 v249, v249, v124
  v_mfma_f32_16x16x32_bf16 v[204:207], a[252:255], a[184:187], v[204:207]
  v_rcp_f32 v255, v255
  v_mul_f32 v250, v125, v125
  v_mfma_f32_16x16x32_bf16 v[204:207], a[248:251], a[168:171], v[204:207]
  buffer_load_dwordx4 v13, s[44:47], s74 offen offset:3072 lds
  v_fma_f32 v250, v250, s80, v248
  v_mfma_f32_16x16x32_bf16 v[188:191], a[248:251], a[164:167], v[188:191]
  s_waitcnt vmcnt(14)
  ds_read_b64_tr_b16 a[224:225], v2
  v_mul_f32 v123, v123, v255
  v_mul_f32 v250, v250, v125
  v_mfma_f32_16x16x32_bf16 v[188:191], a[252:255], a[180:183], v[188:191]
  s_mov_b32 s73, 0x180080
  ds_read_b64_tr_b16 a[232:233], v3
  v_cvt_pk_bf16_f32 v121, v122, v123
  v_mfma_f32_16x16x32_bf16 v[172:175], a[252:255], a[176:179], v[172:175]
  s_add_u32 m0, s72, 0x4000
  v_exp_f32 v249, v249
  v_mfma_f32_16x16x32_bf16 v[172:175], a[248:251], a[160:163], v[172:175]
  buffer_load_dwordx4 v10, s[44:47], s73 offen lds
  v_mfma_f32_16x16x32_bf16 v[32:35], a[192:195], a[128:131], v[32:35]
  s_waitcnt lgkmcnt(4)
  ds_read_b64_tr_b16 a[240:241], v4
  v_fma_f32 v249, v249, s15, s15
  v_mfma_f32_16x16x32_bf16 v[32:35], a[196:199], a[144:147], v[32:35]
  ds_read_b64_tr_b16 a[248:249], v5
  v_rcp_f32 v249, v249
  v_mfma_f32_16x16x32_bf16 v[48:51], a[196:199], a[148:151], v[48:51]
  v_exp_f32 v250, v250
  s_cmp_eq_u32 s14, 14
  s_cbranch_scc1 L_t414
L_r414:
  v_mfma_f32_16x16x32_bf16 v[48:51], a[192:195], a[132:135], v[48:51]
  buffer_load_dwordx4 v11, s[44:47], s73 offen offset:1024 lds
  v_mfma_f32_16x16x32_bf16 v[64:67], a[192:195], a[136:139], v[64:67]
  s_waitcnt vmcnt(14)
  ds_read_b64_tr_b16 a[226:227], v2 offset:2048
  v_mul_f32 v124, v124, v249
  v_mfma_f32_16x16x32_bf16 v[64:67], a[196:199], a[152:155], v[64:67]
  ds_read_b64_tr_b16 a[234:235], v3 offset:2048
  v_fma_f32 v250, v250, s15, s15
  v_mfma_f32_16x16x32_bf16 v[80:83], a[196:199], a[156:159], v[80:83]
  ds_read_b64_tr_b16 a[242:243], v4 offset:2048
  v_mul_f32 v251, v126, v126
  v_mfma_f32_16x16x32_bf16 v[80:83], a[192:195], a[140:143], v[80:83]
  buffer_load_dwordx4 v12, s[44:47], s73 offen offset:2048 lds
  v_mfma_f32_16x16x32_bf16 v[208:211], a[200:203], a[140:143], v[208:211]
  ds_read_b64_tr_b16 a[250:251], v5 offset:2048
  v_fma_f32 v251, v251, s80, v248
  v_mfma_f32_16x16x32_bf16 v[208:211], a[204:207], a[156:159], v[208:211]
  ds_read_b128 a[40:43], v247 offset:10240
  v_mul_f32 v251, v251, v126
  v_mfma_f32_16x16x32_bf16 v[192:195], a[204:207], a[152:155], v[192:195]
  v_rcp_f32 v250, v250
  v_mfma_f32_16x16x32_bf16 v[192:195], a[200:203], a[136:139], v[192:195]
  buffer_load_dwordx4 v13, s[44:47], s73 offen offset:3072 lds
  v_mfma_f32_16x16x32_bf16 v[176:179], a[200:203], a[132:135], v[176:179]
  s_waitcnt vmcnt(14)
  ds_read_b64_tr_b16 a[228:229], v2 offset:4096
  v_mul_f32 v125, v125, v250
  v_mfma_f32_16x16x32_bf16 v[176:179], a[204:207], a[148:151], v[176:179]
  s_mov_b32 s74, 0x1c0080
  ds_read_b64_tr_b16 a[236:237], v3 offset:4096
  v_mul_f32 v252, v127, v127
  v_cvt_pk_bf16_f32 v122, v124, v125
  v_mfma_f32_16x16x32_bf16 v[160:163], a[204:207], a[144:147], v[160:163]
  s_add_u32 m0, s72, 0x5000
  v_exp_f32 v251, v251
  v_mfma_f32_16x16x32_bf16 v[160:163], a[200:203], a[128:131], v[160:163]
  buffer_load_dwordx4 v10, s[44:47], s74 offen lds
  v_mul_f32 v253, v128, v128
  v_mfma_f32_16x16x32_bf16 v[36:39], a[208:211], a[128:131], v[36:39]
  ds_read_b64_tr_b16 a[244:245], v4 offset:4096
  v_fma_f32 v251, v251, s15, s15
  v_fma_f32 v253, v253, s80, v248
  v_mfma_f32_16x16x32_bf16 v[36:39], a[212:215], a[144:147], v[36:39]
  ds_read_b64_tr_b16 a[252:253], v5 offset:4096
  v_fma_f32 v252, v252, s80, v248
  v_mfma_f32_16x16x32_bf16 v[52:55], a[212:215], a[148:151], v[52:55]
  v_rcp_f32 v251, v251
  v_mfma_f32_16x16x32_bf16 v[52:55], a[208:211], a[132:135], v[52:55]
  buffer_load_dwordx4 v11, s[44:47], s74 offen offset:1024 lds
  v_mfma_f32_16x16x32_bf16 v[68:71], a[208:211], a[136:139], v[68:71]
  s_waitcnt vmcnt(14)
  ds_read_b64_tr_b16 a[230:231], v2 offset:6144
  v_mul_f32 v126, v126, v251
  v_mfma_f32_16x16x32_bf16 v[68:71], a[212:215], a[152:155], v[68:71]
  ds_read_b64_tr_b16 a[238:239], v3 offset:6144
  v_mul_f32 v252, v252, v127
  v_mul_f32 v254, v129, v129
  v_mfma_f32_16x16x32_bf16 v[84:87], a[212:215], a[156:159], v[84:87]
  s_waitcnt lgkmcnt(4)
  ds_read_b64_tr_b16 a[246:247], v4 offset:6144
  v_mul_f32 v253, v253, v128
  v_fma_f32 v254, v254, s80, v248
  v_mfma_f32_16x16x32_bf16 v[84:87], a[208:211], a[140:143], v[84:87]
  buffer_load_dwordx4 v12, s[44:47], s74 offen offset:2048 lds
  v_mul_f32 v254, v254, v129
  v_mfma_f32_16x16x32_bf16 v[212:215], a[216:219], a[140:143], v[212:215]
  ds_read_b64_tr_b16 a[254:255], v5 offset:6144
  v_exp_f32 v253, v253
  v_exp_f32 v254, v254
  v_mfma_f32_16x16x32_bf16 v[212:215], a[220:223], a[156:159], v[212:215]
  ds_read_b128 a[56:59], v247 offset:14336
  v_fma_f32 v253, v253, s15, s15
  v_fma_f32 v254, v254, s15, s15
  v_mfma_f32_16x16x32_bf16 v[196:199], a[220:223], a[152:155], v[196:199]
  v_exp_f32 v252, v252
  v_rcp_f32 v254, v254
  v_mfma_f32_16x16x32_bf16 v[196:199], a[216:219], a[136:139], v[196:199]
  buffer_load_dwordx4 v13, s[44:47], s74 offen offset:3072 lds
  v_mul_f32 v129, v129, v254
  v_mfma_f32_16x16x32_bf16 v[180:183], a[216:219], a[132:135], v[180:183]
  s_waitcnt vmcnt(14)
  ds_read_b64_tr_b16 a[192:193], v2 offset:8192
  v_fma_f32 v252, v252, s15, s15
  v_mul_f32 v255, v130, v130
  v_mfma_f32_16x16x32_bf16 v[180:183], a[220:223], a[148:151], v[180:183]
  s_mov_b32 s73, 0x100000
  ds_read_b64_tr_b16 a[200:201], v3 offset:8192
  v_rcp_f32 v253, v253
  v_fma_f32 v255, v255, s80, v248
  v_mfma_f32_16x16x32_bf16 v[164:167], a[220:223], a[144:147], v[164:167]
  s_add_u32 m0, s72, 0
  v_rcp_f32 v252, v252
  v_mul_f32 v255, v255, v130
  v_mfma_f32_16x16x32_bf16 v[164:167], a[216:219], a[128:131], v[164:167]
  buffer_load_dwordx4 v10, s[44:47], s73 offen lds
  v_mfma_f32_16x16x32_bf16 v[40:43], a[224:227], a[128:131], v[40:43]
  s_waitcnt lgkmcnt(3)
  ds_read_b64_tr_b16 a[208:209], v4 offset:8192
  v_mul_f32 v127, v127, v252
  v_mfma_f32_16x16x32_bf16 v[40:43], a[228:231], a[144:147], v[40:43]
  ds_read_b64_tr_b16 a[216:217], v5 offset:8192
  v_cvt_pk_bf16_f32 v123, v126, v127
  v_mfma_f32_16x16x32_bf16 v[56:59], a[228:231], a[148:151], v[56:59]
  v_mul_f32 v128, v128, v253
  s_cmp_eq_u32 s14, 15
  s_cbranch_scc1 L_t415
L_r415:
  v_mfma_f32_16x16x32_bf16 v[56:59], a[224:227], a[132:135], v[56:59]
  buffer_load_dwordx4 v11, s[44:47], s73 offen offset:1024 lds
  v_cvt_pk_bf16_f32 v128, v128, v129
  v_mfma_f32_16x16x32_bf16 v[72:75], a[224:227], a[136:139], v[72:75]
  s_waitcnt vmcnt(14)
  ds_read_b64_tr_b16 a[194:195], v2 offset:10240
  v_exp_f32 v255, v255
  v_mfma_f32_16x16x32_bf16 v[72:75], a[228:231], a[152:155], v[72:75]
  ds_read_b64_tr_b16 a[202:203], v3 offset:10240
  v_fma_f32 v255, v255, s15, s15
  v_mfma_f32_16x16x32_bf16 v[88:91], a[228:231], a[156:159], v[88:91]
  ds_read_b64_tr_b16 a[210:211], v4 offset:10240
  v_mul_f32 v249, v131, v131
  v_mfma_f32_16x16x32_bf16 v[88:91], a[224:227], a[140:143], v[88:91]
  buffer_load_dwordx4 v12, s[44:47], s73 offen offset:2048 lds
  v_mfma_f32_16x16x32_bf16 v[216:219], a[232:235], a[140:143], v[216:219]
  ds_read_b64_tr_b16 a[218:219], v5 offset:10240
  v_fma_f32 v249, v249, s80, v248
  v_mfma_f32_16x16x32_bf16 v[216:219], a[236:239], a[156:159], v[216:219]
  ds_read_b128 a[44:47], v247 offset:11264
  v_mul_f32 v249, v249, v131
  v_mfma_f32_16x16x32_bf16 v[200:203], a[236:239], a[152:155], v[200:203]
  v_rcp_f32 v255, v255
  v_mfma_f32_16x16x32_bf16 v[200:203], a[232:235], a[136:139], v[200:203]
  buffer_load_dwordx4 v13, s[44:47], s73 offen offset:3072 lds
  v_mfma_f32_16x16x32_bf16 v[184:187], a[232:235], a[132:135], v[184:187]
  s_waitcnt vmcnt(14)
  ds_read_b64_tr_b16 a[196:197], v2 offset:12288
  v_mul_f32 v130, v130, v255
  v_mfma_f32_16x16x32_bf16 v[184:187], a[236:239], a[148:151], v[184:187]
  s_mov_b32 s74, 0x140000
  ds_read_b64_tr_b16 a[204:205], v3 offset:12288
  v_mul_f32 v250, v132, v132
  v_mfma_f32_16x16x32_bf16 v[168:171], a[236:239], a[144:147], v[168:171]
  s_add_u32 m0, s72, 0x1000
  v_exp_f32 v249, v249
  v_mfma_f32_16x16x32_bf16 v[168:171], a[232:235], a[128:131], v[168:171]
  buffer_load_dwordx4 v10, s[44:47], s74 offen lds
  v_mfma_f32_16x16x32_bf16 v[44:47], a[240:243], a[128:131], v[44:47]
  ds_read_b64_tr_b16 a[212:213], v4 offset:12288
  v_fma_f32 v249, v249, s15, s15
  v_mfma_f32_16x16x32_bf16 v[44:47], a[244:247], a[144:147], v[44:47]
  ds_read_b64_tr_b16 a[220:221], v5 offset:12288
  v_fma_f32 v250, v250, s80, v248
  v_mul_f32 v251, v133, v133
  v_mfma_f32_16x16x32_bf16 v[60:63], a[244:247], a[148:151], v[60:63]
  v_rcp_f32 v249, v249
  v_fma_f32 v251, v251, s80, v248
  v_mfma_f32_16x16x32_bf16 v[60:63], a[240:243], a[132:135], v[60:63]
  buffer_load_dwordx4 v11, s[44:47], s74 offen offset:1024 lds
  v_mfma_f32_16x16x32_bf16 v[76:79], a[240:243], a[136:139], v[76:79]
  s_waitcnt vmcnt(14)
  ds_read_b64_tr_b16 a[198:199], v2 offset:14336
  v_mul_f32 v131, v131, v249
  v_mfma_f32_16x16x32_bf16 v[76:79], a[244:247], a[152:155], v[76:79]
  ds_read_b64_tr_b16 a[206:207], v3 offset:14336
  v_cvt_pk_bf16_f32 v129, v130, v131
  v_mfma_f32_16x16x32_bf16 v[92:95], a[244:247], a[156:159], v[92:95]
  ds_read_b64_tr_b16 a[214:215], v4 offset:14336
  v_mul_f32 v250, v250, v132
  v_mfma_f32_16x16x32_bf16 v[92:95], a[240:243], a[140:143], v[92:95]
  buffer_load_dwordx4 v12, s[44:47], s74 offen offset:2048 lds
  v_mfma_f32_16x16x32_bf16 v[220:223], a[248:251], a[140:143], v[220:223]
  ds_read_b64_tr_b16 a[222:223], v5 offset:14336
  v_mul_f32 v251, v251, v133
  v_mul_f32 v252, v134, v134
  v_mfma_f32_16x16x32_bf16 v[220:223], a[252:255], a[156:159], v[220:223]
  ds_read_b128 a[60:63], v247 offset:15360
  v_exp_f32 v251, v251
  v_fma_f32 v252, v252, s80, v248
  v_mfma_f32_16x16x32_bf16 v[204:207], a[252:255], a[152:155], v[204:207]
  v_exp_f32 v250, v250
  v_mul_f32 v252, v252, v134
  v_mfma_f32_16x16x32_bf16 v[204:207], a[248:251], a[136:139], v[204:207]
  buffer_load_dwordx4 v13, s[44:47], s74 offen offset:3072 lds
  v_exp_f32 v252, v252
  v_mfma_f32_16x16x32_bf16 v[188:191], a[248:251], a[132:135], v[188:191]
  s_mov_b32 s73, 0x100080
  s_waitcnt vmcnt(14)
  ds_read_b64_tr_b16 a[224:225], v2 offset:16384
  v_fma_f32 v250, v250, s15, s15
  v_mfma_f32_16x16x32_bf16 v[188:191], a[252:255], a[148:151], v[188:191]
  s_add_u32 m0, s72, 0x2000
  ds_read_b64_tr_b16 a[232:233], v3 offset:16384
  v_fma_f32 v251, v251, s15, s15
  v_mfma_f32_16x16x32_bf16 v[172:175], a[252:255], a[144:147], v[172:175]
  s_waitcnt lgkmcnt(4)
  v_rcp_f32 v250, v250
  v_mul_f32 v253, v135, v135
  v_mfma_f32_16x16x32_bf16 v[172:175], a[248:251], a[128:131], v[172:175]
  buffer_load_dwordx4 v10, s[44:47], s73 offen lds
  v_fma_f32 v253, v253, s80, v248
  v_mfma_f32_16x16x32_bf16 v[32:35], a[192:195], a[96:99], v[32:35]
  ds_read_b64_tr_b16 a[240:241], v4 offset:16384
  v_mul_f32 v132, v132, v250
  v_mul_f32 v253, v253, v135
  v_mfma_f32_16x16x32_bf16 v[32:35], a[196:199], a[112:115], v[32:35]
  ds_read_b64_tr_b16 a[248:249], v5 offset:16384
  v_fma_f32 v252, v252, s15, s15
  v_exp_f32 v253, v253
  v_mfma_f32_16x16x32_bf16 v[48:51], a[196:199], a[116:119], v[48:51]
  v_rcp_f32 v251, v251
  v_fma_f32 v253, v253, s15, s15
  v_mfma_f32_16x16x32_bf16 v[48:51], a[192:195], a[100:103], v[48:51]
  buffer_load_dwordx4 v11, s[44:47], s73 offen offset:1024 lds
  v_mfma_f32_16x16x32_bf16 v[64:67], a[192:195], a[104:107], v[64:67]
  s_waitcnt vmcnt(14)
  ds_read_b64_tr_b16 a[226:227], v2 offset:18432
  v_mul_f32 v133, v133, v251
  v_mfma_f32_16x16x32_bf16 v[64:67], a[196:199], a[120:123], v[64:67]
  ds_read_b64_tr_b16 a[234:235], v3 offset:18432
  v_rcp_f32 v252, v252
  v_cvt_pk_bf16_f32 v130, v132, v133
  v_mfma_f32_16x16x32_bf16 v[80:83], a[196:199], a[124:127], v[80:83]
  ds_read_b64_tr_b16 a[242:243], v4 offset:18432
  v_mul_f32 v134, v134, v252
  v_mfma_f32_16x16x32_bf16 v[80:83], a[192:195], a[108:111], v[80:83]
  buffer_load_dwordx4 v12, s[44:47], s73 offen offset:2048 lds
  v_mfma_f32_16x16x32_bf16 v[208:211], a[200:203], a[108:111], v[208:211]
  ds_read_b64_tr_b16 a[250:251], v5 offset:18432
  v_rcp_f32 v253, v253
  v_mfma_f32_16x16x32_bf16 v[208:211], a[204:207], a[124:127], v[208:211]
  ds_read_b128 a[0:3], v247
  v_mul_f32 v135, v135, v253
  v_mfma_f32_16x16x32_bf16 v[192:195], a[204:207], a[120:123], v[192:195]
  v_cvt_pk_bf16_f32 v131, v134, v135
  v_mul_f32 v254, v136, v136
  v_mfma_f32_16x16x32_bf16 v[192:195], a[200:203], a[104:107], v[192:195]
  buffer_load_dwordx4 v13, s[44:47], s73 offen offset:3072 lds
  v_mfma_f32_16x16x32_bf16 v[176:179], a[200:203], a[100:103], v[176:179]
  s_waitcnt vmcnt(14)
  ds_read_b64_tr_b16 a[228:229], v2 offset:20480
  v_fma_f32 v254, v254, s80, v248
  v_mfma_f32_16x16x32_bf16 v[176:179], a[204:207], a[116:119], v[176:179]
  s_mov_b32 s74, 0x140080
  ds_read_b64_tr_b16 a[236:237], v3 offset:20480
  v_mul_f32 v254, v254, v136
  v_mfma_f32_16x16x32_bf16 v[160:163], a[204:207], a[112:115], v[160:163]
  s_add_u32 m0, s72, 0x3000
  v_exp_f32 v254, v254
  v_mfma_f32_16x16x32_bf16 v[160:163], a[200:203], a[96:99], v[160:163]
  buffer_load_dwordx4 v10, s[44:47], s74 offen lds
  v_mfma_f32_16x16x32_bf16 v[36:39], a[208:211], a[96:99], v[36:39]
  ds_read_b64_tr_b16 a[244:245], v4 offset:20480
  v_fma_f32 v254, v254, s15, s15
  v_mfma_f32_16x16x32_bf16 v[36:39], a[212:215], a[112:115], v[36:39]
  ds_read_b64_tr_b16 a[252:253], v5 offset:20480
  v_mul_f32 v255, v137, v137
  v_mfma_f32_16x16x32_bf16 v[52:55], a[212:215], a[116:119], v[52:55]
  v_rcp_f32 v254, v254
  v_mfma_f32_16x16x32_bf16 v[52:55], a[208:211], a[100:103], v[52:55]
  buffer_load_dwordx4 v11, s[44:47], s74 offen offset:1024 lds
  v_mfma_f32_16x16x32_bf16 v[68:71], a[208:211], a[104:107], v[68:71]
  s_waitcnt vmcnt(14)
  ds_read_b64_tr_b16 a[230:231], v2 offset:22528
  v_mul_f32 v136, v136, v254
  v_mfma_f32_16x16x32_bf16 v[68:71], a[212:215], a[120:123], v[68:71]
  ds_read_b64_tr_b16 a[238:239], v3 offset:22528
  v_fma_f32 v255, v255, s80, v248
  v_mfma_f32_16x16x32_bf16 v[84:87], a[212:215], a[124:127], v[84:87]
  s_waitcnt lgkmcnt(4)
  ds_read_b64_tr_b16 a[246:247], v4 offset:22528
  v_mul_f32 v255, v255, v137
  v_mfma_f32_16x16x32_bf16 v[84:87], a[208:211], a[108:111], v[84:87]
  buffer_load_dwordx4 v12, s[44:47], s74 offen offset:2048 lds
  v_mfma_f32_16x16x32_bf16 v[212:215], a[216:219], a[108:111], v[212:215]
  ds_read_b64_tr_b16 a[254:255], v5 offset:22528
  v_mul_f32 v249, v138, v138
  v_mfma_f32_16x16x32_bf16 v[212:215], a[220:223], a[124:127], v[212:215]
  ds_read_b128 a[16:19], v247 offset:4096
  v_fma_f32 v249, v249, s80, v248
  v_mfma_f32_16x16x32_bf16 v[196:199], a[220:223], a[120:123], v[196:199]
  v_exp_f32 v255, v255
  v_mul_f32 v250, v139, v139
  v_mfma_f32_16x16x32_bf16 v[196:199], a[216:219], a[104:107], v[196:199]
  buffer_load_dwordx4 v13, s[44:47], s74 offen offset:3072 lds
  v_fma_f32 v250, v250, s80, v248
  v_mfma_f32_16x16x32_bf16 v[180:183], a[216:219], a[100:103], v[180:183]
  s_waitcnt vmcnt(14)
  ds_read_b64_tr_b16 a[192:193], v2
  v_fma_f32 v255, v255, s15, s15
  v_mfma_f32_16x16x32_bf16 v[180:183], a[220:223], a[116:119], v[180:183]
  s_mov_b32 s73, 0x80000
  ds_read_b64_tr_b16 a[200:201], v3
  v_mul_f32 v249, v249, v138
  v_mfma_f32_16x16x32_bf16 v[164:167], a[220:223], a[112:115], v[164:167]
  s_add_u32 m0, s72, 0x4000
  v_rcp_f32 v255, v255
  v_mfma_f32_16x16x32_bf16 v[164:167], a[216:219], a[96:99], v[164:167]
  buffer_load_dwordx4 v10, s[44:47], s73 offen lds
  v_mfma_f32_16x16x32_bf16 v[40:43], a[224:227], a[96:99], v[40:43]
  s_waitcnt lgkmcnt(4)
  ds_read_b64_tr_b16 a[208:209], v4
  v_mul_f32 v137, v137, v255
  v_mfma_f32_16x16x32_bf16 v[40:43], a[228:231], a[112:115], v[40:43]
  ds_read_b64_tr_b16 a[216:217], v5
  v_mul_f32 v250, v250, v139
  v_cvt_pk_bf16_f32 v136, v136, v137
  v_mul_f32 v251, v140, v140
  v_mfma_f32_16x16x32_bf16 v[56:59], a[228:231], a[116:119], v[56:59]
  v_exp_f32 v249, v249
  v_fma_f32 v251, v251, s80, v248
  v_mfma_f32_16x16x32_bf16 v[56:59], a[224:227], a[100:103], v[56:59]
  buffer_load_dwordx4 v11, s[44:47], s73 offen offset:1024 lds
  v_mul_f32 v251, v251, v140
  v_mfma_f32_16x16x32_bf16 v[72:75], a[224:227], a[104:107], v[72:75]
  s_waitcnt vmcnt(14)
  ds_read_b64_tr_b16 a[194:195], v2 offset:2048
  v_fma_f32 v249, v249, s15, s15
  v_exp_f32 v251, v251
  v_mfma_f32_16x16x32_bf16 v[72:75], a[228:231], a[120:123], v[72:75]
  ds_read_b64_tr_b16 a[202:203], v3 offset:2048
  v_exp_f32 v250, v250
  v_fma_f32 v251, v251, s15, s15
  v_mfma_f32_16x16x32_bf16 v[88:91], a[228:231], a[124:127], v[88:91]
  ds_read_b64_tr_b16 a[210:211], v4 offset:2048
  v_fma_f32 v250, v250, s15, s15
  v_rcp_f32 v251, v251
  v_mfma_f32_16x16x32_bf16 v[88:91], a[224:227], a[108:111], v[88:91]
  buffer_load_dwordx4 v12, s[44:47], s73 offen offset:2048 lds
  v_mul_f32 v140, v140, v251
  v_mul_f32 v252, v141, v141
  v_mfma_f32_16x16x32_bf16 v[216:219], a[232:235], a[108:111], v[216:219]
  ds_read_b64_tr_b16 a[218:219], v5 offset:2048
  v_rcp_f32 v250, v250
  v_fma_f32 v252, v252, s80, v248
  v_mfma_f32_16x16x32_bf16 v[216:219], a[236:239], a[124:127], v[216:219]
  ds_read_b128 a[4:7], v247 offset:1024
  v_mul_f32 v139, v139, v250
  v_mfma_f32_16x16x32_bf16 v[200:203], a[236:239], a[120:123], v[200:203]
  v_rcp_f32 v249, v249
  v_mfma_f32_16x16x32_bf16 v[200:203], a[232:235], a[104:107], v[200:203]
  buffer_load_dwordx4 v13, s[44:47], s73 offen offset:3072 lds
  v_mfma_f32_16x16x32_bf16 v[184:187], a[232:235], a[100:103], v[184:187]
  s_waitcnt vmcnt(14)
  ds_read_b64_tr_b16 a[196:197], v2 offset:4096
  v_mul_f32 v138, v138, v249
  v_mfma_f32_16x16x32_bf16 v[184:187], a[236:239], a[116:119], v[184:187]
  s_mov_b32 s74, 0xc0000
  ds_read_b64_tr_b16 a[204:205], v3 offset:4096
  v_cvt_pk_bf16_f32 v137, v138, v139
  v_mfma_f32_16x16x32_bf16 v[168:171], a[236:239], a[112:115], v[168:171]
  s_add_u32 m0, s72, 0x5000
  v_mul_f32 v252, v252, v141
  v_mul_f32 v253, v142, v142
  v_mfma_f32_16x16x32_bf16 v[168:171], a[232:235], a[96:99], v[168:171]
  buffer_load_dwordx4 v10, s[44:47], s74 offen lds
  v_mfma_f32_16x16x32_bf16 v[44:47], a[240:243], a[96:99], v[44:47]
  ds_read_b64_tr_b16 a[212:213], v4 offset:4096
  v_fma_f32 v253, v253, s80, v248
  v_mfma_f32_16x16x32_bf16 v[44:47], a[244:247], a[112:115], v[44:47]
  ds_read_b64_tr_b16 a[220:221], v5 offset:4096
  v_mul_f32 v253, v253, v142
  v_mfma_f32_16x16x32_bf16 v[60:63], a[244:247], a[116:119], v[60:63]
  v_exp_f32 v252, v252
  v_mfma_f32_16x16x32_bf16 v[60:63], a[240:243], a[100:103], v[60:63]
  buffer_load_dwordx4 v11, s[44:47], s74 offen offset:1024 lds
  v_mfma_f32_16x16x32_bf16 v[76:79], a[240:243], a[104:107], v[76:79]
  s_waitcnt vmcnt(14)
  ds_read_b64_tr_b16 a[198:199], v2 offset:6144
  v_fma_f32 v252, v252, s15, s15
  v_mfma_f32_16x16x32_bf16 v[76:79], a[244:247], a[120:123], v[76:79]
  ds_read_b64_tr_b16 a[206:207], v3 offset:6144
  v_exp_f32 v253, v253
  v_mul_f32 v254, v143, v143
  v_mfma_f32_16x16x32_bf16 v[92:95], a[244:247], a[124:127], v[92:95]
  s_waitcnt lgkmcnt(4)
  ds_read_b64_tr_b16 a[214:215], v4 offset:6144
  v_fma_f32 v253, v253, s15, s15
  v_fma_f32 v254, v254, s80, v248
  v_mfma_f32_16x16x32_bf16 v[92:95], a[240:243], a[108:111], v[92:95]
  buffer_load_dwordx4 v12, s[44:47], s74 offen offset:2048 lds
  v_mul_f32 v254, v254, v143
  v_mfma_f32_16x16x32_bf16 v[220:223], a[248:251], a[108:111], v[220:223]
  ds_read_b64_tr_b16 a[222:223], v5 offset:6144
  v_rcp_f32 v253, v253
  v_mfma_f32_16x16x32_bf16 v[220:223], a[252:255], a[124:127], v[220:223]
  ds_read_b128 a[20:23], v247 offset:5120
  v_mul_f32 v142, v142, v253
  v_mfma_f32_16x16x32_bf16 v[204:207], a[252:255], a[120:123], v[204:207]
  v_rcp_f32 v252, v252
  v_mfma_f32_16x16x32_bf16 v[204:207], a[248:251], a[104:107], v[204:207]
  buffer_load_dwordx4 v13, s[44:47], s74 offen offset:3072 lds
  v_mfma_f32_16x16x32_bf16 v[188:191], a[248:251], a[100:103], v[188:191]
  s_waitcnt vmcnt(14)
  ds_read_b64_tr_b16 a[224:225], v2 offset:8192
  v_mul_f32 v141, v141, v252
  v_mfma_f32_16x16x32_bf16 v[188:191], a[252:255], a[116:119], v[188:191]
  s_mov_b32 s73, 0x80080
  ds_read_b64_tr_b16 a[232:233], v3 offset:8192
  v_exp_f32 v254, v254
  v_mfma_f32_16x16x32_bf16 v[172:175], a[252:255], a[112:115], v[172:175]
  s_add_u32 m0, s72, 0
  v_fma_f32 v254, v254, s15, s15
  v_cvt_pk_bf16_f32 v138, v140, v141
  v_mfma_f32_16x16x32_bf16 v[172:175], a[248:251], a[96:99], v[172:175]
  buffer_load_dwordx4 v10, s[44:47], s73 offen lds
  v_mfma_f32_16x16x32_bf16 v[32:35], a[192:195], a[64:67], v[32:35]
  s_waitcnt lgkmcnt(4)
  ds_read_b64_tr_b16 a[240:241], v4 offset:8192
  v_mul_f32 v255, v144, v144
  v_mfma_f32_16x16x32_bf16 v[32:35], a[196:199], a[80:83], v[32:35]
  ds_read_b64_tr_b16 a[248:249], v5 offset:8192
  v_fma_f32 v255, v255, s80, v248
  v_mfma_f32_16x16x32_bf16 v[48:51], a[196:199], a[84:87], v[48:51]
  v_rcp_f32 v254, v254
  v_mfma_f32_16x16x32_bf16 v[48:51], a[192:195], a[68:71], v[48:51]
  buffer_load_dwordx4 v11, s[44:47], s73 offen offset:1024 lds
  v_mfma_f32_16x16x32_bf16 v[64:67], a[192:195], a[72:75], v[64:67]
  s_waitcnt vmcnt(14)
  ds_read_b64_tr_b16 a[226:227], v2 offset:10240
  v_mul_f32 v143, v143, v254
  v_mfma_f32_16x16x32_bf16 v[64:67], a[196:199], a[88:91], v[64:67]
  ds_read_b64_tr_b16 a[234:235], v3 offset:10240
  v_cvt_pk_bf16_f32 v139, v142, v143
  v_mfma_f32_16x16x32_bf16 v[80:83], a[196:199], a[92:95], v[80:83]
  ds_read_b64_tr_b16 a[242:243], v4 offset:10240
  v_mul_f32 v255, v255, v144
  v_mfma_f32_16x16x32_bf16 v[80:83], a[192:195], a[76:79], v[80:83]
  buffer_load_dwordx4 v12, s[44:47], s73 offen offset:2048 lds
  v_mfma_f32_16x16x32_bf16 v[208:211], a[200:203], a[76:79], v[208:211]
  ds_read_b64_tr_b16 a[250:251], v5 offset:10240
  v_mul_f32 v249, v145, v145
  v_mfma_f32_16x16x32_bf16 v[208:211], a[204:207], a[92:95], v[208:211]
  ds_read_b128 a[8:11], v247 offset:2048
  v_fma_f32 v249, v249, s80, v248
  v_mfma_f32_16x16x32_bf16 v[192:195], a[204:207], a[88:91], v[192:195]
  v_exp_f32 v255, v255
  v_mul_f32 v250, v146, v146
  v_mfma_f32_16x16x32_bf16 v[192:195], a[200:203], a[72:75], v[192:195]
  buffer_load_dwordx4 v13, s[44:47], s73 offen offset:3072 lds
  v_fma_f32 v250, v250, s80, v248
  v_mfma_f32_16x16x32_bf16 v[176:179], a[200:203], a[68:71], v[176:179]
  s_waitcnt vmcnt(14)
  ds_read_b64_tr_b16 a[228:229], v2 offset:12288
  v_fma_f32 v255, v255, s15, s15
  v_mfma_f32_16x16x32_bf16 v[176:179], a[204:207], a[84:87], v[176:179]
  s_mov_b32 s74, 0xc0080
  ds_read_b64_tr_b16 a[236:237], v3 offset:12288
  v_mul_f32 v249, v249, v145
  v_mfma_f32_16x16x32_bf16 v[160:163], a[204:207], a[80:83], v[160:163]
  s_add_u32 m0, s72, 0x1000
  v_rcp_f32 v255, v255
  v_mfma_f32_16x16x32_bf16 v[160:163], a[200:203], a[64:67], v[160:163]
  buffer_load_dwordx4 v10, s[44:47], s74 offen lds
  v_mfma_f32_16x16x32_bf16 v[36:39], a[208:211], a[64:67], v[36:39]
  ds_read_b64_tr_b16 a[244:245], v4 offset:12288
  v_mul_f32 v144, v144, v255
  v_mfma_f32_16x16x32_bf16 v[36:39], a[212:215], a[80:83], v[36:39]
  ds_read_b64_tr_b16 a[252:253], v5 offset:12288
  v_mul_f32 v250, v250, v146
  v_mul_f32 v251, v147, v147
  v_mfma_f32_16x16x32_bf16 v[52:55], a[212:215], a[84:87], v[52:55]
  v_exp_f32 v249, v249
  v_fma_f32 v251, v251, s80, v248
  v_mfma_f32_16x16x32_bf16 v[52:55], a[208:211], a[68:71], v[52:55]
  buffer_load_dwordx4 v11, s[44:47], s74 offen offset:1024 lds
  v_mul_f32 v251, v251, v147
  v_mfma_f32_16x16x32_bf16 v[68:71], a[208:211], a[72:75], v[68:71]
  s_waitcnt vmcnt(14)
  ds_read_b64_tr_b16 a[230:231], v2 offset:14336
  v_fma_f32 v249, v249, s15, s15
  v_exp_f32 v251, v251
  v_mfma_f32_16x16x32_bf16 v[68:71], a[212:215], a[88:91], v[68:71]
L_p9590:
  s_cmp_eq_u32 s95, 1
  s_cbranch_scc1 L_p5141
  ds_read_b64_tr_b16 a[238:239], v3 offset:14336
  v_exp_f32 v250, v250
  v_fma_f32 v251, v251, s15, s15
  v_mfma_f32_16x16x32_bf16 v[84:87], a[212:215], a[92:95], v[84:87]
  s_waitcnt lgkmcnt(4)
  ds_read_b64_tr_b16 a[246:247], v4 offset:14336
  v_fma_f32 v250, v250, s15, s15
  v_rcp_f32 v251, v251
  v_mfma_f32_16x16x32_bf16 v[84:87], a[208:211], a[76:79], v[84:87]
  buffer_load_dwordx4 v12, s[44:47], s74 offen offset:2048 lds
  v_mul_f32 v147, v147, v251
  v_mul_f32 v252, v148, v148
  v_mfma_f32_16x16x32_bf16 v[212:215], a[216:219], a[76:79], v[212:215]
  ds_read_b64_tr_b16 a[254:255], v5 offset:14336
  v_rcp_f32 v250, v250
  v_fma_f32 v252, v252, s80, v248
  v_mfma_f32_16x16x32_bf16 v[212:215], a[220:223], a[92:95], v[212:215]
  ds_read_b128 a[24:27], v247 offset:6144
  v_mul_f32 v146, v146, v250
  v_mfma_f32_16x16x32_bf16 v[196:199], a[220:223], a[88:91], v[196:199]
  v_rcp_f32 v249, v249
  v_mfma_f32_16x16x32_bf16 v[196:199], a[216:219], a[72:75], v[196:199]
  buffer_load_dwordx4 v13, s[44:47], s74 offen offset:3072 lds
  v_mfma_f32_16x16x32_bf16 v[180:183], a[216:219], a[68:71], v[180:183]
  s_waitcnt vmcnt(14)
  ds_read_b64_tr_b16 a[192:193], v2 offset:16384
  v_mul_f32 v145, v145, v249
  v_mfma_f32_16x16x32_bf16 v[180:183], a[220:223], a[84:87], v[180:183]
  s_mov_b32 s73, 0
  ds_read_b64_tr_b16 a[200:201], v3 offset:16384
  v_cvt_pk_bf16_f32 v144, v144, v145
  v_mfma_f32_16x16x32_bf16 v[164:167], a[220:223], a[80:83], v[164:167]
  s_add_u32 m0, s72, 0x2000
  v_cvt_pk_bf16_f32 v145, v146, v147
  v_mul_f32 v252, v252, v148
  v_mfma_f32_16x16x32_bf16 v[164:167], a[216:219], a[64:67], v[164:167]
  buffer_load_dwordx4 v10, s[44:47], s73 offen lds
  v_mfma_f32_16x16x32_bf16 v[40:43], a[224:227], a[64:67], v[40:43]
  s_waitcnt lgkmcnt(4)
  ds_read_b64_tr_b16 a[208:209], v4 offset:16384
  v_mul_f32 v253, v149, v149
  v_mfma_f32_16x16x32_bf16 v[40:43], a[228:231], a[80:83], v[40:43]
  ds_read_b64_tr_b16 a[216:217], v5 offset:16384
  v_fma_f32 v253, v253, s80, v248
  v_mfma_f32_16x16x32_bf16 v[56:59], a[228:231], a[84:87], v[56:59]
  v_exp_f32 v252, v252
  v_mfma_f32_16x16x32_bf16 v[56:59], a[224:227], a[68:71], v[56:59]
  buffer_load_dwordx4 v11, s[44:47], s73 offen offset:1024 lds
  v_mfma_f32_16x16x32_bf16 v[72:75], a[224:227], a[72:75], v[72:75]
  s_waitcnt vmcnt(14)
  ds_read_b64_tr_b16 a[194:195], v2 offset:18432
  v_fma_f32 v252, v252, s15, s15
  v_mfma_f32_16x16x32_bf16 v[72:75], a[228:231], a[88:91], v[72:75]
  ds_read_b64_tr_b16 a[202:203], v3 offset:18432
  v_mul_f32 v253, v253, v149
  v_mfma_f32_16x16x32_bf16 v[88:91], a[228:231], a[92:95], v[88:91]
  ds_read_b64_tr_b16 a[210:211], v4 offset:18432
  v_exp_f32 v253, v253
  v_mfma_f32_16x16x32_bf16 v[88:91], a[224:227], a[76:79], v[88:91]
  buffer_load_dwordx4 v12, s[44:47], s73 offen offset:2048 lds
  v_mfma_f32_16x16x32_bf16 v[216:219], a[232:235], a[76:79], v[216:219]
  ds_read_b64_tr_b16 a[218:219], v5 offset:18432
  v_fma_f32 v253, v253, s15, s15
  v_mfma_f32_16x16x32_bf16 v[216:219], a[236:239], a[92:95], v[216:219]
  ds_read_b128 a[12:15], v247 offset:3072
  v_mul_f32 v254, v150, v150
  v_mfma_f32_16x16x32_bf16 v[200:203], a[236:239], a[88:91], v[200:203]
  v_rcp_f32 v252, v252
  v_mfma_f32_16x16x32_bf16 v[200:203], a[232:235], a[72:75], v[200:203]
  buffer_load_dwordx4 v13, s[44:47], s73 offen offset:3072 lds
  v_mfma_f32_16x16x32_bf16 v[184:187], a[232:235], a[68:71], v[184:187]
  s_waitcnt vmcnt(14)
  ds_read_b64_tr_b16 a[196:197], v2 offset:20480
  v_mul_f32 v148, v148, v252
  v_mul_f32 v255, v151, v151
  v_mfma_f32_16x16x32_bf16 v[184:187], a[236:239], a[84:87], v[184:187]
  s_mov_b32 s74, 0x40000
  ds_read_b64_tr_b16 a[204:205], v3 offset:20480
  v_fma_f32 v254, v254, s80, v248
  v_fma_f32 v255, v255, s80, v248
  v_mfma_f32_16x16x32_bf16 v[168:171], a[236:239], a[80:83], v[168:171]
  s_add_u32 m0, s72, 0x3000
  v_rcp_f32 v253, v253
  v_mul_f32 v255, v255, v151
  v_mfma_f32_16x16x32_bf16 v[168:171], a[232:235], a[64:67], v[168:171]
  buffer_load_dwordx4 v10, s[44:47], s74 offen lds
  v_exp_f32 v255, v255
  v_mfma_f32_16x16x32_bf16 v[44:47], a[240:243], a[64:67], v[44:47]
  ds_read_b64_tr_b16 a[212:213], v4 offset:20480
  v_mul_f32 v149, v149, v253
  v_mfma_f32_16x16x32_bf16 v[44:47], a[244:247], a[80:83], v[44:47]
  ds_read_b64_tr_b16 a[220:221], v5 offset:20480
  v_mul_f32 v254, v254, v150
  v_cvt_pk_bf16_f32 v146, v148, v149
  v_mfma_f32_16x16x32_bf16 v[60:63], a[244:247], a[84:87], v[60:63]
  v_exp_f32 v254, v254
  v_mfma_f32_16x16x32_bf16 v[60:63], a[240:243], a[68:71], v[60:63]
  buffer_load_dwordx4 v11, s[44:47], s74 offen offset:1024 lds
  v_mul_f32 v249, v152, v152
  v_mfma_f32_16x16x32_bf16 v[76:79], a[240:243], a[72:75], v[76:79]
  s_waitcnt vmcnt(14)
  ds_read_b64_tr_b16 a[198:199], v2 offset:22528
  v_fma_f32 v254, v254, s15, s15
  v_mfma_f32_16x16x32_bf16 v[76:79], a[244:247], a[88:91], v[76:79]
  ds_read_b64_tr_b16 a[206:207], v3 offset:22528
  v_fma_f32 v255, v255, s15, s15
  v_mfma_f32_16x16x32_bf16 v[92:95], a[244:247], a[92:95], v[92:95]
  s_waitcnt lgkmcnt(4)
  ds_read_b64_tr_b16 a[214:215], v4 offset:22528
  v_rcp_f32 v255, v255
  v_mfma_f32_16x16x32_bf16 v[92:95], a[240:243], a[76:79], v[92:95]
  buffer_load_dwordx4 v12, s[44:47], s74 offen offset:2048 lds
  v_mfma_f32_16x16x32_bf16 v[220:223], a[248:251], a[76:79], v[220:223]
  ds_read_b64_tr_b16 a[222:223], v5 offset:22528
  v_mul_f32 v151, v151, v255
  v_mfma_f32_16x16x32_bf16 v[220:223], a[252:255], a[92:95], v[220:223]
  ds_read_b128 a[28:31], v247 offset:7168
  v_fma_f32 v249, v249, s80, v248
  v_mfma_f32_16x16x32_bf16 v[204:207], a[252:255], a[88:91], v[204:207]
  v_rcp_f32 v254, v254
  v_mfma_f32_16x16x32_bf16 v[204:207], a[248:251], a[72:75], v[204:207]
  buffer_load_dwordx4 v13, s[44:47], s74 offen offset:3072 lds
  v_mfma_f32_16x16x32_bf16 v[188:191], a[248:251], a[68:71], v[188:191]
  s_waitcnt vmcnt(14)
  ds_read_b64_tr_b16 a[224:225], v2
  v_mul_f32 v150, v150, v254
  v_mfma_f32_16x16x32_bf16 v[188:191], a[252:255], a[84:87], v[188:191]
  s_mov_b32 s73, 0x80
  ds_read_b64_tr_b16 a[232:233], v3
  v_cvt_pk_bf16_f32 v147, v150, v151
  v_mfma_f32_16x16x32_bf16 v[172:175], a[252:255], a[80:83], v[172:175]
  s_add_u32 m0, s72, 0x4000
  v_mul_f32 v249, v249, v152
  v_mul_f32 v250, v153, v153
  v_mfma_f32_16x16x32_bf16 v[172:175], a[248:251], a[64:67], v[172:175]
  buffer_load_dwordx4 v10, s[44:47], s73 offen lds
  v_mfma_f32_16x16x32_bf16 v[32:35], a[192:195], a[32:35], v[32:35]
  s_waitcnt lgkmcnt(4)
  ds_read_b64_tr_b16 a[240:241], v4
  v_fma_f32 v250, v250, s80, v248
  v_mul_f32 v251, v154, v154
  v_mfma_f32_16x16x32_bf16 v[32:35], a[196:199], a[48:51], v[32:35]
  ds_read_b64_tr_b16 a[248:249], v5
  v_mul_f32 v250, v250, v153
  v_fma_f32 v251, v251, s80, v248
  v_mfma_f32_16x16x32_bf16 v[48:51], a[196:199], a[52:55], v[48:51]
  v_exp_f32 v249, v249
  v_mul_f32 v251, v251, v154
  v_mfma_f32_16x16x32_bf16 v[48:51], a[192:195], a[36:39], v[48:51]
  buffer_load_dwordx4 v11, s[44:47], s73 offen offset:1024 lds
  v_exp_f32 v251, v251
  v_mfma_f32_16x16x32_bf16 v[64:67], a[192:195], a[40:43], v[64:67]
  s_waitcnt vmcnt(14)
  ds_read_b64_tr_b16 a[226:227], v2 offset:2048
  v_fma_f32 v249, v249, s15, s15
  v_fma_f32 v251, v251, s15, s15
  v_mfma_f32_16x16x32_bf16 v[64:67], a[196:199], a[56:59], v[64:67]
  ds_read_b64_tr_b16 a[234:235], v3 offset:2048
  v_exp_f32 v250, v250
  v_rcp_f32 v251, v251
  v_mfma_f32_16x16x32_bf16 v[80:83], a[196:199], a[60:63], v[80:83]
  v_rcp_f32 v249, v249
  v_mul_f32 v154, v154, v251
  v_mfma_f32_16x16x32_bf16 v[80:83], a[192:195], a[44:47], v[80:83]
  buffer_load_dwordx4 v12, s[44:47], s73 offen offset:2048 lds
  v_mul_f32 v252, v155, v155
  v_mfma_f32_16x16x32_bf16 v[208:211], a[200:203], a[44:47], v[208:211]
  ds_read_b64_tr_b16 a[242:243], v4 offset:2048
  v_mul_f32 v152, v152, v249
  v_mfma_f32_16x16x32_bf16 v[208:211], a[204:207], a[60:63], v[208:211]
  ds_read_b64_tr_b16 a[250:251], v5 offset:2048
  v_fma_f32 v250, v250, s15, s15
  v_mfma_f32_16x16x32_bf16 v[192:195], a[204:207], a[56:59], v[192:195]
  v_rcp_f32 v250, v250
  v_mfma_f32_16x16x32_bf16 v[192:195], a[200:203], a[40:43], v[192:195]
  buffer_load_dwordx4 v13, s[44:47], s73 offen offset:3072 lds
  v_mfma_f32_16x16x32_bf16 v[176:179], a[200:203], a[36:39], v[176:179]
  s_waitcnt vmcnt(14)
  ds_read_b64_tr_b16 a[228:229], v2 offset:4096
  v_mul_f32 v153, v153, v250
  v_mfma_f32_16x16x32_bf16 v[176:179], a[204:207], a[52:55], v[176:179]
  s_mov_b32 s74, 0x40080
  ds_read_b64_tr_b16 a[236:237], v3 offset:4096
  v_fma_f32 v252, v252, s80, v248
  v_mfma_f32_16x16x32_bf16 v[160:163], a[204:207], a[48:51], v[160:163]
  s_add_u32 m0, s72, 0x5000
  v_mul_f32 v252, v252, v155
  v_cvt_pk_bf16_f32 v152, v152, v153
  v_mfma_f32_16x16x32_bf16 v[160:163], a[200:203], a[32:35], v[160:163]
  buffer_load_dwordx4 v10, s[44:47], s74 offen lds
  v_mfma_f32_16x16x32_bf16 v[36:39], a[208:211], a[32:35], v[36:39]
  ds_read_b64_tr_b16 a[244:245], v4 offset:4096
  v_mul_f32 v253, v156, v156
  v_mfma_f32_16x16x32_bf16 v[36:39], a[212:215], a[48:51], v[36:39]
  ds_read_b64_tr_b16 a[252:253], v5 offset:4096
  v_fma_f32 v253, v253, s80, v248
  v_mfma_f32_16x16x32_bf16 v[52:55], a[212:215], a[52:55], v[52:55]
  v_exp_f32 v252, v252
  v_mfma_f32_16x16x32_bf16 v[52:55], a[208:211], a[36:39], v[52:55]
  buffer_load_dwordx4 v11, s[44:47], s74 offen offset:1024 lds
  v_mfma_f32_16x16x32_bf16 v[68:71], a[208:211], a[40:43], v[68:71]
  s_waitcnt vmcnt(14)
  ds_read_b64_tr_b16 a[230:231], v2 offset:6144
  v_fma_f32 v252, v252, s15, s15
  v_mfma_f32_16x16x32_bf16 v[68:71], a[212:215], a[56:59], v[68:71]
  ds_read_b64_tr_b16 a[238:239], v3 offset:6144
  v_mul_f32 v253, v253, v156
  v_mul_f32 v254, v157, v157
  v_mfma_f32_16x16x32_bf16 v[84:87], a[212:215], a[60:63], v[84:87]
  s_waitcnt lgkmcnt(4)
  v_rcp_f32 v252, v252
  v_fma_f32 v254, v254, s80, v248
  v_mfma_f32_16x16x32_bf16 v[84:87], a[208:211], a[44:47], v[84:87]
  buffer_load_dwordx4 v12, s[44:47], s74 offen offset:2048 lds
  v_mul_f32 v254, v254, v157
  v_mfma_f32_16x16x32_bf16 v[212:215], a[216:219], a[44:47], v[212:215]
  ds_read_b64_tr_b16 a[246:247], v4 offset:6144
  v_mul_f32 v155, v155, v252
  v_mfma_f32_16x16x32_bf16 v[212:215], a[220:223], a[60:63], v[212:215]
  ds_read_b64_tr_b16 a[254:255], v5 offset:6144
  v_cvt_pk_bf16_f32 v153, v154, v155
  v_mfma_f32_16x16x32_bf16 v[196:199], a[220:223], a[56:59], v[196:199]
  v_exp_f32 v253, v253
  v_mfma_f32_16x16x32_bf16 v[196:199], a[216:219], a[40:43], v[196:199]
  buffer_load_dwordx4 v13, s[44:47], s74 offen offset:3072 lds
  v_mfma_f32_16x16x32_bf16 v[180:183], a[216:219], a[36:39], v[180:183]
  s_waitcnt vmcnt(14)
  ds_read_b64_tr_b16 a[192:193], v2 offset:8192
  v_fma_f32 v253, v253, s15, s15
  v_mul_f32 v255, v158, v158
  v_mfma_f32_16x16x32_bf16 v[180:183], a[220:223], a[52:55], v[180:183]
  s_add_u32 s73, s88, 0
  ds_read_b64_tr_b16 a[200:201], v3 offset:8192
  v_exp_f32 v254, v254
  v_fma_f32 v255, v255, s80, v248
  v_mfma_f32_16x16x32_bf16 v[164:167], a[220:223], a[48:51], v[164:167]
  s_add_u32 m0, s72, 0
  v_rcp_f32 v253, v253
  v_mul_f32 v255, v255, v158
  v_mfma_f32_16x16x32_bf16 v[164:167], a[216:219], a[32:35], v[164:167]
  buffer_load_dwordx4 v28, s[52:55], s73 offen lds
  v_exp_f32 v255, v255
  v_mfma_f32_16x16x32_bf16 v[40:43], a[224:227], a[32:35], v[40:43]
  s_waitcnt lgkmcnt(3)
  ds_read_b64_tr_b16 a[208:209], v4 offset:8192
  v_mul_f32 v156, v156, v253
  v_mfma_f32_16x16x32_bf16 v[40:43], a[228:231], a[48:51], v[40:43]
  ds_read_b64_tr_b16 a[216:217], v5 offset:8192
  v_fma_f32 v254, v254, s15, s15
  v_mfma_f32_16x16x32_bf16 v[56:59], a[228:231], a[52:55], v[56:59]
  v_rcp_f32 v254, v254
  v_mfma_f32_16x16x32_bf16 v[56:59], a[224:227], a[36:39], v[56:59]
  buffer_load_dwordx4 v29, s[52:55], s73 offen offset:1024 lds
  v_mul_f32 v249, v159, v159
  v_mfma_f32_16x16x32_bf16 v[72:75], a[224:227], a[40:43], v[72:75]
  s_waitcnt vmcnt(14)
  ds_read_b64_tr_b16 a[194:195], v2 offset:10240
  v_mul_f32 v157, v157, v254
  v_mfma_f32_16x16x32_bf16 v[72:75], a[228:231], a[56:59], v[72:75]
  ds_read_b64_tr_b16 a[202:203], v3 offset:10240
  v_fma_f32 v255, v255, s15, s15
  v_cvt_pk_bf16_f32 v154, v156, v157
  v_mfma_f32_16x16x32_bf16 v[88:91], a[228:231], a[60:63], v[88:91]
  v_rcp_f32 v255, v255
  v_mfma_f32_16x16x32_bf16 v[88:91], a[224:227], a[44:47], v[88:91]
  buffer_load_dwordx4 v30, s[52:55], s73 offen offset:2048 lds
  v_mfma_f32_16x16x32_bf16 v[216:219], a[232:235], a[44:47], v[216:219]
  ds_read_b64_tr_b16 a[210:211], v4 offset:10240
  v_mul_f32 v158, v158, v255
  v_mfma_f32_16x16x32_bf16 v[216:219], a[236:239], a[60:63], v[216:219]
  ds_read_b64_tr_b16 a[218:219], v5 offset:10240
  v_fma_f32 v249, v249, s80, v248
  v_mfma_f32_16x16x32_bf16 v[200:203], a[236:239], a[56:59], v[200:203]
  v_mul_f32 v249, v249, v159
  v_add_u32 v246, s77, v1
  v_mfma_f32_16x16x32_bf16 v[200:203], a[232:235], a[40:43], v[200:203]
  buffer_load_dwordx4 v31, s[52:55], s73 offen offset:3072 lds
  v_mfma_f32_16x16x32_bf16 v[184:187], a[232:235], a[36:39], v[184:187]
  s_waitcnt vmcnt(14)
  ds_read_b64_tr_b16 a[196:197], v2 offset:12288
  v_mfma_f32_16x16x32_bf16 v[184:187], a[236:239], a[52:55], v[184:187]
  s_add_u32 s74, s88, 0x8000
  ds_read_b64_tr_b16 a[204:205], v3 offset:12288
  v_mfma_f32_16x16x32_bf16 v[168:171], a[236:239], a[48:51], v[168:171]
  s_add_u32 m0, s72, 0x1000
  v_exp_f32 v249, v249
  v_mfma_f32_16x16x32_bf16 v[168:171], a[232:235], a[32:35], v[168:171]
  buffer_load_dwordx4 v28, s[52:55], s74 offen lds
  v_mfma_f32_16x16x32_bf16 v[44:47], a[240:243], a[32:35], v[44:47]
  ds_read_b64_tr_b16 a[212:213], v4 offset:12288
  v_fma_f32 v249, v249, s15, s15
  v_mfma_f32_16x16x32_bf16 v[44:47], a[244:247], a[48:51], v[44:47]
  ds_read_b64_tr_b16 a[220:221], v5 offset:12288
  v_mfma_f32_16x16x32_bf16 v[60:63], a[244:247], a[52:55], v[60:63]
  v_rcp_f32 v249, v249
  v_mfma_f32_16x16x32_bf16 v[60:63], a[240:243], a[36:39], v[60:63]
  buffer_load_dwordx4 v29, s[52:55], s74 offen offset:1024 lds
  v_mfma_f32_16x16x32_bf16 v[76:79], a[240:243], a[40:43], v[76:79]
  s_waitcnt vmcnt(14)
  ds_read_b64_tr_b16 a[198:199], v2 offset:14336
  v_mul_f32 v159, v159, v249
  v_mfma_f32_16x16x32_bf16 v[76:79], a[244:247], a[56:59], v[76:79]
  ds_read_b64_tr_b16 a[206:207], v3 offset:14336
  v_cvt_pk_bf16_f32 v155, v158, v159
  v_mfma_f32_16x16x32_bf16 v[92:95], a[244:247], a[60:63], v[92:95]
  s_waitcnt lgkmcnt(6)
  v_mfma_f32_16x16x32_bf16 v[92:95], a[240:243], a[44:47], v[92:95]
  buffer_load_dwordx4 v30, s[52:55], s74 offen offset:2048 lds
  v_mfma_f32_16x16x32_bf16 v[220:223], a[248:251], a[44:47], v[220:223]
  ds_read_b64_tr_b16 a[214:215], v4 offset:14336
  v_mfma_f32_16x16x32_bf16 v[220:223], a[252:255], a[60:63], v[220:223]
  ds_read_b64_tr_b16 a[222:223], v5 offset:14336
  v_mfma_f32_16x16x32_bf16 v[204:207], a[252:255], a[56:59], v[204:207]
  v_mfma_f32_16x16x32_bf16 v[204:207], a[248:251], a[40:43], v[204:207]
  buffer_load_dwordx4 v31, s[52:55], s74 offen offset:3072 lds
  v_mfma_f32_16x16x32_bf16 v[188:191], a[248:251], a[36:39], v[188:191]
  s_waitcnt vmcnt(14)
  ds_read_b64_tr_b16 a[224:225], v2 offset:16384
  v_mfma_f32_16x16x32_bf16 v[188:191], a[252:255], a[52:55], v[188:191]
  s_add_u32 s73, s88, 0x10000
  ds_read_b64_tr_b16 a[232:233], v3 offset:16384
  v_mfma_f32_16x16x32_bf16 v[172:175], a[252:255], a[48:51], v[172:175]
  s_add_u32 m0, s72, 0x2000
  v_mfma_f32_16x16x32_bf16 v[172:175], a[248:251], a[32:35], v[172:175]
  buffer_load_dwordx4 v28, s[52:55], s73 offen lds
  v_mfma_f32_16x16x32_bf16 v[32:35], a[192:195], a[0:3], v[32:35]
  s_waitcnt lgkmcnt(5)
  ds_read_b64_tr_b16 a[240:241], v4 offset:16384
  v_mfma_f32_16x16x32_bf16 v[32:35], a[196:199], a[16:19], v[32:35]
  ds_read_b64_tr_b16 a[248:249], v5 offset:16384
  v_mfma_f32_16x16x32_bf16 v[48:51], a[196:199], a[20:23], v[48:51]
  v_mfma_f32_16x16x32_bf16 v[48:51], a[192:195], a[4:7], v[48:51]
  buffer_load_dwordx4 v29, s[52:55], s73 offen offset:1024 lds
  v_mfma_f32_16x16x32_bf16 v[64:67], a[192:195], a[8:11], v[64:67]
  s_waitcnt vmcnt(14)
  ds_read_b64_tr_b16 a[226:227], v2 offset:18432
  v_mfma_f32_16x16x32_bf16 v[64:67], a[196:199], a[24:27], v[64:67]
  ds_read_b64_tr_b16 a[234:235], v3 offset:18432
  v_mfma_f32_16x16x32_bf16 v[80:83], a[196:199], a[28:31], v[80:83]
  s_barrier
  v_mfma_f32_16x16x32_bf16 v[80:83], a[192:195], a[12:15], v[80:83]
  buffer_load_dwordx4 v30, s[52:55], s73 offen offset:2048 lds
  v_mfma_f32_16x16x32_bf16 v[208:211], a[200:203], a[12:15], v[208:211]
  s_waitcnt lgkmcnt(6)
  ds_read_b64_tr_b16 a[242:243], v4 offset:18432
  v_mfma_f32_16x16x32_bf16 v[208:211], a[204:207], a[28:31], v[208:211]
  ds_read_b64_tr_b16 a[250:251], v5 offset:18432
  v_mfma_f32_16x16x32_bf16 v[192:195], a[204:207], a[24:27], v[192:195]
  v_mfma_f32_16x16x32_bf16 v[192:195], a[200:203], a[8:11], v[192:195]
  buffer_load_dwordx4 v31, s[52:55], s73 offen offset:3072 lds
  v_mfma_f32_16x16x32_bf16 v[176:179], a[200:203], a[4:7], v[176:179]
  s_add_u32 s83, s83, 0x4000
  s_waitcnt vmcnt(14)
  ds_read_b64_tr_b16 a[228:229], v2 offset:20480
  v_mfma_f32_16x16x32_bf16 v[176:179], a[204:207], a[20:23], v[176:179]
  s_and_b32 s83, s83, 0x7ffff
  ds_read_b64_tr_b16 a[236:237], v3 offset:20480
  v_mfma_f32_16x16x32_bf16 v[160:163], a[204:207], a[16:19], v[160:163]
  s_add_u32 m0, s85, 0x8000
  ds_read_b64_tr_b16 a[244:245], v4 offset:20480
  v_mfma_f32_16x16x32_bf16 v[160:163], a[200:203], a[0:3], v[160:163]
  buffer_load_dwordx4 v26, s[36:39], s83 offen lds
  v_mfma_f32_16x16x32_bf16 v[36:39], a[208:211], a[0:3], v[36:39]
  ds_read_b64_tr_b16 a[252:253], v5 offset:20480
  v_mfma_f32_16x16x32_bf16 v[36:39], a[212:215], a[16:19], v[36:39]
  buffer_load_dwordx4 v26, s[36:39], s83 offen offset:1024 lds
  v_mfma_f32_16x16x32_bf16 v[52:55], a[212:215], a[20:23], v[52:55]
  v_mfma_f32_16x16x32_bf16 v[52:55], a[208:211], a[4:7], v[52:55]
  buffer_load_dwordx4 v26, s[36:39], s83 offen offset:2048 lds
  v_mfma_f32_16x16x32_bf16 v[68:71], a[208:211], a[8:11], v[68:71]
  s_waitcnt vmcnt(15)
  ds_read_b64_tr_b16 a[230:231], v2 offset:22528
  v_cvt_pk_bf16_f32 v32, v32, v33
  v_mfma_f32_16x16x32_bf16 v[68:71], a[212:215], a[24:27], v[68:71]
  buffer_load_dwordx4 v26, s[36:39], s83 offen offset:3072 lds
  v_mfma_f32_16x16x32_bf16 v[84:87], a[212:215], a[28:31], v[84:87]
  s_add_u32 s84, s84, 0x4000
  ds_write_b128 v246, v[96:99]
  ds_read_b64_tr_b16 a[238:239], v3 offset:22528
  v_mfma_f32_16x16x32_bf16 v[84:87], a[208:211], a[12:15], v[84:87]
  s_and_b32 s84, s84, 0x7ffff
  ds_write_b128 v246, v[104:107] offset:1024
  ds_read_b64_tr_b16 a[246:247], v4 offset:22528
  v_mfma_f32_16x16x32_bf16 v[212:215], a[216:219], a[12:15], v[212:215]
  s_add_u32 m0, s85, 0xc000
  ds_write_b128 v246, v[112:115] offset:2048
  ds_read_b64_tr_b16 a[254:255], v5 offset:22528
  v_mfma_f32_16x16x32_bf16 v[212:215], a[220:223], a[28:31], v[212:215]
  buffer_load_dwordx4 v27, s[40:43], s84 offen lds
  v_mfma_f32_16x16x32_bf16 v[196:199], a[220:223], a[24:27], v[196:199]
  ds_write_b128 v246, v[120:123] offset:3072
  v_mfma_f32_16x16x32_bf16 v[196:199], a[216:219], a[8:11], v[196:199]
  buffer_load_dwordx4 v27, s[40:43], s84 offen offset:1024 lds
  v_mfma_f32_16x16x32_bf16 v[180:183], a[216:219], a[4:7], v[180:183]
  s_waitcnt vmcnt(16)
  ds_write_b128 v246, v[128:131] offset:4096
  ds_read_b64_tr_b16 a[192:193], v2
  v_mfma_f32_16x16x32_bf16 v[180:183], a[220:223], a[20:23], v[180:183]
  buffer_load_dwordx4 v27, s[40:43], s84 offen offset:2048 lds
  v_mfma_f32_16x16x32_bf16 v[164:167], a[220:223], a[16:19], v[164:167]
  s_waitcnt lgkmcnt(9)
  ds_write_b128 v246, v[136:139] offset:5120
  ds_read_b64_tr_b16 a[200:201], v3
  v_mfma_f32_16x16x32_bf16 v[164:167], a[216:219], a[0:3], v[164:167]
  buffer_load_dwordx4 v27, s[40:43], s84 offen offset:3072 lds
  v_mfma_f32_16x16x32_bf16 v[40:43], a[224:227], a[0:3], v[40:43]
  s_add_u32 s74, s88, 0x18000
  ds_write_b128 v246, v[144:147] offset:6144
  ds_read_b64_tr_b16 a[208:209], v4
  v_mfma_f32_16x16x32_bf16 v[40:43], a[228:231], a[16:19], v[40:43]
  s_add_u32 m0, s72, 0x3000
  ds_write_b128 v246, v[152:155] offset:7168
  ds_read_b64_tr_b16 a[216:217], v5
  v_mfma_f32_16x16x32_bf16 v[56:59], a[228:231], a[20:23], v[56:59]
  buffer_load_dwordx4 v28, s[52:55], s74 offen lds
  v_mfma_f32_16x16x32_bf16 v[56:59], a[224:227], a[4:7], v[56:59]
  v_cvt_pk_bf16_f32 v33, v34, v35
  v_cvt_pk_bf16_f32 v34, v160, v161
  v_mfma_f32_16x16x32_bf16 v[72:75], a[224:227], a[8:11], v[72:75]
  buffer_load_dwordx4 v29, s[52:55], s74 offen offset:1024 lds
  v_mfma_f32_16x16x32_bf16 v[72:75], a[228:231], a[24:27], v[72:75]
  s_waitcnt vmcnt(18)
  ds_read_b64_tr_b16 a[194:195], v2 offset:2048
  ds_read_b64_tr_b16 a[202:203], v3 offset:2048
  v_mfma_f32_16x16x32_bf16 v[88:91], a[228:231], a[28:31], v[88:91]
  buffer_load_dwordx4 v30, s[52:55], s74 offen offset:2048 lds
  v_mfma_f32_16x16x32_bf16 v[88:91], a[224:227], a[12:15], v[88:91]
  s_waitcnt lgkmcnt(6)
  ds_read_b64_tr_b16 a[210:211], v4 offset:2048
  ds_read_b64_tr_b16 a[218:219], v5 offset:2048
  v_mfma_f32_16x16x32_bf16 v[216:219], a[232:235], a[12:15], v[216:219]
  buffer_load_dwordx4 v31, s[52:55], s74 offen offset:3072 lds
  v_mfma_f32_16x16x32_bf16 v[216:219], a[236:239], a[28:31], v[216:219]
  s_add_u32 s73, s88, 0x20000
  v_cvt_pk_bf16_f32 v35, v162, v163
  v_cvt_pk_bf16_f32 v48, v48, v49
  v_mfma_f32_16x16x32_bf16 v[200:203], a[236:239], a[24:27], v[200:203]
  s_add_u32 m0, s72, 0x4000
  s_waitcnt lgkmcnt(5)
  s_barrier
  v_mfma_f32_16x16x32_bf16 v[200:203], a[232:235], a[8:11], v[200:203]
  buffer_load_dwordx4 v28, s[52:55], s73 offen lds
  ds_read2st64_b64 a[32:35], v1 offset0:0 offset1:4
  ds_read2st64_b64 a[48:51], v1 offset0:8 offset1:12
  v_mfma_f32_16x16x32_bf16 v[184:187], a[232:235], a[4:7], v[184:187]
  s_waitcnt vmcnt(19)
  ds_read_b64_tr_b16 a[196:197], v2 offset:4096
  ds_read_b64_tr_b16 a[204:205], v3 offset:4096
  v_mfma_f32_16x16x32_bf16 v[184:187], a[236:239], a[20:23], v[184:187]
  buffer_load_dwordx4 v29, s[52:55], s73 offen offset:1024 lds
  v_mfma_f32_16x16x32_bf16 v[168:171], a[236:239], a[16:19], v[168:171]
  ds_read_b64_tr_b16 a[212:213], v4 offset:4096
  v_cvt_pk_bf16_f32 v49, v50, v51
  v_mfma_f32_16x16x32_bf16 v[168:171], a[232:235], a[0:3], v[168:171]
  buffer_load_dwordx4 v30, s[52:55], s73 offen offset:2048 lds
  v_mfma_f32_16x16x32_bf16 v[44:47], a[240:243], a[0:3], v[44:47]
  ds_read_b64_tr_b16 a[220:221], v5 offset:4096
  ds_read2st64_b64 a[36:39], v241 offset0:0 offset1:4
  v_mfma_f32_16x16x32_bf16 v[44:47], a[244:247], a[16:19], v[44:47]
  buffer_load_dwordx4 v31, s[52:55], s73 offen offset:3072 lds
  v_mfma_f32_16x16x32_bf16 v[60:63], a[244:247], a[20:23], v[60:63]
  s_add_u32 s74, s88, 0x28000
  ds_read2st64_b64 a[52:55], v241 offset0:8 offset1:12
  v_cvt_pk_bf16_f32 v50, v176, v177
  v_mfma_f32_16x16x32_bf16 v[60:63], a[240:243], a[4:7], v[60:63]
  s_add_u32 m0, s72, 0x5000
  ds_read2st64_b64 a[40:43], v1 offset0:2 offset1:6
  v_cvt_pk_bf16_f32 v51, v178, v179
  v_mfma_f32_16x16x32_bf16 v[76:79], a[240:243], a[8:11], v[76:79]
  buffer_load_dwordx4 v28, s[52:55], s74 offen lds
  v_mfma_f32_16x16x32_bf16 v[76:79], a[244:247], a[24:27], v[76:79]
  s_waitcnt vmcnt(21)
  ds_read_b64_tr_b16 a[198:199], v2 offset:6144
  ds_read_b64_tr_b16 a[206:207], v3 offset:6144
  v_mfma_f32_16x16x32_bf16 v[92:95], a[244:247], a[28:31], v[92:95]
  buffer_load_dwordx4 v29, s[52:55], s74 offen offset:1024 lds
  v_mfma_f32_16x16x32_bf16 v[92:95], a[240:243], a[12:15], v[92:95]
  ds_read_b64_tr_b16 a[214:215], v4 offset:6144
  ds_read_b64_tr_b16 a[222:223], v5 offset:6144
  v_mfma_f32_16x16x32_bf16 v[220:223], a[248:251], a[12:15], v[220:223]
  buffer_load_dwordx4 v30, s[52:55], s74 offen offset:2048 lds
  v_mfma_f32_16x16x32_bf16 v[220:223], a[252:255], a[28:31], v[220:223]
  ds_read2st64_b64 a[56:59], v1 offset0:10 offset1:14
  ds_read2st64_b64 a[44:47], v241 offset0:2 offset1:6
  v_mfma_f32_16x16x32_bf16 v[204:207], a[252:255], a[24:27], v[204:207]
  ds_read2st64_b64 a[60:63], v241 offset0:10 offset1:14
  v_cvt_pk_bf16_f32 v64, v64, v65
  v_mfma_f32_16x16x32_bf16 v[204:207], a[248:251], a[8:11], v[204:207]
  buffer_load_dwordx4 v31, s[52:55], s74 offen offset:3072 lds
  v_mfma_f32_16x16x32_bf16 v[188:191], a[248:251], a[4:7], v[188:191]
  s_waitcnt vmcnt(22)
  ds_read_b64_tr_b16 a[224:225], v2 offset:8192
  v_cvt_pk_bf16_f32 v65, v66, v67
  v_mfma_f32_16x16x32_bf16 v[188:191], a[252:255], a[20:23], v[188:191]
  s_add_u32 s73, s88, 0x30000
  ds_read_b64_tr_b16 a[232:233], v3 offset:8192
  v_cvt_pk_bf16_f32 v66, v192, v193
  v_mfma_f32_16x16x32_bf16 v[172:175], a[252:255], a[16:19], v[172:175]
  s_add_u32 m0, s72, 0
  s_waitcnt lgkmcnt(7)
  ds_read_b64_tr_b16 a[240:241], v4 offset:8192
  v_cvt_pk_bf16_f32 v67, v194, v195
  v_mfma_f32_16x16x32_bf16 v[172:175], a[248:251], a[0:3], v[172:175]
  buffer_load_dwordx4 v28, s[52:55], s73 offen lds
  v_mfma_f32_16x16x32_bf16 v[128:131], a[192:195], a[32:35], 0
  ds_read_b64_tr_b16 a[248:249], v5 offset:8192
  v_cvt_pk_bf16_f32 v80, v80, v81
  v_mfma_f32_16x16x32_bf16 v[128:131], a[196:199], a[48:51], v[128:131]
  ds_read2st64_b64 a[64:67], v1 offset0:16 offset1:20
  v_cvt_pk_bf16_f32 v81, v82, v83
  v_mfma_f32_16x16x32_bf16 v[132:135], a[196:199], a[52:55], 0
  ds_read2st64_b64 a[80:83], v1 offset0:24 offset1:28
  v_cvt_pk_bf16_f32 v82, v208, v209
  v_mfma_f32_16x16x32_bf16 v[132:135], a[192:195], a[36:39], v[132:135]
  buffer_load_dwordx4 v29, s[52:55], s73 offen offset:1024 lds
  v_mfma_f32_16x16x32_bf16 v[136:139], a[192:195], a[40:43], 0
  s_waitcnt vmcnt(22) lgkmcnt(6)
  ds_read_b64_tr_b16 a[226:227], v2 offset:10240
  v_cvt_pk_bf16_f32 v83, v210, v211
  v_mfma_f32_16x16x32_bf16 v[136:139], a[196:199], a[56:59], v[136:139]
  ds_read_b64_tr_b16 a[234:235], v3 offset:10240
  v_cvt_pk_bf16_f32 v36, v36, v37
  v_mfma_f32_16x16x32_bf16 v[140:143], a[196:199], a[60:63], 0
  ds_read_b64_tr_b16 a[242:243], v4 offset:10240
  v_cvt_pk_bf16_f32 v37, v38, v39
  v_mfma_f32_16x16x32_bf16 v[140:143], a[192:195], a[44:47], v[140:143]
  buffer_load_dwordx4 v30, s[52:55], s73 offen offset:2048 lds
  v_mfma_f32_16x16x32_bf16 v[108:111], a[200:203], a[44:47], 0
  ds_read_b64_tr_b16 a[250:251], v5 offset:10240
  v_cvt_pk_bf16_f32 v38, v164, v165
  v_mfma_f32_16x16x32_bf16 v[108:111], a[204:207], a[60:63], v[108:111]
  ds_read2st64_b64 a[68:71], v241 offset0:16 offset1:20
  v_cvt_pk_bf16_f32 v39, v166, v167
  v_mfma_f32_16x16x32_bf16 v[104:107], a[204:207], a[56:59], 0
  ds_read2st64_b64 a[84:87], v241 offset0:24 offset1:28
  v_cvt_pk_bf16_f32 v52, v52, v53
  v_mfma_f32_16x16x32_bf16 v[104:107], a[200:203], a[40:43], v[104:107]
  buffer_load_dwordx4 v31, s[52:55], s73 offen offset:3072 lds
  v_mfma_f32_16x16x32_bf16 v[100:103], a[200:203], a[36:39], 0
  s_waitcnt vmcnt(14)
  ds_read_b64_tr_b16 a[228:229], v2 offset:12288
  v_cvt_pk_bf16_f32 v53, v54, v55
  v_mfma_f32_16x16x32_bf16 v[100:103], a[204:207], a[52:55], v[100:103]
  s_add_u32 s74, s88, 0x38000
  ds_read_b64_tr_b16 a[236:237], v3 offset:12288
  v_cvt_pk_bf16_f32 v54, v180, v181
  v_mfma_f32_16x16x32_bf16 v[96:99], a[204:207], a[48:51], 0
  s_add_u32 m0, s72, 0x1000
  ds_read_b64_tr_b16 a[244:245], v4 offset:12288
  v_cvt_pk_bf16_f32 v55, v182, v183
  v_mfma_f32_16x16x32_bf16 v[96:99], a[200:203], a[32:35], v[96:99]
  buffer_load_dwordx4 v28, s[52:55], s74 offen lds
  v_mfma_f32_16x16x32_bf16 v[144:147], a[208:211], a[32:35], 0
  ds_read_b64_tr_b16 a[252:253], v5 offset:12288
  v_cvt_pk_bf16_f32 v68, v68, v69
  v_mfma_f32_16x16x32_bf16 v[144:147], a[212:215], a[48:51], v[144:147]
  ds_read2st64_b64 a[72:75], v1 offset0:18 offset1:22
  v_cvt_pk_bf16_f32 v69, v70, v71
  v_mfma_f32_16x16x32_bf16 v[148:151], a[212:215], a[52:55], 0
  ds_read2st64_b64 a[88:91], v1 offset0:26 offset1:30
  v_cvt_pk_bf16_f32 v70, v196, v197
  v_mfma_f32_16x16x32_bf16 v[148:151], a[208:211], a[36:39], v[148:151]
  buffer_load_dwordx4 v29, s[52:55], s74 offen offset:1024 lds
  v_mfma_f32_16x16x32_bf16 v[152:155], a[208:211], a[40:43], 0
  s_waitcnt vmcnt(14)
  ds_read_b64_tr_b16 a[230:231], v2 offset:14336
  v_cvt_pk_bf16_f32 v71, v198, v199
  v_mfma_f32_16x16x32_bf16 v[152:155], a[212:215], a[56:59], v[152:155]
L_p10121:
  s_cmp_eq_u32 s95, 1
  s_cbranch_scc1 L_p4590
  ds_read_b64_tr_b16 a[238:239], v3 offset:14336
  v_cvt_pk_bf16_f32 v84, v84, v85
  v_mfma_f32_16x16x32_bf16 v[156:159], a[212:215], a[60:63], 0
  ds_read_b64_tr_b16 a[246:247], v4 offset:14336
  v_cvt_pk_bf16_f32 v85, v86, v87
  v_mfma_f32_16x16x32_bf16 v[156:159], a[208:211], a[44:47], v[156:159]
  buffer_load_dwordx4 v30, s[52:55], s74 offen offset:2048 lds
  v_mfma_f32_16x16x32_bf16 v[124:127], a[216:219], a[44:47], 0
  ds_read_b64_tr_b16 a[254:255], v5 offset:14336
  v_cvt_pk_bf16_f32 v86, v212, v213
  v_mfma_f32_16x16x32_bf16 v[124:127], a[220:223], a[60:63], v[124:127]
  ds_read2st64_b64 a[76:79], v241 offset0:18 offset1:22
  v_cvt_pk_bf16_f32 v87, v214, v215
  v_mfma_f32_16x16x32_bf16 v[120:123], a[220:223], a[56:59], 0
  ds_read2st64_b64 a[92:95], v241 offset0:26 offset1:30
  v_cvt_pk_bf16_f32 v40, v40, v41
  v_mfma_f32_16x16x32_bf16 v[120:123], a[216:219], a[40:43], v[120:123]
  buffer_load_dwordx4 v31, s[52:55], s74 offen offset:3072 lds
  v_mfma_f32_16x16x32_bf16 v[116:119], a[216:219], a[36:39], 0
  s_waitcnt vmcnt(14)
  ds_read_b64_tr_b16 a[192:193], v2 offset:16384
  v_cvt_pk_bf16_f32 v41, v42, v43
  v_mfma_f32_16x16x32_bf16 v[116:119], a[220:223], a[52:55], v[116:119]
  s_add_u32 s73, s88, 0x80
  ds_read_b64_tr_b16 a[200:201], v3 offset:16384
  v_cvt_pk_bf16_f32 v42, v168, v169
  v_mfma_f32_16x16x32_bf16 v[112:115], a[220:223], a[48:51], 0
  s_add_u32 m0, s72, 0x2000
  s_waitcnt lgkmcnt(6)
  ds_read_b64_tr_b16 a[208:209], v4 offset:16384
  v_cvt_pk_bf16_f32 v43, v170, v171
  v_mfma_f32_16x16x32_bf16 v[112:115], a[216:219], a[32:35], v[112:115]
  buffer_load_dwordx4 v28, s[52:55], s73 offen lds
  v_mfma_f32_16x16x32_bf16 v[128:131], a[224:227], a[64:67], v[128:131]
  ds_read_b64_tr_b16 a[216:217], v5 offset:16384
  v_cvt_pk_bf16_f32 v56, v56, v57
  v_mfma_f32_16x16x32_bf16 v[128:131], a[228:231], a[80:83], v[128:131]
  ds_read2st64_b64 a[96:99], v1 offset0:32 offset1:36
  v_cvt_pk_bf16_f32 v57, v58, v59
  v_mfma_f32_16x16x32_bf16 v[132:135], a[228:231], a[84:87], v[132:135]
  ds_read2st64_b64 a[112:115], v1 offset0:40 offset1:44
  v_cvt_pk_bf16_f32 v58, v184, v185
  v_mfma_f32_16x16x32_bf16 v[132:135], a[224:227], a[68:71], v[132:135]
  buffer_load_dwordx4 v29, s[52:55], s73 offen offset:1024 lds
  v_mfma_f32_16x16x32_bf16 v[136:139], a[224:227], a[72:75], v[136:139]
  s_waitcnt vmcnt(14)
  ds_read_b64_tr_b16 a[194:195], v2 offset:18432
  v_cvt_pk_bf16_f32 v59, v186, v187
  v_mfma_f32_16x16x32_bf16 v[136:139], a[228:231], a[88:91], v[136:139]
  s_waitcnt lgkmcnt(6)
  ds_read_b64_tr_b16 a[202:203], v3 offset:18432
  v_cvt_pk_bf16_f32 v72, v72, v73
  v_mfma_f32_16x16x32_bf16 v[140:143], a[228:231], a[92:95], v[140:143]
  ds_read_b64_tr_b16 a[210:211], v4 offset:18432
  v_cvt_pk_bf16_f32 v73, v74, v75
  v_mfma_f32_16x16x32_bf16 v[140:143], a[224:227], a[76:79], v[140:143]
  buffer_load_dwordx4 v30, s[52:55], s73 offen offset:2048 lds
  v_mfma_f32_16x16x32_bf16 v[108:111], a[232:235], a[76:79], v[108:111]
  ds_read_b64_tr_b16 a[218:219], v5 offset:18432
  v_cvt_pk_bf16_f32 v74, v200, v201
  v_mfma_f32_16x16x32_bf16 v[108:111], a[236:239], a[92:95], v[108:111]
  ds_read2st64_b64 a[100:103], v241 offset0:32 offset1:36
  v_cvt_pk_bf16_f32 v75, v202, v203
  v_mfma_f32_16x16x32_bf16 v[104:107], a[236:239], a[88:91], v[104:107]
  ds_read2st64_b64 a[116:119], v241 offset0:40 offset1:44
  v_cvt_pk_bf16_f32 v88, v88, v89
  v_mfma_f32_16x16x32_bf16 v[104:107], a[232:235], a[72:75], v[104:107]
  buffer_load_dwordx4 v31, s[52:55], s73 offen offset:3072 lds
  v_mfma_f32_16x16x32_bf16 v[100:103], a[232:235], a[68:71], v[100:103]
  s_waitcnt vmcnt(14)
  ds_read_b64_tr_b16 a[196:197], v2 offset:20480
  v_cvt_pk_bf16_f32 v89, v90, v91
  v_mfma_f32_16x16x32_bf16 v[100:103], a[236:239], a[84:87], v[100:103]
  s_add_u32 s74, s88, 0x8080
  ds_read_b64_tr_b16 a[204:205], v3 offset:20480
  v_cvt_pk_bf16_f32 v90, v216, v217
  v_mfma_f32_16x16x32_bf16 v[96:99], a[236:239], a[80:83], v[96:99]
  s_add_u32 m0, s72, 0x3000
  ds_read_b64_tr_b16 a[212:213], v4 offset:20480
  v_cvt_pk_bf16_f32 v91, v218, v219
  v_mfma_f32_16x16x32_bf16 v[96:99], a[232:235], a[64:67], v[96:99]
  buffer_load_dwordx4 v28, s[52:55], s74 offen lds
  v_mfma_f32_16x16x32_bf16 v[144:147], a[240:243], a[64:67], v[144:147]
  ds_read_b64_tr_b16 a[220:221], v5 offset:20480
  v_cvt_pk_bf16_f32 v44, v44, v45
  v_mfma_f32_16x16x32_bf16 v[144:147], a[244:247], a[80:83], v[144:147]
  ds_read2st64_b64 a[104:107], v1 offset0:34 offset1:38
  v_cvt_pk_bf16_f32 v45, v46, v47
  v_mfma_f32_16x16x32_bf16 v[148:151], a[244:247], a[84:87], v[148:151]
  ds_read2st64_b64 a[120:123], v1 offset0:42 offset1:46
  v_cvt_pk_bf16_f32 v46, v172, v173
  v_mfma_f32_16x16x32_bf16 v[148:151], a[240:243], a[68:71], v[148:151]
  buffer_load_dwordx4 v29, s[52:55], s74 offen offset:1024 lds
  v_mfma_f32_16x16x32_bf16 v[152:155], a[240:243], a[72:75], v[152:155]
  s_waitcnt vmcnt(14)
  ds_read_b64_tr_b16 a[198:199], v2 offset:22528
  v_cvt_pk_bf16_f32 v47, v174, v175
  v_mfma_f32_16x16x32_bf16 v[152:155], a[244:247], a[88:91], v[152:155]
  ds_read_b64_tr_b16 a[206:207], v3 offset:22528
  v_cvt_pk_bf16_f32 v60, v60, v61
  v_mfma_f32_16x16x32_bf16 v[156:159], a[244:247], a[92:95], v[156:159]
  ds_read_b64_tr_b16 a[214:215], v4 offset:22528
  v_cvt_pk_bf16_f32 v61, v62, v63
  v_mfma_f32_16x16x32_bf16 v[156:159], a[240:243], a[76:79], v[156:159]
  buffer_load_dwordx4 v30, s[52:55], s74 offen offset:2048 lds
  v_mfma_f32_16x16x32_bf16 v[124:127], a[248:251], a[76:79], v[124:127]
  ds_read_b64_tr_b16 a[222:223], v5 offset:22528
  v_cvt_pk_bf16_f32 v62, v188, v189
  v_mfma_f32_16x16x32_bf16 v[124:127], a[252:255], a[92:95], v[124:127]
  ds_read2st64_b64 a[108:111], v241 offset0:34 offset1:38
  v_cvt_pk_bf16_f32 v63, v190, v191
  v_mfma_f32_16x16x32_bf16 v[120:123], a[252:255], a[88:91], v[120:123]
  ds_read2st64_b64 a[124:127], v241 offset0:42 offset1:46
  v_cvt_pk_bf16_f32 v76, v76, v77
  v_mfma_f32_16x16x32_bf16 v[120:123], a[248:251], a[72:75], v[120:123]
  buffer_load_dwordx4 v31, s[52:55], s74 offen offset:3072 lds
  v_mfma_f32_16x16x32_bf16 v[116:119], a[248:251], a[68:71], v[116:119]
  s_waitcnt vmcnt(14)
  ds_read_b64_tr_b16 a[224:225], v2
  v_cvt_pk_bf16_f32 v77, v78, v79
  v_mfma_f32_16x16x32_bf16 v[116:119], a[252:255], a[84:87], v[116:119]
  s_add_u32 s73, s88, 0x10080
  ds_read_b64_tr_b16 a[232:233], v3
  v_cvt_pk_bf16_f32 v78, v204, v205
  v_mfma_f32_16x16x32_bf16 v[112:115], a[252:255], a[80:83], v[112:115]
  s_add_u32 m0, s72, 0x4000
  s_waitcnt lgkmcnt(6)
  ds_read_b64_tr_b16 a[240:241], v4
  v_cvt_pk_bf16_f32 v79, v206, v207
  v_mfma_f32_16x16x32_bf16 v[112:115], a[248:251], a[64:67], v[112:115]
  buffer_load_dwordx4 v28, s[52:55], s73 offen lds
  v_mfma_f32_16x16x32_bf16 v[128:131], a[192:195], a[96:99], v[128:131]
  ds_read_b64_tr_b16 a[248:249], v5
  v_cvt_pk_bf16_f32 v92, v92, v93
  v_mfma_f32_16x16x32_bf16 v[128:131], a[196:199], a[112:115], v[128:131]
  ds_read2st64_b64 a[0:3], v1 offset0:48 offset1:52
  v_cvt_pk_bf16_f32 v93, v94, v95
  v_mfma_f32_16x16x32_bf16 v[132:135], a[196:199], a[116:119], v[132:135]
  ds_read2st64_b64 a[16:19], v1 offset0:56 offset1:60
  v_cvt_pk_bf16_f32 v94, v220, v221
  v_mfma_f32_16x16x32_bf16 v[132:135], a[192:195], a[100:103], v[132:135]
  buffer_load_dwordx4 v29, s[52:55], s73 offen offset:1024 lds
  v_mfma_f32_16x16x32_bf16 v[136:139], a[192:195], a[104:107], v[136:139]
  s_waitcnt vmcnt(14)
  ds_read_b64_tr_b16 a[226:227], v2 offset:2048
  v_cvt_pk_bf16_f32 v95, v222, v223
  v_mfma_f32_16x16x32_bf16 v[136:139], a[196:199], a[120:123], v[136:139]
  s_waitcnt lgkmcnt(6)
  ds_read_b64_tr_b16 a[234:235], v3 offset:2048
  v_mov_b32 v224, 0x40c00000
  v_mfma_f32_16x16x32_bf16 v[140:143], a[196:199], a[124:127], v[140:143]
  ds_read_b64_tr_b16 a[242:243], v4 offset:2048
  v_mov_b32 v225, 0x40c00000
  v_mfma_f32_16x16x32_bf16 v[140:143], a[192:195], a[108:111], v[140:143]
  buffer_load_dwordx4 v30, s[52:55], s73 offen offset:2048 lds
  v_mfma_f32_16x16x32_bf16 v[108:111], a[200:203], a[108:111], v[108:111]
  ds_read_b64_tr_b16 a[250:251], v5 offset:2048
  v_mov_b32 v226, 0x40c00000
  v_mfma_f32_16x16x32_bf16 v[108:111], a[204:207], a[124:127], v[108:111]
  ds_read2st64_b64 a[4:7], v241 offset0:48 offset1:52
  v_mov_b32 v227, 0x40c00000
  v_mfma_f32_16x16x32_bf16 v[104:107], a[204:207], a[120:123], v[104:107]
  ds_read2st64_b64 a[20:23], v241 offset0:56 offset1:60
  v_mov_b32 v228, 0x40c00000
  v_mfma_f32_16x16x32_bf16 v[104:107], a[200:203], a[104:107], v[104:107]
  buffer_load_dwordx4 v31, s[52:55], s73 offen offset:3072 lds
  v_mfma_f32_16x16x32_bf16 v[100:103], a[200:203], a[100:103], v[100:103]
  s_waitcnt vmcnt(14)
  ds_read_b64_tr_b16 a[228:229], v2 offset:4096
  v_mov_b32 v229, 0x40c00000
  v_mfma_f32_16x16x32_bf16 v[100:103], a[204:207], a[116:119], v[100:103]
  s_add_u32 s74, s88, 0x18080
  ds_read_b64_tr_b16 a[236:237], v3 offset:4096
  v_mov_b32 v230, 0x40c00000
  v_mfma_f32_16x16x32_bf16 v[96:99], a[204:207], a[112:115], v[96:99]
  s_add_u32 m0, s72, 0x5000
  ds_read_b64_tr_b16 a[244:245], v4 offset:4096
  v_mov_b32 v231, 0x40c00000
  v_mfma_f32_16x16x32_bf16 v[96:99], a[200:203], a[96:99], v[96:99]
  buffer_load_dwordx4 v28, s[52:55], s74 offen lds
  v_mfma_f32_16x16x32_bf16 v[144:147], a[208:211], a[96:99], v[144:147]
  ds_read_b64_tr_b16 a[252:253], v5 offset:4096
  v_mov_b32 v232, 0x40c00000
  v_mfma_f32_16x16x32_bf16 v[144:147], a[212:215], a[112:115], v[144:147]
  ds_read2st64_b64 a[8:11], v1 offset0:50 offset1:54
  v_mov_b32 v233, 0x40c00000
  v_mfma_f32_16x16x32_bf16 v[148:151], a[212:215], a[116:119], v[148:151]
  ds_read2st64_b64 a[24:27], v1 offset0:58 offset1:62
  v_mov_b32 v234, 0x40c00000
  v_mfma_f32_16x16x32_bf16 v[148:151], a[208:211], a[100:103], v[148:151]
  buffer_load_dwordx4 v29, s[52:55], s74 offen offset:1024 lds
  v_mfma_f32_16x16x32_bf16 v[152:155], a[208:211], a[104:107], v[152:155]
  s_waitcnt vmcnt(14)
  ds_read_b64_tr_b16 a[230:231], v2 offset:6144
  v_mov_b32 v235, 0x40c00000
  v_mfma_f32_16x16x32_bf16 v[152:155], a[212:215], a[120:123], v[152:155]
  ds_read_b64_tr_b16 a[238:239], v3 offset:6144
  v_mov_b32 v236, 0x40c00000
  v_mfma_f32_16x16x32_bf16 v[156:159], a[212:215], a[124:127], v[156:159]
  ds_read_b64_tr_b16 a[246:247], v4 offset:6144
  v_mov_b32 v237, 0x40c00000
  v_mfma_f32_16x16x32_bf16 v[156:159], a[208:211], a[108:111], v[156:159]
  buffer_load_dwordx4 v30, s[52:55], s74 offen offset:2048 lds
  v_mfma_f32_16x16x32_bf16 v[124:127], a[216:219], a[108:111], v[124:127]
  ds_read_b64_tr_b16 a[254:255], v5 offset:6144
  v_mov_b32 v238, 0x40c00000
  v_mfma_f32_16x16x32_bf16 v[124:127], a[220:223], a[124:127], v[124:127]
  ds_read2st64_b64 a[12:15], v241 offset0:50 offset1:54
  v_mov_b32 v239, 0x40c00000
  v_mfma_f32_16x16x32_bf16 v[120:123], a[220:223], a[120:123], v[120:123]
  ds_read2st64_b64 a[28:31], v241 offset0:58 offset1:62
  v_bfe_i32 v252, v1, 5, 1
  v_mfma_f32_16x16x32_bf16 v[120:123], a[216:219], a[104:107], v[120:123]
  buffer_load_dwordx4 v31, s[52:55], s74 offen offset:3072 lds
  v_mfma_f32_16x16x32_bf16 v[116:119], a[216:219], a[100:103], v[116:119]
  s_waitcnt vmcnt(14)
  ds_read_b64_tr_b16 a[192:193], v2 offset:8192
  v_not_b32 v252, v252
  v_mfma_f32_16x16x32_bf16 v[116:119], a[220:223], a[116:119], v[116:119]
  s_add_u32 s73, s88, 0x20080
  ds_read_b64_tr_b16 a[200:201], v3 offset:8192
  v_and_b32 v248, 0x3f803f80, v252
  v_mfma_f32_16x16x32_bf16 v[112:115], a[220:223], a[112:115], v[112:115]
  s_add_u32 m0, s72, 0
  s_waitcnt lgkmcnt(6)
  v_permlane16_swap_b32 v32, v34
  v_mfma_f32_16x16x32_bf16 v[112:115], a[216:219], a[96:99], v[112:115]
  buffer_load_dwordx4 v28, s[52:55], s73 offen lds
  v_mfma_f32_16x16x32_bf16 v[128:131], a[224:227], a[0:3], v[128:131]
  ds_read_b64_tr_b16 a[208:209], v4 offset:8192
  v_bfe_i32 v252, v1, 6, 1
  v_mfma_f32_16x16x32_bf16 v[128:131], a[228:231], a[16:19], v[128:131]
  ds_read_b64_tr_b16 a[216:217], v5 offset:8192
  v_and_b32 v252, v252, v248
  v_mfma_f32_16x16x32_bf16 v[132:135], a[228:231], a[20:23], v[132:135]
  v_permlane16_swap_b32 v33, v35
  v_mfma_f32_16x16x32_bf16 v[132:135], a[224:227], a[4:7], v[132:135]
  buffer_load_dwordx4 v29, s[52:55], s73 offen offset:1024 lds
  v_mfma_f32_16x16x32_bf16 v[136:139], a[224:227], a[8:11], v[136:139]
  s_waitcnt lgkmcnt(4)
  s_barrier
  v_mfma_f32_16x16x32_bf16 v[136:139], a[228:231], a[24:27], v[136:139]
  s_waitcnt vmcnt(14)
  ds_read_b64_tr_b16 a[194:195], v2 offset:10240
  v_cvt_pk_bf16_f32 v128, v128, v129
  v_mfma_f32_16x16x32_bf16 v[140:143], a[228:231], a[28:31], v[140:143]
  ds_read_b64_tr_b16 a[202:203], v3 offset:10240
  v_cvt_pk_bf16_f32 v129, v130, v131
  v_mfma_f32_16x16x32_bf16 v[140:143], a[224:227], a[12:15], v[140:143]
  buffer_load_dwordx4 v30, s[52:55], s73 offen offset:2048 lds
  v_mfma_f32_16x16x32_bf16 v[108:111], a[232:235], a[12:15], v[108:111]
  ds_read_b64_tr_b16 a[210:211], v4 offset:10240
  v_xor_b32 v248, v248, v252
  v_mfma_f32_16x16x32_bf16 v[108:111], a[236:239], a[28:31], v[108:111]
  ds_read_b64_tr_b16 a[218:219], v5 offset:10240
  v_mov_b32 v249, v248
  v_mfma_f32_16x16x32_bf16 v[104:107], a[236:239], a[24:27], v[104:107]
  v_permlane16_swap_b32 v48, v50
  v_mfma_f32_16x16x32_bf16 v[104:107], a[232:235], a[8:11], v[104:107]
  buffer_load_dwordx4 v31, s[52:55], s73 offen offset:3072 lds
  v_mfma_f32_16x16x32_bf16 v[100:103], a[232:235], a[4:7], v[100:103]
  s_waitcnt vmcnt(14)
  ds_read_b64_tr_b16 a[196:197], v2 offset:12288
  v_mov_b32 v250, v248
  v_mfma_f32_16x16x32_bf16 v[100:103], a[236:239], a[20:23], v[100:103]
  s_add_u32 s74, s88, 0x28080
  ds_read_b64_tr_b16 a[204:205], v3 offset:12288
  v_mov_b32 v251, v248
  v_mfma_f32_16x16x32_bf16 v[96:99], a[236:239], a[16:19], v[96:99]
  s_add_u32 m0, s72, 0x1000
  v_permlane16_swap_b32 v49, v51
  v_mfma_f32_16x16x32_bf16 v[96:99], a[232:235], a[0:3], v[96:99]
  buffer_load_dwordx4 v28, s[52:55], s74 offen lds
  v_mfma_f32_16x16x32_bf16 v[144:147], a[240:243], a[0:3], v[144:147]
  ds_read_b64_tr_b16 a[212:213], v4 offset:12288
  v_mov_b32 v253, v252
  v_mfma_f32_16x16x32_bf16 v[144:147], a[244:247], a[16:19], v[144:147]
  ds_read_b64_tr_b16 a[220:221], v5 offset:12288
  v_mov_b32 v254, v252
  v_mfma_f32_16x16x32_bf16 v[148:151], a[244:247], a[20:23], v[148:151]
  v_permlane16_swap_b32 v64, v66
  v_mfma_f32_16x16x32_bf16 v[148:151], a[240:243], a[4:7], v[148:151]
  buffer_load_dwordx4 v29, s[52:55], s74 offen offset:1024 lds
  v_mfma_f32_16x16x32_bf16 v[152:155], a[240:243], a[8:11], v[152:155]
  s_waitcnt vmcnt(14)
  ds_read_b64_tr_b16 a[198:199], v2 offset:14336
  v_cvt_pk_bf16_f32 v130, v96, v97
  v_mfma_f32_16x16x32_bf16 v[152:155], a[244:247], a[24:27], v[152:155]
  ds_read_b64_tr_b16 a[206:207], v3 offset:14336
  v_cvt_pk_bf16_f32 v131, v98, v99
  v_mfma_f32_16x16x32_bf16 v[156:159], a[244:247], a[28:31], v[156:159]
  v_permlane16_swap_b32 v65, v67
  v_mfma_f32_16x16x32_bf16 v[156:159], a[240:243], a[12:15], v[156:159]
  buffer_load_dwordx4 v30, s[52:55], s74 offen offset:2048 lds
  v_mfma_f32_16x16x32_bf16 v[124:127], a[248:251], a[12:15], v[124:127]
  ds_read_b64_tr_b16 a[214:215], v4 offset:14336
  v_cvt_pk_bf16_f32 v132, v132, v133
  v_mfma_f32_16x16x32_bf16 v[124:127], a[252:255], a[28:31], v[124:127]
  ds_read_b64_tr_b16 a[222:223], v5 offset:14336
  v_cvt_pk_bf16_f32 v133, v134, v135
  v_mfma_f32_16x16x32_bf16 v[120:123], a[252:255], a[24:27], v[120:123]
  v_permlane16_swap_b32 v80, v82
  v_mfma_f32_16x16x32_bf16 v[120:123], a[248:251], a[8:11], v[120:123]
  buffer_load_dwordx4 v31, s[52:55], s74 offen offset:3072 lds
  v_mfma_f32_16x16x32_bf16 v[116:119], a[248:251], a[4:7], v[116:119]
  s_waitcnt vmcnt(14)
  ds_read_b64_tr_b16 a[224:225], v2 offset:16384
  v_cvt_pk_bf16_f32 v134, v100, v101
  v_mfma_f32_16x16x32_bf16 v[116:119], a[252:255], a[20:23], v[116:119]
  s_add_u32 s73, s88, 0x30080
  ds_read_b64_tr_b16 a[232:233], v3 offset:16384
  v_cvt_pk_bf16_f32 v135, v102, v103
  v_mfma_f32_16x16x32_bf16 v[112:115], a[252:255], a[16:19], v[112:115]
  s_add_u32 m0, s72, 0x2000
  s_waitcnt lgkmcnt(5)
  v_permlane16_swap_b32 v81, v83
  v_mfma_f32_16x16x32_bf16 v[112:115], a[248:251], a[0:3], v[112:115]
  buffer_load_dwordx4 v28, s[52:55], s73 offen lds
  v_mfma_f32_16x16x32_bf16 v[192:195], a[192:195], a[32:35], 0
  ds_read_b64_tr_b16 a[240:241], v4 offset:16384
  v_cvt_pk_bf16_f32 v136, v136, v137
  v_mfma_f32_16x16x32_bf16 v[192:195], a[196:199], a[48:51], v[192:195]
  ds_read_b64_tr_b16 a[248:249], v5 offset:16384
  v_cvt_pk_bf16_f32 v137, v138, v139
  v_mfma_f32_16x16x32_bf16 v[196:199], a[196:199], a[52:55], 0
  v_permlane16_swap_b32 v36, v38
  v_mfma_f32_16x16x32_bf16 v[196:199], a[192:195], a[36:39], v[196:199]
  buffer_load_dwordx4 v29, s[52:55], s73 offen offset:1024 lds
  v_mfma_f32_16x16x32_bf16 v[200:203], a[192:195], a[40:43], 0
  s_waitcnt vmcnt(14)
  ds_read_b64_tr_b16 a[226:227], v2 offset:18432
  v_cvt_pk_bf16_f32 v138, v104, v105
  v_mfma_f32_16x16x32_bf16 v[200:203], a[196:199], a[56:59], v[200:203]
  ds_read_b64_tr_b16 a[234:235], v3 offset:18432
  v_cvt_pk_bf16_f32 v139, v106, v107
  v_mfma_f32_16x16x32_bf16 v[204:207], a[196:199], a[60:63], 0
  v_permlane16_swap_b32 v37, v39
  v_mfma_f32_16x16x32_bf16 v[204:207], a[192:195], a[44:47], v[204:207]
  buffer_load_dwordx4 v30, s[52:55], s73 offen offset:2048 lds
  v_mfma_f32_16x16x32_bf16 v[172:175], a[200:203], a[44:47], 0
  s_waitcnt lgkmcnt(4)
  ds_read_b64_tr_b16 a[242:243], v4 offset:18432
  v_cvt_pk_bf16_f32 v140, v140, v141
  v_mfma_f32_16x16x32_bf16 v[172:175], a[204:207], a[60:63], v[172:175]
  ds_read_b64_tr_b16 a[250:251], v5 offset:18432
  v_cvt_pk_bf16_f32 v141, v142, v143
  v_mfma_f32_16x16x32_bf16 v[168:171], a[204:207], a[56:59], 0
  v_permlane16_swap_b32 v52, v54
  v_mfma_f32_16x16x32_bf16 v[168:171], a[200:203], a[40:43], v[168:171]
  buffer_load_dwordx4 v31, s[52:55], s73 offen offset:3072 lds
  v_mfma_f32_16x16x32_bf16 v[164:167], a[200:203], a[36:39], 0
  s_waitcnt vmcnt(14)
  ds_read_b64_tr_b16 a[228:229], v2 offset:20480
  v_cvt_pk_bf16_f32 v142, v108, v109
  v_mfma_f32_16x16x32_bf16 v[164:167], a[204:207], a[52:55], v[164:167]
  s_add_u32 s74, s88, 0x38080
  ds_read_b64_tr_b16 a[236:237], v3 offset:20480
  v_cvt_pk_bf16_f32 v143, v110, v111
  v_mfma_f32_16x16x32_bf16 v[160:163], a[204:207], a[48:51], 0
  s_add_u32 m0, s72, 0x3000
  v_permlane16_swap_b32 v53, v55
  v_mfma_f32_16x16x32_bf16 v[160:163], a[200:203], a[32:35], v[160:163]
  buffer_load_dwordx4 v28, s[52:55], s74 offen lds
  v_mfma_f32_16x16x32_bf16 v[208:211], a[208:211], a[32:35], 0
  ds_read_b64_tr_b16 a[244:245], v4 offset:20480
  v_cvt_pk_bf16_f32 v144, v144, v145
  v_mfma_f32_16x16x32_bf16 v[208:211], a[212:215], a[48:51], v[208:211]
  ds_read_b64_tr_b16 a[252:253], v5 offset:20480
  v_cvt_pk_bf16_f32 v145, v146, v147
  v_mfma_f32_16x16x32_bf16 v[212:215], a[212:215], a[52:55], 0
  v_permlane16_swap_b32 v68, v70
  v_mfma_f32_16x16x32_bf16 v[212:215], a[208:211], a[36:39], v[212:215]
  buffer_load_dwordx4 v29, s[52:55], s74 offen offset:1024 lds
  v_mfma_f32_16x16x32_bf16 v[216:219], a[208:211], a[40:43], 0
  s_waitcnt vmcnt(14)
  ds_read_b64_tr_b16 a[230:231], v2 offset:22528
  v_cvt_pk_bf16_f32 v146, v112, v113
  v_mfma_f32_16x16x32_bf16 v[216:219], a[212:215], a[56:59], v[216:219]
  ds_read_b64_tr_b16 a[238:239], v3 offset:22528
  v_cvt_pk_bf16_f32 v147, v114, v115
  v_mfma_f32_16x16x32_bf16 v[220:223], a[212:215], a[60:63], 0
  v_permlane16_swap_b32 v69, v71
  v_mfma_f32_16x16x32_bf16 v[220:223], a[208:211], a[44:47], v[220:223]
  buffer_load_dwordx4 v30, s[52:55], s74 offen offset:2048 lds
  v_mfma_f32_16x16x32_bf16 v[188:191], a[216:219], a[44:47], 0
  ds_read_b64_tr_b16 a[246:247], v4 offset:22528
  v_cvt_pk_bf16_f32 v148, v148, v149
  v_mfma_f32_16x16x32_bf16 v[188:191], a[220:223], a[60:63], v[188:191]
  ds_read_b64_tr_b16 a[254:255], v5 offset:22528
  v_cvt_pk_bf16_f32 v149, v150, v151
  v_mfma_f32_16x16x32_bf16 v[184:187], a[220:223], a[56:59], 0
  v_permlane16_swap_b32 v84, v86
  v_mfma_f32_16x16x32_bf16 v[184:187], a[216:219], a[40:43], v[184:187]
  buffer_load_dwordx4 v31, s[52:55], s74 offen offset:3072 lds
  v_mfma_f32_16x16x32_bf16 v[180:183], a[216:219], a[36:39], 0
  s_add_u32 s83, s83, 0x4000
  s_waitcnt vmcnt(14)
  ds_read_b64_tr_b16 a[192:193], v2
  v_cvt_pk_bf16_f32 v150, v116, v117
  v_mfma_f32_16x16x32_bf16 v[180:183], a[220:223], a[52:55], v[180:183]
  s_and_b32 s83, s83, 0x7ffff
  ds_read_b64_tr_b16 a[200:201], v3
  v_cvt_pk_bf16_f32 v151, v118, v119
  v_mfma_f32_16x16x32_bf16 v[176:179], a[220:223], a[48:51], 0
  s_add_u32 m0, s85, 0
  s_waitcnt lgkmcnt(4)
  ds_read_b64_tr_b16 a[208:209], v4
  v_cvt_pk_bf16_f32 v152, v152, v153
  v_mfma_f32_16x16x32_bf16 v[176:179], a[216:219], a[32:35], v[176:179]
  buffer_load_dwordx4 v26, s[36:39], s83 offen lds
  v_mfma_f32_16x16x32_bf16 v[192:195], a[224:227], a[64:67], v[192:195]
  ds_read_b64_tr_b16 a[216:217], v5
  v_cvt_pk_bf16_f32 v153, v154, v155
  v_mfma_f32_16x16x32_bf16 v[192:195], a[228:231], a[80:83], v[192:195]
  buffer_load_dwordx4 v26, s[36:39], s83 offen offset:1024 lds
  v_mfma_f32_16x16x32_bf16 v[196:199], a[228:231], a[84:87], v[196:199]
  v_permlane16_swap_b32 v85, v87
  v_mfma_f32_16x16x32_bf16 v[196:199], a[224:227], a[68:71], v[196:199]
  buffer_load_dwordx4 v26, s[36:39], s83 offen offset:2048 lds
  v_mfma_f32_16x16x32_bf16 v[200:203], a[224:227], a[72:75], v[200:203]
  s_waitcnt vmcnt(15)
  ds_read_b64_tr_b16 a[194:195], v2 offset:2048
  v_cvt_pk_bf16_f32 v154, v120, v121
  v_mfma_f32_16x16x32_bf16 v[200:203], a[228:231], a[88:91], v[200:203]
  buffer_load_dwordx4 v26, s[36:39], s83 offen offset:3072 lds
  v_mfma_f32_16x16x32_bf16 v[204:207], a[228:231], a[92:95], v[204:207]
  s_xor_b32 s90, s21, 0x10000
  ds_read_b64_tr_b16 a[202:203], v3 offset:2048
  v_cvt_pk_bf16_f32 v155, v122, v123
  v_mfma_f32_16x16x32_bf16 v[204:207], a[224:227], a[76:79], v[204:207]
  buffer_store_dwordx4 v[128:131], v1, s[60:63], s90 offen sc1
  v_permlane16_swap_b32 v40, v42
  v_mfma_f32_16x16x32_bf16 v[172:175], a[232:235], a[76:79], v[172:175]
  s_mov_b32 s48, s26
  ds_read_b64_tr_b16 a[210:211], v4 offset:2048
  v_cvt_pk_bf16_f32 v156, v156, v157
  v_mfma_f32_16x16x32_bf16 v[172:175], a[236:239], a[92:95], v[172:175]
  s_mov_b32 s49, s27
  v_permlane16_swap_b32 v41, v43
  v_mfma_f32_16x16x32_bf16 v[168:171], a[236:239], a[88:91], v[168:171]
  s_mov_b32 s50, 0x100
  ds_read_b64_tr_b16 a[218:219], v5 offset:2048
  v_cvt_pk_bf16_f32 v157, v158, v159
  v_mfma_f32_16x16x32_bf16 v[168:171], a[232:235], a[72:75], v[168:171]
  s_mov_b32 s51, 0x20000
  v_permlane16_swap_b32 v56, v58
  v_mfma_f32_16x16x32_bf16 v[164:167], a[232:235], a[68:71], v[164:167]
  s_waitcnt vmcnt(15)
  ds_read_b64_tr_b16 a[196:197], v2 offset:4096
  v_cvt_pk_bf16_f32 v158, v124, v125
  v_mfma_f32_16x16x32_bf16 v[164:167], a[236:239], a[84:87], v[164:167]
  s_mov_b32 s44, s24
  v_permlane16_swap_b32 v57, v59
  v_mfma_f32_16x16x32_bf16 v[160:163], a[236:239], a[80:83], v[160:163]
  s_mov_b32 s45, s25
  ds_read_b64_tr_b16 a[204:205], v3 offset:4096
  v_cvt_pk_bf16_f32 v159, v126, v127
  v_mfma_f32_16x16x32_bf16 v[160:163], a[232:235], a[64:67], v[160:163]
  s_mov_b32 s46, 0x200000
  v_permlane16_swap_b32 v72, v74
  v_mfma_f32_16x16x32_bf16 v[208:211], a[240:243], a[64:67], v[208:211]
  s_waitcnt lgkmcnt(4)
  ds_read_b64_tr_b16 a[212:213], v4 offset:4096
  v_mov_b32 v255, v252
  v_mfma_f32_16x16x32_bf16 v[208:211], a[244:247], a[80:83], v[208:211]
  s_mov_b32 s47, 0x20000
  v_permlane16_swap_b32 v73, v75
  v_mfma_f32_16x16x32_bf16 v[212:215], a[244:247], a[84:87], v[212:215]
  s_mov_b32 s64, s22
  ds_read_b64_tr_b16 a[220:221], v5 offset:4096
  v_bfe_i32 v11, v1, 4, 1
  v_mfma_f32_16x16x32_bf16 v[212:215], a[240:243], a[68:71], v[212:215]
  s_mov_b32 s65, s23
  v_permlane16_swap_b32 v88, v90
  v_mfma_f32_16x16x32_bf16 v[216:219], a[240:243], a[72:75], v[216:219]
  s_waitcnt vmcnt(13)
  ds_read_b64_tr_b16 a[198:199], v2 offset:6144
  v_and_b32 v11, 0xaaaaaaaa, v11
  v_mfma_f32_16x16x32_bf16 v[216:219], a[244:247], a[88:91], v[216:219]
  s_mov_b32 s66, 0x400
  v_permlane16_swap_b32 v89, v91
  v_mfma_f32_16x16x32_bf16 v[220:223], a[244:247], a[92:95], v[220:223]
  s_xor_b32 s91, s21, 0x410400
  ds_read_b64_tr_b16 a[206:207], v3 offset:6144
  v_or_b32 v11, 0x44444444, v11
  v_mfma_f32_16x16x32_bf16 v[220:223], a[240:243], a[76:79], v[220:223]
  buffer_store_dwordx4 v[132:135], v1, s[60:63], s91 offen sc1
  v_permlane16_swap_b32 v44, v46
  v_mfma_f32_16x16x32_bf16 v[188:191], a[248:251], a[76:79], v[188:191]
  s_mov_b32 s67, 0x20000
  ds_read_b64_tr_b16 a[214:215], v4 offset:6144
  v_mov_b32 v240, 0
  v_mfma_f32_16x16x32_bf16 v[188:191], a[252:255], a[92:95], v[188:191]
  s_lshl_b32 s11, s31, 2
  v_permlane16_swap_b32 v45, v47
  v_mfma_f32_16x16x32_bf16 v[184:187], a[252:255], a[88:91], v[184:187]
  s_add_u32 s11, s11, 0x80
  ds_read_b64_tr_b16 a[222:223], v5 offset:6144
  v_mov_b32 v241, 0
  v_mfma_f32_16x16x32_bf16 v[184:187], a[248:251], a[72:75], v[184:187]
  s_lshl_b32 s68, s31, 13
  v_permlane16_swap_b32 v60, v62
  v_mfma_f32_16x16x32_bf16 v[180:183], a[248:251], a[68:71], v[180:183]
  s_waitcnt vmcnt(12)
  ds_read_b64_tr_b16 a[224:225], v2 offset:8192
  v_mov_b32 v242, 0
  v_mfma_f32_16x16x32_bf16 v[180:183], a[252:255], a[84:87], v[180:183]
  s_add_u32 s68, s68, 0x2000000
  ds_read_b64_tr_b16 a[232:233], v3 offset:8192
  v_mov_b32 v243, 0
  v_mfma_f32_16x16x32_bf16 v[176:179], a[252:255], a[80:83], v[176:179]
  s_lshl_b32 s69, s3, 8
  v_permlane16_swap_b32 v61, v63
  v_mfma_f32_16x16x32_bf16 v[176:179], a[248:251], a[64:67], v[176:179]
  s_add_u32 s8, s68, s69
  ds_read_b64_tr_b16 a[240:241], v4 offset:8192
  v_mov_b32 v244, 0
  v_mfma_f32_16x16x32_bf16 v[192:195], a[192:195], a[96:99], v[192:195]
  s_waitcnt lgkmcnt(5)
  ds_read_b64_tr_b16 a[248:249], v5 offset:8192
  v_mov_b32 v245, 0
  v_mfma_f32_16x16x32_bf16 v[192:195], a[196:199], a[112:115], v[192:195]
  s_lshl_b32 s68, s30, 10
  v_permlane16_swap_b32 v76, v78
  v_mfma_f32_16x16x32_bf16 v[196:199], a[196:199], a[116:119], v[196:199]
  s_add_u32 s7, s8, s68
  ds_read_b128 a[128:131], v14 offset:32768
  v_mov_b32 v246, 0
  v_mfma_f32_16x16x32_bf16 v[196:199], a[192:195], a[100:103], v[196:199]
  s_xor_b32 s9, s82, 0x1c00000
  v_permlane16_swap_b32 v77, v79
  v_mfma_f32_16x16x32_bf16 v[200:203], a[192:195], a[104:107], v[200:203]
  s_waitcnt vmcnt(10)
  ds_read_b64_tr_b16 a[226:227], v2 offset:10240
  v_mov_b32 v247, 0
  v_mfma_f32_16x16x32_bf16 v[200:203], a[196:199], a[120:123], v[200:203]
  s_lshr_b32 s68, s30, 2
  ds_read_b64_tr_b16 a[234:235], v3 offset:10240
  v_lshrrev_b32 v6, 2, v1
  v_mfma_f32_16x16x32_bf16 v[204:207], a[196:199], a[124:127], v[204:207]
  s_lshl_b32 s68, s68, 7
  v_permlane16_swap_b32 v92, v94
  v_mfma_f32_16x16x32_bf16 v[204:207], a[192:195], a[108:111], v[204:207]
  s_add_u32 s28, s68, s69
  ds_read_b64_tr_b16 a[242:243], v4 offset:10240
  v_mov_b32 v7, 0
  v_mfma_f32_16x16x32_bf16 v[172:175], a[200:203], a[108:111], v[172:175]
  s_and_b32 s68, s30, 3
  ds_read_b64_tr_b16 a[250:251], v5 offset:10240
  v_mov_b32 v8, 1
  v_mfma_f32_16x16x32_bf16 v[172:175], a[204:207], a[124:127], v[172:175]
  s_lshl_b32 s68, s68, 14
  v_permlane16_swap_b32 v93, v95
  v_mfma_f32_16x16x32_bf16 v[168:171], a[204:207], a[120:123], v[168:171]
  s_xor_b32 s90, s21, 0x810800
  ds_read_b128 a[132:135], v15 offset:32768
  v_lshl_add_u32 v9, v1, 4, s85
  v_mfma_f32_16x16x32_bf16 v[168:171], a[200:203], a[104:107], v[168:171]
  buffer_store_dwordx4 v[136:139], v1, s[60:63], s90 offen sc1
  v_mfma_f32_16x16x32_bf16 v[164:167], a[200:203], a[100:103], v[164:167]
  s_waitcnt vmcnt(9)
  ds_read_b64_tr_b16 a[228:229], v2 offset:12288
  v_bfe_u32 v13, v1, 9, 1
  v_mfma_f32_16x16x32_bf16 v[164:167], a[204:207], a[116:119], v[164:167]
  s_add_u32 s10, s68, s28
  ds_read_b64_tr_b16 a[236:237], v3 offset:12288
  v_bfe_u32 v12, v1, 8, 1
  v_mfma_f32_16x16x32_bf16 v[160:163], a[204:207], a[112:115], v[160:163]
L_p10655:
  s_cmp_eq_u32 s95, 1
  s_cbranch_scc1 L_p4003
  s_lshl_b32 s68, s31, 16
  v_lshl_add_u32 v13, v12, 1, v13
  v_mfma_f32_16x16x32_bf16 v[160:163], a[200:203], a[96:99], v[160:163]
  s_add_u32 s10, s10, s68
  ds_read_b64_tr_b16 a[244:245], v4 offset:12288
  v_lshlrev_b32 v13, 4, v13
  v_mfma_f32_16x16x32_bf16 v[208:211], a[208:211], a[96:99], v[208:211]
  s_waitcnt lgkmcnt(5)
  ds_read_b64_tr_b16 a[252:253], v5 offset:12288
  v_and_b32 v12, 0xf0, v1
  v_mfma_f32_16x16x32_bf16 v[208:211], a[212:215], a[112:115], v[208:211]
  s_mul_i32 s5, s31, 0x4000
  v_lshl_add_u32 v12, v12, 6, v13
  v_mfma_f32_16x16x32_bf16 v[212:215], a[212:215], a[116:119], v[212:215]
  s_mov_b32 s80, 0x7060302
  ds_read_b128 a[136:139], v16 offset:32768
  v_mfma_f32_16x16x32_bf16 v[212:215], a[208:211], a[100:103], v[212:215]
  buffer_store_dword v7, v6, s[60:63], s7 offen sc1
  v_mfma_f32_16x16x32_bf16 v[216:219], a[208:211], a[104:107], v[216:219]
  s_waitcnt vmcnt(8)
  ds_read_b64_tr_b16 a[230:231], v2 offset:14336
  v_mfma_f32_16x16x32_bf16 v[216:219], a[212:215], a[120:123], v[216:219]
  ds_read_b64_tr_b16 a[238:239], v3 offset:14336
  v_mfma_f32_16x16x32_bf16 v[220:223], a[212:215], a[124:127], v[220:223]
  v_mfma_f32_16x16x32_bf16 v[220:223], a[208:211], a[108:111], v[220:223]
  ds_read_b64_tr_b16 a[246:247], v4 offset:14336
  v_mfma_f32_16x16x32_bf16 v[188:191], a[216:219], a[108:111], v[188:191]
  ds_read_b64_tr_b16 a[254:255], v5 offset:14336
  v_mfma_f32_16x16x32_bf16 v[188:191], a[220:223], a[124:127], v[188:191]
  v_mfma_f32_16x16x32_bf16 v[184:187], a[220:223], a[120:123], v[184:187]
  s_xor_b32 s91, s21, 0xc10c00
  ds_read_b128 a[140:143], v17 offset:32768
  v_mfma_f32_16x16x32_bf16 v[184:187], a[216:219], a[104:107], v[184:187]
  buffer_store_dwordx4 v[140:143], v1, s[60:63], s91 offen sc1
  v_mfma_f32_16x16x32_bf16 v[180:183], a[216:219], a[100:103], v[180:183]
  v_mfma_f32_16x16x32_bf16 v[180:183], a[220:223], a[116:119], v[180:183]
  v_mfma_f32_16x16x32_bf16 v[176:179], a[220:223], a[112:115], v[176:179]
  v_mfma_f32_16x16x32_bf16 v[176:179], a[216:219], a[96:99], v[176:179]
  ds_read_b128 a[144:147], v14 offset:33792
  v_mfma_f32_16x16x32_bf16 v[192:195], a[224:227], a[0:3], v[192:195]
  s_waitcnt lgkmcnt(5)
  ds_read_b128 a[148:151], v15 offset:33792
  v_mfma_f32_16x16x32_bf16 v[192:195], a[228:231], a[16:19], v[192:195]
  ds_read_b128 a[152:155], v16 offset:33792
  v_mfma_f32_16x16x32_bf16 v[196:199], a[228:231], a[20:23], v[196:199]
  v_mfma_f32_16x16x32_bf16 v[196:199], a[224:227], a[4:7], v[196:199]
  v_mfma_f32_16x16x32_bf16 v[200:203], a[224:227], a[8:11], v[200:203]
  ds_read_b128 a[156:159], v17 offset:33792
  v_mfma_f32_16x16x32_bf16 v[200:203], a[228:231], a[24:27], v[200:203]
  s_nop 1
  v_cvt_pk_bf16_f32 v192, v192, v193
  v_cvt_pk_bf16_f32 v193, v194, v195
  v_mfma_f32_16x16x32_bf16 v[204:207], a[228:231], a[28:31], v[204:207]
  ds_read_b128 a[160:163], v14 offset:34816
  v_mfma_f32_16x16x32_bf16 v[204:207], a[224:227], a[12:15], v[204:207]
  v_mfma_f32_16x16x32_bf16 v[172:175], a[232:235], a[12:15], v[172:175]
  s_waitcnt lgkmcnt(6)
  v_mfma_f32_16x16x32_bf16 v[172:175], a[236:239], a[28:31], v[172:175]
  ds_read_b128 a[164:167], v15 offset:34816
  v_mfma_f32_16x16x32_bf16 v[168:171], a[236:239], a[24:27], v[168:171]
  s_xor_b32 s90, s21, 0x12000
  v_mfma_f32_16x16x32_bf16 v[168:171], a[232:235], a[8:11], v[168:171]
  buffer_store_dwordx4 v[144:147], v1, s[60:63], s90 offen sc1
  v_mfma_f32_16x16x32_bf16 v[164:167], a[232:235], a[4:7], v[164:167]
  ds_read_b128 a[168:171], v16 offset:34816
  v_mfma_f32_16x16x32_bf16 v[164:167], a[236:239], a[20:23], v[164:167]
  v_mfma_f32_16x16x32_bf16 v[160:163], a[236:239], a[16:19], v[160:163]
  ds_read_b128 a[172:175], v17 offset:34816
  v_mfma_f32_16x16x32_bf16 v[160:163], a[232:235], a[0:3], v[160:163]
  v_mfma_f32_16x16x32_bf16 v[208:211], a[240:243], a[0:3], v[208:211]
  v_mfma_f32_16x16x32_bf16 v[208:211], a[244:247], a[16:19], v[208:211]
  ds_read_b128 a[176:179], v14 offset:35840
  v_mfma_f32_16x16x32_bf16 v[212:215], a[244:247], a[20:23], v[212:215]
  v_mfma_f32_16x16x32_bf16 v[212:215], a[240:243], a[4:7], v[212:215]
  s_nop 2
  v_cvt_pk_bf16_f32 v194, v160, v161
  v_cvt_pk_bf16_f32 v195, v162, v163
  v_mfma_f32_16x16x32_bf16 v[216:219], a[240:243], a[8:11], v[216:219]
  ds_read_b128 a[180:183], v15 offset:35840
  v_cvt_pk_bf16_f32 v196, v196, v197
  v_mfma_f32_16x16x32_bf16 v[216:219], a[244:247], a[24:27], v[216:219]
  v_cvt_pk_bf16_f32 v197, v198, v199
  v_cvt_pk_bf16_f32 v198, v164, v165
  v_mfma_f32_16x16x32_bf16 v[220:223], a[244:247], a[28:31], v[220:223]
  ds_read_b128 a[184:187], v16 offset:35840
  v_cvt_pk_bf16_f32 v199, v166, v167
  v_mfma_f32_16x16x32_bf16 v[220:223], a[240:243], a[12:15], v[220:223]
  v_cvt_pk_bf16_f32 v200, v200, v201
  v_cvt_pk_bf16_f32 v201, v202, v203
  v_mfma_f32_16x16x32_bf16 v[188:191], a[248:251], a[12:15], v[188:191]
  v_cvt_pk_bf16_f32 v202, v168, v169
  v_cvt_pk_bf16_f32 v203, v170, v171
  v_mfma_f32_16x16x32_bf16 v[188:191], a[252:255], a[28:31], v[188:191]
  ds_read_b128 a[188:191], v17 offset:35840
  v_cvt_pk_bf16_f32 v204, v204, v205
  v_mfma_f32_16x16x32_bf16 v[184:187], a[252:255], a[24:27], v[184:187]
  s_xor_b32 s91, s21, 0x412400
  v_cvt_pk_bf16_f32 v205, v206, v207
  v_cvt_pk_bf16_f32 v206, v172, v173
  v_mfma_f32_16x16x32_bf16 v[184:187], a[248:251], a[8:11], v[184:187]
  buffer_store_dwordx4 v[148:151], v1, s[60:63], s91 offen sc1
  v_mfma_f32_16x16x32_bf16 v[180:183], a[248:251], a[4:7], v[180:183]
  v_cvt_pk_bf16_f32 v207, v174, v175
  v_cvt_pk_bf16_f32 v208, v208, v209
  v_mfma_f32_16x16x32_bf16 v[180:183], a[252:255], a[20:23], v[180:183]
  s_andn2_b32 s68, 4, s30
  v_cvt_pk_bf16_f32 v209, v210, v211
  v_mfma_f32_16x16x32_bf16 v[176:179], a[252:255], a[16:19], v[176:179]
  s_lshl_b32 s68, s68, 5
  v_mfma_f32_16x16x32_bf16 v[176:179], a[248:251], a[0:3], v[176:179]
  s_or_b32 s89, s89, s68
  v_mfma_f32_16x16x32_bf16 v[96:99], a[128:131], v[32:35], v[224:227]
  v_mfma_f32_16x16x32_bf16 v[96:99], a[132:135], v[36:39], v[96:99]
  v_mfma_f32_16x16x32_bf16 v[96:99], a[136:139], v[40:43], v[96:99]
  s_waitcnt lgkmcnt(1)
  v_mfma_f32_16x16x32_bf16 v[96:99], a[140:143], v[44:47], v[96:99]
  s_nop 1
  v_cvt_pk_bf16_f32 v210, v176, v177
  v_cvt_pk_bf16_f32 v211, v178, v179
  v_mfma_f32_16x16x32_bf16 v[100:103], a[140:143], v[60:63], v[228:231]
  v_cvt_pk_bf16_f32 v212, v212, v213
  v_cvt_pk_bf16_f32 v213, v214, v215
  v_mfma_f32_16x16x32_bf16 v[100:103], a[136:139], v[56:59], v[100:103]
  v_cvt_pk_bf16_f32 v214, v180, v181
  v_cvt_pk_bf16_f32 v215, v182, v183
  v_mfma_f32_16x16x32_bf16 v[100:103], a[132:135], v[52:55], v[100:103]
  v_cvt_pk_bf16_f32 v216, v216, v217
  v_cvt_pk_bf16_f32 v217, v218, v219
  v_mfma_f32_16x16x32_bf16 v[100:103], a[128:131], v[48:51], v[100:103]
  v_cvt_pk_bf16_f32 v218, v184, v185
  v_cvt_pk_bf16_f32 v219, v186, v187
  v_mfma_f32_16x16x32_bf16 v[104:107], a[128:131], v[64:67], v[232:235]
  v_cvt_pk_bf16_f32 v220, v220, v221
  v_cvt_pk_bf16_f32 v221, v222, v223
  v_mfma_f32_16x16x32_bf16 v[104:107], a[132:135], v[68:71], v[104:107]
  v_cvt_pk_bf16_f32 v222, v188, v189
  v_cvt_pk_bf16_f32 v223, v190, v191
  v_mfma_f32_16x16x32_bf16 v[104:107], a[136:139], v[72:75], v[104:107]
  s_xor_b32 s90, s21, 0x812800
  v_exp_f32 v96, v96
  v_mfma_f32_16x16x32_bf16 v[104:107], a[140:143], v[76:79], v[104:107]
  buffer_store_dwordx4 v[152:155], v1, s[60:63], s90 offen sc1
  v_mfma_f32_16x16x32_bf16 v[108:111], a[140:143], v[92:95], v[236:239]
  v_exp_f32 v97, v97
  v_mfma_f32_16x16x32_bf16 v[108:111], a[136:139], v[88:91], v[108:111]
  v_exp_f32 v98, v98
  v_mfma_f32_16x16x32_bf16 v[108:111], a[132:135], v[84:87], v[108:111]
  v_exp_f32 v99, v99
  v_mfma_f32_16x16x32_bf16 v[108:111], a[128:131], v[80:83], v[108:111]
  v_exp_f32 v100, v100
  v_mfma_f32_16x16x32_bf16 v[124:127], a[144:147], v[80:83], v[236:239]
  v_exp_f32 v101, v101
  v_mfma_f32_16x16x32_bf16 v[124:127], a[148:151], v[84:87], v[124:127]
  v_exp_f32 v102, v102
  v_mfma_f32_16x16x32_bf16 v[124:127], a[152:155], v[88:91], v[124:127]
  v_exp_f32 v103, v103
  v_mfma_f32_16x16x32_bf16 v[124:127], a[156:159], v[92:95], v[124:127]
  v_exp_f32 v104, v104
  v_mfma_f32_16x16x32_bf16 v[120:123], a[156:159], v[76:79], v[232:235]
  v_exp_f32 v105, v105
  v_mfma_f32_16x16x32_bf16 v[120:123], a[152:155], v[72:75], v[120:123]
  v_exp_f32 v106, v106
  v_mfma_f32_16x16x32_bf16 v[120:123], a[148:151], v[68:71], v[120:123]
  v_exp_f32 v107, v107
  v_mfma_f32_16x16x32_bf16 v[120:123], a[144:147], v[64:67], v[120:123]
  v_exp_f32 v108, v108
  v_mfma_f32_16x16x32_bf16 v[116:119], a[144:147], v[48:51], v[228:231]
  v_exp_f32 v109, v109
  v_mfma_f32_16x16x32_bf16 v[116:119], a[148:151], v[52:55], v[116:119]
  v_exp_f32 v110, v110
  v_mfma_f32_16x16x32_bf16 v[116:119], a[152:155], v[56:59], v[116:119]
  s_xor_b32 s91, s21, 0xc12c00
  v_exp_f32 v111, v111
  v_mfma_f32_16x16x32_bf16 v[116:119], a[156:159], v[60:63], v[116:119]
  buffer_store_dwordx4 v[156:159], v1, s[60:63], s91 offen sc1
  v_mfma_f32_16x16x32_bf16 v[112:115], a[156:159], v[44:47], v[224:227]
  v_exp_f32 v124, v124
  v_mfma_f32_16x16x32_bf16 v[112:115], a[152:155], v[40:43], v[112:115]
  v_exp_f32 v125, v125
  v_mfma_f32_16x16x32_bf16 v[112:115], a[148:151], v[36:39], v[112:115]
  v_exp_f32 v126, v126
  v_mfma_f32_16x16x32_bf16 v[112:115], a[144:147], v[32:35], v[112:115]
  v_exp_f32 v127, v127
  v_mfma_f32_16x16x32_bf16 v[128:131], a[160:163], v[32:35], v[224:227]
  v_exp_f32 v120, v120
  v_mfma_f32_16x16x32_bf16 v[128:131], a[164:167], v[36:39], v[128:131]
  v_exp_f32 v121, v121
  v_mfma_f32_16x16x32_bf16 v[128:131], a[168:171], v[40:43], v[128:131]
  v_exp_f32 v122, v122
  v_mfma_f32_16x16x32_bf16 v[128:131], a[172:175], v[44:47], v[128:131]
  v_exp_f32 v123, v123
  v_mfma_f32_16x16x32_bf16 v[132:135], a[172:175], v[60:63], v[228:231]
  v_exp_f32 v116, v116
  v_mfma_f32_16x16x32_bf16 v[132:135], a[168:171], v[56:59], v[132:135]
  s_waitcnt vmcnt(9) lgkmcnt(0)
  s_barrier
  v_mfma_f32_16x16x32_bf16 v[132:135], a[164:167], v[52:55], v[132:135]
  v_exp_f32 v117, v117
  v_mfma_f32_16x16x32_bf16 v[132:135], a[160:163], v[48:51], v[132:135]
  ds_read_b128 a[128:131], v14
  v_cvt_pk_bf16_f32 v160, v96, v97
  v_cvt_pk_bf16_f32 v170, v116, v117
  v_mfma_f32_16x16x32_bf16 v[136:139], a[160:163], v[64:67], v[232:235]
  v_exp_f32 v118, v118
  v_mfma_f32_16x16x32_bf16 v[136:139], a[164:167], v[68:71], v[136:139]
  ds_read_b128 a[132:135], v15
  v_cvt_pk_bf16_f32 v161, v98, v99
  v_mfma_f32_16x16x32_bf16 v[136:139], a[168:171], v[72:75], v[136:139]
  s_xor_b32 s90, s21, 0x1011000
  v_exp_f32 v119, v119
  v_mfma_f32_16x16x32_bf16 v[136:139], a[172:175], v[76:79], v[136:139]
  buffer_store_dwordx4 v[192:195], v1, s[60:63], s90 offen sc1
  v_cvt_pk_bf16_f32 v171, v118, v119
  v_mfma_f32_16x16x32_bf16 v[140:143], a[172:175], v[92:95], v[236:239]
  ds_read_b128 a[136:139], v16
  v_cvt_pk_bf16_f32 v168, v100, v101
  v_mfma_f32_16x16x32_bf16 v[140:143], a[168:171], v[88:91], v[140:143]
  ds_read_b128 a[140:143], v17
  v_cvt_pk_bf16_f32 v169, v102, v103
  v_mfma_f32_16x16x32_bf16 v[140:143], a[164:167], v[84:87], v[140:143]
  v_exp_f32 v112, v112
  v_mfma_f32_16x16x32_bf16 v[140:143], a[160:163], v[80:83], v[140:143]
  ds_read_b128 a[144:147], v14 offset:1024
  v_cvt_pk_bf16_f32 v176, v104, v105
  v_mfma_f32_16x16x32_bf16 v[156:159], a[176:179], v[80:83], v[236:239]
  v_exp_f32 v113, v113
  v_mfma_f32_16x16x32_bf16 v[156:159], a[180:183], v[84:87], v[156:159]
  ds_read_b128 a[148:151], v15 offset:1024
  v_cvt_pk_bf16_f32 v177, v106, v107
  v_cvt_pk_bf16_f32 v162, v112, v113
  v_mfma_f32_16x16x32_bf16 v[156:159], a[184:187], v[88:91], v[156:159]
  v_exp_f32 v114, v114
  v_mfma_f32_16x16x32_bf16 v[156:159], a[188:191], v[92:95], v[156:159]
  ds_read_b128 a[152:155], v16 offset:1024
  v_cvt_pk_bf16_f32 v184, v108, v109
  v_mfma_f32_16x16x32_bf16 v[152:155], a[188:191], v[76:79], v[232:235]
  s_add_u32 s83, s83, 0x4000
  v_exp_f32 v115, v115
  v_mfma_f32_16x16x32_bf16 v[152:155], a[184:187], v[72:75], v[152:155]
  s_and_b32 s83, s83, 0x7ffff
  ds_read_b128 a[156:159], v17 offset:1024
  v_cvt_pk_bf16_f32 v185, v110, v111
  v_cvt_pk_bf16_f32 v163, v114, v115
  v_mfma_f32_16x16x32_bf16 v[152:155], a[180:183], v[68:71], v[152:155]
  s_add_u32 m0, s85, 0x8000
  v_exp_f32 v128, v128
  v_mfma_f32_16x16x32_bf16 v[152:155], a[176:179], v[64:67], v[152:155]
  buffer_load_dwordx4 v26, s[36:39], s83 offen lds
  v_mfma_f32_16x16x32_bf16 v[148:151], a[176:179], v[48:51], v[228:231]
  v_exp_f32 v129, v129
  v_mfma_f32_16x16x32_bf16 v[148:151], a[180:183], v[52:55], v[148:151]
  ds_read_b128 a[160:163], v14 offset:2048
  v_cvt_pk_bf16_f32 v186, v124, v125
  v_cvt_pk_bf16_f32 v164, v128, v129
  v_mfma_f32_16x16x32_bf16 v[148:151], a[184:187], v[56:59], v[148:151]
  v_exp_f32 v130, v130
  v_mfma_f32_16x16x32_bf16 v[148:151], a[188:191], v[60:63], v[148:151]
  ds_read_b128 a[164:167], v15 offset:2048
  v_cvt_pk_bf16_f32 v187, v126, v127
  v_mfma_f32_16x16x32_bf16 v[144:147], a[188:191], v[44:47], v[224:227]
  v_exp_f32 v131, v131
  v_mfma_f32_16x16x32_bf16 v[144:147], a[184:187], v[40:43], v[144:147]
  buffer_load_dwordx4 v26, s[36:39], s83 offen offset:1024 lds
  v_cvt_pk_bf16_f32 v165, v130, v131
  v_mfma_f32_16x16x32_bf16 v[144:147], a[180:183], v[36:39], v[144:147]
  v_exp_f32 v132, v132
  v_exp_f32 v133, v133
  v_exp_f32 v134, v134
  v_exp_f32 v135, v135
  v_exp_f32 v136, v136
  v_exp_f32 v137, v137
  v_exp_f32 v138, v138
  v_exp_f32 v139, v139
  v_exp_f32 v140, v140
  v_exp_f32 v141, v141
  v_mfma_f32_16x16x32_bf16 v[144:147], a[176:179], v[32:35], v[144:147]
  v_cvt_pk_bf16_f32 v178, v120, v121
  v_cvt_pk_bf16_f32 v179, v122, v123
  v_cvt_pk_bf16_f32 v172, v132, v133
  v_cvt_pk_bf16_f32 v173, v134, v135
  v_cvt_pk_bf16_f32 v180, v136, v137
  v_cvt_pk_bf16_f32 v181, v138, v139
  s_branch L_it0
L_wideend:
L_t40:
  v_bfe_u32 v242, v1, 7, 2
  v_lshlrev_b32 v242, 13, v242
  v_and_b32 v243, 0x70, v1
  v_lshl_add_u32 v242, v243, 3, v242
  s_xor_b32 s68, s31, 31
  s_lshl_b32 s68, s68, 17
  s_lshl_b32 s69, s30, 10
  s_add_u32 s68, s68, s69
  s_lshl_b32 s69, s3, 15
  s_add_u32 s68, s68, s69
  buffer_load_dword v244, v242, s[44:47], s68 offen
  v_min_u32 v243, 0xf0, v1
  v_lshlrev_b32 v243, 3, v243
  s_lshl_b32 s68, s31, 2
  s_add_u32 s68, s68, s3
  s_mul_i32 s68, s68, 0x800
  s_add_u32 s68, s68, s88
  buffer_load_dword v244, v243, s[52:55], s68 offen
  s_branch L_r40
L_t41:
  v_bfe_u32 v242, v1, 7, 2
  v_lshlrev_b32 v242, 13, v242
  v_and_b32 v243, 0x70, v1
  v_lshl_add_u32 v242, v243, 3, v242
  s_xor_b32 s68, s31, 31
  s_lshl_b32 s68, s68, 17
  s_lshl_b32 s69, s30, 10
  s_add_u32 s68, s68, s69
  s_lshl_b32 s69, s3, 15
  s_add_u32 s68, s68, s69
  buffer_load_dword v244, v242, s[44:47], s68 offen
  v_min_u32 v243, 0xf0, v1
  v_lshlrev_b32 v243, 3, v243
  s_lshl_b32 s68, s31, 2
  s_add_u32 s68, s68, s3
  s_mul_i32 s68, s68, 0x800
  s_add_u32 s68, s68, s88
  buffer_load_dword v244, v243, s[52:55], s68 offen
  s_branch L_r41
L_t42:
  v_bfe_u32 v242, v1, 7, 2
  v_lshlrev_b32 v242, 13, v242
  v_and_b32 v243, 0x70, v1
  v_lshl_add_u32 v242, v243, 3, v242
  s_xor_b32 s68, s31, 31
  s_lshl_b32 s68, s68, 17
  s_lshl_b32 s69, s30, 10
  s_add_u32 s68, s68, s69
  s_lshl_b32 s69, s3, 15
  s_add_u32 s68, s68, s69
  buffer_load_dword v244, v242, s[44:47], s68 offen
  v_min_u32 v243, 0xf0, v1
  v_lshlrev_b32 v243, 3, v243
  s_lshl_b32 s68, s31, 2
  s_add_u32 s68, s68, s3
  s_mul_i32 s68, s68, 0x800
  s_add_u32 s68, s68, s88
  buffer_load_dword v244, v243, s[52:55], s68 offen
  s_branch L_r42
L_t43:
  v_bfe_u32 v242, v1, 7, 2
  v_lshlrev_b32 v242, 13, v242
  v_and_b32 v243, 0x70, v1
  v_lshl_add_u32 v242, v243, 3, v242
  s_xor_b32 s68, s31, 31
  s_lshl_b32 s68, s68, 17
  s_lshl_b32 s69, s30, 10
  s_add_u32 s68, s68, s69
  s_lshl_b32 s69, s3, 15
  s_add_u32 s68, s68, s69
  buffer_load_dword v244, v242, s[44:47], s68 offen
  v_min_u32 v243, 0xf0, v1
  v_lshlrev_b32 v243, 3, v243
  s_lshl_b32 s68, s31, 2
  s_add_u32 s68, s68, s3
  s_mul_i32 s68, s68, 0x800
  s_add_u32 s68, s68, s88
  buffer_load_dword v244, v243, s[52:55], s68 offen
  s_branch L_r43
L_t44:
  v_bfe_u32 v242, v1, 7, 2
  v_lshlrev_b32 v242, 13, v242
  v_and_b32 v243, 0x70, v1
  v_lshl_add_u32 v242, v243, 3, v242
  s_xor_b32 s68, s31, 31
  s_lshl_b32 s68, s68, 17
  s_lshl_b32 s69, s30, 10
  s_add_u32 s68, s68, s69
  s_lshl_b32 s69, s3, 15
  s_add_u32 s68, s68, s69
  buffer_load_dword v244, v242, s[44:47], s68 offen
  v_min_u32 v243, 0xf0, v1
  v_lshlrev_b32 v243, 3, v243
  s_lshl_b32 s68, s31, 2
  s_add_u32 s68, s68, s3
  s_mul_i32 s68, s68, 0x800
  s_add_u32 s68, s68, s88
  buffer_load_dword v244, v243, s[52:55], s68 offen
  s_branch L_r44
L_t45:
  v_bfe_u32 v242, v1, 7, 2
  v_lshlrev_b32 v242, 13, v242
  v_and_b32 v243, 0x70, v1
  v_lshl_add_u32 v242, v243, 3, v242
  s_xor_b32 s68, s31, 31
  s_lshl_b32 s68, s68, 17
  s_lshl_b32 s69, s30, 10
  s_add_u32 s68, s68, s69
  s_lshl_b32 s69, s3, 15
  s_add_u32 s68, s68, s69
  buffer_load_dword v244, v242, s[44:47], s68 offen
  v_min_u32 v243, 0xf0, v1
  v_lshlrev_b32 v243, 3, v243
  s_lshl_b32 s68, s31, 2
  s_add_u32 s68, s68, s3
  s_mul_i32 s68, s68, 0x800
  s_add_u32 s68, s68, s88
  buffer_load_dword v244, v243, s[52:55], s68 offen
  s_branch L_r45
L_t46:
  v_bfe_u32 v242, v1, 7, 2
  v_lshlrev_b32 v242, 13, v242
  v_and_b32 v243, 0x70, v1
  v_lshl_add_u32 v242, v243, 3, v242
  s_xor_b32 s68, s31, 31
  s_lshl_b32 s68, s68, 17
  s_lshl_b32 s69, s30, 10
  s_add_u32 s68, s68, s69
  s_lshl_b32 s69, s3, 15
  s_add_u32 s68, s68, s69
  buffer_load_dword v244, v242, s[44:47], s68 offen
  v_min_u32 v243, 0xf0, v1
  v_lshlrev_b32 v243, 3, v243
  s_lshl_b32 s68, s31, 2
  s_add_u32 s68, s68, s3
  s_mul_i32 s68, s68, 0x800
  s_add_u32 s68, s68, s88
  buffer_load_dword v244, v243, s[52:55], s68 offen
  s_branch L_r46
L_t47:
  v_bfe_u32 v242, v1, 7, 2
  v_lshlrev_b32 v242, 13, v242
  v_and_b32 v243, 0x70, v1
  v_lshl_add_u32 v242, v243, 3, v242
  s_xor_b32 s68, s31, 31
  s_lshl_b32 s68, s68, 17
  s_lshl_b32 s69, s30, 10
  s_add_u32 s68, s68, s69
  s_lshl_b32 s69, s3, 15
  s_add_u32 s68, s68, s69
  buffer_load_dword v244, v242, s[44:47], s68 offen
  v_min_u32 v243, 0xf0, v1
  v_lshlrev_b32 v243, 3, v243
  s_lshl_b32 s68, s31, 2
  s_add_u32 s68, s68, s3
  s_mul_i32 s68, s68, 0x800
  s_add_u32 s68, s68, s88
  buffer_load_dword v244, v243, s[52:55], s68 offen
  s_branch L_r47
L_t48:
  v_bfe_u32 v242, v1, 7, 2
  v_lshlrev_b32 v242, 13, v242
  v_and_b32 v243, 0x70, v1
  v_lshl_add_u32 v242, v243, 3, v242
  s_xor_b32 s68, s31, 31
  s_lshl_b32 s68, s68, 17
  s_lshl_b32 s69, s30, 10
  s_add_u32 s68, s68, s69
  s_lshl_b32 s69, s3, 15
  s_add_u32 s68, s68, s69
  buffer_load_dword v244, v242, s[44:47], s68 offen
  v_min_u32 v243, 0xf0, v1
  v_lshlrev_b32 v243, 3, v243
  s_lshl_b32 s68, s31, 2
  s_add_u32 s68, s68, s3
  s_mul_i32 s68, s68, 0x800
  s_add_u32 s68, s68, s88
  buffer_load_dword v244, v243, s[52:55], s68 offen
  s_branch L_r48
L_t49:
  v_bfe_u32 v242, v1, 7, 2
  v_lshlrev_b32 v242, 13, v242
  v_and_b32 v243, 0x70, v1
  v_lshl_add_u32 v242, v243, 3, v242
  s_xor_b32 s68, s31, 31
  s_lshl_b32 s68, s68, 17
  s_lshl_b32 s69, s30, 10
  s_add_u32 s68, s68, s69
  s_lshl_b32 s69, s3, 15
  s_add_u32 s68, s68, s69
  buffer_load_dword v244, v242, s[44:47], s68 offen
  v_min_u32 v243, 0xf0, v1
  v_lshlrev_b32 v243, 3, v243
  s_lshl_b32 s68, s31, 2
  s_add_u32 s68, s68, s3
  s_mul_i32 s68, s68, 0x800
  s_add_u32 s68, s68, s88
  buffer_load_dword v244, v243, s[52:55], s68 offen
  s_branch L_r49
L_t410:
  v_bfe_u32 v242, v1, 7, 2
  v_lshlrev_b32 v242, 13, v242
  v_and_b32 v243, 0x70, v1
  v_lshl_add_u32 v242, v243, 3, v242
  s_xor_b32 s68, s31, 31
  s_lshl_b32 s68, s68, 17
  s_lshl_b32 s69, s30, 10
  s_add_u32 s68, s68, s69
  s_lshl_b32 s69, s3, 15
  s_add_u32 s68, s68, s69
  buffer_load_dword v244, v242, s[44:47], s68 offen
  v_min_u32 v243, 0xf0, v1
  v_lshlrev_b32 v243, 3, v243
  s_lshl_b32 s68, s31, 2
  s_add_u32 s68, s68, s3
  s_mul_i32 s68, s68, 0x800
  s_add_u32 s68, s68, s88
  buffer_load_dword v244, v243, s[52:55], s68 offen
  s_branch L_r410
L_t411:
  v_bfe_u32 v242, v1, 7, 2
  v_lshlrev_b32 v242, 13, v242
  v_and_b32 v243, 0x70, v1
  v_lshl_add_u32 v242, v243, 3, v242
  s_xor_b32 s68, s31, 31
  s_lshl_b32 s68, s68, 17
  s_lshl_b32 s69, s30, 10
  s_add_u32 s68, s68, s69
  s_lshl_b32 s69, s3, 15
  s_add_u32 s68, s68, s69
  buffer_load_dword v244, v242, s[44:47], s68 offen
  v_min_u32 v243, 0xf0, v1
  v_lshlrev_b32 v243, 3, v243
  s_lshl_b32 s68, s31, 2
  s_add_u32 s68, s68, s3
  s_mul_i32 s68, s68, 0x800
  s_add_u32 s68, s68, s88
  buffer_load_dword v244, v243, s[52:55], s68 offen
  s_branch L_r411
L_t412:
  v_bfe_u32 v242, v1, 7, 2
  v_lshlrev_b32 v242, 13, v242
  v_and_b32 v243, 0x70, v1
  v_lshl_add_u32 v242, v243, 3, v242
  s_xor_b32 s68, s31, 31
  s_lshl_b32 s68, s68, 17
  s_lshl_b32 s69, s30, 10
  s_add_u32 s68, s68, s69
  s_lshl_b32 s69, s3, 15
  s_add_u32 s68, s68, s69
  buffer_load_dword v244, v242, s[44:47], s68 offen
  v_min_u32 v243, 0xf0, v1
  v_lshlrev_b32 v243, 3, v243
  s_lshl_b32 s68, s31, 2
  s_add_u32 s68, s68, s3
  s_mul_i32 s68, s68, 0x800
  s_add_u32 s68, s68, s88
  buffer_load_dword v244, v243, s[52:55], s68 offen
  s_branch L_r412
L_t413:
  v_bfe_u32 v242, v1, 7, 2
  v_lshlrev_b32 v242, 13, v242
  v_and_b32 v243, 0x70, v1
  v_lshl_add_u32 v242, v243, 3, v242
  s_xor_b32 s68, s31, 31
  s_lshl_b32 s68, s68, 17
  s_lshl_b32 s69, s30, 10
  s_add_u32 s68, s68, s69
  s_lshl_b32 s69, s3, 15
  s_add_u32 s68, s68, s69
  buffer_load_dword v244, v242, s[44:47], s68 offen
  v_min_u32 v243, 0xf0, v1
  v_lshlrev_b32 v243, 3, v243
  s_lshl_b32 s68, s31, 2
  s_add_u32 s68, s68, s3
  s_mul_i32 s68, s68, 0x800
  s_add_u32 s68, s68, s88
  buffer_load_dword v244, v243, s[52:55], s68 offen
  s_branch L_r413
L_t414:
  v_bfe_u32 v242, v1, 7, 2
  v_lshlrev_b32 v242, 13, v242
  v_and_b32 v243, 0x70, v1
  v_lshl_add_u32 v242, v243, 3, v242
  s_xor_b32 s68, s31, 31
  s_lshl_b32 s68, s68, 17
  s_lshl_b32 s69, s30, 10
  s_add_u32 s68, s68, s69
  s_lshl_b32 s69, s3, 15
  s_add_u32 s68, s68, s69
  buffer_load_dword v244, v242, s[44:47], s68 offen
  v_min_u32 v243, 0xf0, v1
  v_lshlrev_b32 v243, 3, v243
  s_lshl_b32 s68, s31, 2
  s_add_u32 s68, s68, s3
  s_mul_i32 s68, s68, 0x800
  s_add_u32 s68, s68, s88
  buffer_load_dword v244, v243, s[52:55], s68 offen
  s_branch L_r414
L_t415:
  v_bfe_u32 v242, v1, 7, 2
  v_lshlrev_b32 v242, 13, v242
  v_and_b32 v243, 0x70, v1
  v_lshl_add_u32 v242, v243, 3, v242
  s_xor_b32 s68, s31, 31
  s_lshl_b32 s68, s68, 17
  s_lshl_b32 s69, s30, 10
  s_add_u32 s68, s68, s69
  s_lshl_b32 s69, s3, 15
  s_add_u32 s68, s68, s69
  buffer_load_dword v244, v242, s[44:47], s68 offen
  v_min_u32 v243, 0xf0, v1
  v_lshlrev_b32 v243, 3, v243
  s_lshl_b32 s68, s31, 2
  s_add_u32 s68, s68, s3
  s_mul_i32 s68, s68, 0x800
  s_add_u32 s68, s68, s88
  buffer_load_dword v244, v243, s[52:55], s68 offen
  s_branch L_r415
L_cntwait:
  s_mov_b32 s16, 0x100000
L_cnt1:
  buffer_load_dword v10, v7, s[48:51], s11 offen sc1
  s_waitcnt vmcnt(0)
  v_readfirstlane_b32 s71, v10
  s_nop 1
  s_cmp_ge_u32 s71, 8
  s_cbranch_scc1 L_cntok
  s_sub_u32 s16, s16, 1
  s_cbranch_scc0 L_cnt1
  s_branch L_cntok
L_slow:
  s_waitcnt vmcnt(0) lgkmcnt(0)
  s_mov_b32 s87, -1
  s_mov_b32 s86, 0
  s_mov_b32 s83, s94
  v_mov_b32 v160, 0xff800000
  v_mov_b32 v161, 0xff800000
  v_mov_b32 v162, 0xff800000
  v_mov_b32 v163, 0xff800000
  v_mov_b32 v224, 0
  v_mov_b32 v225, 0
  v_mov_b32 v226, 0
  v_mov_b32 v227, 0
  v_mov_b32 v228, 0
  v_mov_b32 v229, 0
  v_mov_b32 v230, 0
  v_mov_b32 v231, 0
  v_mov_b32 v232, 0
  v_mov_b32 v233, 0
  v_mov_b32 v234, 0
  v_mov_b32 v235, 0
  v_mov_b32 v236, 0
  v_mov_b32 v237, 0
  v_mov_b32 v238, 0
  v_mov_b32 v239, 0
L_max:
  s_barrier
  s_add_u32 s83, s83, 0x4000
  s_and_b32 s83, s83, 0x7ffff
  s_add_u32 m0, s85, 0x8000
  s_nop 0
  buffer_load_dwordx4 v26, s[36:39], s83 offen lds
  buffer_load_dwordx4 v26, s[36:39], s83 offen offset:1024 lds
  buffer_load_dwordx4 v26, s[36:39], s83 offen offset:2048 lds
  buffer_load_dwordx4 v26, s[36:39], s83 offen offset:3072 lds
  s_waitcnt vmcnt(0)
  s_barrier
  ds_read_b128 a[128:131], v14 offset:32768
  ds_read_b128 a[132:135], v15 offset:32768
  ds_read_b128 a[136:139], v16 offset:32768
  ds_read_b128 a[140:143], v17 offset:32768
  ds_read_b128 a[144:147], v14 offset:33792
  ds_read_b128 a[148:151], v15 offset:33792
  ds_read_b128 a[152:155], v16 offset:33792
  ds_read_b128 a[156:159], v17 offset:33792
  ds_read_b128 a[160:163], v14 offset:34816
  ds_read_b128 a[164:167], v15 offset:34816
  ds_read_b128 a[168:171], v16 offset:34816
  ds_read_b128 a[172:175], v17 offset:34816
  ds_read_b128 a[176:179], v14 offset:35840
  ds_read_b128 a[180:183], v15 offset:35840
  ds_read_b128 a[184:187], v16 offset:35840
  ds_read_b128 a[188:191], v17 offset:35840
  s_waitcnt lgkmcnt(14)
  v_mfma_f32_16x16x32_bf16 v[96:99], a[128:131], v[32:35], v[224:227]
  s_waitcnt lgkmcnt(14)
  v_mfma_f32_16x16x32_bf16 v[96:99], a[132:135], v[36:39], v[96:99]
  s_waitcnt lgkmcnt(13)
  v_mfma_f32_16x16x32_bf16 v[96:99], a[136:139], v[40:43], v[96:99]
  s_waitcnt lgkmcnt(12)
  v_mfma_f32_16x16x32_bf16 v[96:99], a[140:143], v[44:47], v[96:99]
  v_mfma_f32_16x16x32_bf16 v[100:103], a[140:143], v[60:63], v[228:231]
  v_mfma_f32_16x16x32_bf16 v[100:103], a[136:139], v[56:59], v[100:103]
  v_mfma_f32_16x16x32_bf16 v[100:103], a[132:135], v[52:55], v[100:103]
  v_mfma_f32_16x16x32_bf16 v[100:103], a[128:131], v[48:51], v[100:103]
  v_mfma_f32_16x16x32_bf16 v[104:107], a[128:131], v[64:67], v[232:235]
  v_mfma_f32_16x16x32_bf16 v[104:107], a[132:135], v[68:71], v[104:107]
  v_mfma_f32_16x16x32_bf16 v[104:107], a[136:139], v[72:75], v[104:107]
  v_mfma_f32_16x16x32_bf16 v[104:107], a[140:143], v[76:79], v[104:107]
  v_mfma_f32_16x16x32_bf16 v[108:111], a[140:143], v[92:95], v[236:239]
  v_mfma_f32_16x16x32_bf16 v[108:111], a[136:139], v[88:91], v[108:111]
  v_mfma_f32_16x16x32_bf16 v[108:111], a[132:135], v[84:87], v[108:111]
  v_mfma_f32_16x16x32_bf16 v[108:111], a[128:131], v[80:83], v[108:111]
  s_waitcnt lgkmcnt(9)
  v_mfma_f32_16x16x32_bf16 v[124:127], a[144:147], v[80:83], v[236:239]
  v_mfma_f32_16x16x32_bf16 v[124:127], a[148:151], v[84:87], v[124:127]
  v_mfma_f32_16x16x32_bf16 v[124:127], a[152:155], v[88:91], v[124:127]
  s_waitcnt lgkmcnt(6)
  v_mfma_f32_16x16x32_bf16 v[124:127], a[156:159], v[92:95], v[124:127]
  v_mfma_f32_16x16x32_bf16 v[120:123], a[156:159], v[76:79], v[232:235]
  v_mfma_f32_16x16x32_bf16 v[120:123], a[152:155], v[72:75], v[120:123]
  v_mfma_f32_16x16x32_bf16 v[120:123], a[148:151], v[68:71], v[120:123]
  v_mfma_f32_16x16x32_bf16 v[120:123], a[144:147], v[64:67], v[120:123]
  v_mfma_f32_16x16x32_bf16 v[116:119], a[144:147], v[48:51], v[228:231]
  v_mfma_f32_16x16x32_bf16 v[116:119], a[148:151], v[52:55], v[116:119]
  v_mfma_f32_16x16x32_bf16 v[116:119], a[152:155], v[56:59], v[116:119]
  v_mfma_f32_16x16x32_bf16 v[116:119], a[156:159], v[60:63], v[116:119]
  v_mfma_f32_16x16x32_bf16 v[112:115], a[156:159], v[44:47], v[224:227]
  v_mfma_f32_16x16x32_bf16 v[112:115], a[152:155], v[40:43], v[112:115]
  v_mfma_f32_16x16x32_bf16 v[112:115], a[148:151], v[36:39], v[112:115]
  v_mfma_f32_16x16x32_bf16 v[112:115], a[144:147], v[32:35], v[112:115]
  v_mfma_f32_16x16x32_bf16 v[128:131], a[160:163], v[32:35], v[224:227]
  v_mfma_f32_16x16x32_bf16 v[128:131], a[164:167], v[36:39], v[128:131]
  s_waitcnt lgkmcnt(0)
  v_mfma_f32_16x16x32_bf16 v[128:131], a[168:171], v[40:43], v[128:131]
  v_mfma_f32_16x16x32_bf16 v[128:131], a[172:175], v[44:47], v[128:131]
  v_mfma_f32_16x16x32_bf16 v[132:135], a[172:175], v[60:63], v[228:231]
  v_mfma_f32_16x16x32_bf16 v[132:135], a[168:171], v[56:59], v[132:135]
  v_mfma_f32_16x16x32_bf16 v[132:135], a[164:167], v[52:55], v[132:135]
  v_mfma_f32_16x16x32_bf16 v[132:135], a[160:163], v[48:51], v[132:135]
  v_mfma_f32_16x16x32_bf16 v[136:139], a[160:163], v[64:67], v[232:235]
  v_mfma_f32_16x16x32_bf16 v[136:139], a[164:167], v[68:71], v[136:139]
  v_mfma_f32_16x16x32_bf16 v[136:139], a[168:171], v[72:75], v[136:139]
  v_mfma_f32_16x16x32_bf16 v[136:139], a[172:175], v[76:79], v[136:139]
  v_mfma_f32_16x16x32_bf16 v[140:143], a[172:175], v[92:95], v[236:239]
  v_mfma_f32_16x16x32_bf16 v[140:143], a[168:171], v[88:91], v[140:143]
  v_mfma_f32_16x16x32_bf16 v[140:143], a[164:167], v[84:87], v[140:143]
  v_mfma_f32_16x16x32_bf16 v[140:143], a[160:163], v[80:83], v[140:143]
  v_mfma_f32_16x16x32_bf16 v[156:159], a[176:179], v[80:83], v[236:239]
  v_mfma_f32_16x16x32_bf16 v[156:159], a[180:183], v[84:87], v[156:159]
  v_mfma_f32_16x16x32_bf16 v[156:159], a[184:187], v[88:91], v[156:159]
  v_mfma_f32_16x16x32_bf16 v[156:159], a[188:191], v[92:95], v[156:159]
  v_mfma_f32_16x16x32_bf16 v[152:155], a[188:191], v[76:79], v[232:235]
  v_mfma_f32_16x16x32_bf16 v[152:155], a[184:187], v[72:75], v[152:155]
  v_mfma_f32_16x16x32_bf16 v[152:155], a[180:183], v[68:71], v[152:155]
  v_mfma_f32_16x16x32_bf16 v[152:155], a[176:179], v[64:67], v[152:155]
  v_mfma_f32_16x16x32_bf16 v[148:151], a[176:179], v[48:51], v[228:231]
  v_mfma_f32_16x16x32_bf16 v[148:151], a[180:183], v[52:55], v[148:151]
  v_mfma_f32_16x16x32_bf16 v[148:151], a[184:187], v[56:59], v[148:151]
  v_mfma_f32_16x16x32_bf16 v[148:151], a[188:191], v[60:63], v[148:151]
  v_mfma_f32_16x16x32_bf16 v[144:147], a[188:191], v[44:47], v[224:227]
  v_mfma_f32_16x16x32_bf16 v[144:147], a[184:187], v[40:43], v[144:147]
  v_mfma_f32_16x16x32_bf16 v[144:147], a[180:183], v[36:39], v[144:147]
  v_mfma_f32_16x16x32_bf16 v[144:147], a[176:179], v[32:35], v[144:147]
  v_max3_f32 v160, v96, v97, v160
  v_max3_f32 v160, v98, v99, v160
  v_max3_f32 v161, v100, v101, v161
  v_max3_f32 v161, v102, v103, v161
  v_max3_f32 v162, v104, v105, v162
  v_max3_f32 v162, v106, v107, v162
  v_max3_f32 v163, v108, v109, v163
  v_max3_f32 v163, v110, v111, v163
  v_max3_f32 v160, v112, v113, v160
  v_max3_f32 v160, v114, v115, v160
  v_max3_f32 v161, v116, v117, v161
  v_max3_f32 v161, v118, v119, v161
  v_max3_f32 v162, v120, v121, v162
  v_max3_f32 v162, v122, v123, v162
  v_max3_f32 v163, v124, v125, v163
  v_max3_f32 v163, v126, v127, v163
  v_max3_f32 v160, v128, v129, v160
  v_max3_f32 v160, v130, v131, v160
  v_max3_f32 v161, v132, v133, v161
  v_max3_f32 v161, v134, v135, v161
  v_max3_f32 v162, v136, v137, v162
  v_max3_f32 v162, v138, v139, v162
  v_max3_f32 v163, v140, v141, v163
  v_max3_f32 v163, v142, v143, v163
  v_max3_f32 v160, v144, v145, v160
  v_max3_f32 v160, v146, v147, v160
  v_max3_f32 v161, v148, v149, v161
  v_max3_f32 v161, v150, v151, v161
  v_max3_f32 v162, v152, v153, v162
  v_max3_f32 v162, v154, v155, v162
  v_max3_f32 v163, v156, v157, v163
  v_max3_f32 v163, v158, v159, v163
  s_add_u32 s86, s86, 1
  s_cmp_lt_u32 s86, 32
  s_cbranch_scc1 L_max
  v_mov_b32 v164, v160
  s_nop 1
  v_permlane32_swap_b32 v160, v164
  v_max_f32 v160, v160, v164
  v_mov_b32 v164, v160
  s_nop 1
  v_permlane16_swap_b32 v160, v164
  v_max_f32 v160, v160, v164
  v_sub_f32 v224, 0, v160
  v_sub_f32 v225, 0, v160
  v_sub_f32 v226, 0, v160
  v_sub_f32 v227, 0, v160
  v_mov_b32 v164, v161
  s_nop 1
  v_permlane32_swap_b32 v161, v164
  v_max_f32 v161, v161, v164
  v_mov_b32 v164, v161
  s_nop 1
  v_permlane16_swap_b32 v161, v164
  v_max_f32 v161, v161, v164
  v_sub_f32 v228, 0, v161
  v_sub_f32 v229, 0, v161
  v_sub_f32 v230, 0, v161
  v_sub_f32 v231, 0, v161
  v_mov_b32 v164, v162
  s_nop 1
  v_permlane32_swap_b32 v162, v164
  v_max_f32 v162, v162, v164
  v_mov_b32 v164, v162
  s_nop 1
  v_permlane16_swap_b32 v162, v164
  v_max_f32 v162, v162, v164
  v_sub_f32 v232, 0, v162
  v_sub_f32 v233, 0, v162
  v_sub_f32 v234, 0, v162
  v_sub_f32 v235, 0, v162
  v_mov_b32 v164, v163
  s_nop 1
  v_permlane32_swap_b32 v163, v164
  v_max_f32 v163, v163, v164
  v_mov_b32 v164, v163
  s_nop 1
  v_permlane16_swap_b32 v163, v164
  v_max_f32 v163, v163, v164
  v_sub_f32 v236, 0, v163
  v_sub_f32 v237, 0, v163
  v_sub_f32 v238, 0, v163
  v_sub_f32 v239, 0, v163
  v_mov_b32 v240, 0
  v_mov_b32 v241, 0
  v_mov_b32 v242, 0
  v_mov_b32 v243, 0
  v_mov_b32 v244, 0
  v_mov_b32 v245, 0
  v_mov_b32 v246, 0
  v_mov_b32 v247, 0
  s_mov_b32 s83, s94
  s_mov_b32 s84, s94
  s_or_b32 s21, s21, 0x20000000
  s_barrier
  s_add_u32 s83, s83, 0x4000
  s_and_b32 s83, s83, 0x7ffff
  s_add_u32 m0, s85, 0x8000
  s_nop 0
  buffer_load_dwordx4 v26, s[36:39], s83 offen lds
  buffer_load_dwordx4 v26, s[36:39], s83 offen offset:1024 lds
  buffer_load_dwordx4 v26, s[36:39], s83 offen offset:2048 lds
  buffer_load_dwordx4 v26, s[36:39], s83 offen offset:3072 lds
  s_add_u32 s83, s83, 0x4000
  s_and_b32 s83, s83, 0x7ffff
  s_add_u32 m0, s85, 0
  s_nop 0
  buffer_load_dwordx4 v26, s[36:39], s83 offen lds
  buffer_load_dwordx4 v26, s[36:39], s83 offen offset:1024 lds
  buffer_load_dwordx4 v26, s[36:39], s83 offen offset:2048 lds
  buffer_load_dwordx4 v26, s[36:39], s83 offen offset:3072 lds
  s_add_u32 s84, s84, 0x4000
  s_and_b32 s84, s84, 0x7ffff
  s_add_u32 m0, s85, 0xc000
  s_nop 0
  buffer_load_dwordx4 v27, s[40:43], s84 offen lds
  buffer_load_dwordx4 v27, s[40:43], s84 offen offset:1024 lds
  buffer_load_dwordx4 v27, s[40:43], s84 offen offset:2048 lds
  buffer_load_dwordx4 v27, s[40:43], s84 offen offset:3072 lds
  s_waitcnt vmcnt(8)
  s_barrier
  ds_read_b128 a[128:131], v14 offset:32768
  ds_read_b128 a[132:135], v15 offset:32768
  ds_read_b128 a[136:139], v16 offset:32768
  ds_read_b128 a[140:143], v17 offset:32768
  ds_read_b128 a[144:147], v14 offset:33792
  ds_read_b128 a[148:151], v15 offset:33792
  ds_read_b128 a[152:155], v16 offset:33792
  ds_read_b128 a[156:159], v17 offset:33792
  ds_read_b128 a[160:163], v14 offset:34816
  ds_read_b128 a[164:167], v15 offset:34816
  ds_read_b128 a[168:171], v16 offset:34816
  ds_read_b128 a[172:175], v17 offset:34816
  ds_read_b128 a[176:179], v14 offset:35840
  ds_read_b128 a[180:183], v15 offset:35840
  ds_read_b128 a[184:187], v16 offset:35840
  ds_read_b128 a[188:191], v17 offset:35840
  s_waitcnt lgkmcnt(14)
  v_mfma_f32_16x16x32_bf16 v[96:99], a[128:131], v[32:35], v[224:227]
  s_waitcnt lgkmcnt(14)
  v_mfma_f32_16x16x32_bf16 v[96:99], a[132:135], v[36:39], v[96:99]
  s_waitcnt lgkmcnt(13)
  v_mfma_f32_16x16x32_bf16 v[96:99], a[136:139], v[40:43], v[96:99]
  s_waitcnt lgkmcnt(12)
  v_mfma_f32_16x16x32_bf16 v[96:99], a[140:143], v[44:47], v[96:99]
  v_mfma_f32_16x16x32_bf16 v[100:103], a[140:143], v[60:63], v[228:231]
  v_mfma_f32_16x16x32_bf16 v[100:103], a[136:139], v[56:59], v[100:103]
  v_mfma_f32_16x16x32_bf16 v[100:103], a[132:135], v[52:55], v[100:103]
  v_mfma_f32_16x16x32_bf16 v[100:103], a[128:131], v[48:51], v[100:103]
  s_nop 3
  v_exp_f32 v96, v96
  v_mfma_f32_16x16x32_bf16 v[104:107], a[128:131], v[64:67], v[232:235]
  v_exp_f32 v97, v97
  v_mfma_f32_16x16x32_bf16 v[104:107], a[132:135], v[68:71], v[104:107]
  v_exp_f32 v98, v98
  v_mfma_f32_16x16x32_bf16 v[104:107], a[136:139], v[72:75], v[104:107]
  v_exp_f32 v99, v99
  v_mfma_f32_16x16x32_bf16 v[104:107], a[140:143], v[76:79], v[104:107]
  v_exp_f32 v100, v100
  v_mfma_f32_16x16x32_bf16 v[108:111], a[140:143], v[92:95], v[236:239]
  v_exp_f32 v101, v101
  v_mfma_f32_16x16x32_bf16 v[108:111], a[136:139], v[88:91], v[108:111]
  v_exp_f32 v102, v102
  v_mfma_f32_16x16x32_bf16 v[108:111], a[132:135], v[84:87], v[108:111]
  v_exp_f32 v103, v103
  v_mfma_f32_16x16x32_bf16 v[108:111], a[128:131], v[80:83], v[108:111]
  s_waitcnt lgkmcnt(0)
  v_exp_f32 v104, v104
  v_mfma_f32_16x16x32_bf16 v[124:127], a[144:147], v[80:83], v[236:239]
  v_exp_f32 v105, v105
  v_mfma_f32_16x16x32_bf16 v[124:127], a[148:151], v[84:87], v[124:127]
  v_exp_f32 v106, v106
  v_mfma_f32_16x16x32_bf16 v[124:127], a[152:155], v[88:91], v[124:127]
  v_exp_f32 v107, v107
  v_mfma_f32_16x16x32_bf16 v[124:127], a[156:159], v[92:95], v[124:127]
  v_exp_f32 v108, v108
  v_mfma_f32_16x16x32_bf16 v[120:123], a[156:159], v[76:79], v[232:235]
  v_exp_f32 v109, v109
  v_mfma_f32_16x16x32_bf16 v[120:123], a[152:155], v[72:75], v[120:123]
  v_exp_f32 v110, v110
  v_mfma_f32_16x16x32_bf16 v[120:123], a[148:151], v[68:71], v[120:123]
  v_exp_f32 v111, v111
  v_mfma_f32_16x16x32_bf16 v[120:123], a[144:147], v[64:67], v[120:123]
  v_exp_f32 v124, v124
  v_mfma_f32_16x16x32_bf16 v[116:119], a[144:147], v[48:51], v[228:231]
  v_exp_f32 v125, v125
  v_mfma_f32_16x16x32_bf16 v[116:119], a[148:151], v[52:55], v[116:119]
  v_exp_f32 v126, v126
  v_mfma_f32_16x16x32_bf16 v[116:119], a[152:155], v[56:59], v[116:119]
  v_exp_f32 v127, v127
  v_mfma_f32_16x16x32_bf16 v[116:119], a[156:159], v[60:63], v[116:119]
  v_exp_f32 v120, v120
  v_mfma_f32_16x16x32_bf16 v[112:115], a[156:159], v[44:47], v[224:227]
  v_exp_f32 v121, v121
  v_mfma_f32_16x16x32_bf16 v[112:115], a[152:155], v[40:43], v[112:115]
  v_exp_f32 v122, v122
  v_mfma_f32_16x16x32_bf16 v[112:115], a[148:151], v[36:39], v[112:115]
  v_exp_f32 v123, v123
  v_mfma_f32_16x16x32_bf16 v[112:115], a[144:147], v[32:35], v[112:115]
  v_exp_f32 v116, v116
  v_mfma_f32_16x16x32_bf16 v[128:131], a[160:163], v[32:35], v[224:227]
  v_exp_f32 v117, v117
  v_mfma_f32_16x16x32_bf16 v[128:131], a[164:167], v[36:39], v[128:131]
  v_exp_f32 v118, v118
  v_cvt_pk_bf16_f32 v170, v116, v117
  v_mfma_f32_16x16x32_bf16 v[128:131], a[168:171], v[40:43], v[128:131]
  v_exp_f32 v119, v119
  v_mfma_f32_16x16x32_bf16 v[128:131], a[172:175], v[44:47], v[128:131]
  v_exp_f32 v112, v112
  v_cvt_pk_bf16_f32 v171, v118, v119
  v_mfma_f32_16x16x32_bf16 v[132:135], a[172:175], v[60:63], v[228:231]
  v_exp_f32 v113, v113
  v_mfma_f32_16x16x32_bf16 v[132:135], a[168:171], v[56:59], v[132:135]
  s_waitcnt vmcnt(0)
  s_barrier
  v_cvt_pk_bf16_f32 v162, v112, v113
  v_mfma_f32_16x16x32_bf16 v[132:135], a[164:167], v[52:55], v[132:135]
  v_exp_f32 v114, v114
  v_mfma_f32_16x16x32_bf16 v[132:135], a[160:163], v[48:51], v[132:135]
  ds_read_b128 a[128:131], v14
  v_cvt_pk_bf16_f32 v160, v96, v97
  v_mfma_f32_16x16x32_bf16 v[136:139], a[160:163], v[64:67], v[232:235]
  v_exp_f32 v115, v115
  v_mfma_f32_16x16x32_bf16 v[136:139], a[164:167], v[68:71], v[136:139]
  ds_read_b128 a[132:135], v15
  v_cvt_pk_bf16_f32 v161, v98, v99
  v_cvt_pk_bf16_f32 v163, v114, v115
  v_mfma_f32_16x16x32_bf16 v[136:139], a[168:171], v[72:75], v[136:139]
  v_exp_f32 v128, v128
  v_mfma_f32_16x16x32_bf16 v[136:139], a[172:175], v[76:79], v[136:139]
  ds_read_b128 a[136:139], v16
  v_cvt_pk_bf16_f32 v168, v100, v101
  v_mfma_f32_16x16x32_bf16 v[140:143], a[172:175], v[92:95], v[236:239]
  v_exp_f32 v129, v129
  v_mfma_f32_16x16x32_bf16 v[140:143], a[168:171], v[88:91], v[140:143]
  ds_read_b128 a[140:143], v17
  v_cvt_pk_bf16_f32 v169, v102, v103
  v_cvt_pk_bf16_f32 v164, v128, v129
  v_mfma_f32_16x16x32_bf16 v[140:143], a[164:167], v[84:87], v[140:143]
  v_exp_f32 v130, v130
  v_mfma_f32_16x16x32_bf16 v[140:143], a[160:163], v[80:83], v[140:143]
  ds_read_b128 a[144:147], v14 offset:1024
  v_cvt_pk_bf16_f32 v176, v104, v105
  v_mfma_f32_16x16x32_bf16 v[156:159], a[176:179], v[80:83], v[236:239]
  v_exp_f32 v131, v131
  v_mfma_f32_16x16x32_bf16 v[156:159], a[180:183], v[84:87], v[156:159]
  ds_read_b128 a[148:151], v15 offset:1024
  v_cvt_pk_bf16_f32 v177, v106, v107
  v_cvt_pk_bf16_f32 v165, v130, v131
  v_mfma_f32_16x16x32_bf16 v[156:159], a[184:187], v[88:91], v[156:159]
  v_exp_f32 v132, v132
  v_mfma_f32_16x16x32_bf16 v[156:159], a[188:191], v[92:95], v[156:159]
  ds_read_b128 a[152:155], v16 offset:1024
  v_cvt_pk_bf16_f32 v184, v108, v109
  v_mfma_f32_16x16x32_bf16 v[152:155], a[188:191], v[76:79], v[232:235]
  s_add_u32 s83, s83, 0x4000
  v_exp_f32 v133, v133
  v_mfma_f32_16x16x32_bf16 v[152:155], a[184:187], v[72:75], v[152:155]
  s_and_b32 s83, s83, 0x7ffff
  ds_read_b128 a[156:159], v17 offset:1024
  v_cvt_pk_bf16_f32 v185, v110, v111
  v_cvt_pk_bf16_f32 v172, v132, v133
  v_mfma_f32_16x16x32_bf16 v[152:155], a[180:183], v[68:71], v[152:155]
  s_add_u32 m0, s85, 0x8000
  v_exp_f32 v134, v134
  v_mfma_f32_16x16x32_bf16 v[152:155], a[176:179], v[64:67], v[152:155]
  buffer_load_dwordx4 v26, s[36:39], s83 offen lds
  v_mfma_f32_16x16x32_bf16 v[148:151], a[176:179], v[48:51], v[228:231]
  v_exp_f32 v135, v135
  v_mfma_f32_16x16x32_bf16 v[148:151], a[180:183], v[52:55], v[148:151]
  ds_read_b128 a[160:163], v14 offset:2048
  v_cvt_pk_bf16_f32 v186, v124, v125
  v_cvt_pk_bf16_f32 v173, v134, v135
  v_mfma_f32_16x16x32_bf16 v[148:151], a[184:187], v[56:59], v[148:151]
  v_exp_f32 v136, v136
  v_mfma_f32_16x16x32_bf16 v[148:151], a[188:191], v[60:63], v[148:151]
  ds_read_b128 a[164:167], v15 offset:2048
  v_cvt_pk_bf16_f32 v187, v126, v127
  v_mfma_f32_16x16x32_bf16 v[144:147], a[188:191], v[44:47], v[224:227]
  v_exp_f32 v137, v137
  v_mfma_f32_16x16x32_bf16 v[144:147], a[184:187], v[40:43], v[144:147]
  buffer_load_dwordx4 v26, s[36:39], s83 offen offset:1024 lds
  v_cvt_pk_bf16_f32 v180, v136, v137
  v_mfma_f32_16x16x32_bf16 v[144:147], a[180:183], v[36:39], v[144:147]
  v_exp_f32 v138, v138
  v_exp_f32 v139, v139
  v_exp_f32 v140, v140
  v_exp_f32 v141, v141
  v_mfma_f32_16x16x32_bf16 v[144:147], a[176:179], v[32:35], v[144:147]
  v_cvt_pk_bf16_f32 v178, v120, v121
  v_cvt_pk_bf16_f32 v179, v122, v123
  v_cvt_pk_bf16_f32 v181, v138, v139
  s_branch L_it0
L_codeend:
.section .rodata,"a"
.p2align 6
.amdhsa_kernel recurrent_scan__gqa_block_cached__dense_activation_gelu__prompt_kernel
  .amdhsa_next_free_vgpr 512
  .amdhsa_next_free_sgpr 102
  .amdhsa_accum_offset 256
  .amdhsa_group_segment_fixed_size 0
  .amdhsa_kernarg_size 104
  .amdhsa_user_sgpr_count 2
  .amdhsa_user_sgpr_kernarg_segment_ptr 1
  .amdhsa_system_sgpr_workgroup_id_x 1
.end_amdhsa_kernel
```
